```python
import torch

def _softmax(x, axis=-1):
    return torch.softmax(x, dim=axis)
def _gelu(x):
    return torch.nn.functional.gelu(x, approximate="tanh")
def _silu(x):
    return torch.nn.functional.silu(x)
def _sigmoid(x):
    return torch.sigmoid(x)
def _layernorm(x, axis=-1, eps=1e-5):
    m = x.mean(dim=axis, keepdim=True)
    v = x.var(dim=axis, keepdim=True, unbiased=False)
    return (x - m) / torch.sqrt(v + eps)
def _scatter_add(tgt, idx, src, axis=0):
    return tgt.clone().index_add_(axis, idx, src)
def _segment_sum(src, seg, n):
    out = torch.zeros((n,) + src.shape[1:], dtype=src.dtype)
    return out.index_add_(0, seg, src)
def _pad(x, pw):
    flat = tuple(v for pair in reversed(pw) for v in pair)
    return torch.nn.functional.pad(x, flat)

kernel_name = 'concat_heads__spectral_gfnet__compressed_kv_cla__prompt'

def setup_inputs():

    _w = (lambda a: (lambda t: t.to(torch.bfloat16) if t.is_floating_point() else t)(torch.as_tensor(a)))
    def _A_setup():
        B, S, D = 1, 2048, 448
        Df = D // 2 + 1
        return {
            "x": _w((lambda *s: torch.randn(*s, dtype=torch.bfloat16) * 0.05)(B, S, D)),
            "w_r": _w((lambda *s: torch.randn(*s, dtype=torch.bfloat16) * 0.05)(S, Df) * 0.02),
            "w_i": _w((lambda *s: torch.randn(*s, dtype=torch.bfloat16) * 0.05)(S, Df) * 0.02),
        }
    _A_in = _A_setup()

    def _B_setup():
        B, H, Sq, Sk, D, M = 1, 16, 2048, 2048, 256, 448
        Dc = 4 * D
        return {
            "x": _w((lambda *s: torch.randn(*s, dtype=torch.bfloat16) * 3.2)(B, Sq, M)),
            "c_kv": _w((lambda *s: torch.randn(*s, dtype=torch.bfloat16) * 0.05)(B, Sk, Dc)),
            "w_q": _w((lambda *s: torch.randn(*s, dtype=torch.bfloat16) * 3.2)(M, H, D) * (M ** -0.5)),
            "w_uk": _w((lambda *s: torch.randn(*s, dtype=torch.bfloat16) * 3.2)(Dc, H, D) * (Dc ** -0.5)),
            "w_uv": _w((lambda *s: torch.randn(*s, dtype=torch.bfloat16) * 0.05)(Dc, H, D) * (Dc ** -0.5)),
            "w_o": _w((lambda *s: torch.randn(*s, dtype=torch.bfloat16) * 0.05)(H, D, M) * ((H * D) ** -0.5)),
        }
    _B_in = _B_setup()

    return {
        "A_x": _A_in["x"],
        "A_w_r": _A_in["w_r"],
        "A_w_i": _A_in["w_i"],
        "B_x": _B_in["x"],
        "B_c_kv": _B_in["c_kv"],
        "B_w_q": _B_in["w_q"],
        "B_w_uk": _B_in["w_uk"],
        "B_w_uv": _B_in["w_uv"],
        "B_w_o": _B_in["w_o"],
    }

def reference(A_x, A_w_r, A_w_i, B_x, B_c_kv, B_w_q, B_w_uk, B_w_uv, B_w_o):
    def _A_ref(x, w_r, w_i):
        B, S, D = x.shape
        X = (lambda x, axes=(-2,-1): torch.fft.rfft2(x.float(), dim=axes))(x, axes=(-2, -1))
        W = w_r + 1j * w_i
        X = X * W
        y = (lambda x, s, axes=(-2,-1): torch.fft.irfft2(x, s=s, dim=axes).to(torch.bfloat16))(X, (S, D), axes=(-2, -1))
        return y

    def _B_ref(x, c_kv, w_q, w_uk, w_uv, w_o):
        B, Sq, M = x.shape[0], x.shape[1], x.shape[2]
        Sk = c_kv.shape[1]
        H, D = w_q.shape[1], w_q.shape[2]
        q = torch.einsum("bqm,mhd->bhqd", x, w_q)
        k = torch.einsum("bkc,chd->bhkd", c_kv, w_uk)
        v = torch.einsum("bkc,chd->bhkd", c_kv, w_uv)
        scores = torch.einsum("bhqd,bhkd->bhqk", q, k) * (D ** -0.5)
        off = Sk - Sq
        qi = torch.arange(Sq)[:, None]
        kj = torch.arange(Sk)[None, :]
        cmask = kj <= (qi + off)
        scores = torch.where(cmask[None, None], scores, -1e9)
        p = _softmax(scores, axis=-1)
        ctx = torch.einsum("bhqk,bhkd->bhqd", p, v)
        return torch.einsum("bhqd,hdm->bqm", ctx, w_o)

    a = _A_ref(A_x, A_w_r, A_w_i)
    b = _B_ref(B_x, B_c_kv, B_w_q, B_w_uk, B_w_uv, B_w_o)
    return torch.concatenate([a, b], axis=-1)
```

```asm
; @launch grid=(256,1,1) block=(256,1,1) lds=163840
.amdgcn_target "amdgcn-amd-amdhsa--gfx950"
.text
.globl concat_heads__spectral_gfnet__compressed_kv_cla__prompt_kernel
.p2align 8
.type concat_heads__spectral_gfnet__compressed_kv_cla__prompt_kernel,@function
concat_heads__spectral_gfnet__compressed_kv_cla__prompt_kernel:
  s_cmp_ge_u32 s2, 256
  s_cbranch_scc1 K2_END
  s_load_dwordx16 s[36:51], s[0:1], 24
  s_load_dwordx2 s[52:53], s[0:1], 88
  s_load_dwordx4 s[96:99], s[0:1], 0
  s_load_dwordx2 s[100:101], s[0:1], 16
  s_getpc_b64 s[20:21]
L_pc_1:
  s_and_b32 s21, s21, 0xffff
  s_mov_b32 s22, K1_Q-L_pc_1
  s_mov_b32 s23, 0x20000
  v_lshlrev_b32 v1, 7, v0
  buffer_load_dword v23, v1, s[20:23], 0 offen
  v_lshrrev_b32 v1, 6, v0
  s_nop 0
  v_readfirstlane_b32 s24, v1
  s_and_b32 s54, s2, 7
  s_lshr_b32 s55, s2, 3
  s_lshr_b32 s3, s55, 4
  s_lshl_b32 s54, s54, 1
  s_add_u32 s54, s54, s3
  s_lshr_b32 s56, s55, 3
  s_and_b32 s56, s56, 1
  s_and_b32 s57, s55, 7
  s_lshl_b32 s25, s24, 12
  s_add_u32 s25, s25, 98304
  s_lshl_b32 s33, s24, 13
  s_add_u32 s34, s33, 4096
  s_mov_b32 s32, 65536
  s_lshl_b32 s6, s57, 19
  s_lshl_b32 s27, s54, 9
  s_and_b32 s3, s2, 7
  s_lshl_b32 s26, s3, 8
  s_lshl_b32 s3, s3, 20
  s_add_u32 s27, s27, s3
  s_add_u32 s28, s6, s26
  s_mov_b32 s29, 0
  v_and_b32 v1, 63, v0
  v_lshrrev_b32 v2, 3, v1
  s_lshl_b32 s3, s24, 6
  v_add_u32 v2, s3, v2
  v_mul_u32_u24 v2, 2048, v2
  v_lshrrev_b32 v3, 4, v1
  v_and_b32 v1, 7, v1
  v_xor_b32 v1, v1, v3
  v_lshlrev_b32 v1, 4, v1
  v_add_u32 v4, v2, v1
  v_xor_b32 v3, 64, v1
  v_add_u32 v5, v2, v3
  v_add_u32 v5, 15360, v5
  v_add_u32 v6, v2, v1
  v_add_u32 v6, 30720, v6
  v_xor_b32 v3, 64, v1
  v_add_u32 v7, v2, v3
  v_add_u32 v7, 46080, v7
  v_and_b32 v1, 63, v0
  v_lshrrev_b32 v2, 3, v1
  v_lshlrev_b32 v2, 13, v2
  s_lshl_b32 s3, s24, 7
  v_add_u32 v2, s3, v2
  v_lshrrev_b32 v3, 3, v1
  v_and_b32 v3, 2, v3
  v_and_b32 v1, 7, v1
  v_xor_b32 v1, v1, v3
  v_lshlrev_b32 v1, 4, v1
  v_add_u32 v8, v2, v1
  v_xor_b32 v3, 64, v1
  v_add_u32 v9, v2, v3
  v_add_u32 v9, 64512, v9
  v_add_u32 v10, v2, v1
  v_add_u32 v10, 129024, v10
  v_xor_b32 v3, 64, v1
  v_add_u32 v11, v2, v3
  v_add_u32 v11, 193536, v11
  s_waitcnt lgkmcnt(0)
  s_mov_b32 s8, s38
  s_and_b32 s9, s39, 0xffff
  s_mov_b32 s10, 0x400000
  s_mov_b32 s11, 0x20000
  s_cmp_eq_u32 s56, 0
  s_cselect_b32 s4, s42, s44
  s_cselect_b32 s5, s43, s45
  s_mov_b32 s12, s4
  s_and_b32 s13, s5, 0xffff
  s_mov_b32 s14, 0x800000
  s_mov_b32 s15, 0x20000
  s_mov_b32 s16, s52
  s_and_b32 s17, s53, 0xffff
  s_mov_b32 s18, 0x3000000
  s_mov_b32 s19, 0x20000
  s_add_u32 m0, s29, s33
  s_nop 0
  buffer_load_dwordx4 v4, s[8:11], s28 offen offset:0  lds
  buffer_load_dwordx4 v5, s[8:11], s28 offen offset:1024  lds
  buffer_load_dwordx4 v6, s[8:11], s28 offen offset:2048  lds
  buffer_load_dwordx4 v7, s[8:11], s28 offen offset:3072  lds
  s_add_u32 m0, s25, 0
  s_nop 0
  buffer_load_dwordx4 v8, s[12:15], s27 offen offset:0 nt lds
  buffer_load_dwordx4 v9, s[12:15], s27 offen offset:1024 nt lds
  buffer_load_dwordx4 v10, s[12:15], s27 offen offset:2048 nt lds
  buffer_load_dwordx4 v11, s[12:15], s27 offen offset:3072 nt lds
  s_add_u32 s27, s27, 0x40000
  s_and_b32 s27, s27, 0x7fffff
  s_add_u32 s20, s52, 0x6000000
  s_addc_u32 s21, s53, 0
  s_and_b32 s21, s21, 0xffff
  s_mov_b32 s22, 0x8000
  s_mov_b32 s23, 0x20000
  s_lshl_b32 s3, s54, 3
  s_bfe_u32 s4, s55, 0x30001
  s_add_u32 s3, s3, s4
  s_lshl_b32 s3, s3, 2
  s_add_u32 s3, s3, s24
  s_lshl_b32 s3, s3, 6
  s_bitcmp1_b32 s55, 0
  s_cselect_b32 s3, s3, 0x7fff0000
  v_mov_b32 v1, 0
  v_mov_b32 v2, 0
  buffer_store_dword v1, v2, s[20:23], s3 offen sc1
  s_mov_b32 s86, s50
  s_mov_b32 s87, s51
  s_and_b32 s5, s55, 7
  s_and_b32 s3, s2, 7
  s_lshl_b32 s3, s3, 2
  s_lshr_b32 s4, s55, 3
  s_add_u32 s4, s4, s3
  s_add_u32 s5, s5, 16
  s_lshl_b32 s5, s5, 5
  s_add_u32 s4, s4, s5
  s_lshl_b32 s84, s4, 18
  s_lshl_b32 s3, s54, 5
  s_and_b32 s4, s55, 15
  s_add_u32 s3, s3, s4
  s_lshl_b32 s3, s3, 2
  s_add_u32 s84, s84, s3
  s_bfe_u32 s3, s55, 0x30001
  s_sub_u32 s4, 15, s3
  s_bitcmp1_b32 s55, 0
  s_cselect_b32 s3, s4, s3
  s_lshl_b32 s3, s3, 5
  s_add_u32 s3, s3, s54
  s_lshl_b32 s3, s3, 2
  s_add_u32 s82, s3, 4096
  s_mov_b32 s90, s48
  s_mov_b32 s91, s49
  s_add_u32 s20, s52, 0x6008000
  s_addc_u32 s21, s53, 0
  s_and_b32 s21, s21, 0xffff
  s_mov_b32 s22, 0x2000
  s_mov_b32 s23, 0x20000
  s_lshr_b32 s3, s84, 16
  v_mov_b32 v2, s3
  s_and_b32 s3, s84, 0xffff
  v_writelane_b32 v2, s3, 0
  s_lshl_b32 s3, s2, 2
  s_add_u32 s3, s3, 3072
  v_writelane_b32 v2, s3, 2
  v_writelane_b32 v2, s82, 3
  s_add_u32 s3, s82, 2048
  v_writelane_b32 v2, s3, 4
  v_mov_b32 v3, 0x7fff0000
  v_cmp_gt_u32 vcc, 5, v0
  s_nop 1
  v_cndmask_b32 v2, v3, v2, vcc
  buffer_store_dword v1, v2, s[20:23], 0 offen sc1
  s_mov_b32 s92, s86
  s_and_b32 s93, s87, 0xffff
  s_mov_b32 s94, 0x100
  s_mov_b32 s95, 0x20000
  s_lshl_b32 s3, s54, 4
  s_and_b32 s4, s55, 15
  s_add_u32 s3, s3, s4
  v_lshlrev_b32 v166, 8, v0
  v_add_u32 v166, s3, v166
  v_mov_b32 v165, 16
  s_mul_i32 s85, s2, 6
  s_lshr_b32 s85, s85, 8
  s_mov_b32 s49, 0x7fff0000
  v_mov_b64 v[32:33], 0
  v_mov_b64 v[34:35], 0
  s_nop 1
  s_add_u32 m0, s29, s34
  s_add_u32 s35, s28, s32
  buffer_load_dwordx4 v4, s[8:11], s35 offen offset:0  lds
  buffer_load_dwordx4 v5, s[8:11], s35 offen offset:1024  lds
  buffer_load_dwordx4 v6, s[8:11], s35 offen offset:2048  lds
  buffer_load_dwordx4 v7, s[8:11], s35 offen offset:3072  lds
  s_add_u32 s26, s26, 128
  s_and_b32 s26, s26, 0x7ff
  s_add_u32 s28, s6, s26
  s_add_u32 s29, s29, 0x8000
  s_cmp_eq_u32 s29, 0x18000
  s_cselect_b32 s29, 0, s29
  s_add_u32 m0, s25, 16384
  s_nop 0
  buffer_load_dwordx4 v8, s[12:15], s27 offen offset:0 nt lds
  buffer_load_dwordx4 v9, s[12:15], s27 offen offset:1024 nt lds
  buffer_load_dwordx4 v10, s[12:15], s27 offen offset:2048 nt lds
  buffer_load_dwordx4 v11, s[12:15], s27 offen offset:3072 nt lds
  s_add_u32 s27, s27, 0x40000
  s_and_b32 s27, s27, 0x7fffff
  v_mfma_f32_32x32x16_bf16 a[0:15], v[32:35], v[32:35], 0
  v_mfma_f32_32x32x16_bf16 a[16:31], v[32:35], v[32:35], 0
  v_mfma_f32_32x32x16_bf16 a[32:47], v[32:35], v[32:35], 0
  v_mfma_f32_32x32x16_bf16 a[48:63], v[32:35], v[32:35], 0
  v_mfma_f32_32x32x16_bf16 a[64:79], v[32:35], v[32:35], 0
  v_mfma_f32_32x32x16_bf16 a[80:95], v[32:35], v[32:35], 0
  v_mfma_f32_32x32x16_bf16 a[96:111], v[32:35], v[32:35], 0
  v_mfma_f32_32x32x16_bf16 a[112:127], v[32:35], v[32:35], 0
  v_mfma_f32_32x32x16_bf16 a[128:143], v[32:35], v[32:35], 0
  v_mfma_f32_32x32x16_bf16 a[144:159], v[32:35], v[32:35], 0
  v_mfma_f32_32x32x16_bf16 a[160:175], v[32:35], v[32:35], 0
  v_mfma_f32_32x32x16_bf16 a[176:191], v[32:35], v[32:35], 0
  v_mfma_f32_32x32x16_bf16 a[192:207], v[32:35], v[32:35], 0
  v_mfma_f32_32x32x16_bf16 a[208:223], v[32:35], v[32:35], 0
  v_mfma_f32_32x32x16_bf16 a[224:239], v[32:35], v[32:35], 0
  v_mfma_f32_32x32x16_bf16 a[240:255], v[32:35], v[32:35], 0
  s_add_u32 m0, s29, s33
  s_nop 0
  buffer_load_dwordx4 v4, s[8:11], s28 offen offset:0  lds
  buffer_load_dwordx4 v5, s[8:11], s28 offen offset:1024  lds
  buffer_load_dwordx4 v6, s[8:11], s28 offen offset:2048  lds
  buffer_load_dwordx4 v7, s[8:11], s28 offen offset:3072  lds
  v_mov_b32 v160, 0
  v_mov_b32 v161, 0
  v_mov_b32 v162, 0
  v_and_b32 v1, 3, v0
  s_lshl_b32 s3, s24, 2
  v_add_u32 v1, s3, v1
  v_min_u32 v1, 13, v1
  v_mov_b32 v163, 0
  s_mul_i32 s3, s2, 7168
  s_add_u32 s4, s36, s3
  s_addc_u32 s5, s37, 0
  v_subrev_u32 v2, 0, v1
  v_mul_u32_u24 v2, 28, v2
  v_min_u32 v2, 28, v2
  v_mul_u32_u24 v2, 128, v2
  v_mov_b32 v25, s5
  v_add_co_u32 v24, vcc, s4, v2
  v_mov_b32 v26, 512
  s_nop 0
  v_addc_co_u32 v25, vcc, 0, v25, vcc
  v_cmp_le_u32 vcc, 0, v1
  s_nop 1
  v_cndmask_b32 v160, v160, v24, vcc
  v_cndmask_b32 v161, v161, v25, vcc
  v_cndmask_b32 v162, v162, v26, vcc
  s_mul_i32 s3, s2, 7168
  s_add_u32 s4, s96, s3
  s_addc_u32 s5, s97, 0
  v_subrev_u32 v2, 2, v1
  v_mul_u32_u24 v2, 28, v2
  v_min_u32 v2, 28, v2
  v_mul_u32_u24 v2, 128, v2
  v_mov_b32 v25, s5
  v_add_co_u32 v24, vcc, s4, v2
  v_mov_b32 v26, 512
  s_nop 0
  v_addc_co_u32 v25, vcc, 0, v25, vcc
  v_cmp_le_u32 vcc, 2, v1
  s_nop 1
  v_cndmask_b32 v160, v160, v24, vcc
  v_cndmask_b32 v161, v161, v25, vcc
  v_cndmask_b32 v162, v162, v26, vcc
  s_mul_i32 s3, s2, 14336
  s_add_u32 s4, s40, s3
  s_addc_u32 s5, s41, 0
  v_subrev_u32 v2, 4, v1
  v_mul_u32_u24 v2, 28, v2
  v_min_u32 v2, 84, v2
  v_mul_u32_u24 v2, 128, v2
  v_mov_b32 v25, s5
  v_add_co_u32 v24, vcc, s4, v2
  v_mov_b32 v26, 512
  s_nop 0
  v_addc_co_u32 v25, vcc, 0, v25, vcc
  v_cmp_le_u32 vcc, 4, v1
  s_nop 1
  v_cndmask_b32 v160, v160, v24, vcc
  v_cndmask_b32 v161, v161, v25, vcc
  v_cndmask_b32 v162, v162, v26, vcc
  s_mul_i32 s3, s2, 14336
  s_add_u32 s4, s46, s3
  s_addc_u32 s5, s47, 0
  v_subrev_u32 v2, 8, v1
  v_mul_u32_u24 v2, 28, v2
  v_min_u32 v2, 84, v2
  v_mul_u32_u24 v2, 128, v2
  v_mov_b32 v25, s5
  v_add_co_u32 v24, vcc, s4, v2
  v_mov_b32 v26, 512
  s_nop 0
  v_addc_co_u32 v25, vcc, 0, v25, vcc
  v_cmp_le_u32 vcc, 8, v1
  s_nop 1
  v_cndmask_b32 v160, v160, v24, vcc
  v_cndmask_b32 v161, v161, v25, vcc
  v_cndmask_b32 v162, v162, v26, vcc
  s_mul_i32 s3, s2, 3600
  s_add_u32 s4, s98, s3
  s_addc_u32 s5, s99, 0
  v_subrev_u32 v2, 12, v1
  v_mul_u32_u24 v2, 1, v2
  v_min_u32 v2, 0, v2
  v_mul_u32_u24 v2, 128, v2
  v_mov_b32 v25, s5
  v_add_co_u32 v24, vcc, s4, v2
  v_mov_b32 v26, 512
  s_nop 0
  v_addc_co_u32 v25, vcc, 0, v25, vcc
  v_cmp_le_u32 vcc, 12, v1
  s_nop 1
  v_cndmask_b32 v160, v160, v24, vcc
  v_cndmask_b32 v161, v161, v25, vcc
  v_cndmask_b32 v162, v162, v26, vcc
  s_mul_i32 s3, s2, 3600
  s_add_u32 s4, s100, s3
  s_addc_u32 s5, s101, 0
  v_subrev_u32 v2, 13, v1
  v_mul_u32_u24 v2, 1, v2
  v_min_u32 v2, 0, v2
  v_mul_u32_u24 v2, 128, v2
  v_mov_b32 v25, s5
  v_add_co_u32 v24, vcc, s4, v2
  v_mov_b32 v26, 512
  s_nop 0
  v_addc_co_u32 v25, vcc, 0, v25, vcc
  v_cmp_le_u32 vcc, 13, v1
  s_nop 1
  v_cndmask_b32 v160, v160, v24, vcc
  v_cndmask_b32 v161, v161, v25, vcc
  v_cndmask_b32 v162, v162, v26, vcc
  v_mov_b32 v164, v162
  s_add_u32 m0, s29, s34
  s_add_u32 s35, s28, s32
  buffer_load_dwordx4 v4, s[8:11], s35 offen offset:0  lds
  buffer_load_dwordx4 v5, s[8:11], s35 offen offset:1024  lds
  buffer_load_dwordx4 v6, s[8:11], s35 offen offset:2048  lds
  buffer_load_dwordx4 v7, s[8:11], s35 offen offset:3072  lds
  s_add_u32 s26, s26, 128
  s_and_b32 s26, s26, 0x7ff
  s_add_u32 s28, s6, s26
  s_add_u32 s29, s29, 0x8000
  s_cmp_eq_u32 s29, 0x18000
  s_cselect_b32 s29, 0, s29
  global_load_dword v23, v[160:161], off offset:0
  s_add_u32 m0, s25, 32768
  s_nop 0
  buffer_load_dwordx4 v8, s[12:15], s27 offen offset:0 nt lds
  buffer_load_dwordx4 v9, s[12:15], s27 offen offset:1024 nt lds
  buffer_load_dwordx4 v10, s[12:15], s27 offen offset:2048 nt lds
  buffer_load_dwordx4 v11, s[12:15], s27 offen offset:3072 nt lds
  s_add_u32 s27, s27, 0x40000
  s_and_b32 s27, s27, 0x7fffff
  s_add_u32 m0, s25, 49152
  s_nop 0
  buffer_load_dwordx4 v8, s[12:15], s27 offen offset:0 nt lds
  buffer_load_dwordx4 v9, s[12:15], s27 offen offset:1024 nt lds
  buffer_load_dwordx4 v10, s[12:15], s27 offen offset:2048 nt lds
  buffer_load_dwordx4 v11, s[12:15], s27 offen offset:3072 nt lds
  s_add_u32 s27, s27, 0x40000
  s_and_b32 s27, s27, 0x7fffff
  global_load_dword v23, v[160:161], off offset:0
  s_add_u32 m0, s29, s33
  s_nop 0
  buffer_load_dwordx4 v4, s[8:11], s28 offen offset:0  lds
  buffer_load_dwordx4 v5, s[8:11], s28 offen offset:1024  lds
  buffer_load_dwordx4 v6, s[8:11], s28 offen offset:2048  lds
  buffer_load_dwordx4 v7, s[8:11], s28 offen offset:3072  lds
  s_add_u32 m0, s29, s34
  s_add_u32 s35, s28, s32
  buffer_load_dwordx4 v4, s[8:11], s35 offen offset:0  lds
  buffer_load_dwordx4 v5, s[8:11], s35 offen offset:1024  lds
  buffer_load_dwordx4 v6, s[8:11], s35 offen offset:2048  lds
  buffer_load_dwordx4 v7, s[8:11], s35 offen offset:3072  lds
  s_add_u32 s26, s26, 128
  s_and_b32 s26, s26, 0x7ff
  s_add_u32 s28, s6, s26
  s_add_u32 s29, s29, 0x8000
  s_cmp_eq_u32 s29, 0x18000
  s_cselect_b32 s29, 0, s29
  v_and_b32 v1, 15, v0
  v_bfe_u32 v2, v0, 4, 2
  v_lshrrev_b32 v3, 1, v1
  v_xor_b32 v3, v3, v2
  v_lshlrev_b32 v3, 4, v3
  v_lshl_add_u32 v12, v1, 7, v3
  s_lshr_b32 s3, s24, 1
  s_lshl_b32 s58, s3, 14
  v_add_u32 v12, s58, v12
  v_xor_b32 v13, 64, v12
  v_bfe_u32 v3, v0, 2, 2
  v_lshl_add_u32 v24, v2, 3, v3
  v_lshlrev_b32 v24, 7, v24
  v_and_b32 v25, 3, v0
  v_lshl_add_u32 v24, v25, 3, v24
  v_lshrrev_b32 v3, 1, v3
  v_and_b32 v2, 1, v2
  v_lshl_add_u32 v3, v2, 1, v3
  s_and_b32 s3, s24, 1
  s_lshl_b32 s59, s3, 13
  s_add_u32 s3, s59, 98304
  v_add_u32 v24, s3, v24
  v_xor_b32 v2, 0, v3
  v_lshl_add_u32 v16, v2, 5, v24
  v_xor_b32 v2, 1, v3
  v_lshl_add_u32 v17, v2, 5, v24
  v_xor_b32 v2, 2, v3
  v_lshl_add_u32 v18, v2, 5, v24
  v_xor_b32 v2, 3, v3
  v_lshl_add_u32 v19, v2, 5, v24
  v_and_b32 v2, 63, v0
  v_lshlrev_b32 v20, 4, v2
  s_mov_b32 s30, 0
  v_mov_b32 v14, v12
  v_mov_b32 v15, v13
  s_waitcnt vmcnt(26)
  s_barrier
  s_mov_b32 s31, 0
  s_and_b32 s7, s41, 0xffff
  s_lshl_b32 s51, s54, 9
  s_mov_b32 s50, 6
  s_cmp_eq_u32 s56, 0
  s_cbranch_scc0 K1_V
K1_K:
  ds_read_b128 v[32:35], v14 offset:0
  ds_read_b128 v[64:67], v15 offset:0
  ds_read_b64_tr_b16 v[168:169], v16 offset:0
  ds_read_b64_tr_b16 v[170:171], v16 offset:512
  ds_read_b64_tr_b16 v[172:173], v16 offset:16384
  ds_read_b64_tr_b16 v[174:175], v16 offset:16896
  ds_read_b128 v[36:39], v14 offset:2048
  ds_read_b128 v[68:71], v15 offset:2048
  ds_read_b64_tr_b16 v[176:177], v17 offset:0
  ds_read_b64_tr_b16 v[178:179], v17 offset:512
  ds_read_b64_tr_b16 v[180:181], v17 offset:16384
  ds_read_b64_tr_b16 v[182:183], v17 offset:16896
  ds_read_b128 v[40:43], v14 offset:4096
  ds_read_b128 v[72:75], v15 offset:4096
  ds_read_b64_tr_b16 v[184:185], v18 offset:0
  ds_read_b64_tr_b16 v[186:187], v18 offset:512
  ds_read_b64_tr_b16 v[188:189], v18 offset:16384
  ds_read_b64_tr_b16 v[190:191], v18 offset:16896
  ds_read_b128 v[44:47], v14 offset:6144
  ds_read_b128 v[76:79], v15 offset:6144
  ds_read_b64_tr_b16 v[192:193], v19 offset:0
  ds_read_b64_tr_b16 v[194:195], v19 offset:512
  ds_read_b64_tr_b16 v[196:197], v19 offset:16384
  ds_read_b64_tr_b16 v[198:199], v19 offset:16896
  ds_read_b128 v[48:51], v14 offset:8192
  ds_read_b128 v[80:83], v15 offset:8192
  ds_read_b64_tr_b16 v[200:201], v16 offset:4096
  ds_read_b64_tr_b16 v[202:203], v16 offset:4608
  ds_read_b64_tr_b16 v[204:205], v16 offset:20480
  ds_read_b64_tr_b16 v[206:207], v16 offset:20992
  ds_read_b128 v[52:55], v14 offset:10240
  ds_read_b128 v[84:87], v15 offset:10240
  ds_read_b64_tr_b16 v[208:209], v17 offset:4096
  ds_read_b64_tr_b16 v[210:211], v17 offset:4608
  ds_read_b64_tr_b16 v[212:213], v17 offset:20480
  ds_read_b64_tr_b16 v[214:215], v17 offset:20992
  ds_read_b128 v[56:59], v14 offset:12288
  ds_read_b128 v[88:91], v15 offset:12288
  ds_read_b64_tr_b16 v[216:217], v18 offset:4096
  ds_read_b64_tr_b16 v[218:219], v18 offset:4608
  ds_read_b64_tr_b16 v[220:221], v18 offset:20480
  ds_read_b64_tr_b16 v[222:223], v18 offset:20992
  ds_read_b128 v[60:63], v14 offset:14336
  ds_read_b128 v[92:95], v15 offset:14336
  ds_read_b64_tr_b16 v[224:225], v19 offset:4096
  ds_read_b64_tr_b16 v[226:227], v19 offset:4608
  ds_read_b64_tr_b16 v[228:229], v19 offset:20480
  ds_read_b64_tr_b16 v[230:231], v19 offset:20992
.p2align 6
K1_K_loop:
  s_waitcnt vmcnt(18) lgkmcnt(0)
  s_barrier
  v_mfma_f32_16x16x32_bf16 a[0:3], v[168:171], v[32:35], a[0:3]
  s_add_u32 s30, s30, 0x8000
  v_mfma_f32_16x16x32_bf16 a[0:3], v[172:175], v[64:67], a[0:3]
  s_cmp_eq_u32 s30, 0x18000
  global_load_dword v23, v[160:161], off offset:0
  v_mfma_f32_16x16x32_bf16 a[4:7], v[168:171], v[36:39], a[4:7]
  s_cselect_b32 s30, 0, s30
  v_mfma_f32_16x16x32_bf16 a[4:7], v[172:175], v[68:71], a[4:7]
  v_add_u32 v14, s30, v12
  v_add_u32 v15, s30, v13
  v_mfma_f32_16x16x32_bf16 a[8:11], v[168:171], v[40:43], a[8:11]
  ds_read_b128 v[96:99], v14 offset:0
  v_mfma_f32_16x16x32_bf16 a[8:11], v[172:175], v[72:75], a[8:11]
  s_add_u32 m0, s25, 0
  v_mfma_f32_16x16x32_bf16 a[12:15], v[168:171], v[44:47], a[12:15]
  v_mfma_f32_16x16x32_bf16 a[12:15], v[172:175], v[76:79], a[12:15]
  buffer_load_dwordx4 v8, s[12:15], s27 offen offset:0 nt lds
  v_mfma_f32_16x16x32_bf16 a[16:19], v[168:171], v[48:51], a[16:19]
  ds_read_b128 v[128:131], v15 offset:0
  v_mfma_f32_16x16x32_bf16 a[16:19], v[172:175], v[80:83], a[16:19]
  v_mfma_f32_16x16x32_bf16 a[20:23], v[168:171], v[52:55], a[20:23]
  ds_read_b128 v[100:103], v14 offset:2048
  v_mfma_f32_16x16x32_bf16 a[20:23], v[172:175], v[84:87], a[20:23]
  v_mfma_f32_16x16x32_bf16 a[24:27], v[168:171], v[56:59], a[24:27]
  v_mfma_f32_16x16x32_bf16 a[24:27], v[172:175], v[88:91], a[24:27]
  buffer_load_dwordx4 v9, s[12:15], s27 offen offset:1024 nt lds
  v_mfma_f32_16x16x32_bf16 a[28:31], v[168:171], v[60:63], a[28:31]
  ds_read_b128 v[132:135], v15 offset:2048
  v_mfma_f32_16x16x32_bf16 a[28:31], v[172:175], v[92:95], a[28:31]
  v_mfma_f32_16x16x32_bf16 a[60:63], v[176:179], v[60:63], a[60:63]
  ds_read_b128 v[104:107], v14 offset:4096
  v_mfma_f32_16x16x32_bf16 a[60:63], v[180:183], v[92:95], a[60:63]
  v_mfma_f32_16x16x32_bf16 a[56:59], v[176:179], v[56:59], a[56:59]
  v_mfma_f32_16x16x32_bf16 a[56:59], v[180:183], v[88:91], a[56:59]
  buffer_load_dwordx4 v10, s[12:15], s27 offen offset:2048 nt lds
  v_mfma_f32_16x16x32_bf16 a[52:55], v[176:179], v[52:55], a[52:55]
  ds_read_b128 v[136:139], v15 offset:4096
  v_mfma_f32_16x16x32_bf16 a[52:55], v[180:183], v[84:87], a[52:55]
  v_mfma_f32_16x16x32_bf16 a[48:51], v[176:179], v[48:51], a[48:51]
  ds_read_b128 v[108:111], v14 offset:6144
  v_mfma_f32_16x16x32_bf16 a[48:51], v[180:183], v[80:83], a[48:51]
  v_mfma_f32_16x16x32_bf16 a[44:47], v[176:179], v[44:47], a[44:47]
  v_mfma_f32_16x16x32_bf16 a[44:47], v[180:183], v[76:79], a[44:47]
  buffer_load_dwordx4 v11, s[12:15], s27 offen offset:3072 nt lds
  v_mfma_f32_16x16x32_bf16 a[40:43], v[176:179], v[40:43], a[40:43]
  s_add_u32 s27, s27, 0x40000
  ds_read_b128 v[140:143], v15 offset:6144
  v_mfma_f32_16x16x32_bf16 a[40:43], v[180:183], v[72:75], a[40:43]
  s_and_b32 s27, s27, 0x7fffff
  v_mfma_f32_16x16x32_bf16 a[36:39], v[176:179], v[36:39], a[36:39]
  s_add_u32 m0, s25, 16384
  v_mfma_f32_16x16x32_bf16 a[36:39], v[180:183], v[68:71], a[36:39]
  ds_read_b128 v[112:115], v14 offset:8192
  v_mfma_f32_16x16x32_bf16 a[32:35], v[176:179], v[32:35], a[32:35]
  v_mfma_f32_16x16x32_bf16 a[32:35], v[180:183], v[64:67], a[32:35]
  v_mfma_f32_16x16x32_bf16 a[64:67], v[184:187], v[32:35], a[64:67]
  ds_read_b128 v[144:147], v15 offset:8192
  v_mfma_f32_16x16x32_bf16 a[64:67], v[188:191], v[64:67], a[64:67]
  buffer_load_dwordx4 v8, s[12:15], s27 offen offset:0 nt lds
  v_mfma_f32_16x16x32_bf16 a[68:71], v[184:187], v[36:39], a[68:71]
  v_mfma_f32_16x16x32_bf16 a[68:71], v[188:191], v[68:71], a[68:71]
  ds_read_b128 v[116:119], v14 offset:10240
  v_mfma_f32_16x16x32_bf16 a[72:75], v[184:187], v[40:43], a[72:75]
  v_mfma_f32_16x16x32_bf16 a[72:75], v[188:191], v[72:75], a[72:75]
  v_mfma_f32_16x16x32_bf16 a[76:79], v[184:187], v[44:47], a[76:79]
  ds_read_b128 v[148:151], v15 offset:10240
  v_mfma_f32_16x16x32_bf16 a[76:79], v[188:191], v[76:79], a[76:79]
  buffer_load_dwordx4 v9, s[12:15], s27 offen offset:1024 nt lds
  v_mfma_f32_16x16x32_bf16 a[80:83], v[184:187], v[48:51], a[80:83]
  v_mfma_f32_16x16x32_bf16 a[80:83], v[188:191], v[80:83], a[80:83]
  ds_read_b128 v[120:123], v14 offset:12288
  v_mfma_f32_16x16x32_bf16 a[84:87], v[184:187], v[52:55], a[84:87]
  v_mfma_f32_16x16x32_bf16 a[84:87], v[188:191], v[84:87], a[84:87]
  v_mfma_f32_16x16x32_bf16 a[88:91], v[184:187], v[56:59], a[88:91]
  ds_read_b128 v[152:155], v15 offset:12288
  v_mfma_f32_16x16x32_bf16 a[88:91], v[188:191], v[88:91], a[88:91]
  buffer_load_dwordx4 v10, s[12:15], s27 offen offset:2048 nt lds
  v_mfma_f32_16x16x32_bf16 a[92:95], v[184:187], v[60:63], a[92:95]
  v_mfma_f32_16x16x32_bf16 a[92:95], v[188:191], v[92:95], a[92:95]
  ds_read_b128 v[124:127], v14 offset:14336
  v_mfma_f32_16x16x32_bf16 a[124:127], v[192:195], v[60:63], a[124:127]
  v_mfma_f32_16x16x32_bf16 a[124:127], v[196:199], v[92:95], a[124:127]
  v_mfma_f32_16x16x32_bf16 a[120:123], v[192:195], v[56:59], a[120:123]
  ds_read_b128 v[156:159], v15 offset:14336
  v_mfma_f32_16x16x32_bf16 a[120:123], v[196:199], v[88:91], a[120:123]
  buffer_load_dwordx4 v11, s[12:15], s27 offen offset:3072 nt lds
  v_mfma_f32_16x16x32_bf16 a[116:119], v[192:195], v[52:55], a[116:119]
  s_add_u32 s27, s27, 0x40000
  v_mfma_f32_16x16x32_bf16 a[116:119], v[196:199], v[84:87], a[116:119]
  s_and_b32 s27, s27, 0x7fffff
  v_mfma_f32_16x16x32_bf16 a[112:115], v[192:195], v[48:51], a[112:115]
  v_mfma_f32_16x16x32_bf16 a[112:115], v[196:199], v[80:83], a[112:115]
  s_waitcnt vmcnt(18)
  s_barrier
  v_mfma_f32_16x16x32_bf16 a[108:111], v[192:195], v[44:47], a[108:111]
  ds_read_b64_tr_b16 v[232:233], v19 offset:36864
  v_mfma_f32_16x16x32_bf16 a[108:111], v[196:199], v[76:79], a[108:111]
  global_load_dword v23, v[160:161], off offset:128
  v_mfma_f32_16x16x32_bf16 a[104:107], v[192:195], v[40:43], a[104:107]
  s_add_u32 m0, s29, s33
  ds_read_b64_tr_b16 v[234:235], v19 offset:37376
  v_mfma_f32_16x16x32_bf16 a[104:107], v[196:199], v[72:75], a[104:107]
  ds_read_b64_tr_b16 v[236:237], v19 offset:53248
  v_mfma_f32_16x16x32_bf16 a[100:103], v[192:195], v[36:39], a[100:103]
  v_mfma_f32_16x16x32_bf16 a[100:103], v[196:199], v[68:71], a[100:103]
  ds_read_b64_tr_b16 v[238:239], v19 offset:53760
  v_mfma_f32_16x16x32_bf16 a[96:99], v[192:195], v[32:35], a[96:99]
  v_mfma_f32_16x16x32_bf16 a[96:99], v[196:199], v[64:67], a[96:99]
  buffer_load_dwordx4 v4, s[8:11], s28 offen offset:0  lds
  v_mfma_f32_16x16x32_bf16 a[128:131], v[200:203], v[32:35], a[128:131]
  ds_read_b64_tr_b16 v[168:169], v16 offset:32768
  v_mfma_f32_16x16x32_bf16 a[128:131], v[204:207], v[64:67], a[128:131]
  ds_read_b64_tr_b16 v[170:171], v16 offset:33280
  v_mfma_f32_16x16x32_bf16 a[132:135], v[200:203], v[36:39], a[132:135]
  ds_read_b64_tr_b16 v[172:173], v16 offset:49152
  v_mfma_f32_16x16x32_bf16 a[132:135], v[204:207], v[68:71], a[132:135]
  v_mfma_f32_16x16x32_bf16 a[136:139], v[200:203], v[40:43], a[136:139]
  ds_read_b64_tr_b16 v[174:175], v16 offset:49664
  v_mfma_f32_16x16x32_bf16 a[136:139], v[204:207], v[72:75], a[136:139]
  buffer_load_dwordx4 v5, s[8:11], s28 offen offset:1024  lds
  v_mfma_f32_16x16x32_bf16 a[140:143], v[200:203], v[44:47], a[140:143]
  ds_read_b64_tr_b16 v[176:177], v17 offset:32768
  v_mfma_f32_16x16x32_bf16 a[140:143], v[204:207], v[76:79], a[140:143]
  v_mfma_f32_16x16x32_bf16 a[144:147], v[200:203], v[48:51], a[144:147]
  ds_read_b64_tr_b16 v[178:179], v17 offset:33280
  v_mfma_f32_16x16x32_bf16 a[144:147], v[204:207], v[80:83], a[144:147]
  v_mfma_f32_16x16x32_bf16 a[148:151], v[200:203], v[52:55], a[148:151]
  ds_read_b64_tr_b16 v[180:181], v17 offset:49152
  v_mfma_f32_16x16x32_bf16 a[148:151], v[204:207], v[84:87], a[148:151]
  buffer_load_dwordx4 v6, s[8:11], s28 offen offset:2048  lds
  v_mfma_f32_16x16x32_bf16 a[152:155], v[200:203], v[56:59], a[152:155]
  ds_read_b64_tr_b16 v[182:183], v17 offset:49664
  v_mfma_f32_16x16x32_bf16 a[152:155], v[204:207], v[88:91], a[152:155]
  ds_read_b64_tr_b16 v[184:185], v18 offset:32768
  v_mfma_f32_16x16x32_bf16 a[156:159], v[200:203], v[60:63], a[156:159]
  v_mfma_f32_16x16x32_bf16 a[156:159], v[204:207], v[92:95], a[156:159]
  ds_read_b64_tr_b16 v[186:187], v18 offset:33280
  v_mfma_f32_16x16x32_bf16 a[188:191], v[208:211], v[60:63], a[188:191]
  v_mfma_f32_16x16x32_bf16 a[188:191], v[212:215], v[92:95], a[188:191]
  buffer_load_dwordx4 v7, s[8:11], s28 offen offset:3072  lds
  v_mfma_f32_16x16x32_bf16 a[184:187], v[208:211], v[56:59], a[184:187]
  s_add_u32 m0, s29, s34
  ds_read_b64_tr_b16 v[188:189], v18 offset:49152
  v_mfma_f32_16x16x32_bf16 a[184:187], v[212:215], v[88:91], a[184:187]
  s_add_u32 s35, s28, s32
  ds_read_b64_tr_b16 v[190:191], v18 offset:49664
  ds_read_b64_tr_b16 v[192:193], v19 offset:32768
  v_mfma_f32_16x16x32_bf16 a[180:183], v[208:211], v[52:55], a[180:183]
  ds_read_b64_tr_b16 v[194:195], v19 offset:33280
  ds_read_b64_tr_b16 v[196:197], v19 offset:49152
  v_mfma_f32_16x16x32_bf16 a[180:183], v[212:215], v[84:87], a[180:183]
  ds_read_b64_tr_b16 v[198:199], v19 offset:49664
  ds_read_b64_tr_b16 v[200:201], v16 offset:36864
  v_mfma_f32_16x16x32_bf16 a[176:179], v[208:211], v[48:51], a[176:179]
  ds_read_b64_tr_b16 v[202:203], v16 offset:37376
  ds_read_b64_tr_b16 v[204:205], v16 offset:53248
  v_mfma_f32_16x16x32_bf16 a[176:179], v[212:215], v[80:83], a[176:179]
  buffer_load_dwordx4 v4, s[8:11], s35 offen offset:0  lds
  v_mfma_f32_16x16x32_bf16 a[172:175], v[208:211], v[44:47], a[172:175]
  ds_read_b64_tr_b16 v[206:207], v16 offset:53760
  v_mfma_f32_16x16x32_bf16 a[172:175], v[212:215], v[76:79], a[172:175]
  v_mfma_f32_16x16x32_bf16 a[168:171], v[208:211], v[40:43], a[168:171]
  v_mfma_f32_16x16x32_bf16 a[168:171], v[212:215], v[72:75], a[168:171]
  v_mfma_f32_16x16x32_bf16 a[164:167], v[208:211], v[36:39], a[164:167]
  v_mfma_f32_16x16x32_bf16 a[164:167], v[212:215], v[68:71], a[164:167]
  buffer_load_dwordx4 v5, s[8:11], s35 offen offset:1024  lds
  v_mfma_f32_16x16x32_bf16 a[160:163], v[208:211], v[32:35], a[160:163]
  v_mfma_f32_16x16x32_bf16 a[160:163], v[212:215], v[64:67], a[160:163]
  v_mfma_f32_16x16x32_bf16 a[192:195], v[216:219], v[32:35], a[192:195]
  ds_read_b64_tr_b16 v[208:209], v17 offset:36864
  v_mfma_f32_16x16x32_bf16 a[192:195], v[220:223], v[64:67], a[192:195]
  ds_read_b64_tr_b16 v[210:211], v17 offset:37376
  v_mfma_f32_16x16x32_bf16 a[196:199], v[216:219], v[36:39], a[196:199]
  ds_read_b64_tr_b16 v[212:213], v17 offset:53248
  v_mfma_f32_16x16x32_bf16 a[196:199], v[220:223], v[68:71], a[196:199]
  buffer_load_dwordx4 v6, s[8:11], s35 offen offset:2048  lds
  v_mfma_f32_16x16x32_bf16 a[200:203], v[216:219], v[40:43], a[200:203]
  ds_read_b64_tr_b16 v[214:215], v17 offset:53760
  v_mfma_f32_16x16x32_bf16 a[200:203], v[220:223], v[72:75], a[200:203]
  v_mfma_f32_16x16x32_bf16 a[204:207], v[216:219], v[44:47], a[204:207]
  v_mfma_f32_16x16x32_bf16 a[204:207], v[220:223], v[76:79], a[204:207]
  v_mfma_f32_16x16x32_bf16 a[208:211], v[216:219], v[48:51], a[208:211]
  v_mfma_f32_16x16x32_bf16 a[208:211], v[220:223], v[80:83], a[208:211]
  buffer_load_dwordx4 v7, s[8:11], s35 offen offset:3072  lds
  v_mfma_f32_16x16x32_bf16 a[212:215], v[216:219], v[52:55], a[212:215]
  s_add_u32 s26, s26, 128
  v_mfma_f32_16x16x32_bf16 a[212:215], v[220:223], v[84:87], a[212:215]
  s_and_b32 s26, s26, 0x7ff
  v_mfma_f32_16x16x32_bf16 a[216:219], v[216:219], v[56:59], a[216:219]
  s_add_u32 s28, s6, s26
  v_mfma_f32_16x16x32_bf16 a[216:219], v[220:223], v[88:91], a[216:219]
  s_add_u32 s29, s29, 0x8000
  v_mfma_f32_16x16x32_bf16 a[220:223], v[216:219], v[60:63], a[220:223]
  s_cmp_eq_u32 s29, 0x18000
  v_mfma_f32_16x16x32_bf16 a[220:223], v[220:223], v[92:95], a[220:223]
  s_cselect_b32 s29, 0, s29
  v_mfma_f32_16x16x32_bf16 a[252:255], v[224:227], v[60:63], a[252:255]
  s_cmp_eq_u32 s31, s85
  ds_read_b64_tr_b16 v[216:217], v18 offset:36864
  v_mfma_f32_16x16x32_bf16 a[252:255], v[228:231], v[92:95], a[252:255]
  s_cselect_b32 s49, 0, 0x7fff0000
  ds_read_b64_tr_b16 v[218:219], v18 offset:37376
  v_mfma_f32_16x16x32_bf16 a[248:251], v[224:227], v[56:59], a[248:251]
  ds_read_b64_tr_b16 v[220:221], v18 offset:53248
  v_mfma_f32_16x16x32_bf16 a[248:251], v[228:231], v[88:91], a[248:251]
  ds_read_b64_tr_b16 v[222:223], v18 offset:53760
  v_mfma_f32_16x16x32_bf16 a[244:247], v[224:227], v[52:55], a[244:247]
  v_mfma_f32_16x16x32_bf16 a[244:247], v[228:231], v[84:87], a[244:247]
  v_mfma_f32_16x16x32_bf16 a[240:243], v[224:227], v[48:51], a[240:243]
  v_mfma_f32_16x16x32_bf16 a[240:243], v[228:231], v[80:83], a[240:243]
  v_mfma_f32_16x16x32_bf16 a[236:239], v[224:227], v[44:47], a[236:239]
  v_mfma_f32_16x16x32_bf16 a[236:239], v[228:231], v[76:79], a[236:239]
  buffer_store_byte v165, v166, s[92:95], s49 offen sc1
  v_mfma_f32_16x16x32_bf16 a[232:235], v[224:227], v[40:43], a[232:235]
  v_mfma_f32_16x16x32_bf16 a[232:235], v[228:231], v[72:75], a[232:235]
  v_mfma_f32_16x16x32_bf16 a[228:231], v[224:227], v[36:39], a[228:231]
  v_mfma_f32_16x16x32_bf16 a[228:231], v[228:231], v[68:71], a[228:231]
  s_cmp_eq_u32 s31, s50
  v_mfma_f32_16x16x32_bf16 a[224:227], v[224:227], v[32:35], a[224:227]
  v_mfma_f32_16x16x32_bf16 a[224:227], v[228:231], v[64:67], a[224:227]
  s_cbranch_scc1 K1_K_swx
K1_K_swx_back:
  s_waitcnt vmcnt(18) lgkmcnt(0)
  s_barrier
  v_mfma_f32_16x16x32_bf16 a[0:3], v[168:171], v[96:99], a[0:3]
  s_add_u32 s30, s30, 0x8000
  v_mfma_f32_16x16x32_bf16 a[0:3], v[172:175], v[128:131], a[0:3]
  s_cmp_eq_u32 s30, 0x18000
  global_load_dword v23, v[160:161], off offset:256
  v_mfma_f32_16x16x32_bf16 a[4:7], v[168:171], v[100:103], a[4:7]
  s_cselect_b32 s30, 0, s30
  v_mfma_f32_16x16x32_bf16 a[4:7], v[172:175], v[132:135], a[4:7]
  v_add_u32 v14, s30, v12
  v_add_u32 v15, s30, v13
  v_mfma_f32_16x16x32_bf16 a[8:11], v[168:171], v[104:107], a[8:11]
  ds_read_b128 v[32:35], v14 offset:0
  v_mfma_f32_16x16x32_bf16 a[8:11], v[172:175], v[136:139], a[8:11]
  s_add_u32 m0, s25, 32768
  v_mfma_f32_16x16x32_bf16 a[12:15], v[168:171], v[108:111], a[12:15]
  v_mfma_f32_16x16x32_bf16 a[12:15], v[172:175], v[140:143], a[12:15]
  buffer_load_dwordx4 v8, s[12:15], s27 offen offset:0 nt lds
  v_mfma_f32_16x16x32_bf16 a[16:19], v[168:171], v[112:115], a[16:19]
  ds_read_b128 v[64:67], v15 offset:0
  v_mfma_f32_16x16x32_bf16 a[16:19], v[172:175], v[144:147], a[16:19]
  v_mfma_f32_16x16x32_bf16 a[20:23], v[168:171], v[116:119], a[20:23]
  ds_read_b128 v[36:39], v14 offset:2048
  v_mfma_f32_16x16x32_bf16 a[20:23], v[172:175], v[148:151], a[20:23]
  v_mfma_f32_16x16x32_bf16 a[24:27], v[168:171], v[120:123], a[24:27]
  v_mfma_f32_16x16x32_bf16 a[24:27], v[172:175], v[152:155], a[24:27]
  buffer_load_dwordx4 v9, s[12:15], s27 offen offset:1024 nt lds
  v_mfma_f32_16x16x32_bf16 a[28:31], v[168:171], v[124:127], a[28:31]
  ds_read_b128 v[68:71], v15 offset:2048
  v_mfma_f32_16x16x32_bf16 a[28:31], v[172:175], v[156:159], a[28:31]
  v_mfma_f32_16x16x32_bf16 a[60:63], v[176:179], v[124:127], a[60:63]
  ds_read_b128 v[40:43], v14 offset:4096
  v_mfma_f32_16x16x32_bf16 a[60:63], v[180:183], v[156:159], a[60:63]
  v_mfma_f32_16x16x32_bf16 a[56:59], v[176:179], v[120:123], a[56:59]
  v_mfma_f32_16x16x32_bf16 a[56:59], v[180:183], v[152:155], a[56:59]
  buffer_load_dwordx4 v10, s[12:15], s27 offen offset:2048 nt lds
  v_mfma_f32_16x16x32_bf16 a[52:55], v[176:179], v[116:119], a[52:55]
  ds_read_b128 v[72:75], v15 offset:4096
  v_mfma_f32_16x16x32_bf16 a[52:55], v[180:183], v[148:151], a[52:55]
  v_mfma_f32_16x16x32_bf16 a[48:51], v[176:179], v[112:115], a[48:51]
  ds_read_b128 v[44:47], v14 offset:6144
  v_mfma_f32_16x16x32_bf16 a[48:51], v[180:183], v[144:147], a[48:51]
  v_mfma_f32_16x16x32_bf16 a[44:47], v[176:179], v[108:111], a[44:47]
  v_mfma_f32_16x16x32_bf16 a[44:47], v[180:183], v[140:143], a[44:47]
  buffer_load_dwordx4 v11, s[12:15], s27 offen offset:3072 nt lds
  v_mfma_f32_16x16x32_bf16 a[40:43], v[176:179], v[104:107], a[40:43]
  s_add_u32 s27, s27, 0x40000
  ds_read_b128 v[76:79], v15 offset:6144
  v_mfma_f32_16x16x32_bf16 a[40:43], v[180:183], v[136:139], a[40:43]
  s_and_b32 s27, s27, 0x7fffff
  v_mfma_f32_16x16x32_bf16 a[36:39], v[176:179], v[100:103], a[36:39]
  s_add_u32 m0, s25, 49152
  v_mfma_f32_16x16x32_bf16 a[36:39], v[180:183], v[132:135], a[36:39]
  ds_read_b128 v[48:51], v14 offset:8192
  v_mfma_f32_16x16x32_bf16 a[32:35], v[176:179], v[96:99], a[32:35]
  v_mfma_f32_16x16x32_bf16 a[32:35], v[180:183], v[128:131], a[32:35]
  v_mfma_f32_16x16x32_bf16 a[64:67], v[184:187], v[96:99], a[64:67]
  ds_read_b128 v[80:83], v15 offset:8192
  v_mfma_f32_16x16x32_bf16 a[64:67], v[188:191], v[128:131], a[64:67]
  buffer_load_dwordx4 v8, s[12:15], s27 offen offset:0 nt lds
  v_mfma_f32_16x16x32_bf16 a[68:71], v[184:187], v[100:103], a[68:71]
  v_mfma_f32_16x16x32_bf16 a[68:71], v[188:191], v[132:135], a[68:71]
  ds_read_b128 v[52:55], v14 offset:10240
  v_mfma_f32_16x16x32_bf16 a[72:75], v[184:187], v[104:107], a[72:75]
  v_mfma_f32_16x16x32_bf16 a[72:75], v[188:191], v[136:139], a[72:75]
  v_mfma_f32_16x16x32_bf16 a[76:79], v[184:187], v[108:111], a[76:79]
  ds_read_b128 v[84:87], v15 offset:10240
  v_mfma_f32_16x16x32_bf16 a[76:79], v[188:191], v[140:143], a[76:79]
  buffer_load_dwordx4 v9, s[12:15], s27 offen offset:1024 nt lds
  v_mfma_f32_16x16x32_bf16 a[80:83], v[184:187], v[112:115], a[80:83]
  v_mfma_f32_16x16x32_bf16 a[80:83], v[188:191], v[144:147], a[80:83]
  ds_read_b128 v[56:59], v14 offset:12288
  v_mfma_f32_16x16x32_bf16 a[84:87], v[184:187], v[116:119], a[84:87]
  v_mfma_f32_16x16x32_bf16 a[84:87], v[188:191], v[148:151], a[84:87]
  v_mfma_f32_16x16x32_bf16 a[88:91], v[184:187], v[120:123], a[88:91]
  ds_read_b128 v[88:91], v15 offset:12288
  v_mfma_f32_16x16x32_bf16 a[88:91], v[188:191], v[152:155], a[88:91]
  buffer_load_dwordx4 v10, s[12:15], s27 offen offset:2048 nt lds
  v_mfma_f32_16x16x32_bf16 a[92:95], v[184:187], v[124:127], a[92:95]
  v_mfma_f32_16x16x32_bf16 a[92:95], v[188:191], v[156:159], a[92:95]
  ds_read_b128 v[60:63], v14 offset:14336
  v_mfma_f32_16x16x32_bf16 a[124:127], v[192:195], v[124:127], a[124:127]
  v_mfma_f32_16x16x32_bf16 a[124:127], v[196:199], v[156:159], a[124:127]
  v_mfma_f32_16x16x32_bf16 a[120:123], v[192:195], v[120:123], a[120:123]
  ds_read_b128 v[92:95], v15 offset:14336
  v_mfma_f32_16x16x32_bf16 a[120:123], v[196:199], v[152:155], a[120:123]
  buffer_load_dwordx4 v11, s[12:15], s27 offen offset:3072 nt lds
  v_mfma_f32_16x16x32_bf16 a[116:119], v[192:195], v[116:119], a[116:119]
  s_add_u32 s27, s27, 0x40000
  v_mfma_f32_16x16x32_bf16 a[116:119], v[196:199], v[148:151], a[116:119]
  s_and_b32 s27, s27, 0x7fffff
  v_mfma_f32_16x16x32_bf16 a[112:115], v[192:195], v[112:115], a[112:115]
  v_mfma_f32_16x16x32_bf16 a[112:115], v[196:199], v[144:147], a[112:115]
  s_waitcnt vmcnt(18)
  s_barrier
  v_mfma_f32_16x16x32_bf16 a[108:111], v[192:195], v[108:111], a[108:111]
  ds_read_b64_tr_b16 v[224:225], v19 offset:4096
  v_mfma_f32_16x16x32_bf16 a[108:111], v[196:199], v[140:143], a[108:111]
  global_load_dword v23, v[160:161], off offset:384
  v_mfma_f32_16x16x32_bf16 a[104:107], v[192:195], v[104:107], a[104:107]
  s_add_u32 m0, s29, s33
  ds_read_b64_tr_b16 v[226:227], v19 offset:4608
  v_mfma_f32_16x16x32_bf16 a[104:107], v[196:199], v[136:139], a[104:107]
  ds_read_b64_tr_b16 v[228:229], v19 offset:20480
  v_mfma_f32_16x16x32_bf16 a[100:103], v[192:195], v[100:103], a[100:103]
  v_mfma_f32_16x16x32_bf16 a[100:103], v[196:199], v[132:135], a[100:103]
  ds_read_b64_tr_b16 v[230:231], v19 offset:20992
  v_mfma_f32_16x16x32_bf16 a[96:99], v[192:195], v[96:99], a[96:99]
  v_mfma_f32_16x16x32_bf16 a[96:99], v[196:199], v[128:131], a[96:99]
  buffer_load_dwordx4 v4, s[8:11], s28 offen offset:0  lds
  v_mfma_f32_16x16x32_bf16 a[128:131], v[200:203], v[96:99], a[128:131]
  ds_read_b64_tr_b16 v[168:169], v16 offset:0
  v_mfma_f32_16x16x32_bf16 a[128:131], v[204:207], v[128:131], a[128:131]
  ds_read_b64_tr_b16 v[170:171], v16 offset:512
  v_mfma_f32_16x16x32_bf16 a[132:135], v[200:203], v[100:103], a[132:135]
  ds_read_b64_tr_b16 v[172:173], v16 offset:16384
  v_mfma_f32_16x16x32_bf16 a[132:135], v[204:207], v[132:135], a[132:135]
  v_mfma_f32_16x16x32_bf16 a[136:139], v[200:203], v[104:107], a[136:139]
  ds_read_b64_tr_b16 v[174:175], v16 offset:16896
  v_mfma_f32_16x16x32_bf16 a[136:139], v[204:207], v[136:139], a[136:139]
  buffer_load_dwordx4 v5, s[8:11], s28 offen offset:1024  lds
  v_mfma_f32_16x16x32_bf16 a[140:143], v[200:203], v[108:111], a[140:143]
  ds_read_b64_tr_b16 v[176:177], v17 offset:0
  v_mfma_f32_16x16x32_bf16 a[140:143], v[204:207], v[140:143], a[140:143]
  v_mfma_f32_16x16x32_bf16 a[144:147], v[200:203], v[112:115], a[144:147]
  ds_read_b64_tr_b16 v[178:179], v17 offset:512
  v_mfma_f32_16x16x32_bf16 a[144:147], v[204:207], v[144:147], a[144:147]
  v_mfma_f32_16x16x32_bf16 a[148:151], v[200:203], v[116:119], a[148:151]
  ds_read_b64_tr_b16 v[180:181], v17 offset:16384
  v_mfma_f32_16x16x32_bf16 a[148:151], v[204:207], v[148:151], a[148:151]
  buffer_load_dwordx4 v6, s[8:11], s28 offen offset:2048  lds
  v_mfma_f32_16x16x32_bf16 a[152:155], v[200:203], v[120:123], a[152:155]
  ds_read_b64_tr_b16 v[182:183], v17 offset:16896
  v_mfma_f32_16x16x32_bf16 a[152:155], v[204:207], v[152:155], a[152:155]
  ds_read_b64_tr_b16 v[184:185], v18 offset:0
  v_mfma_f32_16x16x32_bf16 a[156:159], v[200:203], v[124:127], a[156:159]
  v_mfma_f32_16x16x32_bf16 a[156:159], v[204:207], v[156:159], a[156:159]
  ds_read_b64_tr_b16 v[186:187], v18 offset:512
  v_mfma_f32_16x16x32_bf16 a[188:191], v[208:211], v[124:127], a[188:191]
  v_mfma_f32_16x16x32_bf16 a[188:191], v[212:215], v[156:159], a[188:191]
  buffer_load_dwordx4 v7, s[8:11], s28 offen offset:3072  lds
  v_mfma_f32_16x16x32_bf16 a[184:187], v[208:211], v[120:123], a[184:187]
  s_add_u32 m0, s29, s34
  ds_read_b64_tr_b16 v[188:189], v18 offset:16384
  v_mfma_f32_16x16x32_bf16 a[184:187], v[212:215], v[152:155], a[184:187]
  s_add_u32 s35, s28, s32
  ds_read_b64_tr_b16 v[190:191], v18 offset:16896
  ds_read_b64_tr_b16 v[192:193], v19 offset:0
  v_mfma_f32_16x16x32_bf16 a[180:183], v[208:211], v[116:119], a[180:183]
  ds_read_b64_tr_b16 v[194:195], v19 offset:512
  ds_read_b64_tr_b16 v[196:197], v19 offset:16384
  v_mfma_f32_16x16x32_bf16 a[180:183], v[212:215], v[148:151], a[180:183]
  ds_read_b64_tr_b16 v[198:199], v19 offset:16896
  ds_read_b64_tr_b16 v[200:201], v16 offset:4096
  v_mfma_f32_16x16x32_bf16 a[176:179], v[208:211], v[112:115], a[176:179]
  ds_read_b64_tr_b16 v[202:203], v16 offset:4608
  ds_read_b64_tr_b16 v[204:205], v16 offset:20480
  v_mfma_f32_16x16x32_bf16 a[176:179], v[212:215], v[144:147], a[176:179]
  buffer_load_dwordx4 v4, s[8:11], s35 offen offset:0  lds
  v_mfma_f32_16x16x32_bf16 a[172:175], v[208:211], v[108:111], a[172:175]
  ds_read_b64_tr_b16 v[206:207], v16 offset:20992
  v_mfma_f32_16x16x32_bf16 a[172:175], v[212:215], v[140:143], a[172:175]
  v_mfma_f32_16x16x32_bf16 a[168:171], v[208:211], v[104:107], a[168:171]
  v_mfma_f32_16x16x32_bf16 a[168:171], v[212:215], v[136:139], a[168:171]
  v_mfma_f32_16x16x32_bf16 a[164:167], v[208:211], v[100:103], a[164:167]
  v_mfma_f32_16x16x32_bf16 a[164:167], v[212:215], v[132:135], a[164:167]
  buffer_load_dwordx4 v5, s[8:11], s35 offen offset:1024  lds
  v_mfma_f32_16x16x32_bf16 a[160:163], v[208:211], v[96:99], a[160:163]
  v_mfma_f32_16x16x32_bf16 a[160:163], v[212:215], v[128:131], a[160:163]
  v_mfma_f32_16x16x32_bf16 a[192:195], v[216:219], v[96:99], a[192:195]
  ds_read_b64_tr_b16 v[208:209], v17 offset:4096
  v_mfma_f32_16x16x32_bf16 a[192:195], v[220:223], v[128:131], a[192:195]
  ds_read_b64_tr_b16 v[210:211], v17 offset:4608
  v_mfma_f32_16x16x32_bf16 a[196:199], v[216:219], v[100:103], a[196:199]
  ds_read_b64_tr_b16 v[212:213], v17 offset:20480
  v_mfma_f32_16x16x32_bf16 a[196:199], v[220:223], v[132:135], a[196:199]
  buffer_load_dwordx4 v6, s[8:11], s35 offen offset:2048  lds
  v_mfma_f32_16x16x32_bf16 a[200:203], v[216:219], v[104:107], a[200:203]
  ds_read_b64_tr_b16 v[214:215], v17 offset:20992
  v_mfma_f32_16x16x32_bf16 a[200:203], v[220:223], v[136:139], a[200:203]
  v_mfma_f32_16x16x32_bf16 a[204:207], v[216:219], v[108:111], a[204:207]
  v_mfma_f32_16x16x32_bf16 a[204:207], v[220:223], v[140:143], a[204:207]
  v_mfma_f32_16x16x32_bf16 a[208:211], v[216:219], v[112:115], a[208:211]
  v_mfma_f32_16x16x32_bf16 a[208:211], v[220:223], v[144:147], a[208:211]
  buffer_load_dwordx4 v7, s[8:11], s35 offen offset:3072  lds
  v_mfma_f32_16x16x32_bf16 a[212:215], v[216:219], v[116:119], a[212:215]
  s_add_u32 s26, s26, 128
  v_mfma_f32_16x16x32_bf16 a[212:215], v[220:223], v[148:151], a[212:215]
  s_and_b32 s26, s26, 0x7ff
  v_mfma_f32_16x16x32_bf16 a[216:219], v[216:219], v[120:123], a[216:219]
  s_add_u32 s28, s6, s26
  v_mfma_f32_16x16x32_bf16 a[216:219], v[220:223], v[152:155], a[216:219]
  s_add_u32 s29, s29, 0x8000
  v_mfma_f32_16x16x32_bf16 a[220:223], v[216:219], v[124:127], a[220:223]
  s_cmp_eq_u32 s29, 0x18000
  v_mfma_f32_16x16x32_bf16 a[220:223], v[220:223], v[156:159], a[220:223]
  s_cselect_b32 s29, 0, s29
  v_mfma_f32_16x16x32_bf16 a[252:255], v[232:235], v[124:127], a[252:255]
  ds_read_b64_tr_b16 v[216:217], v18 offset:4096
  v_mfma_f32_16x16x32_bf16 a[252:255], v[236:239], v[156:159], a[252:255]
  v_lshl_add_u64 v[160:161], v[162:163], 0, v[160:161]
  v_mfma_f32_16x16x32_bf16 a[248:251], v[232:235], v[120:123], a[248:251]
  ds_read_b64_tr_b16 v[218:219], v18 offset:4608
  v_mfma_f32_16x16x32_bf16 a[248:251], v[236:239], v[152:155], a[248:251]
  v_mov_b32 v162, v164
  ds_read_b64_tr_b16 v[220:221], v18 offset:20480
  v_mfma_f32_16x16x32_bf16 a[244:247], v[232:235], v[116:119], a[244:247]
  ds_read_b64_tr_b16 v[222:223], v18 offset:20992
  v_mfma_f32_16x16x32_bf16 a[244:247], v[236:239], v[148:151], a[244:247]
  v_mfma_f32_16x16x32_bf16 a[240:243], v[232:235], v[112:115], a[240:243]
  v_mfma_f32_16x16x32_bf16 a[240:243], v[236:239], v[144:147], a[240:243]
  s_cmp_eq_u32 s31, 6
  v_mfma_f32_16x16x32_bf16 a[236:239], v[232:235], v[108:111], a[236:239]
  s_cselect_b32 s12, s40, s12
  v_mfma_f32_16x16x32_bf16 a[236:239], v[236:239], v[140:143], a[236:239]
  s_cselect_b32 s13, s7, s13
  v_mfma_f32_16x16x32_bf16 a[232:235], v[232:235], v[104:107], a[232:235]
  s_cselect_b32 s14, 0x380000, s14
  v_mfma_f32_16x16x32_bf16 a[232:235], v[236:239], v[136:139], a[232:235]
  s_cselect_b32 s27, s51, s27
  v_mfma_f32_16x16x32_bf16 a[228:231], v[232:235], v[100:103], a[228:231]
  s_add_u32 s31, s31, 1
  v_mfma_f32_16x16x32_bf16 a[228:231], v[236:239], v[132:135], a[228:231]
  s_cmp_lt_u32 s31, 8
  v_mfma_f32_16x16x32_bf16 a[224:227], v[232:235], v[96:99], a[224:227]
  v_mfma_f32_16x16x32_bf16 a[224:227], v[236:239], v[128:131], a[224:227]
  s_branch K1_K_loop
K1_K_last:
  s_waitcnt vmcnt(18) lgkmcnt(0)
  s_barrier
  v_mfma_f32_16x16x32_bf16 a[0:3], v[168:171], v[96:99], a[0:3]
  s_add_u32 s30, s30, 0x8000
  v_subrev_u32 v12, s58, v12
  v_mfma_f32_16x16x32_bf16 a[0:3], v[172:175], v[128:131], a[0:3]
  s_cmp_eq_u32 s30, 0x18000
  global_load_dword v23, v[160:161], off offset:256
  v_mfma_f32_16x16x32_bf16 a[4:7], v[168:171], v[100:103], a[4:7]
  s_cselect_b32 s30, 0, s30
  v_xor_b32 v13, 64, v12
  v_mfma_f32_16x16x32_bf16 a[4:7], v[172:175], v[132:135], a[4:7]
  v_add_u32 v14, s30, v12
  v_mfma_f32_16x16x32_bf16 a[8:11], v[168:171], v[104:107], a[8:11]
  v_add_u32 v16, s45, v16
  v_add_u32 v17, s45, v17
  v_mfma_f32_16x16x32_bf16 a[8:11], v[172:175], v[136:139], a[8:11]
  s_add_u32 m0, s25, 32768
  v_add_u32 v18, s45, v18
  v_add_u32 v19, s45, v19
  v_mfma_f32_16x16x32_bf16 a[12:15], v[168:171], v[108:111], a[12:15]
  v_mfma_f32_16x16x32_bf16 a[12:15], v[172:175], v[140:143], a[12:15]
  buffer_load_dwordx4 v8, s[12:15], s27 offen offset:0 nt lds
  v_mfma_f32_16x16x32_bf16 a[16:19], v[168:171], v[112:115], a[16:19]
  ds_read_b128 v[32:35], v14 offset:0
  v_mfma_f32_16x16x32_bf16 a[16:19], v[172:175], v[144:147], a[16:19]
  v_mfma_f32_16x16x32_bf16 a[20:23], v[168:171], v[116:119], a[20:23]
  ds_read_b128 v[36:39], v14 offset:2048
  v_mfma_f32_16x16x32_bf16 a[20:23], v[172:175], v[148:151], a[20:23]
  v_mfma_f32_16x16x32_bf16 a[24:27], v[168:171], v[120:123], a[24:27]
  v_mfma_f32_16x16x32_bf16 a[24:27], v[172:175], v[152:155], a[24:27]
  buffer_load_dwordx4 v9, s[12:15], s27 offen offset:1024 nt lds
  v_mfma_f32_16x16x32_bf16 a[28:31], v[168:171], v[124:127], a[28:31]
  ds_read_b128 v[40:43], v14 offset:4096
  v_mfma_f32_16x16x32_bf16 a[28:31], v[172:175], v[156:159], a[28:31]
  v_mfma_f32_16x16x32_bf16 a[60:63], v[176:179], v[124:127], a[60:63]
  ds_read_b128 v[44:47], v14 offset:6144
  v_mfma_f32_16x16x32_bf16 a[60:63], v[180:183], v[156:159], a[60:63]
  v_mfma_f32_16x16x32_bf16 a[56:59], v[176:179], v[120:123], a[56:59]
  v_mfma_f32_16x16x32_bf16 a[56:59], v[180:183], v[152:155], a[56:59]
  buffer_load_dwordx4 v10, s[12:15], s27 offen offset:2048 nt lds
  v_mfma_f32_16x16x32_bf16 a[52:55], v[176:179], v[116:119], a[52:55]
  ds_read_b128 v[48:51], v14 offset:8192
  v_mfma_f32_16x16x32_bf16 a[52:55], v[180:183], v[148:151], a[52:55]
  v_mfma_f32_16x16x32_bf16 a[48:51], v[176:179], v[112:115], a[48:51]
  ds_read_b128 v[52:55], v14 offset:10240
  v_mfma_f32_16x16x32_bf16 a[48:51], v[180:183], v[144:147], a[48:51]
  v_mfma_f32_16x16x32_bf16 a[44:47], v[176:179], v[108:111], a[44:47]
  v_mfma_f32_16x16x32_bf16 a[44:47], v[180:183], v[140:143], a[44:47]
  buffer_load_dwordx4 v11, s[12:15], s27 offen offset:3072 nt lds
  v_mfma_f32_16x16x32_bf16 a[40:43], v[176:179], v[104:107], a[40:43]
  s_add_u32 s27, s27, 0x40000
  ds_read_b128 v[56:59], v14 offset:12288
  v_mfma_f32_16x16x32_bf16 a[40:43], v[180:183], v[136:139], a[40:43]
  s_and_b32 s27, s27, 0x7fffff
  v_mfma_f32_16x16x32_bf16 a[36:39], v[176:179], v[100:103], a[36:39]
  s_add_u32 m0, s25, 49152
  ds_read_b128 v[60:63], v14 offset:14336
  v_mfma_f32_16x16x32_bf16 a[36:39], v[180:183], v[132:135], a[36:39]
  v_mfma_f32_16x16x32_bf16 a[32:35], v[176:179], v[96:99], a[32:35]
  v_mfma_f32_16x16x32_bf16 a[32:35], v[180:183], v[128:131], a[32:35]
  v_mfma_f32_16x16x32_bf16 a[64:67], v[184:187], v[96:99], a[64:67]
  v_mfma_f32_16x16x32_bf16 a[64:67], v[188:191], v[128:131], a[64:67]
  buffer_load_dwordx4 v8, s[12:15], s27 offen offset:0 nt lds
  v_mfma_f32_16x16x32_bf16 a[68:71], v[184:187], v[100:103], a[68:71]
  v_mfma_f32_16x16x32_bf16 a[68:71], v[188:191], v[132:135], a[68:71]
  v_mfma_f32_16x16x32_bf16 a[72:75], v[184:187], v[104:107], a[72:75]
  v_mfma_f32_16x16x32_bf16 a[72:75], v[188:191], v[136:139], a[72:75]
  v_mfma_f32_16x16x32_bf16 a[76:79], v[184:187], v[108:111], a[76:79]
  v_mfma_f32_16x16x32_bf16 a[76:79], v[188:191], v[140:143], a[76:79]
  buffer_load_dwordx4 v9, s[12:15], s27 offen offset:1024 nt lds
  v_mfma_f32_16x16x32_bf16 a[80:83], v[184:187], v[112:115], a[80:83]
  v_mfma_f32_16x16x32_bf16 a[80:83], v[188:191], v[144:147], a[80:83]
  v_mfma_f32_16x16x32_bf16 a[84:87], v[184:187], v[116:119], a[84:87]
  v_mfma_f32_16x16x32_bf16 a[84:87], v[188:191], v[148:151], a[84:87]
  v_mfma_f32_16x16x32_bf16 a[88:91], v[184:187], v[120:123], a[88:91]
  v_mfma_f32_16x16x32_bf16 a[88:91], v[188:191], v[152:155], a[88:91]
  buffer_load_dwordx4 v10, s[12:15], s27 offen offset:2048 nt lds
  v_mfma_f32_16x16x32_bf16 a[92:95], v[184:187], v[124:127], a[92:95]
  v_mfma_f32_16x16x32_bf16 a[92:95], v[188:191], v[156:159], a[92:95]
  v_mfma_f32_16x16x32_bf16 a[124:127], v[192:195], v[124:127], a[124:127]
  v_mfma_f32_16x16x32_bf16 a[124:127], v[196:199], v[156:159], a[124:127]
  v_mfma_f32_16x16x32_bf16 a[120:123], v[192:195], v[120:123], a[120:123]
  v_mfma_f32_16x16x32_bf16 a[120:123], v[196:199], v[152:155], a[120:123]
  buffer_load_dwordx4 v11, s[12:15], s27 offen offset:3072 nt lds
  v_mfma_f32_16x16x32_bf16 a[116:119], v[192:195], v[116:119], a[116:119]
  s_add_u32 s27, s27, 0x40000
  v_mfma_f32_16x16x32_bf16 a[116:119], v[196:199], v[148:151], a[116:119]
  s_and_b32 s27, s27, 0x7fffff
  v_mfma_f32_16x16x32_bf16 a[112:115], v[192:195], v[112:115], a[112:115]
  v_mfma_f32_16x16x32_bf16 a[112:115], v[196:199], v[144:147], a[112:115]
  s_waitcnt vmcnt(18)
  s_barrier
  v_mfma_f32_16x16x32_bf16 a[108:111], v[192:195], v[108:111], a[108:111]
  ds_read_b64_tr_b16 v[64:65], v16 offset:0
  v_mfma_f32_16x16x32_bf16 a[108:111], v[196:199], v[140:143], a[108:111]
  global_load_dword v23, v[160:161], off offset:384
  v_mfma_f32_16x16x32_bf16 a[104:107], v[192:195], v[104:107], a[104:107]
  s_add_u32 m0, s29, s33
  ds_read_b64_tr_b16 v[66:67], v16 offset:512
  v_mfma_f32_16x16x32_bf16 a[104:107], v[196:199], v[136:139], a[104:107]
  v_mfma_f32_16x16x32_bf16 a[100:103], v[192:195], v[100:103], a[100:103]
  v_mfma_f32_16x16x32_bf16 a[100:103], v[196:199], v[132:135], a[100:103]
  ds_read_b64_tr_b16 v[68:69], v17 offset:0
  v_mfma_f32_16x16x32_bf16 a[96:99], v[192:195], v[96:99], a[96:99]
  v_mfma_f32_16x16x32_bf16 a[96:99], v[196:199], v[128:131], a[96:99]
  buffer_load_dwordx4 v4, s[8:11], s28 offen offset:0  lds
  v_mfma_f32_16x16x32_bf16 a[128:131], v[200:203], v[96:99], a[128:131]
  ds_read_b64_tr_b16 v[70:71], v17 offset:512
  v_mfma_f32_16x16x32_bf16 a[128:131], v[204:207], v[128:131], a[128:131]
  v_mfma_f32_16x16x32_bf16 a[132:135], v[200:203], v[100:103], a[132:135]
  ds_read_b64_tr_b16 v[72:73], v18 offset:0
  v_mfma_f32_16x16x32_bf16 a[132:135], v[204:207], v[132:135], a[132:135]
  v_mfma_f32_16x16x32_bf16 a[136:139], v[200:203], v[104:107], a[136:139]
  ds_read_b64_tr_b16 v[74:75], v18 offset:512
  v_mfma_f32_16x16x32_bf16 a[136:139], v[204:207], v[136:139], a[136:139]
  buffer_load_dwordx4 v5, s[8:11], s28 offen offset:1024  lds
  v_mfma_f32_16x16x32_bf16 a[140:143], v[200:203], v[108:111], a[140:143]
  v_mfma_f32_16x16x32_bf16 a[140:143], v[204:207], v[140:143], a[140:143]
  ds_read_b64_tr_b16 v[76:77], v19 offset:0
  v_mfma_f32_16x16x32_bf16 a[144:147], v[200:203], v[112:115], a[144:147]
  v_mfma_f32_16x16x32_bf16 a[144:147], v[204:207], v[144:147], a[144:147]
  ds_read_b64_tr_b16 v[78:79], v19 offset:512
  v_mfma_f32_16x16x32_bf16 a[148:151], v[200:203], v[116:119], a[148:151]
  v_mfma_f32_16x16x32_bf16 a[148:151], v[204:207], v[148:151], a[148:151]
  buffer_load_dwordx4 v6, s[8:11], s28 offen offset:2048  lds
  v_mfma_f32_16x16x32_bf16 a[152:155], v[200:203], v[120:123], a[152:155]
  v_mfma_f32_16x16x32_bf16 a[152:155], v[204:207], v[152:155], a[152:155]
  v_mfma_f32_16x16x32_bf16 a[156:159], v[200:203], v[124:127], a[156:159]
  v_mfma_f32_16x16x32_bf16 a[156:159], v[204:207], v[156:159], a[156:159]
  v_mfma_f32_16x16x32_bf16 a[188:191], v[208:211], v[124:127], a[188:191]
  v_mfma_f32_16x16x32_bf16 a[188:191], v[212:215], v[156:159], a[188:191]
  buffer_load_dwordx4 v7, s[8:11], s28 offen offset:3072  lds
  v_mfma_f32_16x16x32_bf16 a[184:187], v[208:211], v[120:123], a[184:187]
  s_add_u32 m0, s29, s34
  v_mfma_f32_16x16x32_bf16 a[184:187], v[212:215], v[152:155], a[184:187]
  s_add_u32 s35, s28, s32
  v_mfma_f32_16x16x32_bf16 a[180:183], v[208:211], v[116:119], a[180:183]
  v_mfma_f32_16x16x32_bf16 a[180:183], v[212:215], v[148:151], a[180:183]
  v_mfma_f32_16x16x32_bf16 a[176:179], v[208:211], v[112:115], a[176:179]
  v_mfma_f32_16x16x32_bf16 a[176:179], v[212:215], v[144:147], a[176:179]
  buffer_load_dwordx4 v4, s[8:11], s35 offen offset:0  lds
  v_mfma_f32_16x16x32_bf16 a[172:175], v[208:211], v[108:111], a[172:175]
  v_mfma_f32_16x16x32_bf16 a[172:175], v[212:215], v[140:143], a[172:175]
  v_mfma_f32_16x16x32_bf16 a[168:171], v[208:211], v[104:107], a[168:171]
  v_mfma_f32_16x16x32_bf16 a[168:171], v[212:215], v[136:139], a[168:171]
  v_mfma_f32_16x16x32_bf16 a[164:167], v[208:211], v[100:103], a[164:167]
  v_mfma_f32_16x16x32_bf16 a[164:167], v[212:215], v[132:135], a[164:167]
  buffer_load_dwordx4 v5, s[8:11], s35 offen offset:1024  lds
  v_mfma_f32_16x16x32_bf16 a[160:163], v[208:211], v[96:99], a[160:163]
  v_mfma_f32_16x16x32_bf16 a[160:163], v[212:215], v[128:131], a[160:163]
  v_mfma_f32_16x16x32_bf16 a[192:195], v[216:219], v[96:99], a[192:195]
  v_mfma_f32_16x16x32_bf16 a[192:195], v[220:223], v[128:131], a[192:195]
  v_mfma_f32_16x16x32_bf16 a[196:199], v[216:219], v[100:103], a[196:199]
  v_mfma_f32_16x16x32_bf16 a[196:199], v[220:223], v[132:135], a[196:199]
  buffer_load_dwordx4 v6, s[8:11], s35 offen offset:2048  lds
  v_mfma_f32_16x16x32_bf16 a[200:203], v[216:219], v[104:107], a[200:203]
  v_mfma_f32_16x16x32_bf16 a[200:203], v[220:223], v[136:139], a[200:203]
  v_mfma_f32_16x16x32_bf16 a[204:207], v[216:219], v[108:111], a[204:207]
  v_mfma_f32_16x16x32_bf16 a[204:207], v[220:223], v[140:143], a[204:207]
  v_mfma_f32_16x16x32_bf16 a[208:211], v[216:219], v[112:115], a[208:211]
  v_mfma_f32_16x16x32_bf16 a[208:211], v[220:223], v[144:147], a[208:211]
  buffer_load_dwordx4 v7, s[8:11], s35 offen offset:3072  lds
  v_mfma_f32_16x16x32_bf16 a[212:215], v[216:219], v[116:119], a[212:215]
  s_add_u32 s26, s26, 128
  v_mfma_f32_16x16x32_bf16 a[212:215], v[220:223], v[148:151], a[212:215]
  s_and_b32 s26, s26, 0x7ff
  v_mfma_f32_16x16x32_bf16 a[216:219], v[216:219], v[120:123], a[216:219]
  s_add_u32 s28, s6, s26
  v_mfma_f32_16x16x32_bf16 a[216:219], v[220:223], v[152:155], a[216:219]
  s_add_u32 s29, s29, 0x8000
  v_mfma_f32_16x16x32_bf16 a[220:223], v[216:219], v[124:127], a[220:223]
  s_cmp_eq_u32 s29, 0x18000
  v_mfma_f32_16x16x32_bf16 a[220:223], v[220:223], v[156:159], a[220:223]
  s_cselect_b32 s29, 0, s29
  v_mfma_f32_16x16x32_bf16 a[252:255], v[232:235], v[124:127], a[252:255]
  v_mfma_f32_16x16x32_bf16 a[252:255], v[236:239], v[156:159], a[252:255]
  v_lshl_add_u64 v[160:161], v[162:163], 0, v[160:161]
  v_mfma_f32_16x16x32_bf16 a[248:251], v[232:235], v[120:123], a[248:251]
  v_mfma_f32_16x16x32_bf16 a[248:251], v[236:239], v[152:155], a[248:251]
  v_mov_b32 v162, v164
  v_mfma_f32_16x16x32_bf16 a[244:247], v[232:235], v[116:119], a[244:247]
  v_mfma_f32_16x16x32_bf16 a[244:247], v[236:239], v[148:151], a[244:247]
  v_mfma_f32_16x16x32_bf16 a[240:243], v[232:235], v[112:115], a[240:243]
  v_mfma_f32_16x16x32_bf16 a[240:243], v[236:239], v[144:147], a[240:243]
  v_mfma_f32_16x16x32_bf16 a[236:239], v[232:235], v[108:111], a[236:239]
  v_mfma_f32_16x16x32_bf16 a[236:239], v[236:239], v[140:143], a[236:239]
  v_mfma_f32_16x16x32_bf16 a[232:235], v[232:235], v[104:107], a[232:235]
  v_mfma_f32_16x16x32_bf16 a[232:235], v[236:239], v[136:139], a[232:235]
  v_mfma_f32_16x16x32_bf16 a[228:231], v[232:235], v[100:103], a[228:231]
  v_mfma_f32_16x16x32_bf16 a[228:231], v[236:239], v[132:135], a[228:231]
  v_mfma_f32_16x16x32_bf16 a[224:227], v[232:235], v[96:99], a[224:227]
  v_mfma_f32_16x16x32_bf16 a[224:227], v[236:239], v[128:131], a[224:227]
  s_branch K1_Q
.p2align 6
K1_V:
  ds_read_b128 v[168:171], v14 offset:0
  ds_read_b128 v[172:175], v15 offset:0
  ds_read_b64_tr_b16 v[32:33], v16 offset:0
  ds_read_b64_tr_b16 v[34:35], v16 offset:512
  ds_read_b64_tr_b16 v[64:65], v16 offset:16384
  ds_read_b64_tr_b16 v[66:67], v16 offset:16896
  ds_read_b128 v[176:179], v14 offset:2048
  ds_read_b128 v[180:183], v15 offset:2048
  ds_read_b64_tr_b16 v[36:37], v17 offset:0
  ds_read_b64_tr_b16 v[38:39], v17 offset:512
  ds_read_b64_tr_b16 v[68:69], v17 offset:16384
  ds_read_b64_tr_b16 v[70:71], v17 offset:16896
  ds_read_b128 v[184:187], v14 offset:4096
  ds_read_b128 v[188:191], v15 offset:4096
  ds_read_b64_tr_b16 v[40:41], v18 offset:0
  ds_read_b64_tr_b16 v[42:43], v18 offset:512
  ds_read_b64_tr_b16 v[72:73], v18 offset:16384
  ds_read_b64_tr_b16 v[74:75], v18 offset:16896
  ds_read_b128 v[192:195], v14 offset:6144
  ds_read_b128 v[196:199], v15 offset:6144
  ds_read_b64_tr_b16 v[44:45], v19 offset:0
  ds_read_b64_tr_b16 v[46:47], v19 offset:512
  ds_read_b64_tr_b16 v[76:77], v19 offset:16384
  ds_read_b64_tr_b16 v[78:79], v19 offset:16896
  ds_read_b128 v[200:203], v14 offset:8192
  ds_read_b128 v[204:207], v15 offset:8192
  ds_read_b64_tr_b16 v[48:49], v16 offset:4096
  ds_read_b64_tr_b16 v[50:51], v16 offset:4608
  ds_read_b64_tr_b16 v[80:81], v16 offset:20480
  ds_read_b64_tr_b16 v[82:83], v16 offset:20992
  ds_read_b128 v[208:211], v14 offset:10240
  ds_read_b128 v[212:215], v15 offset:10240
  ds_read_b64_tr_b16 v[52:53], v17 offset:4096
  ds_read_b64_tr_b16 v[54:55], v17 offset:4608
  ds_read_b64_tr_b16 v[84:85], v17 offset:20480
  ds_read_b64_tr_b16 v[86:87], v17 offset:20992
  ds_read_b128 v[216:219], v14 offset:12288
  ds_read_b128 v[220:223], v15 offset:12288
  ds_read_b64_tr_b16 v[56:57], v18 offset:4096
  ds_read_b64_tr_b16 v[58:59], v18 offset:4608
  ds_read_b64_tr_b16 v[88:89], v18 offset:20480
  ds_read_b64_tr_b16 v[90:91], v18 offset:20992
  ds_read_b128 v[224:227], v14 offset:14336
  ds_read_b128 v[228:231], v15 offset:14336
  ds_read_b64_tr_b16 v[60:61], v19 offset:4096
  ds_read_b64_tr_b16 v[62:63], v19 offset:4608
  ds_read_b64_tr_b16 v[92:93], v19 offset:20480
  ds_read_b64_tr_b16 v[94:95], v19 offset:20992
.p2align 6
K1_V_loop:
  s_waitcnt vmcnt(18) lgkmcnt(0)
  s_barrier
  v_mfma_f32_16x16x32_bf16 a[0:3], v[168:171], v[32:35], a[0:3]
  s_add_u32 s30, s30, 0x8000
  v_mfma_f32_16x16x32_bf16 a[0:3], v[172:175], v[64:67], a[0:3]
  s_cmp_eq_u32 s30, 0x18000
  global_load_dword v23, v[160:161], off offset:0
  v_mfma_f32_16x16x32_bf16 a[4:7], v[168:171], v[36:39], a[4:7]
  s_cselect_b32 s30, 0, s30
  v_mfma_f32_16x16x32_bf16 a[4:7], v[172:175], v[68:71], a[4:7]
  v_add_u32 v14, s30, v12
  v_add_u32 v15, s30, v13
  v_mfma_f32_16x16x32_bf16 a[8:11], v[168:171], v[40:43], a[8:11]
  ds_read_b128 v[232:235], v14 offset:14336
  ds_read_b128 v[236:239], v15 offset:14336
  v_mfma_f32_16x16x32_bf16 a[8:11], v[172:175], v[72:75], a[8:11]
  s_add_u32 m0, s25, 0
  v_mfma_f32_16x16x32_bf16 a[12:15], v[168:171], v[44:47], a[12:15]
  v_mfma_f32_16x16x32_bf16 a[12:15], v[172:175], v[76:79], a[12:15]
  buffer_load_dwordx4 v8, s[12:15], s27 offen offset:0 nt lds
  v_mfma_f32_16x16x32_bf16 a[16:19], v[168:171], v[48:51], a[16:19]
  v_mfma_f32_16x16x32_bf16 a[16:19], v[172:175], v[80:83], a[16:19]
  v_mfma_f32_16x16x32_bf16 a[20:23], v[168:171], v[52:55], a[20:23]
  v_mfma_f32_16x16x32_bf16 a[20:23], v[172:175], v[84:87], a[20:23]
  v_mfma_f32_16x16x32_bf16 a[24:27], v[168:171], v[56:59], a[24:27]
  v_mfma_f32_16x16x32_bf16 a[24:27], v[172:175], v[88:91], a[24:27]
  buffer_load_dwordx4 v9, s[12:15], s27 offen offset:1024 nt lds
  v_mfma_f32_16x16x32_bf16 a[28:31], v[168:171], v[60:63], a[28:31]
  v_mfma_f32_16x16x32_bf16 a[28:31], v[172:175], v[92:95], a[28:31]
  v_mfma_f32_16x16x32_bf16 a[60:63], v[176:179], v[60:63], a[60:63]
  ds_read_b128 v[168:171], v14 offset:0
  v_mfma_f32_16x16x32_bf16 a[60:63], v[180:183], v[92:95], a[60:63]
  ds_read_b128 v[172:175], v15 offset:0
  v_mfma_f32_16x16x32_bf16 a[56:59], v[176:179], v[56:59], a[56:59]
  v_mfma_f32_16x16x32_bf16 a[56:59], v[180:183], v[88:91], a[56:59]
  buffer_load_dwordx4 v10, s[12:15], s27 offen offset:2048 nt lds
  v_mfma_f32_16x16x32_bf16 a[52:55], v[176:179], v[52:55], a[52:55]
  v_mfma_f32_16x16x32_bf16 a[52:55], v[180:183], v[84:87], a[52:55]
  v_mfma_f32_16x16x32_bf16 a[48:51], v[176:179], v[48:51], a[48:51]
  v_mfma_f32_16x16x32_bf16 a[48:51], v[180:183], v[80:83], a[48:51]
  v_mfma_f32_16x16x32_bf16 a[44:47], v[176:179], v[44:47], a[44:47]
  v_mfma_f32_16x16x32_bf16 a[44:47], v[180:183], v[76:79], a[44:47]
  buffer_load_dwordx4 v11, s[12:15], s27 offen offset:3072 nt lds
  v_mfma_f32_16x16x32_bf16 a[40:43], v[176:179], v[40:43], a[40:43]
  s_add_u32 s27, s27, 0x40000
  v_mfma_f32_16x16x32_bf16 a[40:43], v[180:183], v[72:75], a[40:43]
  s_and_b32 s27, s27, 0x7fffff
  v_mfma_f32_16x16x32_bf16 a[36:39], v[176:179], v[36:39], a[36:39]
  s_add_u32 m0, s25, 16384
  v_mfma_f32_16x16x32_bf16 a[36:39], v[180:183], v[68:71], a[36:39]
  v_mfma_f32_16x16x32_bf16 a[32:35], v[176:179], v[32:35], a[32:35]
  v_mfma_f32_16x16x32_bf16 a[32:35], v[180:183], v[64:67], a[32:35]
  v_mfma_f32_16x16x32_bf16 a[64:67], v[184:187], v[32:35], a[64:67]
  ds_read_b128 v[176:179], v14 offset:2048
  v_mfma_f32_16x16x32_bf16 a[64:67], v[188:191], v[64:67], a[64:67]
  buffer_load_dwordx4 v8, s[12:15], s27 offen offset:0 nt lds
  v_mfma_f32_16x16x32_bf16 a[68:71], v[184:187], v[36:39], a[68:71]
  ds_read_b128 v[180:183], v15 offset:2048
  v_mfma_f32_16x16x32_bf16 a[68:71], v[188:191], v[68:71], a[68:71]
  v_mfma_f32_16x16x32_bf16 a[72:75], v[184:187], v[40:43], a[72:75]
  v_mfma_f32_16x16x32_bf16 a[72:75], v[188:191], v[72:75], a[72:75]
  v_mfma_f32_16x16x32_bf16 a[76:79], v[184:187], v[44:47], a[76:79]
  v_mfma_f32_16x16x32_bf16 a[76:79], v[188:191], v[76:79], a[76:79]
  buffer_load_dwordx4 v9, s[12:15], s27 offen offset:1024 nt lds
  v_mfma_f32_16x16x32_bf16 a[80:83], v[184:187], v[48:51], a[80:83]
  v_mfma_f32_16x16x32_bf16 a[80:83], v[188:191], v[80:83], a[80:83]
  v_mfma_f32_16x16x32_bf16 a[84:87], v[184:187], v[52:55], a[84:87]
  v_mfma_f32_16x16x32_bf16 a[84:87], v[188:191], v[84:87], a[84:87]
  v_mfma_f32_16x16x32_bf16 a[88:91], v[184:187], v[56:59], a[88:91]
  v_mfma_f32_16x16x32_bf16 a[88:91], v[188:191], v[88:91], a[88:91]
  buffer_load_dwordx4 v10, s[12:15], s27 offen offset:2048 nt lds
  v_mfma_f32_16x16x32_bf16 a[92:95], v[184:187], v[60:63], a[92:95]
  v_mfma_f32_16x16x32_bf16 a[92:95], v[188:191], v[92:95], a[92:95]
  v_mfma_f32_16x16x32_bf16 a[124:127], v[192:195], v[60:63], a[124:127]
  ds_read_b128 v[184:187], v14 offset:4096
  v_mfma_f32_16x16x32_bf16 a[124:127], v[196:199], v[92:95], a[124:127]
  ds_read_b128 v[188:191], v15 offset:4096
  v_mfma_f32_16x16x32_bf16 a[120:123], v[192:195], v[56:59], a[120:123]
  v_mfma_f32_16x16x32_bf16 a[120:123], v[196:199], v[88:91], a[120:123]
  buffer_load_dwordx4 v11, s[12:15], s27 offen offset:3072 nt lds
  v_mfma_f32_16x16x32_bf16 a[116:119], v[192:195], v[52:55], a[116:119]
  s_add_u32 s27, s27, 0x40000
  v_mfma_f32_16x16x32_bf16 a[116:119], v[196:199], v[84:87], a[116:119]
  s_and_b32 s27, s27, 0x7fffff
  v_mfma_f32_16x16x32_bf16 a[112:115], v[192:195], v[48:51], a[112:115]
  v_mfma_f32_16x16x32_bf16 a[112:115], v[196:199], v[80:83], a[112:115]
  s_waitcnt vmcnt(18)
  s_barrier
  v_mfma_f32_16x16x32_bf16 a[108:111], v[192:195], v[44:47], a[108:111]
  ds_read_b64_tr_b16 v[96:97], v16 offset:32768
  v_mfma_f32_16x16x32_bf16 a[108:111], v[196:199], v[76:79], a[108:111]
  global_load_dword v23, v[160:161], off offset:128
  v_mfma_f32_16x16x32_bf16 a[104:107], v[192:195], v[40:43], a[104:107]
  s_add_u32 m0, s29, s33
  ds_read_b64_tr_b16 v[98:99], v16 offset:33280
  v_mfma_f32_16x16x32_bf16 a[104:107], v[196:199], v[72:75], a[104:107]
  ds_read_b64_tr_b16 v[128:129], v16 offset:49152
  v_mfma_f32_16x16x32_bf16 a[100:103], v[192:195], v[36:39], a[100:103]
  v_mfma_f32_16x16x32_bf16 a[100:103], v[196:199], v[68:71], a[100:103]
  ds_read_b64_tr_b16 v[130:131], v16 offset:49664
  v_mfma_f32_16x16x32_bf16 a[96:99], v[192:195], v[32:35], a[96:99]
  v_mfma_f32_16x16x32_bf16 a[96:99], v[196:199], v[64:67], a[96:99]
  buffer_load_dwordx4 v4, s[8:11], s28 offen offset:0  lds
  v_mfma_f32_16x16x32_bf16 a[128:131], v[200:203], v[32:35], a[128:131]
  ds_read_b128 v[192:195], v14 offset:6144
  ds_read_b64_tr_b16 v[100:101], v17 offset:32768
  v_mfma_f32_16x16x32_bf16 a[128:131], v[204:207], v[64:67], a[128:131]
  ds_read_b128 v[196:199], v15 offset:6144
  ds_read_b64_tr_b16 v[102:103], v17 offset:33280
  v_mfma_f32_16x16x32_bf16 a[132:135], v[200:203], v[36:39], a[132:135]
  v_mfma_f32_16x16x32_bf16 a[132:135], v[204:207], v[68:71], a[132:135]
  ds_read_b64_tr_b16 v[132:133], v17 offset:49152
  v_mfma_f32_16x16x32_bf16 a[136:139], v[200:203], v[40:43], a[136:139]
  v_mfma_f32_16x16x32_bf16 a[136:139], v[204:207], v[72:75], a[136:139]
  buffer_load_dwordx4 v5, s[8:11], s28 offen offset:1024  lds
  v_mfma_f32_16x16x32_bf16 a[140:143], v[200:203], v[44:47], a[140:143]
  ds_read_b64_tr_b16 v[134:135], v17 offset:49664
  v_mfma_f32_16x16x32_bf16 a[140:143], v[204:207], v[76:79], a[140:143]
  ds_read_b64_tr_b16 v[104:105], v18 offset:32768
  v_mfma_f32_16x16x32_bf16 a[144:147], v[200:203], v[48:51], a[144:147]
  v_mfma_f32_16x16x32_bf16 a[144:147], v[204:207], v[80:83], a[144:147]
  ds_read_b64_tr_b16 v[106:107], v18 offset:33280
  v_mfma_f32_16x16x32_bf16 a[148:151], v[200:203], v[52:55], a[148:151]
  v_mfma_f32_16x16x32_bf16 a[148:151], v[204:207], v[84:87], a[148:151]
  buffer_load_dwordx4 v6, s[8:11], s28 offen offset:2048  lds
  v_mfma_f32_16x16x32_bf16 a[152:155], v[200:203], v[56:59], a[152:155]
  ds_read_b64_tr_b16 v[136:137], v18 offset:49152
  v_mfma_f32_16x16x32_bf16 a[152:155], v[204:207], v[88:91], a[152:155]
  ds_read_b64_tr_b16 v[138:139], v18 offset:49664
  v_mfma_f32_16x16x32_bf16 a[156:159], v[200:203], v[60:63], a[156:159]
  v_mfma_f32_16x16x32_bf16 a[156:159], v[204:207], v[92:95], a[156:159]
  ds_read_b64_tr_b16 v[108:109], v19 offset:32768
  v_mfma_f32_16x16x32_bf16 a[188:191], v[208:211], v[60:63], a[188:191]
  ds_read_b128 v[200:203], v14 offset:8192
  v_mfma_f32_16x16x32_bf16 a[188:191], v[212:215], v[92:95], a[188:191]
  buffer_load_dwordx4 v7, s[8:11], s28 offen offset:3072  lds
  v_mfma_f32_16x16x32_bf16 a[184:187], v[208:211], v[56:59], a[184:187]
  s_add_u32 m0, s29, s34
  ds_read_b128 v[204:207], v15 offset:8192
  ds_read_b64_tr_b16 v[110:111], v19 offset:33280
  v_mfma_f32_16x16x32_bf16 a[184:187], v[212:215], v[88:91], a[184:187]
  s_add_u32 s35, s28, s32
  ds_read_b64_tr_b16 v[140:141], v19 offset:49152
  v_mfma_f32_16x16x32_bf16 a[180:183], v[208:211], v[52:55], a[180:183]
  v_mfma_f32_16x16x32_bf16 a[180:183], v[212:215], v[84:87], a[180:183]
  ds_read_b64_tr_b16 v[142:143], v19 offset:49664
  v_mfma_f32_16x16x32_bf16 a[176:179], v[208:211], v[48:51], a[176:179]
  v_mfma_f32_16x16x32_bf16 a[176:179], v[212:215], v[80:83], a[176:179]
  buffer_load_dwordx4 v4, s[8:11], s35 offen offset:0  lds
  v_mfma_f32_16x16x32_bf16 a[172:175], v[208:211], v[44:47], a[172:175]
  ds_read_b64_tr_b16 v[112:113], v16 offset:36864
  v_mfma_f32_16x16x32_bf16 a[172:175], v[212:215], v[76:79], a[172:175]
  ds_read_b64_tr_b16 v[114:115], v16 offset:37376
  v_mfma_f32_16x16x32_bf16 a[168:171], v[208:211], v[40:43], a[168:171]
  v_mfma_f32_16x16x32_bf16 a[168:171], v[212:215], v[72:75], a[168:171]
  ds_read_b64_tr_b16 v[144:145], v16 offset:53248
  v_mfma_f32_16x16x32_bf16 a[164:167], v[208:211], v[36:39], a[164:167]
  v_mfma_f32_16x16x32_bf16 a[164:167], v[212:215], v[68:71], a[164:167]
  buffer_load_dwordx4 v5, s[8:11], s35 offen offset:1024  lds
  v_mfma_f32_16x16x32_bf16 a[160:163], v[208:211], v[32:35], a[160:163]
  ds_read_b64_tr_b16 v[146:147], v16 offset:53760
  v_mfma_f32_16x16x32_bf16 a[160:163], v[212:215], v[64:67], a[160:163]
  ds_read_b64_tr_b16 v[116:117], v17 offset:36864
  v_mfma_f32_16x16x32_bf16 a[192:195], v[216:219], v[32:35], a[192:195]
  ds_read_b128 v[208:211], v14 offset:10240
  v_mfma_f32_16x16x32_bf16 a[192:195], v[220:223], v[64:67], a[192:195]
  ds_read_b128 v[212:215], v15 offset:10240
  ds_read_b64_tr_b16 v[118:119], v17 offset:37376
  v_mfma_f32_16x16x32_bf16 a[196:199], v[216:219], v[36:39], a[196:199]
  v_mfma_f32_16x16x32_bf16 a[196:199], v[220:223], v[68:71], a[196:199]
  buffer_load_dwordx4 v6, s[8:11], s35 offen offset:2048  lds
  v_mfma_f32_16x16x32_bf16 a[200:203], v[216:219], v[40:43], a[200:203]
  ds_read_b64_tr_b16 v[148:149], v17 offset:53248
  v_mfma_f32_16x16x32_bf16 a[200:203], v[220:223], v[72:75], a[200:203]
  ds_read_b64_tr_b16 v[150:151], v17 offset:53760
  v_mfma_f32_16x16x32_bf16 a[204:207], v[216:219], v[44:47], a[204:207]
  v_mfma_f32_16x16x32_bf16 a[204:207], v[220:223], v[76:79], a[204:207]
  ds_read_b64_tr_b16 v[120:121], v18 offset:36864
  v_mfma_f32_16x16x32_bf16 a[208:211], v[216:219], v[48:51], a[208:211]
  v_mfma_f32_16x16x32_bf16 a[208:211], v[220:223], v[80:83], a[208:211]
  buffer_load_dwordx4 v7, s[8:11], s35 offen offset:3072  lds
  v_mfma_f32_16x16x32_bf16 a[212:215], v[216:219], v[52:55], a[212:215]
  s_add_u32 s26, s26, 128
  ds_read_b64_tr_b16 v[122:123], v18 offset:37376
  v_mfma_f32_16x16x32_bf16 a[212:215], v[220:223], v[84:87], a[212:215]
  s_and_b32 s26, s26, 0x7ff
  ds_read_b64_tr_b16 v[152:153], v18 offset:53248
  v_mfma_f32_16x16x32_bf16 a[216:219], v[216:219], v[56:59], a[216:219]
  s_add_u32 s28, s6, s26
  v_mfma_f32_16x16x32_bf16 a[216:219], v[220:223], v[88:91], a[216:219]
  s_add_u32 s29, s29, 0x8000
  ds_read_b64_tr_b16 v[154:155], v18 offset:53760
  v_mfma_f32_16x16x32_bf16 a[220:223], v[216:219], v[60:63], a[220:223]
  s_cmp_eq_u32 s29, 0x18000
  v_mfma_f32_16x16x32_bf16 a[220:223], v[220:223], v[92:95], a[220:223]
  s_cselect_b32 s29, 0, s29
  ds_read_b64_tr_b16 v[124:125], v19 offset:36864
  v_mfma_f32_16x16x32_bf16 a[252:255], v[224:227], v[60:63], a[252:255]
  s_cmp_eq_u32 s31, s85
  ds_read_b128 v[216:219], v14 offset:12288
  v_mfma_f32_16x16x32_bf16 a[252:255], v[228:231], v[92:95], a[252:255]
  s_cselect_b32 s49, 0, 0x7fff0000
  ds_read_b128 v[220:223], v15 offset:12288
  ds_read_b64_tr_b16 v[126:127], v19 offset:37376
  v_mfma_f32_16x16x32_bf16 a[248:251], v[224:227], v[56:59], a[248:251]
  v_mfma_f32_16x16x32_bf16 a[248:251], v[228:231], v[88:91], a[248:251]
  ds_read_b64_tr_b16 v[156:157], v19 offset:53248
  v_mfma_f32_16x16x32_bf16 a[244:247], v[224:227], v[52:55], a[244:247]
  v_mfma_f32_16x16x32_bf16 a[244:247], v[228:231], v[84:87], a[244:247]
  ds_read_b64_tr_b16 v[158:159], v19 offset:53760
  v_mfma_f32_16x16x32_bf16 a[240:243], v[224:227], v[48:51], a[240:243]
  v_mfma_f32_16x16x32_bf16 a[240:243], v[228:231], v[80:83], a[240:243]
  v_mfma_f32_16x16x32_bf16 a[236:239], v[224:227], v[44:47], a[236:239]
  v_mfma_f32_16x16x32_bf16 a[236:239], v[228:231], v[76:79], a[236:239]
  buffer_store_byte v165, v166, s[92:95], s49 offen sc1
  v_mfma_f32_16x16x32_bf16 a[232:235], v[224:227], v[40:43], a[232:235]
  v_mfma_f32_16x16x32_bf16 a[232:235], v[228:231], v[72:75], a[232:235]
  v_mfma_f32_16x16x32_bf16 a[228:231], v[224:227], v[36:39], a[228:231]
  v_mfma_f32_16x16x32_bf16 a[228:231], v[228:231], v[68:71], a[228:231]
  s_cmp_eq_u32 s31, s50
  v_mfma_f32_16x16x32_bf16 a[224:227], v[224:227], v[32:35], a[224:227]
  v_mfma_f32_16x16x32_bf16 a[224:227], v[228:231], v[64:67], a[224:227]
  s_cbranch_scc1 K1_V_swx
K1_V_swx_back:
  s_waitcnt vmcnt(18) lgkmcnt(0)
  s_barrier
  v_mfma_f32_16x16x32_bf16 a[0:3], v[168:171], v[96:99], a[0:3]
  s_add_u32 s30, s30, 0x8000
  v_mfma_f32_16x16x32_bf16 a[0:3], v[172:175], v[128:131], a[0:3]
  s_cmp_eq_u32 s30, 0x18000
  global_load_dword v23, v[160:161], off offset:256
  v_mfma_f32_16x16x32_bf16 a[4:7], v[168:171], v[100:103], a[4:7]
  s_cselect_b32 s30, 0, s30
  v_mfma_f32_16x16x32_bf16 a[4:7], v[172:175], v[132:135], a[4:7]
  v_add_u32 v14, s30, v12
  v_add_u32 v15, s30, v13
  v_mfma_f32_16x16x32_bf16 a[8:11], v[168:171], v[104:107], a[8:11]
  ds_read_b128 v[224:227], v14 offset:14336
  ds_read_b128 v[228:231], v15 offset:14336
  v_mfma_f32_16x16x32_bf16 a[8:11], v[172:175], v[136:139], a[8:11]
  s_add_u32 m0, s25, 32768
  v_mfma_f32_16x16x32_bf16 a[12:15], v[168:171], v[108:111], a[12:15]
  v_mfma_f32_16x16x32_bf16 a[12:15], v[172:175], v[140:143], a[12:15]
  buffer_load_dwordx4 v8, s[12:15], s27 offen offset:0 nt lds
  v_mfma_f32_16x16x32_bf16 a[16:19], v[168:171], v[112:115], a[16:19]
  v_mfma_f32_16x16x32_bf16 a[16:19], v[172:175], v[144:147], a[16:19]
  v_mfma_f32_16x16x32_bf16 a[20:23], v[168:171], v[116:119], a[20:23]
  v_mfma_f32_16x16x32_bf16 a[20:23], v[172:175], v[148:151], a[20:23]
  v_mfma_f32_16x16x32_bf16 a[24:27], v[168:171], v[120:123], a[24:27]
  v_mfma_f32_16x16x32_bf16 a[24:27], v[172:175], v[152:155], a[24:27]
  buffer_load_dwordx4 v9, s[12:15], s27 offen offset:1024 nt lds
  v_mfma_f32_16x16x32_bf16 a[28:31], v[168:171], v[124:127], a[28:31]
  v_mfma_f32_16x16x32_bf16 a[28:31], v[172:175], v[156:159], a[28:31]
  v_mfma_f32_16x16x32_bf16 a[60:63], v[176:179], v[124:127], a[60:63]
  ds_read_b128 v[168:171], v14 offset:0
  v_mfma_f32_16x16x32_bf16 a[60:63], v[180:183], v[156:159], a[60:63]
  ds_read_b128 v[172:175], v15 offset:0
  v_mfma_f32_16x16x32_bf16 a[56:59], v[176:179], v[120:123], a[56:59]
  v_mfma_f32_16x16x32_bf16 a[56:59], v[180:183], v[152:155], a[56:59]
  buffer_load_dwordx4 v10, s[12:15], s27 offen offset:2048 nt lds
  v_mfma_f32_16x16x32_bf16 a[52:55], v[176:179], v[116:119], a[52:55]
  v_mfma_f32_16x16x32_bf16 a[52:55], v[180:183], v[148:151], a[52:55]
  v_mfma_f32_16x16x32_bf16 a[48:51], v[176:179], v[112:115], a[48:51]
  v_mfma_f32_16x16x32_bf16 a[48:51], v[180:183], v[144:147], a[48:51]
  v_mfma_f32_16x16x32_bf16 a[44:47], v[176:179], v[108:111], a[44:47]
  v_mfma_f32_16x16x32_bf16 a[44:47], v[180:183], v[140:143], a[44:47]
  buffer_load_dwordx4 v11, s[12:15], s27 offen offset:3072 nt lds
  v_mfma_f32_16x16x32_bf16 a[40:43], v[176:179], v[104:107], a[40:43]
  s_add_u32 s27, s27, 0x40000
  v_mfma_f32_16x16x32_bf16 a[40:43], v[180:183], v[136:139], a[40:43]
  s_and_b32 s27, s27, 0x7fffff
  v_mfma_f32_16x16x32_bf16 a[36:39], v[176:179], v[100:103], a[36:39]
  s_add_u32 m0, s25, 49152
  v_mfma_f32_16x16x32_bf16 a[36:39], v[180:183], v[132:135], a[36:39]
  v_mfma_f32_16x16x32_bf16 a[32:35], v[176:179], v[96:99], a[32:35]
  v_mfma_f32_16x16x32_bf16 a[32:35], v[180:183], v[128:131], a[32:35]
  v_mfma_f32_16x16x32_bf16 a[64:67], v[184:187], v[96:99], a[64:67]
  ds_read_b128 v[176:179], v14 offset:2048
  v_mfma_f32_16x16x32_bf16 a[64:67], v[188:191], v[128:131], a[64:67]
  buffer_load_dwordx4 v8, s[12:15], s27 offen offset:0 nt lds
  v_mfma_f32_16x16x32_bf16 a[68:71], v[184:187], v[100:103], a[68:71]
  ds_read_b128 v[180:183], v15 offset:2048
  v_mfma_f32_16x16x32_bf16 a[68:71], v[188:191], v[132:135], a[68:71]
  v_mfma_f32_16x16x32_bf16 a[72:75], v[184:187], v[104:107], a[72:75]
  v_mfma_f32_16x16x32_bf16 a[72:75], v[188:191], v[136:139], a[72:75]
  v_mfma_f32_16x16x32_bf16 a[76:79], v[184:187], v[108:111], a[76:79]
  v_mfma_f32_16x16x32_bf16 a[76:79], v[188:191], v[140:143], a[76:79]
  buffer_load_dwordx4 v9, s[12:15], s27 offen offset:1024 nt lds
  v_mfma_f32_16x16x32_bf16 a[80:83], v[184:187], v[112:115], a[80:83]
  v_mfma_f32_16x16x32_bf16 a[80:83], v[188:191], v[144:147], a[80:83]
  v_mfma_f32_16x16x32_bf16 a[84:87], v[184:187], v[116:119], a[84:87]
  v_mfma_f32_16x16x32_bf16 a[84:87], v[188:191], v[148:151], a[84:87]
  v_mfma_f32_16x16x32_bf16 a[88:91], v[184:187], v[120:123], a[88:91]
  v_mfma_f32_16x16x32_bf16 a[88:91], v[188:191], v[152:155], a[88:91]
  buffer_load_dwordx4 v10, s[12:15], s27 offen offset:2048 nt lds
  v_mfma_f32_16x16x32_bf16 a[92:95], v[184:187], v[124:127], a[92:95]
  v_mfma_f32_16x16x32_bf16 a[92:95], v[188:191], v[156:159], a[92:95]
  v_mfma_f32_16x16x32_bf16 a[124:127], v[192:195], v[124:127], a[124:127]
  ds_read_b128 v[184:187], v14 offset:4096
  v_mfma_f32_16x16x32_bf16 a[124:127], v[196:199], v[156:159], a[124:127]
  ds_read_b128 v[188:191], v15 offset:4096
  v_mfma_f32_16x16x32_bf16 a[120:123], v[192:195], v[120:123], a[120:123]
  v_mfma_f32_16x16x32_bf16 a[120:123], v[196:199], v[152:155], a[120:123]
  buffer_load_dwordx4 v11, s[12:15], s27 offen offset:3072 nt lds
  v_mfma_f32_16x16x32_bf16 a[116:119], v[192:195], v[116:119], a[116:119]
  s_add_u32 s27, s27, 0x40000
  v_mfma_f32_16x16x32_bf16 a[116:119], v[196:199], v[148:151], a[116:119]
  s_and_b32 s27, s27, 0x7fffff
  v_mfma_f32_16x16x32_bf16 a[112:115], v[192:195], v[112:115], a[112:115]
  v_mfma_f32_16x16x32_bf16 a[112:115], v[196:199], v[144:147], a[112:115]
  s_waitcnt vmcnt(18)
  s_barrier
  v_mfma_f32_16x16x32_bf16 a[108:111], v[192:195], v[108:111], a[108:111]
  ds_read_b64_tr_b16 v[32:33], v16 offset:0
  v_mfma_f32_16x16x32_bf16 a[108:111], v[196:199], v[140:143], a[108:111]
  global_load_dword v23, v[160:161], off offset:384
  v_mfma_f32_16x16x32_bf16 a[104:107], v[192:195], v[104:107], a[104:107]
  s_add_u32 m0, s29, s33
  ds_read_b64_tr_b16 v[34:35], v16 offset:512
  v_mfma_f32_16x16x32_bf16 a[104:107], v[196:199], v[136:139], a[104:107]
  ds_read_b64_tr_b16 v[64:65], v16 offset:16384
  v_mfma_f32_16x16x32_bf16 a[100:103], v[192:195], v[100:103], a[100:103]
  v_mfma_f32_16x16x32_bf16 a[100:103], v[196:199], v[132:135], a[100:103]
  ds_read_b64_tr_b16 v[66:67], v16 offset:16896
  v_mfma_f32_16x16x32_bf16 a[96:99], v[192:195], v[96:99], a[96:99]
  v_mfma_f32_16x16x32_bf16 a[96:99], v[196:199], v[128:131], a[96:99]
  buffer_load_dwordx4 v4, s[8:11], s28 offen offset:0  lds
  v_mfma_f32_16x16x32_bf16 a[128:131], v[200:203], v[96:99], a[128:131]
  ds_read_b128 v[192:195], v14 offset:6144
  ds_read_b64_tr_b16 v[36:37], v17 offset:0
  v_mfma_f32_16x16x32_bf16 a[128:131], v[204:207], v[128:131], a[128:131]
  ds_read_b128 v[196:199], v15 offset:6144
  ds_read_b64_tr_b16 v[38:39], v17 offset:512
  v_mfma_f32_16x16x32_bf16 a[132:135], v[200:203], v[100:103], a[132:135]
  v_mfma_f32_16x16x32_bf16 a[132:135], v[204:207], v[132:135], a[132:135]
  ds_read_b64_tr_b16 v[68:69], v17 offset:16384
  v_mfma_f32_16x16x32_bf16 a[136:139], v[200:203], v[104:107], a[136:139]
  v_mfma_f32_16x16x32_bf16 a[136:139], v[204:207], v[136:139], a[136:139]
  buffer_load_dwordx4 v5, s[8:11], s28 offen offset:1024  lds
  v_mfma_f32_16x16x32_bf16 a[140:143], v[200:203], v[108:111], a[140:143]
  ds_read_b64_tr_b16 v[70:71], v17 offset:16896
  v_mfma_f32_16x16x32_bf16 a[140:143], v[204:207], v[140:143], a[140:143]
  ds_read_b64_tr_b16 v[40:41], v18 offset:0
  v_mfma_f32_16x16x32_bf16 a[144:147], v[200:203], v[112:115], a[144:147]
  v_mfma_f32_16x16x32_bf16 a[144:147], v[204:207], v[144:147], a[144:147]
  ds_read_b64_tr_b16 v[42:43], v18 offset:512
  v_mfma_f32_16x16x32_bf16 a[148:151], v[200:203], v[116:119], a[148:151]
  v_mfma_f32_16x16x32_bf16 a[148:151], v[204:207], v[148:151], a[148:151]
  buffer_load_dwordx4 v6, s[8:11], s28 offen offset:2048  lds
  v_mfma_f32_16x16x32_bf16 a[152:155], v[200:203], v[120:123], a[152:155]
  ds_read_b64_tr_b16 v[72:73], v18 offset:16384
  v_mfma_f32_16x16x32_bf16 a[152:155], v[204:207], v[152:155], a[152:155]
  ds_read_b64_tr_b16 v[74:75], v18 offset:16896
  v_mfma_f32_16x16x32_bf16 a[156:159], v[200:203], v[124:127], a[156:159]
  v_mfma_f32_16x16x32_bf16 a[156:159], v[204:207], v[156:159], a[156:159]
  ds_read_b64_tr_b16 v[44:45], v19 offset:0
  v_mfma_f32_16x16x32_bf16 a[188:191], v[208:211], v[124:127], a[188:191]
  ds_read_b128 v[200:203], v14 offset:8192
  v_mfma_f32_16x16x32_bf16 a[188:191], v[212:215], v[156:159], a[188:191]
  buffer_load_dwordx4 v7, s[8:11], s28 offen offset:3072  lds
  v_mfma_f32_16x16x32_bf16 a[184:187], v[208:211], v[120:123], a[184:187]
  s_add_u32 m0, s29, s34
  ds_read_b128 v[204:207], v15 offset:8192
  ds_read_b64_tr_b16 v[46:47], v19 offset:512
  v_mfma_f32_16x16x32_bf16 a[184:187], v[212:215], v[152:155], a[184:187]
  s_add_u32 s35, s28, s32
  ds_read_b64_tr_b16 v[76:77], v19 offset:16384
  v_mfma_f32_16x16x32_bf16 a[180:183], v[208:211], v[116:119], a[180:183]
  v_mfma_f32_16x16x32_bf16 a[180:183], v[212:215], v[148:151], a[180:183]
  ds_read_b64_tr_b16 v[78:79], v19 offset:16896
  v_mfma_f32_16x16x32_bf16 a[176:179], v[208:211], v[112:115], a[176:179]
  v_mfma_f32_16x16x32_bf16 a[176:179], v[212:215], v[144:147], a[176:179]
  buffer_load_dwordx4 v4, s[8:11], s35 offen offset:0  lds
  v_mfma_f32_16x16x32_bf16 a[172:175], v[208:211], v[108:111], a[172:175]
  ds_read_b64_tr_b16 v[48:49], v16 offset:4096
  v_mfma_f32_16x16x32_bf16 a[172:175], v[212:215], v[140:143], a[172:175]
  ds_read_b64_tr_b16 v[50:51], v16 offset:4608
  v_mfma_f32_16x16x32_bf16 a[168:171], v[208:211], v[104:107], a[168:171]
  v_mfma_f32_16x16x32_bf16 a[168:171], v[212:215], v[136:139], a[168:171]
  ds_read_b64_tr_b16 v[80:81], v16 offset:20480
  v_mfma_f32_16x16x32_bf16 a[164:167], v[208:211], v[100:103], a[164:167]
  v_mfma_f32_16x16x32_bf16 a[164:167], v[212:215], v[132:135], a[164:167]
  buffer_load_dwordx4 v5, s[8:11], s35 offen offset:1024  lds
  v_mfma_f32_16x16x32_bf16 a[160:163], v[208:211], v[96:99], a[160:163]
  ds_read_b64_tr_b16 v[82:83], v16 offset:20992
  v_mfma_f32_16x16x32_bf16 a[160:163], v[212:215], v[128:131], a[160:163]
  ds_read_b64_tr_b16 v[52:53], v17 offset:4096
  v_mfma_f32_16x16x32_bf16 a[192:195], v[216:219], v[96:99], a[192:195]
  ds_read_b128 v[208:211], v14 offset:10240
  v_mfma_f32_16x16x32_bf16 a[192:195], v[220:223], v[128:131], a[192:195]
  ds_read_b128 v[212:215], v15 offset:10240
  ds_read_b64_tr_b16 v[54:55], v17 offset:4608
  v_mfma_f32_16x16x32_bf16 a[196:199], v[216:219], v[100:103], a[196:199]
  v_mfma_f32_16x16x32_bf16 a[196:199], v[220:223], v[132:135], a[196:199]
  buffer_load_dwordx4 v6, s[8:11], s35 offen offset:2048  lds
  v_mfma_f32_16x16x32_bf16 a[200:203], v[216:219], v[104:107], a[200:203]
  ds_read_b64_tr_b16 v[84:85], v17 offset:20480
  v_mfma_f32_16x16x32_bf16 a[200:203], v[220:223], v[136:139], a[200:203]
  ds_read_b64_tr_b16 v[86:87], v17 offset:20992
  v_mfma_f32_16x16x32_bf16 a[204:207], v[216:219], v[108:111], a[204:207]
  v_mfma_f32_16x16x32_bf16 a[204:207], v[220:223], v[140:143], a[204:207]
  ds_read_b64_tr_b16 v[56:57], v18 offset:4096
  v_mfma_f32_16x16x32_bf16 a[208:211], v[216:219], v[112:115], a[208:211]
  v_mfma_f32_16x16x32_bf16 a[208:211], v[220:223], v[144:147], a[208:211]
  buffer_load_dwordx4 v7, s[8:11], s35 offen offset:3072  lds
  v_mfma_f32_16x16x32_bf16 a[212:215], v[216:219], v[116:119], a[212:215]
  s_add_u32 s26, s26, 128
  ds_read_b64_tr_b16 v[58:59], v18 offset:4608
  v_mfma_f32_16x16x32_bf16 a[212:215], v[220:223], v[148:151], a[212:215]
  s_and_b32 s26, s26, 0x7ff
  ds_read_b64_tr_b16 v[88:89], v18 offset:20480
  v_mfma_f32_16x16x32_bf16 a[216:219], v[216:219], v[120:123], a[216:219]
  s_add_u32 s28, s6, s26
  v_mfma_f32_16x16x32_bf16 a[216:219], v[220:223], v[152:155], a[216:219]
  s_add_u32 s29, s29, 0x8000
  ds_read_b64_tr_b16 v[90:91], v18 offset:20992
  v_mfma_f32_16x16x32_bf16 a[220:223], v[216:219], v[124:127], a[220:223]
  s_cmp_eq_u32 s29, 0x18000
  v_mfma_f32_16x16x32_bf16 a[220:223], v[220:223], v[156:159], a[220:223]
  s_cselect_b32 s29, 0, s29
  ds_read_b64_tr_b16 v[60:61], v19 offset:4096
  v_mfma_f32_16x16x32_bf16 a[252:255], v[232:235], v[124:127], a[252:255]
  ds_read_b128 v[216:219], v14 offset:12288
  v_mfma_f32_16x16x32_bf16 a[252:255], v[236:239], v[156:159], a[252:255]
  v_lshl_add_u64 v[160:161], v[162:163], 0, v[160:161]
  v_mfma_f32_16x16x32_bf16 a[248:251], v[232:235], v[120:123], a[248:251]
  ds_read_b128 v[220:223], v15 offset:12288
  ds_read_b64_tr_b16 v[62:63], v19 offset:4608
  v_mfma_f32_16x16x32_bf16 a[248:251], v[236:239], v[152:155], a[248:251]
  v_mov_b32 v162, v164
  ds_read_b64_tr_b16 v[92:93], v19 offset:20480
  v_mfma_f32_16x16x32_bf16 a[244:247], v[232:235], v[116:119], a[244:247]
  v_mfma_f32_16x16x32_bf16 a[244:247], v[236:239], v[148:151], a[244:247]
  ds_read_b64_tr_b16 v[94:95], v19 offset:20992
  v_mfma_f32_16x16x32_bf16 a[240:243], v[232:235], v[112:115], a[240:243]
  v_mfma_f32_16x16x32_bf16 a[240:243], v[236:239], v[144:147], a[240:243]
  s_cmp_eq_u32 s31, 6
  v_mfma_f32_16x16x32_bf16 a[236:239], v[232:235], v[108:111], a[236:239]
  s_cselect_b32 s12, s40, s12
  v_mfma_f32_16x16x32_bf16 a[236:239], v[236:239], v[140:143], a[236:239]
  s_cselect_b32 s13, s7, s13
  v_mfma_f32_16x16x32_bf16 a[232:235], v[232:235], v[104:107], a[232:235]
  s_cselect_b32 s14, 0x380000, s14
  v_mfma_f32_16x16x32_bf16 a[232:235], v[236:239], v[136:139], a[232:235]
  s_cselect_b32 s27, s51, s27
  v_mfma_f32_16x16x32_bf16 a[228:231], v[232:235], v[100:103], a[228:231]
  s_add_u32 s31, s31, 1
  v_mfma_f32_16x16x32_bf16 a[228:231], v[236:239], v[132:135], a[228:231]
  s_cmp_lt_u32 s31, 8
  v_mfma_f32_16x16x32_bf16 a[224:227], v[232:235], v[96:99], a[224:227]
  v_mfma_f32_16x16x32_bf16 a[224:227], v[236:239], v[128:131], a[224:227]
  s_branch K1_V_loop
K1_V_last:
  s_waitcnt vmcnt(18) lgkmcnt(0)
  s_barrier
  v_mfma_f32_16x16x32_bf16 a[0:3], v[168:171], v[96:99], a[0:3]
  s_add_u32 s30, s30, 0x8000
  v_subrev_u32 v12, s58, v12
  v_mfma_f32_16x16x32_bf16 a[0:3], v[172:175], v[128:131], a[0:3]
  s_cmp_eq_u32 s30, 0x18000
  global_load_dword v23, v[160:161], off offset:256
  v_mfma_f32_16x16x32_bf16 a[4:7], v[168:171], v[100:103], a[4:7]
  s_cselect_b32 s30, 0, s30
  v_xor_b32 v13, 64, v12
  v_mfma_f32_16x16x32_bf16 a[4:7], v[172:175], v[132:135], a[4:7]
  v_add_u32 v14, s30, v12
  v_mfma_f32_16x16x32_bf16 a[8:11], v[168:171], v[104:107], a[8:11]
  v_add_u32 v16, s45, v16
  v_add_u32 v17, s45, v17
  v_mfma_f32_16x16x32_bf16 a[8:11], v[172:175], v[136:139], a[8:11]
  s_add_u32 m0, s25, 32768
  v_add_u32 v18, s45, v18
  v_add_u32 v19, s45, v19
  v_mfma_f32_16x16x32_bf16 a[12:15], v[168:171], v[108:111], a[12:15]
  v_mfma_f32_16x16x32_bf16 a[12:15], v[172:175], v[140:143], a[12:15]
  buffer_load_dwordx4 v8, s[12:15], s27 offen offset:0 nt lds
  v_mfma_f32_16x16x32_bf16 a[16:19], v[168:171], v[112:115], a[16:19]
  ds_read_b128 v[32:35], v14 offset:0
  v_mfma_f32_16x16x32_bf16 a[16:19], v[172:175], v[144:147], a[16:19]
  v_mfma_f32_16x16x32_bf16 a[20:23], v[168:171], v[116:119], a[20:23]
  ds_read_b128 v[36:39], v14 offset:2048
  v_mfma_f32_16x16x32_bf16 a[20:23], v[172:175], v[148:151], a[20:23]
  v_mfma_f32_16x16x32_bf16 a[24:27], v[168:171], v[120:123], a[24:27]
  v_mfma_f32_16x16x32_bf16 a[24:27], v[172:175], v[152:155], a[24:27]
  buffer_load_dwordx4 v9, s[12:15], s27 offen offset:1024 nt lds
  v_mfma_f32_16x16x32_bf16 a[28:31], v[168:171], v[124:127], a[28:31]
  ds_read_b128 v[40:43], v14 offset:4096
  v_mfma_f32_16x16x32_bf16 a[28:31], v[172:175], v[156:159], a[28:31]
  v_mfma_f32_16x16x32_bf16 a[60:63], v[176:179], v[124:127], a[60:63]
  ds_read_b128 v[44:47], v14 offset:6144
  v_mfma_f32_16x16x32_bf16 a[60:63], v[180:183], v[156:159], a[60:63]
  v_mfma_f32_16x16x32_bf16 a[56:59], v[176:179], v[120:123], a[56:59]
  v_mfma_f32_16x16x32_bf16 a[56:59], v[180:183], v[152:155], a[56:59]
  buffer_load_dwordx4 v10, s[12:15], s27 offen offset:2048 nt lds
  v_mfma_f32_16x16x32_bf16 a[52:55], v[176:179], v[116:119], a[52:55]
  ds_read_b128 v[48:51], v14 offset:8192
  v_mfma_f32_16x16x32_bf16 a[52:55], v[180:183], v[148:151], a[52:55]
  v_mfma_f32_16x16x32_bf16 a[48:51], v[176:179], v[112:115], a[48:51]
  ds_read_b128 v[52:55], v14 offset:10240
  v_mfma_f32_16x16x32_bf16 a[48:51], v[180:183], v[144:147], a[48:51]
  v_mfma_f32_16x16x32_bf16 a[44:47], v[176:179], v[108:111], a[44:47]
  v_mfma_f32_16x16x32_bf16 a[44:47], v[180:183], v[140:143], a[44:47]
  buffer_load_dwordx4 v11, s[12:15], s27 offen offset:3072 nt lds
  v_mfma_f32_16x16x32_bf16 a[40:43], v[176:179], v[104:107], a[40:43]
  s_add_u32 s27, s27, 0x40000
  ds_read_b128 v[56:59], v14 offset:12288
  v_mfma_f32_16x16x32_bf16 a[40:43], v[180:183], v[136:139], a[40:43]
  s_and_b32 s27, s27, 0x7fffff
  v_mfma_f32_16x16x32_bf16 a[36:39], v[176:179], v[100:103], a[36:39]
  s_add_u32 m0, s25, 49152
  ds_read_b128 v[60:63], v14 offset:14336
  v_mfma_f32_16x16x32_bf16 a[36:39], v[180:183], v[132:135], a[36:39]
  v_mfma_f32_16x16x32_bf16 a[32:35], v[176:179], v[96:99], a[32:35]
  v_mfma_f32_16x16x32_bf16 a[32:35], v[180:183], v[128:131], a[32:35]
  v_mfma_f32_16x16x32_bf16 a[64:67], v[184:187], v[96:99], a[64:67]
  v_mfma_f32_16x16x32_bf16 a[64:67], v[188:191], v[128:131], a[64:67]
  buffer_load_dwordx4 v8, s[12:15], s27 offen offset:0 nt lds
  v_mfma_f32_16x16x32_bf16 a[68:71], v[184:187], v[100:103], a[68:71]
  v_mfma_f32_16x16x32_bf16 a[68:71], v[188:191], v[132:135], a[68:71]
  v_mfma_f32_16x16x32_bf16 a[72:75], v[184:187], v[104:107], a[72:75]
  v_mfma_f32_16x16x32_bf16 a[72:75], v[188:191], v[136:139], a[72:75]
  v_mfma_f32_16x16x32_bf16 a[76:79], v[184:187], v[108:111], a[76:79]
  v_mfma_f32_16x16x32_bf16 a[76:79], v[188:191], v[140:143], a[76:79]
  buffer_load_dwordx4 v9, s[12:15], s27 offen offset:1024 nt lds
  v_mfma_f32_16x16x32_bf16 a[80:83], v[184:187], v[112:115], a[80:83]
  v_mfma_f32_16x16x32_bf16 a[80:83], v[188:191], v[144:147], a[80:83]
  v_mfma_f32_16x16x32_bf16 a[84:87], v[184:187], v[116:119], a[84:87]
  v_mfma_f32_16x16x32_bf16 a[84:87], v[188:191], v[148:151], a[84:87]
  v_mfma_f32_16x16x32_bf16 a[88:91], v[184:187], v[120:123], a[88:91]
  v_mfma_f32_16x16x32_bf16 a[88:91], v[188:191], v[152:155], a[88:91]
  buffer_load_dwordx4 v10, s[12:15], s27 offen offset:2048 nt lds
  v_mfma_f32_16x16x32_bf16 a[92:95], v[184:187], v[124:127], a[92:95]
  v_mfma_f32_16x16x32_bf16 a[92:95], v[188:191], v[156:159], a[92:95]
  v_mfma_f32_16x16x32_bf16 a[124:127], v[192:195], v[124:127], a[124:127]
  v_mfma_f32_16x16x32_bf16 a[124:127], v[196:199], v[156:159], a[124:127]
  v_mfma_f32_16x16x32_bf16 a[120:123], v[192:195], v[120:123], a[120:123]
  v_mfma_f32_16x16x32_bf16 a[120:123], v[196:199], v[152:155], a[120:123]
  buffer_load_dwordx4 v11, s[12:15], s27 offen offset:3072 nt lds
  v_mfma_f32_16x16x32_bf16 a[116:119], v[192:195], v[116:119], a[116:119]
  s_add_u32 s27, s27, 0x40000
  v_mfma_f32_16x16x32_bf16 a[116:119], v[196:199], v[148:151], a[116:119]
  s_and_b32 s27, s27, 0x7fffff
  v_mfma_f32_16x16x32_bf16 a[112:115], v[192:195], v[112:115], a[112:115]
  v_mfma_f32_16x16x32_bf16 a[112:115], v[196:199], v[144:147], a[112:115]
  s_waitcnt vmcnt(18)
  s_barrier
  v_mfma_f32_16x16x32_bf16 a[108:111], v[192:195], v[108:111], a[108:111]
  ds_read_b64_tr_b16 v[64:65], v16 offset:0
  v_mfma_f32_16x16x32_bf16 a[108:111], v[196:199], v[140:143], a[108:111]
  global_load_dword v23, v[160:161], off offset:384
  v_mfma_f32_16x16x32_bf16 a[104:107], v[192:195], v[104:107], a[104:107]
  s_add_u32 m0, s29, s33
  ds_read_b64_tr_b16 v[66:67], v16 offset:512
  v_mfma_f32_16x16x32_bf16 a[104:107], v[196:199], v[136:139], a[104:107]
  v_mfma_f32_16x16x32_bf16 a[100:103], v[192:195], v[100:103], a[100:103]
  v_mfma_f32_16x16x32_bf16 a[100:103], v[196:199], v[132:135], a[100:103]
  ds_read_b64_tr_b16 v[68:69], v17 offset:0
  v_mfma_f32_16x16x32_bf16 a[96:99], v[192:195], v[96:99], a[96:99]
  v_mfma_f32_16x16x32_bf16 a[96:99], v[196:199], v[128:131], a[96:99]
  buffer_load_dwordx4 v4, s[8:11], s28 offen offset:0  lds
  v_mfma_f32_16x16x32_bf16 a[128:131], v[200:203], v[96:99], a[128:131]
  ds_read_b64_tr_b16 v[70:71], v17 offset:512
  v_mfma_f32_16x16x32_bf16 a[128:131], v[204:207], v[128:131], a[128:131]
  v_mfma_f32_16x16x32_bf16 a[132:135], v[200:203], v[100:103], a[132:135]
  ds_read_b64_tr_b16 v[72:73], v18 offset:0
  v_mfma_f32_16x16x32_bf16 a[132:135], v[204:207], v[132:135], a[132:135]
  v_mfma_f32_16x16x32_bf16 a[136:139], v[200:203], v[104:107], a[136:139]
  ds_read_b64_tr_b16 v[74:75], v18 offset:512
  v_mfma_f32_16x16x32_bf16 a[136:139], v[204:207], v[136:139], a[136:139]
  buffer_load_dwordx4 v5, s[8:11], s28 offen offset:1024  lds
  v_mfma_f32_16x16x32_bf16 a[140:143], v[200:203], v[108:111], a[140:143]
  v_mfma_f32_16x16x32_bf16 a[140:143], v[204:207], v[140:143], a[140:143]
  ds_read_b64_tr_b16 v[76:77], v19 offset:0
  v_mfma_f32_16x16x32_bf16 a[144:147], v[200:203], v[112:115], a[144:147]
  v_mfma_f32_16x16x32_bf16 a[144:147], v[204:207], v[144:147], a[144:147]
  ds_read_b64_tr_b16 v[78:79], v19 offset:512
  v_mfma_f32_16x16x32_bf16 a[148:151], v[200:203], v[116:119], a[148:151]
  v_mfma_f32_16x16x32_bf16 a[148:151], v[204:207], v[148:151], a[148:151]
  buffer_load_dwordx4 v6, s[8:11], s28 offen offset:2048  lds
  v_mfma_f32_16x16x32_bf16 a[152:155], v[200:203], v[120:123], a[152:155]
  v_mfma_f32_16x16x32_bf16 a[152:155], v[204:207], v[152:155], a[152:155]
  v_mfma_f32_16x16x32_bf16 a[156:159], v[200:203], v[124:127], a[156:159]
  v_mfma_f32_16x16x32_bf16 a[156:159], v[204:207], v[156:159], a[156:159]
  v_mfma_f32_16x16x32_bf16 a[188:191], v[208:211], v[124:127], a[188:191]
  v_mfma_f32_16x16x32_bf16 a[188:191], v[212:215], v[156:159], a[188:191]
  buffer_load_dwordx4 v7, s[8:11], s28 offen offset:3072  lds
  v_mfma_f32_16x16x32_bf16 a[184:187], v[208:211], v[120:123], a[184:187]
  s_add_u32 m0, s29, s34
  v_mfma_f32_16x16x32_bf16 a[184:187], v[212:215], v[152:155], a[184:187]
  s_add_u32 s35, s28, s32
  v_mfma_f32_16x16x32_bf16 a[180:183], v[208:211], v[116:119], a[180:183]
  v_mfma_f32_16x16x32_bf16 a[180:183], v[212:215], v[148:151], a[180:183]
  v_mfma_f32_16x16x32_bf16 a[176:179], v[208:211], v[112:115], a[176:179]
  v_mfma_f32_16x16x32_bf16 a[176:179], v[212:215], v[144:147], a[176:179]
  buffer_load_dwordx4 v4, s[8:11], s35 offen offset:0  lds
  v_mfma_f32_16x16x32_bf16 a[172:175], v[208:211], v[108:111], a[172:175]
  v_mfma_f32_16x16x32_bf16 a[172:175], v[212:215], v[140:143], a[172:175]
  v_mfma_f32_16x16x32_bf16 a[168:171], v[208:211], v[104:107], a[168:171]
  v_mfma_f32_16x16x32_bf16 a[168:171], v[212:215], v[136:139], a[168:171]
  v_mfma_f32_16x16x32_bf16 a[164:167], v[208:211], v[100:103], a[164:167]
  v_mfma_f32_16x16x32_bf16 a[164:167], v[212:215], v[132:135], a[164:167]
  buffer_load_dwordx4 v5, s[8:11], s35 offen offset:1024  lds
  v_mfma_f32_16x16x32_bf16 a[160:163], v[208:211], v[96:99], a[160:163]
  v_mfma_f32_16x16x32_bf16 a[160:163], v[212:215], v[128:131], a[160:163]
  v_mfma_f32_16x16x32_bf16 a[192:195], v[216:219], v[96:99], a[192:195]
  v_mfma_f32_16x16x32_bf16 a[192:195], v[220:223], v[128:131], a[192:195]
  v_mfma_f32_16x16x32_bf16 a[196:199], v[216:219], v[100:103], a[196:199]
  v_mfma_f32_16x16x32_bf16 a[196:199], v[220:223], v[132:135], a[196:199]
  buffer_load_dwordx4 v6, s[8:11], s35 offen offset:2048  lds
  v_mfma_f32_16x16x32_bf16 a[200:203], v[216:219], v[104:107], a[200:203]
  v_mfma_f32_16x16x32_bf16 a[200:203], v[220:223], v[136:139], a[200:203]
  v_mfma_f32_16x16x32_bf16 a[204:207], v[216:219], v[108:111], a[204:207]
  v_mfma_f32_16x16x32_bf16 a[204:207], v[220:223], v[140:143], a[204:207]
  v_mfma_f32_16x16x32_bf16 a[208:211], v[216:219], v[112:115], a[208:211]
  v_mfma_f32_16x16x32_bf16 a[208:211], v[220:223], v[144:147], a[208:211]
  buffer_load_dwordx4 v7, s[8:11], s35 offen offset:3072  lds
  v_mfma_f32_16x16x32_bf16 a[212:215], v[216:219], v[116:119], a[212:215]
  s_add_u32 s26, s26, 128
  v_mfma_f32_16x16x32_bf16 a[212:215], v[220:223], v[148:151], a[212:215]
  s_and_b32 s26, s26, 0x7ff
  v_mfma_f32_16x16x32_bf16 a[216:219], v[216:219], v[120:123], a[216:219]
  s_add_u32 s28, s6, s26
  v_mfma_f32_16x16x32_bf16 a[216:219], v[220:223], v[152:155], a[216:219]
  s_add_u32 s29, s29, 0x8000
  v_mfma_f32_16x16x32_bf16 a[220:223], v[216:219], v[124:127], a[220:223]
  s_cmp_eq_u32 s29, 0x18000
  v_mfma_f32_16x16x32_bf16 a[220:223], v[220:223], v[156:159], a[220:223]
  s_cselect_b32 s29, 0, s29
  v_mfma_f32_16x16x32_bf16 a[252:255], v[232:235], v[124:127], a[252:255]
  v_mfma_f32_16x16x32_bf16 a[252:255], v[236:239], v[156:159], a[252:255]
  v_lshl_add_u64 v[160:161], v[162:163], 0, v[160:161]
  v_mfma_f32_16x16x32_bf16 a[248:251], v[232:235], v[120:123], a[248:251]
  v_mfma_f32_16x16x32_bf16 a[248:251], v[236:239], v[152:155], a[248:251]
  v_mov_b32 v162, v164
  v_mfma_f32_16x16x32_bf16 a[244:247], v[232:235], v[116:119], a[244:247]
  v_mfma_f32_16x16x32_bf16 a[244:247], v[236:239], v[148:151], a[244:247]
  v_mfma_f32_16x16x32_bf16 a[240:243], v[232:235], v[112:115], a[240:243]
  v_mfma_f32_16x16x32_bf16 a[240:243], v[236:239], v[144:147], a[240:243]
  v_mfma_f32_16x16x32_bf16 a[236:239], v[232:235], v[108:111], a[236:239]
  v_mfma_f32_16x16x32_bf16 a[236:239], v[236:239], v[140:143], a[236:239]
  v_mfma_f32_16x16x32_bf16 a[232:235], v[232:235], v[104:107], a[232:235]
  v_mfma_f32_16x16x32_bf16 a[232:235], v[236:239], v[136:139], a[232:235]
  v_mfma_f32_16x16x32_bf16 a[228:231], v[232:235], v[100:103], a[228:231]
  v_mfma_f32_16x16x32_bf16 a[228:231], v[236:239], v[132:135], a[228:231]
  v_mfma_f32_16x16x32_bf16 a[224:227], v[232:235], v[96:99], a[224:227]
  v_mfma_f32_16x16x32_bf16 a[224:227], v[236:239], v[128:131], a[224:227]
K1_Q:
  s_mov_b32 s48, s46
  s_mov_b32 s49, s47
  s_and_b32 s41, s55, 7
  s_and_b32 s3, s2, 7
  s_lshl_b32 s3, s3, 2
  s_lshr_b32 s40, s55, 3
  s_add_u32 s40, s40, s3
  s_mul_i32 s42, s40, 57344
  v_and_b32 v1, 63, v0
  v_lshrrev_b32 v2, 3, v1
  v_lshlrev_b32 v2, 2, v2
  v_add_u32 v2, s24, v2
  v_mul_u32_u24 v2, 896, v2
  v_lshrrev_b32 v3, 4, v1
  v_and_b32 v1, 7, v1
  v_xor_b32 v1, v1, v3
  v_lshlrev_b32 v1, 4, v1
  v_add_u32 v21, v2, v1
  v_xor_b32 v1, 64, v1
  v_add_u32 v22, v2, v1
  v_add_u32 v22, 27648, v22
  s_lshl_b32 s43, s24, 11
  s_mov_b32 s20, s96
  s_and_b32 s21, s97, 0xffff
  s_mov_b32 s22, 0x1c0000
  s_mov_b32 s23, 0x20000
  s_waitcnt vmcnt(28) lgkmcnt(0)
  s_barrier
  v_mfma_f32_16x16x32_bf16 v[128:131], v[64:67], v[32:35], 0
  s_add_u32 m0, s25, 0
  v_add_u32 v14, 0x8000, v13
  ds_read_b64_tr_b16 v[112:113], v16 offset:16384
  v_mfma_f32_16x16x32_bf16 v[132:135], v[64:67], v[36:39], 0
  buffer_load_dwordx4 v8, s[12:15], s27 offen offset:0  lds
  v_mfma_f32_16x16x32_bf16 v[136:139], v[64:67], v[40:43], 0
  ds_read_b64_tr_b16 v[114:115], v16 offset:16896
  v_accvgpr_read_b32 v24, a0
  v_mfma_f32_16x16x32_bf16 v[140:143], v[64:67], v[44:47], 0
  buffer_load_dwordx4 v9, s[12:15], s27 offen offset:1024  lds
  v_mfma_f32_16x16x32_bf16 v[144:147], v[64:67], v[48:51], 0
  ds_read_b128 v[80:83], v14 offset:0
  v_accvgpr_read_b32 v25, a1
  v_mfma_f32_16x16x32_bf16 v[148:151], v[64:67], v[52:55], 0
  buffer_load_dwordx4 v10, s[12:15], s27 offen offset:2048  lds
  v_mfma_f32_16x16x32_bf16 v[152:155], v[64:67], v[56:59], 0
  ds_read_b128 v[84:87], v14 offset:2048
  ds_read_b64_tr_b16 v[116:117], v17 offset:16384
  v_mfma_f32_16x16x32_bf16 v[156:159], v[64:67], v[60:63], 0
  buffer_load_dwordx4 v11, s[12:15], s27 offen offset:3072  lds
  v_mfma_f32_16x16x32_bf16 v[188:191], v[68:71], v[60:63], 0
  s_add_u32 s27, s27, 0x40000
  ds_read_b64_tr_b16 v[118:119], v17 offset:16896
  v_accvgpr_read_b32 v26, a2
  v_mfma_f32_16x16x32_bf16 v[184:187], v[68:71], v[56:59], 0
  v_accvgpr_read_b32 v27, a3
  v_cvt_pk_bf16_f32 v28, v24, v25
  v_mfma_f32_16x16x32_bf16 v[180:183], v[68:71], v[52:55], 0
  ds_read_b128 v[88:91], v14 offset:4096
  v_cvt_pk_bf16_f32 v29, v26, v27
  v_mfma_f32_16x16x32_bf16 v[176:179], v[68:71], v[48:51], 0
  ds_read_b128 v[92:95], v14 offset:6144
  v_accvgpr_read_b32 v24, a32
  v_mfma_f32_16x16x32_bf16 v[172:175], v[68:71], v[44:47], 0
  v_accvgpr_read_b32 v25, a33
  v_accvgpr_read_b32 v26, a34
  v_mfma_f32_16x16x32_bf16 v[168:171], v[68:71], v[40:43], 0
  ds_read_b64_tr_b16 v[120:121], v18 offset:16384
  v_accvgpr_read_b32 v27, a35
  v_mfma_f32_16x16x32_bf16 v[164:167], v[68:71], v[36:39], 0
  v_cvt_pk_bf16_f32 v30, v24, v25
  v_cvt_pk_bf16_f32 v31, v26, v27
  v_mfma_f32_16x16x32_bf16 v[160:163], v[68:71], v[32:35], 0
  ds_read_b64_tr_b16 v[122:123], v18 offset:16896
  v_mfma_f32_16x16x32_bf16 v[192:195], v[72:75], v[32:35], 0
  ds_read_b128 v[96:99], v14 offset:8192
  v_mfma_f32_16x16x32_bf16 v[196:199], v[72:75], v[36:39], 0
  buffer_store_dwordx4 v[28:31], v20, s[16:19], s36 offen sc1
  v_mfma_f32_16x16x32_bf16 v[200:203], v[72:75], v[40:43], 0
  s_add_u32 s36, s36, s39
  ds_read_b128 v[100:103], v14 offset:10240
  v_accvgpr_read_b32 v24, a4
  v_mfma_f32_16x16x32_bf16 v[204:207], v[72:75], v[44:47], 0
  v_accvgpr_read_b32 v25, a5
  v_accvgpr_read_b32 v26, a6
  v_mfma_f32_16x16x32_bf16 v[208:211], v[72:75], v[48:51], 0
  ds_read_b64_tr_b16 v[124:125], v19 offset:16384
  v_accvgpr_read_b32 v27, a7
  v_mfma_f32_16x16x32_bf16 v[212:215], v[72:75], v[52:55], 0
  ds_read_b64_tr_b16 v[126:127], v19 offset:16896
  v_cvt_pk_bf16_f32 v28, v24, v25
  v_mfma_f32_16x16x32_bf16 v[216:219], v[72:75], v[56:59], 0
  v_cvt_pk_bf16_f32 v29, v26, v27
  v_accvgpr_read_b32 v24, a36
  v_mfma_f32_16x16x32_bf16 v[220:223], v[72:75], v[60:63], 0
  ds_read_b128 v[104:107], v14 offset:12288
  v_accvgpr_read_b32 v25, a37
  v_mfma_f32_16x16x32_bf16 v[252:255], v[76:79], v[60:63], 0
  v_accvgpr_read_b32 v26, a38
  v_accvgpr_read_b32 v27, a39
  v_mfma_f32_16x16x32_bf16 v[248:251], v[76:79], v[56:59], 0
  ds_read_b128 v[108:111], v14 offset:14336
  v_cvt_pk_bf16_f32 v30, v24, v25
  v_mfma_f32_16x16x32_bf16 v[244:247], v[76:79], v[52:55], 0
  v_cvt_pk_bf16_f32 v31, v26, v27
  v_mfma_f32_16x16x32_bf16 v[240:243], v[76:79], v[48:51], 0
  buffer_store_dwordx4 v[28:31], v20, s[16:19], s36 offen sc1
  v_mfma_f32_16x16x32_bf16 v[236:239], v[76:79], v[44:47], 0
  s_add_u32 s36, s36, s44
  v_accvgpr_read_b32 v24, a8
  v_accvgpr_read_b32 v25, a9
  v_mfma_f32_16x16x32_bf16 v[232:235], v[76:79], v[40:43], 0
  v_accvgpr_read_b32 v26, a10
  v_accvgpr_read_b32 v27, a11
  v_mfma_f32_16x16x32_bf16 v[228:231], v[76:79], v[36:39], 0
  v_cvt_pk_bf16_f32 v28, v24, v25
  v_mfma_f32_16x16x32_bf16 v[224:227], v[76:79], v[32:35], 0
  s_waitcnt vmcnt(19) lgkmcnt(0)
  s_barrier
  v_mfma_f32_16x16x32_bf16 v[128:131], v[112:115], v[80:83], v[128:131]
  s_add_u32 m0, s25, 16384
  v_add_u32 v14, 0x10000, v12
  ds_read_b64_tr_b16 v[64:65], v16 offset:32768
  v_mfma_f32_16x16x32_bf16 v[132:135], v[112:115], v[84:87], v[132:135]
  buffer_load_dwordx4 v8, s[12:15], s27 offen offset:0  lds
  v_mfma_f32_16x16x32_bf16 v[136:139], v[112:115], v[88:91], v[136:139]
  ds_read_b64_tr_b16 v[66:67], v16 offset:33280
  v_cvt_pk_bf16_f32 v29, v26, v27
  v_mfma_f32_16x16x32_bf16 v[140:143], v[112:115], v[92:95], v[140:143]
  buffer_load_dwordx4 v9, s[12:15], s27 offen offset:1024  lds
  v_mfma_f32_16x16x32_bf16 v[144:147], v[112:115], v[96:99], v[144:147]
  ds_read_b128 v[32:35], v14 offset:0
  v_accvgpr_read_b32 v24, a40
  v_mfma_f32_16x16x32_bf16 v[148:151], v[112:115], v[100:103], v[148:151]
  buffer_load_dwordx4 v10, s[12:15], s27 offen offset:2048  lds
  v_mfma_f32_16x16x32_bf16 v[152:155], v[112:115], v[104:107], v[152:155]
  ds_read_b128 v[36:39], v14 offset:2048
  ds_read_b64_tr_b16 v[68:69], v17 offset:32768
  v_mfma_f32_16x16x32_bf16 v[156:159], v[112:115], v[108:111], v[156:159]
  buffer_load_dwordx4 v11, s[12:15], s27 offen offset:3072  lds
  v_mfma_f32_16x16x32_bf16 v[188:191], v[116:119], v[108:111], v[188:191]
  s_add_u32 s27, s27, 0x40000
  ds_read_b64_tr_b16 v[70:71], v17 offset:33280
  v_accvgpr_read_b32 v25, a41
  v_mfma_f32_16x16x32_bf16 v[184:187], v[116:119], v[104:107], v[184:187]
  s_add_u32 m0, s33, 0x8000
  v_accvgpr_read_b32 v26, a42
  v_accvgpr_read_b32 v27, a43
  v_mfma_f32_16x16x32_bf16 v[180:183], v[116:119], v[100:103], v[180:183]
  ds_read_b128 v[40:43], v14 offset:4096
  v_cvt_pk_bf16_f32 v30, v24, v25
  v_mfma_f32_16x16x32_bf16 v[176:179], v[116:119], v[96:99], v[176:179]
  buffer_load_dwordx4 v4, s[8:11], s28 offen offset:0  lds
  v_mfma_f32_16x16x32_bf16 v[172:175], v[116:119], v[92:95], v[172:175]
  ds_read_b128 v[44:47], v14 offset:6144
  v_cvt_pk_bf16_f32 v31, v26, v27
  v_mfma_f32_16x16x32_bf16 v[168:171], v[116:119], v[88:91], v[168:171]
  buffer_load_dwordx4 v5, s[8:11], s28 offen offset:1024  lds
  v_mfma_f32_16x16x32_bf16 v[164:167], v[116:119], v[84:87], v[164:167]
  ds_read_b64_tr_b16 v[72:73], v18 offset:32768
  v_mfma_f32_16x16x32_bf16 v[160:163], v[116:119], v[80:83], v[160:163]
  buffer_load_dwordx4 v6, s[8:11], s28 offen offset:2048  lds
  v_mfma_f32_16x16x32_bf16 v[192:195], v[120:123], v[80:83], v[192:195]
  ds_read_b64_tr_b16 v[74:75], v18 offset:33280
  ds_read_b128 v[48:51], v14 offset:8192
  v_mfma_f32_16x16x32_bf16 v[196:199], v[120:123], v[84:87], v[196:199]
  buffer_load_dwordx4 v7, s[8:11], s28 offen offset:3072  lds
  v_mfma_f32_16x16x32_bf16 v[200:203], v[120:123], v[88:91], v[200:203]
  ds_read_b128 v[52:55], v14 offset:10240
  v_mfma_f32_16x16x32_bf16 v[204:207], v[120:123], v[92:95], v[204:207]
  buffer_store_dwordx4 v[28:31], v20, s[16:19], s36 offen sc1
  v_mfma_f32_16x16x32_bf16 v[208:211], v[120:123], v[96:99], v[208:211]
  s_add_u32 s36, s36, s39
  ds_read_b64_tr_b16 v[76:77], v19 offset:32768
  v_accvgpr_read_b32 v24, a12
  v_mfma_f32_16x16x32_bf16 v[212:215], v[120:123], v[100:103], v[212:215]
  ds_read_b64_tr_b16 v[78:79], v19 offset:33280
  v_accvgpr_read_b32 v25, a13
  v_mfma_f32_16x16x32_bf16 v[216:219], v[120:123], v[104:107], v[216:219]
  v_accvgpr_read_b32 v26, a14
  v_accvgpr_read_b32 v27, a15
  v_mfma_f32_16x16x32_bf16 v[220:223], v[120:123], v[108:111], v[220:223]
  ds_read_b128 v[56:59], v14 offset:12288
  v_cvt_pk_bf16_f32 v28, v24, v25
  v_mfma_f32_16x16x32_bf16 v[252:255], v[124:127], v[108:111], v[252:255]
  v_cvt_pk_bf16_f32 v29, v26, v27
  v_accvgpr_read_b32 v24, a44
  v_mfma_f32_16x16x32_bf16 v[248:251], v[124:127], v[104:107], v[248:251]
  ds_read_b128 v[60:63], v14 offset:14336
  v_accvgpr_read_b32 v25, a45
  v_mfma_f32_16x16x32_bf16 v[244:247], v[124:127], v[100:103], v[244:247]
  v_accvgpr_read_b32 v26, a46
  v_accvgpr_read_b32 v27, a47
  v_mfma_f32_16x16x32_bf16 v[240:243], v[124:127], v[96:99], v[240:243]
  v_cvt_pk_bf16_f32 v30, v24, v25
  v_cvt_pk_bf16_f32 v31, v26, v27
  v_mfma_f32_16x16x32_bf16 v[236:239], v[124:127], v[92:95], v[236:239]
  buffer_store_dwordx4 v[28:31], v20, s[16:19], s36 offen sc1
  v_mfma_f32_16x16x32_bf16 v[232:235], v[124:127], v[88:91], v[232:235]
  s_add_u32 s36, s36, s44
  v_accvgpr_read_b32 v24, a16
  v_accvgpr_read_b32 v25, a17
  v_mfma_f32_16x16x32_bf16 v[228:231], v[124:127], v[84:87], v[228:231]
  v_accvgpr_read_b32 v26, a18
  v_accvgpr_read_b32 v27, a19
  v_mfma_f32_16x16x32_bf16 v[224:227], v[124:127], v[80:83], v[224:227]
  v_cvt_pk_bf16_f32 v28, v24, v25
  v_cvt_pk_bf16_f32 v29, v26, v27
  s_waitcnt vmcnt(25) lgkmcnt(0)
  s_barrier
  v_mfma_f32_16x16x32_bf16 v[128:131], v[64:67], v[32:35], v[128:131]
  s_add_u32 m0, s25, 32768
  v_add_u32 v14, 0x10000, v13
  ds_read_b64_tr_b16 v[112:113], v16 offset:49152
  v_mfma_f32_16x16x32_bf16 v[132:135], v[64:67], v[36:39], v[132:135]
  buffer_load_dwordx4 v8, s[12:15], s27 offen offset:0  lds
  v_mfma_f32_16x16x32_bf16 v[136:139], v[64:67], v[40:43], v[136:139]
  ds_read_b64_tr_b16 v[114:115], v16 offset:49664
  v_accvgpr_read_b32 v24, a48
  v_mfma_f32_16x16x32_bf16 v[140:143], v[64:67], v[44:47], v[140:143]
  buffer_load_dwordx4 v9, s[12:15], s27 offen offset:1024  lds
  v_mfma_f32_16x16x32_bf16 v[144:147], v[64:67], v[48:51], v[144:147]
  ds_read_b128 v[80:83], v14 offset:0
  v_accvgpr_read_b32 v25, a49
  v_mfma_f32_16x16x32_bf16 v[148:151], v[64:67], v[52:55], v[148:151]
  buffer_load_dwordx4 v10, s[12:15], s27 offen offset:2048  lds
  v_mfma_f32_16x16x32_bf16 v[152:155], v[64:67], v[56:59], v[152:155]
  ds_read_b128 v[84:87], v14 offset:2048
  ds_read_b64_tr_b16 v[116:117], v17 offset:49152
  v_mfma_f32_16x16x32_bf16 v[156:159], v[64:67], v[60:63], v[156:159]
  buffer_load_dwordx4 v11, s[12:15], s27 offen offset:3072  lds
  v_mfma_f32_16x16x32_bf16 v[188:191], v[68:71], v[60:63], v[188:191]
  s_add_u32 s27, s27, 0x40000
  ds_read_b64_tr_b16 v[118:119], v17 offset:49664
  v_accvgpr_read_b32 v26, a50
  v_mfma_f32_16x16x32_bf16 v[184:187], v[68:71], v[56:59], v[184:187]
  s_add_u32 m0, s43, 49152
  v_accvgpr_read_b32 v27, a51
  v_cvt_pk_bf16_f32 v30, v24, v25
  v_mfma_f32_16x16x32_bf16 v[180:183], v[68:71], v[52:55], v[180:183]
  ds_read_b128 v[88:91], v14 offset:4096
  v_cvt_pk_bf16_f32 v31, v26, v27
  v_mfma_f32_16x16x32_bf16 v[176:179], v[68:71], v[48:51], v[176:179]
  buffer_load_dwordx4 v21, s[20:23], s42 offen offset:0  lds
  v_mfma_f32_16x16x32_bf16 v[172:175], v[68:71], v[44:47], v[172:175]
  ds_read_b128 v[92:95], v14 offset:6144
  v_mfma_f32_16x16x32_bf16 v[168:171], v[68:71], v[40:43], v[168:171]
  buffer_load_dwordx4 v22, s[20:23], s42 offen offset:1024  lds
  v_mfma_f32_16x16x32_bf16 v[164:167], v[68:71], v[36:39], v[164:167]
  s_add_u32 s42, s42, 128
  ds_read_b64_tr_b16 v[120:121], v18 offset:49152
  v_mfma_f32_16x16x32_bf16 v[160:163], v[68:71], v[32:35], v[160:163]
  ds_read_b64_tr_b16 v[122:123], v18 offset:49664
  v_mfma_f32_16x16x32_bf16 v[192:195], v[72:75], v[32:35], v[192:195]
  ds_read_b128 v[96:99], v14 offset:8192
  v_mfma_f32_16x16x32_bf16 v[196:199], v[72:75], v[36:39], v[196:199]
  buffer_store_dwordx4 v[28:31], v20, s[16:19], s36 offen sc1
  v_mfma_f32_16x16x32_bf16 v[200:203], v[72:75], v[40:43], v[200:203]
  s_add_u32 s36, s36, s39
  ds_read_b128 v[100:103], v14 offset:10240
  v_accvgpr_read_b32 v24, a20
  v_mfma_f32_16x16x32_bf16 v[204:207], v[72:75], v[44:47], v[204:207]
  v_accvgpr_read_b32 v25, a21
  v_accvgpr_read_b32 v26, a22
  v_mfma_f32_16x16x32_bf16 v[208:211], v[72:75], v[48:51], v[208:211]
  ds_read_b64_tr_b16 v[124:125], v19 offset:49152
  v_accvgpr_read_b32 v27, a23
  v_mfma_f32_16x16x32_bf16 v[212:215], v[72:75], v[52:55], v[212:215]
  ds_read_b64_tr_b16 v[126:127], v19 offset:49664
  v_cvt_pk_bf16_f32 v28, v24, v25
  v_mfma_f32_16x16x32_bf16 v[216:219], v[72:75], v[56:59], v[216:219]
  v_cvt_pk_bf16_f32 v29, v26, v27
  v_accvgpr_read_b32 v24, a52
  v_mfma_f32_16x16x32_bf16 v[220:223], v[72:75], v[60:63], v[220:223]
  ds_read_b128 v[104:107], v14 offset:12288
  v_accvgpr_read_b32 v25, a53
  v_mfma_f32_16x16x32_bf16 v[252:255], v[76:79], v[60:63], v[252:255]
  v_accvgpr_read_b32 v26, a54
  v_accvgpr_read_b32 v27, a55
  v_mfma_f32_16x16x32_bf16 v[248:251], v[76:79], v[56:59], v[248:251]
  ds_read_b128 v[108:111], v14 offset:14336
  v_cvt_pk_bf16_f32 v30, v24, v25
  v_mfma_f32_16x16x32_bf16 v[244:247], v[76:79], v[52:55], v[244:247]
  v_cvt_pk_bf16_f32 v31, v26, v27
  v_mfma_f32_16x16x32_bf16 v[240:243], v[76:79], v[48:51], v[240:243]
  buffer_store_dwordx4 v[28:31], v20, s[16:19], s36 offen sc1
  v_mfma_f32_16x16x32_bf16 v[236:239], v[76:79], v[44:47], v[236:239]
  s_add_u32 s36, s36, s44
  v_accvgpr_read_b32 v24, a24
  v_accvgpr_read_b32 v25, a25
  v_mfma_f32_16x16x32_bf16 v[232:235], v[76:79], v[40:43], v[232:235]
  v_accvgpr_read_b32 v26, a26
  v_accvgpr_read_b32 v27, a27
  v_mfma_f32_16x16x32_bf16 v[228:231], v[76:79], v[36:39], v[228:231]
  v_cvt_pk_bf16_f32 v28, v24, v25
  v_cvt_pk_bf16_f32 v29, v26, v27
  v_mfma_f32_16x16x32_bf16 v[224:227], v[76:79], v[32:35], v[224:227]
  v_accvgpr_read_b32 v24, a56
  v_accvgpr_read_b32 v25, a57
  s_waitcnt vmcnt(20) lgkmcnt(0)
  s_barrier
  v_mfma_f32_16x16x32_bf16 v[128:131], v[112:115], v[80:83], v[128:131]
  s_add_u32 m0, s25, 49152
  v_add_u32 v14, 0x0, v12
  ds_read_b64_tr_b16 v[64:65], v16 offset:0
  v_mfma_f32_16x16x32_bf16 v[132:135], v[112:115], v[84:87], v[132:135]
  buffer_load_dwordx4 v8, s[12:15], s27 offen offset:0  lds
  v_mfma_f32_16x16x32_bf16 v[136:139], v[112:115], v[88:91], v[136:139]
  ds_read_b64_tr_b16 v[66:67], v16 offset:512
  v_accvgpr_read_b32 v26, a58
  v_mfma_f32_16x16x32_bf16 v[140:143], v[112:115], v[92:95], v[140:143]
  buffer_load_dwordx4 v9, s[12:15], s27 offen offset:1024  lds
  v_mfma_f32_16x16x32_bf16 v[144:147], v[112:115], v[96:99], v[144:147]
  ds_read_b128 v[32:35], v14 offset:0
  v_accvgpr_read_b32 v27, a59
  v_mfma_f32_16x16x32_bf16 v[148:151], v[112:115], v[100:103], v[148:151]
  buffer_load_dwordx4 v10, s[12:15], s27 offen offset:2048  lds
  v_mfma_f32_16x16x32_bf16 v[152:155], v[112:115], v[104:107], v[152:155]
  ds_read_b128 v[36:39], v14 offset:2048
  ds_read_b64_tr_b16 v[68:69], v17 offset:0
  v_mfma_f32_16x16x32_bf16 v[156:159], v[112:115], v[108:111], v[156:159]
  buffer_load_dwordx4 v11, s[12:15], s27 offen offset:3072  lds
  v_mfma_f32_16x16x32_bf16 v[188:191], v[116:119], v[108:111], v[188:191]
  s_add_u32 s27, s27, 0x40000
  ds_read_b64_tr_b16 v[70:71], v17 offset:512
  v_cvt_pk_bf16_f32 v30, v24, v25
  v_mfma_f32_16x16x32_bf16 v[184:187], v[116:119], v[104:107], v[184:187]
  s_add_u32 s28, s28, 128
  v_cvt_pk_bf16_f32 v31, v26, v27
  v_mfma_f32_16x16x32_bf16 v[180:183], v[116:119], v[100:103], v[180:183]
  s_add_u32 m0, s33, 0x10000
  ds_read_b128 v[40:43], v14 offset:4096
  v_mfma_f32_16x16x32_bf16 v[176:179], v[116:119], v[96:99], v[176:179]
  buffer_load_dwordx4 v4, s[8:11], s28 offen offset:0  lds
  v_mfma_f32_16x16x32_bf16 v[172:175], v[116:119], v[92:95], v[172:175]
  ds_read_b128 v[44:47], v14 offset:6144
  v_mfma_f32_16x16x32_bf16 v[168:171], v[116:119], v[88:91], v[168:171]
  buffer_load_dwordx4 v5, s[8:11], s28 offen offset:1024  lds
  v_mfma_f32_16x16x32_bf16 v[164:167], v[116:119], v[84:87], v[164:167]
  ds_read_b64_tr_b16 v[72:73], v18 offset:0
  v_mfma_f32_16x16x32_bf16 v[160:163], v[116:119], v[80:83], v[160:163]
  buffer_load_dwordx4 v6, s[8:11], s28 offen offset:2048  lds
  v_mfma_f32_16x16x32_bf16 v[192:195], v[120:123], v[80:83], v[192:195]
  ds_read_b64_tr_b16 v[74:75], v18 offset:512
  ds_read_b128 v[48:51], v14 offset:8192
  v_mfma_f32_16x16x32_bf16 v[196:199], v[120:123], v[84:87], v[196:199]
  buffer_load_dwordx4 v7, s[8:11], s28 offen offset:3072  lds
  v_mfma_f32_16x16x32_bf16 v[200:203], v[120:123], v[88:91], v[200:203]
  ds_read_b128 v[52:55], v14 offset:10240
  v_mfma_f32_16x16x32_bf16 v[204:207], v[120:123], v[92:95], v[204:207]
  buffer_store_dwordx4 v[28:31], v20, s[16:19], s36 offen sc1
  v_mfma_f32_16x16x32_bf16 v[208:211], v[120:123], v[96:99], v[208:211]
  s_add_u32 s36, s36, s39
  ds_read_b64_tr_b16 v[76:77], v19 offset:0
  v_accvgpr_read_b32 v24, a28
  v_mfma_f32_16x16x32_bf16 v[212:215], v[120:123], v[100:103], v[212:215]
  ds_read_b64_tr_b16 v[78:79], v19 offset:512
  v_accvgpr_read_b32 v25, a29
  v_mfma_f32_16x16x32_bf16 v[216:219], v[120:123], v[104:107], v[216:219]
  v_accvgpr_read_b32 v26, a30
  v_accvgpr_read_b32 v27, a31
  v_mfma_f32_16x16x32_bf16 v[220:223], v[120:123], v[108:111], v[220:223]
  ds_read_b128 v[56:59], v14 offset:12288
  v_cvt_pk_bf16_f32 v28, v24, v25
  v_mfma_f32_16x16x32_bf16 v[252:255], v[124:127], v[108:111], v[252:255]
  v_cvt_pk_bf16_f32 v29, v26, v27
  v_accvgpr_read_b32 v24, a60
  v_mfma_f32_16x16x32_bf16 v[248:251], v[124:127], v[104:107], v[248:251]
  ds_read_b128 v[60:63], v14 offset:14336
  v_accvgpr_read_b32 v25, a61
  v_mfma_f32_16x16x32_bf16 v[244:247], v[124:127], v[100:103], v[244:247]
  v_accvgpr_read_b32 v26, a62
  v_accvgpr_read_b32 v27, a63
  v_mfma_f32_16x16x32_bf16 v[240:243], v[124:127], v[96:99], v[240:243]
  v_cvt_pk_bf16_f32 v30, v24, v25
  v_cvt_pk_bf16_f32 v31, v26, v27
  v_mfma_f32_16x16x32_bf16 v[236:239], v[124:127], v[92:95], v[236:239]
  buffer_store_dwordx4 v[28:31], v20, s[16:19], s36 offen sc1
  v_mfma_f32_16x16x32_bf16 v[232:235], v[124:127], v[88:91], v[232:235]
  s_add_u32 s37, s37, s38
  v_mfma_f32_16x16x32_bf16 v[228:231], v[124:127], v[84:87], v[228:231]
  s_mov_b32 s36, s37
  v_accvgpr_read_b32 v24, a64
  v_accvgpr_read_b32 v25, a65
  v_mfma_f32_16x16x32_bf16 v[224:227], v[124:127], v[80:83], v[224:227]
  v_accvgpr_read_b32 v26, a66
  v_accvgpr_read_b32 v27, a67
  s_waitcnt vmcnt(24) lgkmcnt(0)
  s_barrier
  v_mfma_f32_16x16x32_bf16 v[128:131], v[64:67], v[32:35], v[128:131]
  s_add_u32 m0, s25, 0
  v_add_u32 v14, 0x0, v13
  ds_read_b64_tr_b16 v[112:113], v16 offset:16384
  v_mfma_f32_16x16x32_bf16 v[132:135], v[64:67], v[36:39], v[132:135]
  buffer_load_dwordx4 v8, s[12:15], s27 offen offset:0  lds
  v_mfma_f32_16x16x32_bf16 v[136:139], v[64:67], v[40:43], v[136:139]
  ds_read_b64_tr_b16 v[114:115], v16 offset:16896
  v_cvt_pk_bf16_f32 v28, v24, v25
  v_mfma_f32_16x16x32_bf16 v[140:143], v[64:67], v[44:47], v[140:143]
  buffer_load_dwordx4 v9, s[12:15], s27 offen offset:1024  lds
  v_mfma_f32_16x16x32_bf16 v[144:147], v[64:67], v[48:51], v[144:147]
  ds_read_b128 v[80:83], v14 offset:0
  v_cvt_pk_bf16_f32 v29, v26, v27
  v_mfma_f32_16x16x32_bf16 v[148:151], v[64:67], v[52:55], v[148:151]
  buffer_load_dwordx4 v10, s[12:15], s27 offen offset:2048  lds
  v_mfma_f32_16x16x32_bf16 v[152:155], v[64:67], v[56:59], v[152:155]
  ds_read_b128 v[84:87], v14 offset:2048
  ds_read_b64_tr_b16 v[116:117], v17 offset:16384
  v_mfma_f32_16x16x32_bf16 v[156:159], v[64:67], v[60:63], v[156:159]
  buffer_load_dwordx4 v11, s[12:15], s27 offen offset:3072  lds
  v_mfma_f32_16x16x32_bf16 v[188:191], v[68:71], v[60:63], v[188:191]
  s_add_u32 s27, s27, 0x40000
  ds_read_b64_tr_b16 v[118:119], v17 offset:16896
  v_accvgpr_read_b32 v24, a96
  v_mfma_f32_16x16x32_bf16 v[184:187], v[68:71], v[56:59], v[184:187]
  s_add_u32 m0, s43, 57344
  v_accvgpr_read_b32 v25, a97
  v_accvgpr_read_b32 v26, a98
  v_mfma_f32_16x16x32_bf16 v[180:183], v[68:71], v[52:55], v[180:183]
  ds_read_b128 v[88:91], v14 offset:4096
  v_accvgpr_read_b32 v27, a99
  v_mfma_f32_16x16x32_bf16 v[176:179], v[68:71], v[48:51], v[176:179]
  buffer_load_dwordx4 v21, s[20:23], s42 offen offset:0  lds
  v_mfma_f32_16x16x32_bf16 v[172:175], v[68:71], v[44:47], v[172:175]
  ds_read_b128 v[92:95], v14 offset:6144
  v_cvt_pk_bf16_f32 v30, v24, v25
  v_mfma_f32_16x16x32_bf16 v[168:171], v[68:71], v[40:43], v[168:171]
  buffer_load_dwordx4 v22, s[20:23], s42 offen offset:1024  lds
  v_mfma_f32_16x16x32_bf16 v[164:167], v[68:71], v[36:39], v[164:167]
  s_add_u32 s42, s42, 128
  ds_read_b64_tr_b16 v[120:121], v18 offset:16384
  v_cvt_pk_bf16_f32 v31, v26, v27
  v_mfma_f32_16x16x32_bf16 v[160:163], v[68:71], v[32:35], v[160:163]
  ds_read_b64_tr_b16 v[122:123], v18 offset:16896
  v_mfma_f32_16x16x32_bf16 v[192:195], v[72:75], v[32:35], v[192:195]
  ds_read_b128 v[96:99], v14 offset:8192
  v_mfma_f32_16x16x32_bf16 v[196:199], v[72:75], v[36:39], v[196:199]
  buffer_store_dwordx4 v[28:31], v20, s[16:19], s36 offen sc1
  v_mfma_f32_16x16x32_bf16 v[200:203], v[72:75], v[40:43], v[200:203]
  s_add_u32 s36, s36, s39
  ds_read_b128 v[100:103], v14 offset:10240
  v_accvgpr_read_b32 v24, a68
  v_mfma_f32_16x16x32_bf16 v[204:207], v[72:75], v[44:47], v[204:207]
  v_accvgpr_read_b32 v25, a69
  v_accvgpr_read_b32 v26, a70
  v_mfma_f32_16x16x32_bf16 v[208:211], v[72:75], v[48:51], v[208:211]
  ds_read_b64_tr_b16 v[124:125], v19 offset:16384
  v_accvgpr_read_b32 v27, a71
  v_mfma_f32_16x16x32_bf16 v[212:215], v[72:75], v[52:55], v[212:215]
  ds_read_b64_tr_b16 v[126:127], v19 offset:16896
  v_cvt_pk_bf16_f32 v28, v24, v25
  v_mfma_f32_16x16x32_bf16 v[216:219], v[72:75], v[56:59], v[216:219]
  v_cvt_pk_bf16_f32 v29, v26, v27
  v_accvgpr_read_b32 v24, a100
  v_mfma_f32_16x16x32_bf16 v[220:223], v[72:75], v[60:63], v[220:223]
  ds_read_b128 v[104:107], v14 offset:12288
  v_accvgpr_read_b32 v25, a101
  v_mfma_f32_16x16x32_bf16 v[252:255], v[76:79], v[60:63], v[252:255]
  v_accvgpr_read_b32 v26, a102
  v_accvgpr_read_b32 v27, a103
  v_mfma_f32_16x16x32_bf16 v[248:251], v[76:79], v[56:59], v[248:251]
  ds_read_b128 v[108:111], v14 offset:14336
  v_cvt_pk_bf16_f32 v30, v24, v25
  v_mfma_f32_16x16x32_bf16 v[244:247], v[76:79], v[52:55], v[244:247]
  v_cvt_pk_bf16_f32 v31, v26, v27
  v_mfma_f32_16x16x32_bf16 v[240:243], v[76:79], v[48:51], v[240:243]
  buffer_store_dwordx4 v[28:31], v20, s[16:19], s36 offen sc1
  v_mfma_f32_16x16x32_bf16 v[236:239], v[76:79], v[44:47], v[236:239]
  s_add_u32 s36, s36, s44
  v_accvgpr_read_b32 v24, a72
  v_accvgpr_read_b32 v25, a73
  v_mfma_f32_16x16x32_bf16 v[232:235], v[76:79], v[40:43], v[232:235]
  v_accvgpr_read_b32 v26, a74
  v_accvgpr_read_b32 v27, a75
  v_mfma_f32_16x16x32_bf16 v[228:231], v[76:79], v[36:39], v[228:231]
  v_cvt_pk_bf16_f32 v28, v24, v25
  v_cvt_pk_bf16_f32 v29, v26, v27
  v_mfma_f32_16x16x32_bf16 v[224:227], v[76:79], v[32:35], v[224:227]
  v_accvgpr_read_b32 v24, a104
  v_accvgpr_read_b32 v25, a105
  s_waitcnt vmcnt(22) lgkmcnt(0)
  s_barrier
  v_mfma_f32_16x16x32_bf16 v[128:131], v[112:115], v[80:83], v[128:131]
  s_add_u32 m0, s25, 16384
  v_add_u32 v14, 0x8000, v12
  ds_read_b64_tr_b16 v[64:65], v16 offset:32768
  v_mfma_f32_16x16x32_bf16 v[132:135], v[112:115], v[84:87], v[132:135]
  buffer_load_dwordx4 v8, s[12:15], s27 offen offset:0  lds
  v_mfma_f32_16x16x32_bf16 v[136:139], v[112:115], v[88:91], v[136:139]
  ds_read_b64_tr_b16 v[66:67], v16 offset:33280
  v_accvgpr_read_b32 v26, a106
  v_mfma_f32_16x16x32_bf16 v[140:143], v[112:115], v[92:95], v[140:143]
  buffer_load_dwordx4 v9, s[12:15], s27 offen offset:1024  lds
  v_mfma_f32_16x16x32_bf16 v[144:147], v[112:115], v[96:99], v[144:147]
  ds_read_b128 v[32:35], v14 offset:0
  v_accvgpr_read_b32 v27, a107
  v_mfma_f32_16x16x32_bf16 v[148:151], v[112:115], v[100:103], v[148:151]
  buffer_load_dwordx4 v10, s[12:15], s27 offen offset:2048  lds
  v_mfma_f32_16x16x32_bf16 v[152:155], v[112:115], v[104:107], v[152:155]
  ds_read_b128 v[36:39], v14 offset:2048
  ds_read_b64_tr_b16 v[68:69], v17 offset:32768
  v_mfma_f32_16x16x32_bf16 v[156:159], v[112:115], v[108:111], v[156:159]
  buffer_load_dwordx4 v11, s[12:15], s27 offen offset:3072  lds
  v_mfma_f32_16x16x32_bf16 v[188:191], v[116:119], v[108:111], v[188:191]
  s_add_u32 s27, s27, 0x40000
  ds_read_b64_tr_b16 v[70:71], v17 offset:33280
  v_cvt_pk_bf16_f32 v30, v24, v25
  v_mfma_f32_16x16x32_bf16 v[184:187], v[116:119], v[104:107], v[184:187]
  s_add_u32 s28, s28, 128
  v_cvt_pk_bf16_f32 v31, v26, v27
  v_mfma_f32_16x16x32_bf16 v[180:183], v[116:119], v[100:103], v[180:183]
  s_add_u32 m0, s33, 0x0
  ds_read_b128 v[40:43], v14 offset:4096
  v_mfma_f32_16x16x32_bf16 v[176:179], v[116:119], v[96:99], v[176:179]
  buffer_load_dwordx4 v4, s[8:11], s28 offen offset:0  lds
  v_mfma_f32_16x16x32_bf16 v[172:175], v[116:119], v[92:95], v[172:175]
  ds_read_b128 v[44:47], v14 offset:6144
  v_mfma_f32_16x16x32_bf16 v[168:171], v[116:119], v[88:91], v[168:171]
  buffer_load_dwordx4 v5, s[8:11], s28 offen offset:1024  lds
  v_mfma_f32_16x16x32_bf16 v[164:167], v[116:119], v[84:87], v[164:167]
  ds_read_b64_tr_b16 v[72:73], v18 offset:32768
  v_mfma_f32_16x16x32_bf16 v[160:163], v[116:119], v[80:83], v[160:163]
  buffer_load_dwordx4 v6, s[8:11], s28 offen offset:2048  lds
  v_mfma_f32_16x16x32_bf16 v[192:195], v[120:123], v[80:83], v[192:195]
  ds_read_b64_tr_b16 v[74:75], v18 offset:33280
  ds_read_b128 v[48:51], v14 offset:8192
  v_mfma_f32_16x16x32_bf16 v[196:199], v[120:123], v[84:87], v[196:199]
  buffer_load_dwordx4 v7, s[8:11], s28 offen offset:3072  lds
  v_mfma_f32_16x16x32_bf16 v[200:203], v[120:123], v[88:91], v[200:203]
  ds_read_b128 v[52:55], v14 offset:10240
  v_mfma_f32_16x16x32_bf16 v[204:207], v[120:123], v[92:95], v[204:207]
  buffer_store_dwordx4 v[28:31], v20, s[16:19], s36 offen sc1
  v_mfma_f32_16x16x32_bf16 v[208:211], v[120:123], v[96:99], v[208:211]
  s_add_u32 s36, s36, s39
  ds_read_b64_tr_b16 v[76:77], v19 offset:32768
  v_accvgpr_read_b32 v24, a76
  v_mfma_f32_16x16x32_bf16 v[212:215], v[120:123], v[100:103], v[212:215]
  ds_read_b64_tr_b16 v[78:79], v19 offset:33280
  v_accvgpr_read_b32 v25, a77
  v_mfma_f32_16x16x32_bf16 v[216:219], v[120:123], v[104:107], v[216:219]
  v_accvgpr_read_b32 v26, a78
  v_accvgpr_read_b32 v27, a79
  v_mfma_f32_16x16x32_bf16 v[220:223], v[120:123], v[108:111], v[220:223]
  ds_read_b128 v[56:59], v14 offset:12288
  v_cvt_pk_bf16_f32 v28, v24, v25
  v_mfma_f32_16x16x32_bf16 v[252:255], v[124:127], v[108:111], v[252:255]
  v_cvt_pk_bf16_f32 v29, v26, v27
  v_accvgpr_read_b32 v24, a108
  v_mfma_f32_16x16x32_bf16 v[248:251], v[124:127], v[104:107], v[248:251]
  ds_read_b128 v[60:63], v14 offset:14336
  v_accvgpr_read_b32 v25, a109
  v_mfma_f32_16x16x32_bf16 v[244:247], v[124:127], v[100:103], v[244:247]
  v_accvgpr_read_b32 v26, a110
  v_accvgpr_read_b32 v27, a111
  v_mfma_f32_16x16x32_bf16 v[240:243], v[124:127], v[96:99], v[240:243]
  v_cvt_pk_bf16_f32 v30, v24, v25
  v_cvt_pk_bf16_f32 v31, v26, v27
  v_mfma_f32_16x16x32_bf16 v[236:239], v[124:127], v[92:95], v[236:239]
  buffer_store_dwordx4 v[28:31], v20, s[16:19], s36 offen sc1
  v_mfma_f32_16x16x32_bf16 v[232:235], v[124:127], v[88:91], v[232:235]
  s_add_u32 s36, s36, s44
  v_accvgpr_read_b32 v24, a80
  v_accvgpr_read_b32 v25, a81
  v_mfma_f32_16x16x32_bf16 v[228:231], v[124:127], v[84:87], v[228:231]
  v_accvgpr_read_b32 v26, a82
  v_accvgpr_read_b32 v27, a83
  v_mfma_f32_16x16x32_bf16 v[224:227], v[124:127], v[80:83], v[224:227]
  v_cvt_pk_bf16_f32 v28, v24, v25
  v_cvt_pk_bf16_f32 v29, v26, v27
  s_waitcnt vmcnt(24) lgkmcnt(0)
  s_barrier
  v_mfma_f32_16x16x32_bf16 v[128:131], v[64:67], v[32:35], v[128:131]
  s_add_u32 m0, s25, 32768
  v_add_u32 v14, 0x8000, v13
  ds_read_b64_tr_b16 v[112:113], v16 offset:49152
  v_mfma_f32_16x16x32_bf16 v[132:135], v[64:67], v[36:39], v[132:135]
  buffer_load_dwordx4 v8, s[12:15], s27 offen offset:0  lds
  v_mfma_f32_16x16x32_bf16 v[136:139], v[64:67], v[40:43], v[136:139]
  ds_read_b64_tr_b16 v[114:115], v16 offset:49664
  v_accvgpr_read_b32 v24, a112
  v_mfma_f32_16x16x32_bf16 v[140:143], v[64:67], v[44:47], v[140:143]
  buffer_load_dwordx4 v9, s[12:15], s27 offen offset:1024  lds
  v_mfma_f32_16x16x32_bf16 v[144:147], v[64:67], v[48:51], v[144:147]
  ds_read_b128 v[80:83], v14 offset:0
  v_accvgpr_read_b32 v25, a113
  v_mfma_f32_16x16x32_bf16 v[148:151], v[64:67], v[52:55], v[148:151]
  buffer_load_dwordx4 v10, s[12:15], s27 offen offset:2048  lds
  v_mfma_f32_16x16x32_bf16 v[152:155], v[64:67], v[56:59], v[152:155]
  ds_read_b128 v[84:87], v14 offset:2048
  ds_read_b64_tr_b16 v[116:117], v17 offset:49152
  v_mfma_f32_16x16x32_bf16 v[156:159], v[64:67], v[60:63], v[156:159]
  buffer_load_dwordx4 v11, s[12:15], s27 offen offset:3072  lds
  v_mfma_f32_16x16x32_bf16 v[188:191], v[68:71], v[60:63], v[188:191]
  s_add_u32 s27, s27, 0x40000
  ds_read_b64_tr_b16 v[118:119], v17 offset:49664
  v_accvgpr_read_b32 v26, a114
  v_mfma_f32_16x16x32_bf16 v[184:187], v[68:71], v[56:59], v[184:187]
  s_add_u32 m0, s43, 16384
  v_accvgpr_read_b32 v27, a115
  v_cvt_pk_bf16_f32 v30, v24, v25
  v_mfma_f32_16x16x32_bf16 v[180:183], v[68:71], v[52:55], v[180:183]
  ds_read_b128 v[88:91], v14 offset:4096
  v_cvt_pk_bf16_f32 v31, v26, v27
  v_mfma_f32_16x16x32_bf16 v[176:179], v[68:71], v[48:51], v[176:179]
  buffer_load_dwordx4 v21, s[20:23], s42 offen offset:0  lds
  v_mfma_f32_16x16x32_bf16 v[172:175], v[68:71], v[44:47], v[172:175]
  ds_read_b128 v[92:95], v14 offset:6144
  v_mfma_f32_16x16x32_bf16 v[168:171], v[68:71], v[40:43], v[168:171]
  buffer_load_dwordx4 v22, s[20:23], s42 offen offset:1024  lds
  v_mfma_f32_16x16x32_bf16 v[164:167], v[68:71], v[36:39], v[164:167]
  s_add_u32 s42, s42, 128
  ds_read_b64_tr_b16 v[120:121], v18 offset:49152
  v_mfma_f32_16x16x32_bf16 v[160:163], v[68:71], v[32:35], v[160:163]
  ds_read_b64_tr_b16 v[122:123], v18 offset:49664
  v_mfma_f32_16x16x32_bf16 v[192:195], v[72:75], v[32:35], v[192:195]
  ds_read_b128 v[96:99], v14 offset:8192
  v_mfma_f32_16x16x32_bf16 v[196:199], v[72:75], v[36:39], v[196:199]
  buffer_store_dwordx4 v[28:31], v20, s[16:19], s36 offen sc1
  v_mfma_f32_16x16x32_bf16 v[200:203], v[72:75], v[40:43], v[200:203]
  s_add_u32 s36, s36, s39
  ds_read_b128 v[100:103], v14 offset:10240
  v_accvgpr_read_b32 v24, a84
  v_mfma_f32_16x16x32_bf16 v[204:207], v[72:75], v[44:47], v[204:207]
  v_accvgpr_read_b32 v25, a85
  v_accvgpr_read_b32 v26, a86
  v_mfma_f32_16x16x32_bf16 v[208:211], v[72:75], v[48:51], v[208:211]
  ds_read_b64_tr_b16 v[124:125], v19 offset:49152
  v_accvgpr_read_b32 v27, a87
  v_mfma_f32_16x16x32_bf16 v[212:215], v[72:75], v[52:55], v[212:215]
  ds_read_b64_tr_b16 v[126:127], v19 offset:49664
  v_cvt_pk_bf16_f32 v28, v24, v25
  v_mfma_f32_16x16x32_bf16 v[216:219], v[72:75], v[56:59], v[216:219]
  v_cvt_pk_bf16_f32 v29, v26, v27
  v_accvgpr_read_b32 v24, a116
  v_mfma_f32_16x16x32_bf16 v[220:223], v[72:75], v[60:63], v[220:223]
  ds_read_b128 v[104:107], v14 offset:12288
  v_accvgpr_read_b32 v25, a117
  v_mfma_f32_16x16x32_bf16 v[252:255], v[76:79], v[60:63], v[252:255]
  v_accvgpr_read_b32 v26, a118
  v_accvgpr_read_b32 v27, a119
  v_mfma_f32_16x16x32_bf16 v[248:251], v[76:79], v[56:59], v[248:251]
  ds_read_b128 v[108:111], v14 offset:14336
  v_cvt_pk_bf16_f32 v30, v24, v25
  v_mfma_f32_16x16x32_bf16 v[244:247], v[76:79], v[52:55], v[244:247]
  v_cvt_pk_bf16_f32 v31, v26, v27
  v_mfma_f32_16x16x32_bf16 v[240:243], v[76:79], v[48:51], v[240:243]
  buffer_store_dwordx4 v[28:31], v20, s[16:19], s36 offen sc1
  v_mfma_f32_16x16x32_bf16 v[236:239], v[76:79], v[44:47], v[236:239]
  s_add_u32 s36, s36, s44
  v_accvgpr_read_b32 v24, a88
  v_accvgpr_read_b32 v25, a89
  v_mfma_f32_16x16x32_bf16 v[232:235], v[76:79], v[40:43], v[232:235]
  v_accvgpr_read_b32 v26, a90
  v_accvgpr_read_b32 v27, a91
  v_mfma_f32_16x16x32_bf16 v[228:231], v[76:79], v[36:39], v[228:231]
  v_cvt_pk_bf16_f32 v28, v24, v25
  v_cvt_pk_bf16_f32 v29, v26, v27
  v_mfma_f32_16x16x32_bf16 v[224:227], v[76:79], v[32:35], v[224:227]
  v_accvgpr_read_b32 v24, a120
  v_accvgpr_read_b32 v25, a121
  s_waitcnt vmcnt(22) lgkmcnt(0)
  s_barrier
  v_mfma_f32_16x16x32_bf16 v[128:131], v[112:115], v[80:83], v[128:131]
  s_add_u32 m0, s25, 49152
  v_add_u32 v14, 0x10000, v12
  ds_read_b64_tr_b16 v[64:65], v16 offset:0
  v_mfma_f32_16x16x32_bf16 v[132:135], v[112:115], v[84:87], v[132:135]
  buffer_load_dwordx4 v8, s[12:15], s27 offen offset:0  lds
  v_mfma_f32_16x16x32_bf16 v[136:139], v[112:115], v[88:91], v[136:139]
  ds_read_b64_tr_b16 v[66:67], v16 offset:512
  v_accvgpr_read_b32 v26, a122
  v_mfma_f32_16x16x32_bf16 v[140:143], v[112:115], v[92:95], v[140:143]
  buffer_load_dwordx4 v9, s[12:15], s27 offen offset:1024  lds
  v_mfma_f32_16x16x32_bf16 v[144:147], v[112:115], v[96:99], v[144:147]
  ds_read_b128 v[32:35], v14 offset:0
  v_accvgpr_read_b32 v27, a123
  v_mfma_f32_16x16x32_bf16 v[148:151], v[112:115], v[100:103], v[148:151]
  buffer_load_dwordx4 v10, s[12:15], s27 offen offset:2048  lds
  v_mfma_f32_16x16x32_bf16 v[152:155], v[112:115], v[104:107], v[152:155]
  ds_read_b128 v[36:39], v14 offset:2048
  ds_read_b64_tr_b16 v[68:69], v17 offset:0
  v_mfma_f32_16x16x32_bf16 v[156:159], v[112:115], v[108:111], v[156:159]
  buffer_load_dwordx4 v11, s[12:15], s27 offen offset:3072  lds
  v_mfma_f32_16x16x32_bf16 v[188:191], v[116:119], v[108:111], v[188:191]
  s_add_u32 s27, s27, 0x40000
  ds_read_b64_tr_b16 v[70:71], v17 offset:512
  v_cvt_pk_bf16_f32 v30, v24, v25
  v_mfma_f32_16x16x32_bf16 v[184:187], v[116:119], v[104:107], v[184:187]
  s_add_u32 s28, s28, 128
  v_cvt_pk_bf16_f32 v31, v26, v27
  v_mfma_f32_16x16x32_bf16 v[180:183], v[116:119], v[100:103], v[180:183]
  s_add_u32 m0, s33, 0x8000
  ds_read_b128 v[40:43], v14 offset:4096
  v_mfma_f32_16x16x32_bf16 v[176:179], v[116:119], v[96:99], v[176:179]
  buffer_load_dwordx4 v4, s[8:11], s28 offen offset:0  lds
  v_mfma_f32_16x16x32_bf16 v[172:175], v[116:119], v[92:95], v[172:175]
  ds_read_b128 v[44:47], v14 offset:6144
  v_mfma_f32_16x16x32_bf16 v[168:171], v[116:119], v[88:91], v[168:171]
  buffer_load_dwordx4 v5, s[8:11], s28 offen offset:1024  lds
  v_mfma_f32_16x16x32_bf16 v[164:167], v[116:119], v[84:87], v[164:167]
  ds_read_b64_tr_b16 v[72:73], v18 offset:0
  v_mfma_f32_16x16x32_bf16 v[160:163], v[116:119], v[80:83], v[160:163]
  buffer_load_dwordx4 v6, s[8:11], s28 offen offset:2048  lds
  v_mfma_f32_16x16x32_bf16 v[192:195], v[120:123], v[80:83], v[192:195]
  ds_read_b64_tr_b16 v[74:75], v18 offset:512
  ds_read_b128 v[48:51], v14 offset:8192
  v_mfma_f32_16x16x32_bf16 v[196:199], v[120:123], v[84:87], v[196:199]
  buffer_load_dwordx4 v7, s[8:11], s28 offen offset:3072  lds
  v_mfma_f32_16x16x32_bf16 v[200:203], v[120:123], v[88:91], v[200:203]
  ds_read_b128 v[52:55], v14 offset:10240
  v_mfma_f32_16x16x32_bf16 v[204:207], v[120:123], v[92:95], v[204:207]
  buffer_store_dwordx4 v[28:31], v20, s[16:19], s36 offen sc1
  v_mfma_f32_16x16x32_bf16 v[208:211], v[120:123], v[96:99], v[208:211]
  s_add_u32 s36, s36, s39
  ds_read_b64_tr_b16 v[76:77], v19 offset:0
  v_accvgpr_read_b32 v24, a92
  v_mfma_f32_16x16x32_bf16 v[212:215], v[120:123], v[100:103], v[212:215]
  ds_read_b64_tr_b16 v[78:79], v19 offset:512
  v_accvgpr_read_b32 v25, a93
  v_mfma_f32_16x16x32_bf16 v[216:219], v[120:123], v[104:107], v[216:219]
  v_accvgpr_read_b32 v26, a94
  v_accvgpr_read_b32 v27, a95
  v_mfma_f32_16x16x32_bf16 v[220:223], v[120:123], v[108:111], v[220:223]
  ds_read_b128 v[56:59], v14 offset:12288
  v_cvt_pk_bf16_f32 v28, v24, v25
  v_mfma_f32_16x16x32_bf16 v[252:255], v[124:127], v[108:111], v[252:255]
  v_cvt_pk_bf16_f32 v29, v26, v27
  v_accvgpr_read_b32 v24, a124
  v_mfma_f32_16x16x32_bf16 v[248:251], v[124:127], v[104:107], v[248:251]
  ds_read_b128 v[60:63], v14 offset:14336
  v_accvgpr_read_b32 v25, a125
  v_mfma_f32_16x16x32_bf16 v[244:247], v[124:127], v[100:103], v[244:247]
  v_accvgpr_read_b32 v26, a126
  v_accvgpr_read_b32 v27, a127
  v_mfma_f32_16x16x32_bf16 v[240:243], v[124:127], v[96:99], v[240:243]
  v_cvt_pk_bf16_f32 v30, v24, v25
  v_cvt_pk_bf16_f32 v31, v26, v27
  v_mfma_f32_16x16x32_bf16 v[236:239], v[124:127], v[92:95], v[236:239]
  buffer_store_dwordx4 v[28:31], v20, s[16:19], s36 offen sc1
  v_mfma_f32_16x16x32_bf16 v[232:235], v[124:127], v[88:91], v[232:235]
  s_add_u32 s37, s37, s38
  v_mfma_f32_16x16x32_bf16 v[228:231], v[124:127], v[84:87], v[228:231]
  s_mov_b32 s36, s37
  v_accvgpr_read_b32 v24, a128
  v_accvgpr_read_b32 v25, a129
  v_mfma_f32_16x16x32_bf16 v[224:227], v[124:127], v[80:83], v[224:227]
  v_accvgpr_read_b32 v26, a130
  v_accvgpr_read_b32 v27, a131
  s_waitcnt vmcnt(24) lgkmcnt(0)
  s_barrier
  v_mfma_f32_16x16x32_bf16 v[128:131], v[64:67], v[32:35], v[128:131]
  s_add_u32 m0, s25, 0
  v_add_u32 v14, 0x10000, v13
  ds_read_b64_tr_b16 v[112:113], v16 offset:16384
  v_mfma_f32_16x16x32_bf16 v[132:135], v[64:67], v[36:39], v[132:135]
  buffer_load_dwordx4 v8, s[12:15], s27 offen offset:0  lds
  v_mfma_f32_16x16x32_bf16 v[136:139], v[64:67], v[40:43], v[136:139]
  ds_read_b64_tr_b16 v[114:115], v16 offset:16896
  v_cvt_pk_bf16_f32 v28, v24, v25
  v_mfma_f32_16x16x32_bf16 v[140:143], v[64:67], v[44:47], v[140:143]
  buffer_load_dwordx4 v9, s[12:15], s27 offen offset:1024  lds
  v_mfma_f32_16x16x32_bf16 v[144:147], v[64:67], v[48:51], v[144:147]
  ds_read_b128 v[80:83], v14 offset:0
  v_cvt_pk_bf16_f32 v29, v26, v27
  v_mfma_f32_16x16x32_bf16 v[148:151], v[64:67], v[52:55], v[148:151]
  buffer_load_dwordx4 v10, s[12:15], s27 offen offset:2048  lds
  v_mfma_f32_16x16x32_bf16 v[152:155], v[64:67], v[56:59], v[152:155]
  ds_read_b128 v[84:87], v14 offset:2048
  ds_read_b64_tr_b16 v[116:117], v17 offset:16384
  v_mfma_f32_16x16x32_bf16 v[156:159], v[64:67], v[60:63], v[156:159]
  buffer_load_dwordx4 v11, s[12:15], s27 offen offset:3072  lds
  v_mfma_f32_16x16x32_bf16 v[188:191], v[68:71], v[60:63], v[188:191]
  s_add_u32 s27, s27, 0x40000
  ds_read_b64_tr_b16 v[118:119], v17 offset:16896
  v_accvgpr_read_b32 v24, a160
  v_mfma_f32_16x16x32_bf16 v[184:187], v[68:71], v[56:59], v[184:187]
  s_add_u32 m0, s43, 24576
  v_accvgpr_read_b32 v25, a161
  v_accvgpr_read_b32 v26, a162
  v_mfma_f32_16x16x32_bf16 v[180:183], v[68:71], v[52:55], v[180:183]
  ds_read_b128 v[88:91], v14 offset:4096
  v_accvgpr_read_b32 v27, a163
  v_mfma_f32_16x16x32_bf16 v[176:179], v[68:71], v[48:51], v[176:179]
  buffer_load_dwordx4 v21, s[20:23], s42 offen offset:0  lds
  v_mfma_f32_16x16x32_bf16 v[172:175], v[68:71], v[44:47], v[172:175]
  ds_read_b128 v[92:95], v14 offset:6144
  v_cvt_pk_bf16_f32 v30, v24, v25
  v_mfma_f32_16x16x32_bf16 v[168:171], v[68:71], v[40:43], v[168:171]
  buffer_load_dwordx4 v22, s[20:23], s42 offen offset:1024  lds
  v_mfma_f32_16x16x32_bf16 v[164:167], v[68:71], v[36:39], v[164:167]
  s_add_u32 s42, s42, 128
  ds_read_b64_tr_b16 v[120:121], v18 offset:16384
  v_cvt_pk_bf16_f32 v31, v26, v27
  v_mfma_f32_16x16x32_bf16 v[160:163], v[68:71], v[32:35], v[160:163]
  ds_read_b64_tr_b16 v[122:123], v18 offset:16896
  v_mfma_f32_16x16x32_bf16 v[192:195], v[72:75], v[32:35], v[192:195]
  ds_read_b128 v[96:99], v14 offset:8192
  v_mfma_f32_16x16x32_bf16 v[196:199], v[72:75], v[36:39], v[196:199]
  buffer_store_dwordx4 v[28:31], v20, s[16:19], s36 offen sc1
  v_mfma_f32_16x16x32_bf16 v[200:203], v[72:75], v[40:43], v[200:203]
  s_add_u32 s36, s36, s39
  ds_read_b128 v[100:103], v14 offset:10240
  v_accvgpr_read_b32 v24, a132
  v_mfma_f32_16x16x32_bf16 v[204:207], v[72:75], v[44:47], v[204:207]
  v_accvgpr_read_b32 v25, a133
  v_accvgpr_read_b32 v26, a134
  v_mfma_f32_16x16x32_bf16 v[208:211], v[72:75], v[48:51], v[208:211]
  ds_read_b64_tr_b16 v[124:125], v19 offset:16384
  v_accvgpr_read_b32 v27, a135
  v_mfma_f32_16x16x32_bf16 v[212:215], v[72:75], v[52:55], v[212:215]
  ds_read_b64_tr_b16 v[126:127], v19 offset:16896
  v_cvt_pk_bf16_f32 v28, v24, v25
  v_mfma_f32_16x16x32_bf16 v[216:219], v[72:75], v[56:59], v[216:219]
  v_cvt_pk_bf16_f32 v29, v26, v27
  v_accvgpr_read_b32 v24, a164
  v_mfma_f32_16x16x32_bf16 v[220:223], v[72:75], v[60:63], v[220:223]
  ds_read_b128 v[104:107], v14 offset:12288
  v_accvgpr_read_b32 v25, a165
  v_mfma_f32_16x16x32_bf16 v[252:255], v[76:79], v[60:63], v[252:255]
  v_accvgpr_read_b32 v26, a166
  v_accvgpr_read_b32 v27, a167
  v_mfma_f32_16x16x32_bf16 v[248:251], v[76:79], v[56:59], v[248:251]
  ds_read_b128 v[108:111], v14 offset:14336
  v_cvt_pk_bf16_f32 v30, v24, v25
  v_mfma_f32_16x16x32_bf16 v[244:247], v[76:79], v[52:55], v[244:247]
  v_cvt_pk_bf16_f32 v31, v26, v27
  v_mfma_f32_16x16x32_bf16 v[240:243], v[76:79], v[48:51], v[240:243]
  buffer_store_dwordx4 v[28:31], v20, s[16:19], s36 offen sc1
  v_mfma_f32_16x16x32_bf16 v[236:239], v[76:79], v[44:47], v[236:239]
  s_add_u32 s36, s36, s44
  v_accvgpr_read_b32 v24, a136
  v_accvgpr_read_b32 v25, a137
  v_mfma_f32_16x16x32_bf16 v[232:235], v[76:79], v[40:43], v[232:235]
  v_accvgpr_read_b32 v26, a138
  v_accvgpr_read_b32 v27, a139
  v_mfma_f32_16x16x32_bf16 v[228:231], v[76:79], v[36:39], v[228:231]
  v_cvt_pk_bf16_f32 v28, v24, v25
  v_cvt_pk_bf16_f32 v29, v26, v27
  v_mfma_f32_16x16x32_bf16 v[224:227], v[76:79], v[32:35], v[224:227]
  v_accvgpr_read_b32 v24, a168
  v_accvgpr_read_b32 v25, a169
  s_waitcnt vmcnt(22) lgkmcnt(0)
  s_barrier
  v_mfma_f32_16x16x32_bf16 v[128:131], v[112:115], v[80:83], v[128:131]
  s_add_u32 m0, s25, 16384
  v_add_u32 v14, 0x0, v12
  ds_read_b64_tr_b16 v[64:65], v16 offset:32768
  v_mfma_f32_16x16x32_bf16 v[132:135], v[112:115], v[84:87], v[132:135]
  buffer_load_dwordx4 v8, s[12:15], s27 offen offset:0  lds
  v_mfma_f32_16x16x32_bf16 v[136:139], v[112:115], v[88:91], v[136:139]
  ds_read_b64_tr_b16 v[66:67], v16 offset:33280
  v_accvgpr_read_b32 v26, a170
  v_mfma_f32_16x16x32_bf16 v[140:143], v[112:115], v[92:95], v[140:143]
  buffer_load_dwordx4 v9, s[12:15], s27 offen offset:1024  lds
  v_mfma_f32_16x16x32_bf16 v[144:147], v[112:115], v[96:99], v[144:147]
  ds_read_b128 v[32:35], v14 offset:0
  v_accvgpr_read_b32 v27, a171
  v_mfma_f32_16x16x32_bf16 v[148:151], v[112:115], v[100:103], v[148:151]
  buffer_load_dwordx4 v10, s[12:15], s27 offen offset:2048  lds
  v_mfma_f32_16x16x32_bf16 v[152:155], v[112:115], v[104:107], v[152:155]
  ds_read_b128 v[36:39], v14 offset:2048
  ds_read_b64_tr_b16 v[68:69], v17 offset:32768
  v_mfma_f32_16x16x32_bf16 v[156:159], v[112:115], v[108:111], v[156:159]
  buffer_load_dwordx4 v11, s[12:15], s27 offen offset:3072  lds
  v_mfma_f32_16x16x32_bf16 v[188:191], v[116:119], v[108:111], v[188:191]
  s_add_u32 s27, s27, 0x40000
  ds_read_b64_tr_b16 v[70:71], v17 offset:33280
  v_cvt_pk_bf16_f32 v30, v24, v25
  v_mfma_f32_16x16x32_bf16 v[184:187], v[116:119], v[104:107], v[184:187]
  s_add_u32 m0, s43, 81920
  v_cvt_pk_bf16_f32 v31, v26, v27
  v_mfma_f32_16x16x32_bf16 v[180:183], v[116:119], v[100:103], v[180:183]
  ds_read_b128 v[40:43], v14 offset:4096
  v_mfma_f32_16x16x32_bf16 v[176:179], v[116:119], v[96:99], v[176:179]
  buffer_load_dwordx4 v21, s[20:23], s42 offen offset:0  lds
  v_mfma_f32_16x16x32_bf16 v[172:175], v[116:119], v[92:95], v[172:175]
  ds_read_b128 v[44:47], v14 offset:6144
  v_mfma_f32_16x16x32_bf16 v[168:171], v[116:119], v[88:91], v[168:171]
  buffer_load_dwordx4 v22, s[20:23], s42 offen offset:1024  lds
  v_mfma_f32_16x16x32_bf16 v[164:167], v[116:119], v[84:87], v[164:167]
  s_add_u32 s42, s42, 128
  ds_read_b64_tr_b16 v[72:73], v18 offset:32768
  v_mfma_f32_16x16x32_bf16 v[160:163], v[116:119], v[80:83], v[160:163]
  ds_read_b64_tr_b16 v[74:75], v18 offset:33280
  v_mfma_f32_16x16x32_bf16 v[192:195], v[120:123], v[80:83], v[192:195]
  ds_read_b128 v[48:51], v14 offset:8192
  v_mfma_f32_16x16x32_bf16 v[196:199], v[120:123], v[84:87], v[196:199]
  buffer_store_dwordx4 v[28:31], v20, s[16:19], s36 offen sc1
  v_mfma_f32_16x16x32_bf16 v[200:203], v[120:123], v[88:91], v[200:203]
  s_add_u32 s36, s36, s39
  ds_read_b128 v[52:55], v14 offset:10240
  v_accvgpr_read_b32 v24, a140
  v_mfma_f32_16x16x32_bf16 v[204:207], v[120:123], v[92:95], v[204:207]
  v_accvgpr_read_b32 v25, a141
  v_accvgpr_read_b32 v26, a142
  v_mfma_f32_16x16x32_bf16 v[208:211], v[120:123], v[96:99], v[208:211]
  ds_read_b64_tr_b16 v[76:77], v19 offset:32768
  v_accvgpr_read_b32 v27, a143
  v_mfma_f32_16x16x32_bf16 v[212:215], v[120:123], v[100:103], v[212:215]
  ds_read_b64_tr_b16 v[78:79], v19 offset:33280
  v_cvt_pk_bf16_f32 v28, v24, v25
  v_mfma_f32_16x16x32_bf16 v[216:219], v[120:123], v[104:107], v[216:219]
  v_cvt_pk_bf16_f32 v29, v26, v27
  v_accvgpr_read_b32 v24, a172
  v_mfma_f32_16x16x32_bf16 v[220:223], v[120:123], v[108:111], v[220:223]
  ds_read_b128 v[56:59], v14 offset:12288
  v_accvgpr_read_b32 v25, a173
  v_mfma_f32_16x16x32_bf16 v[252:255], v[124:127], v[108:111], v[252:255]
  v_accvgpr_read_b32 v26, a174
  v_accvgpr_read_b32 v27, a175
  v_mfma_f32_16x16x32_bf16 v[248:251], v[124:127], v[104:107], v[248:251]
  ds_read_b128 v[60:63], v14 offset:14336
  v_cvt_pk_bf16_f32 v30, v24, v25
  v_mfma_f32_16x16x32_bf16 v[244:247], v[124:127], v[100:103], v[244:247]
  v_cvt_pk_bf16_f32 v31, v26, v27
  v_mfma_f32_16x16x32_bf16 v[240:243], v[124:127], v[96:99], v[240:243]
  buffer_store_dwordx4 v[28:31], v20, s[16:19], s36 offen sc1
  v_mfma_f32_16x16x32_bf16 v[236:239], v[124:127], v[92:95], v[236:239]
  s_add_u32 s36, s36, s44
  v_accvgpr_read_b32 v24, a144
  v_accvgpr_read_b32 v25, a145
  v_mfma_f32_16x16x32_bf16 v[232:235], v[124:127], v[88:91], v[232:235]
  v_accvgpr_read_b32 v26, a146
  v_accvgpr_read_b32 v27, a147
  v_mfma_f32_16x16x32_bf16 v[228:231], v[124:127], v[84:87], v[228:231]
  v_cvt_pk_bf16_f32 v28, v24, v25
  v_cvt_pk_bf16_f32 v29, v26, v27
  v_mfma_f32_16x16x32_bf16 v[224:227], v[124:127], v[80:83], v[224:227]
  v_accvgpr_read_b32 v24, a176
  v_accvgpr_read_b32 v25, a177
  s_waitcnt vmcnt(22) lgkmcnt(0)
  s_barrier
  v_mfma_f32_16x16x32_bf16 v[128:131], v[64:67], v[32:35], v[128:131]
  s_add_u32 m0, s43, 90112
  v_add_u32 v14, 0x0, v13
  ds_read_b64_tr_b16 v[112:113], v16 offset:49152
  v_mfma_f32_16x16x32_bf16 v[132:135], v[64:67], v[36:39], v[132:135]
  buffer_load_dwordx4 v21, s[20:23], s42 offen offset:0  lds
  v_mfma_f32_16x16x32_bf16 v[136:139], v[64:67], v[40:43], v[136:139]
  ds_read_b64_tr_b16 v[114:115], v16 offset:49664
  v_accvgpr_read_b32 v26, a178
  v_mfma_f32_16x16x32_bf16 v[140:143], v[64:67], v[44:47], v[140:143]
  buffer_load_dwordx4 v22, s[20:23], s42 offen offset:1024  lds
  v_mfma_f32_16x16x32_bf16 v[144:147], v[64:67], v[48:51], v[144:147]
  s_add_u32 s42, s42, 128
  ds_read_b128 v[80:83], v14 offset:0
  v_accvgpr_read_b32 v27, a179
  v_mfma_f32_16x16x32_bf16 v[148:151], v[64:67], v[52:55], v[148:151]
  ds_read_b128 v[84:87], v14 offset:2048
  v_cvt_pk_bf16_f32 v30, v24, v25
  v_mfma_f32_16x16x32_bf16 v[152:155], v[64:67], v[56:59], v[152:155]
  ds_read_b64_tr_b16 v[116:117], v17 offset:49152
  v_cvt_pk_bf16_f32 v31, v26, v27
  v_mfma_f32_16x16x32_bf16 v[156:159], v[64:67], v[60:63], v[156:159]
  buffer_store_dwordx4 v[28:31], v20, s[16:19], s36 offen sc1
  v_mfma_f32_16x16x32_bf16 v[188:191], v[68:71], v[60:63], v[188:191]
  s_add_u32 s36, s36, s39
  ds_read_b64_tr_b16 v[118:119], v17 offset:49664
  v_accvgpr_read_b32 v24, a148
  v_mfma_f32_16x16x32_bf16 v[184:187], v[68:71], v[56:59], v[184:187]
  v_accvgpr_read_b32 v25, a149
  v_accvgpr_read_b32 v26, a150
  v_mfma_f32_16x16x32_bf16 v[180:183], v[68:71], v[52:55], v[180:183]
  ds_read_b128 v[88:91], v14 offset:4096
  v_accvgpr_read_b32 v27, a151
  v_mfma_f32_16x16x32_bf16 v[176:179], v[68:71], v[48:51], v[176:179]
  ds_read_b128 v[92:95], v14 offset:6144
  v_cvt_pk_bf16_f32 v28, v24, v25
  v_mfma_f32_16x16x32_bf16 v[172:175], v[68:71], v[44:47], v[172:175]
  v_cvt_pk_bf16_f32 v29, v26, v27
  v_accvgpr_read_b32 v24, a180
  v_mfma_f32_16x16x32_bf16 v[168:171], v[68:71], v[40:43], v[168:171]
  ds_read_b64_tr_b16 v[120:121], v18 offset:49152
  v_accvgpr_read_b32 v25, a181
  v_mfma_f32_16x16x32_bf16 v[164:167], v[68:71], v[36:39], v[164:167]
  v_accvgpr_read_b32 v26, a182
  v_accvgpr_read_b32 v27, a183
  v_mfma_f32_16x16x32_bf16 v[160:163], v[68:71], v[32:35], v[160:163]
  ds_read_b64_tr_b16 v[122:123], v18 offset:49664
  v_cvt_pk_bf16_f32 v30, v24, v25
  v_mfma_f32_16x16x32_bf16 v[192:195], v[72:75], v[32:35], v[192:195]
  ds_read_b128 v[96:99], v14 offset:8192
  v_cvt_pk_bf16_f32 v31, v26, v27
  v_mfma_f32_16x16x32_bf16 v[196:199], v[72:75], v[36:39], v[196:199]
  buffer_store_dwordx4 v[28:31], v20, s[16:19], s36 offen sc1
  v_mfma_f32_16x16x32_bf16 v[200:203], v[72:75], v[40:43], v[200:203]
  s_add_u32 s36, s36, s44
  ds_read_b128 v[100:103], v14 offset:10240
  v_accvgpr_read_b32 v24, a152
  v_mfma_f32_16x16x32_bf16 v[204:207], v[72:75], v[44:47], v[204:207]
  v_accvgpr_read_b32 v25, a153
  v_accvgpr_read_b32 v26, a154
  v_mfma_f32_16x16x32_bf16 v[208:211], v[72:75], v[48:51], v[208:211]
  ds_read_b64_tr_b16 v[124:125], v19 offset:49152
  v_accvgpr_read_b32 v27, a155
  v_mfma_f32_16x16x32_bf16 v[212:215], v[72:75], v[52:55], v[212:215]
  ds_read_b64_tr_b16 v[126:127], v19 offset:49664
  v_cvt_pk_bf16_f32 v28, v24, v25
  v_mfma_f32_16x16x32_bf16 v[216:219], v[72:75], v[56:59], v[216:219]
  v_cvt_pk_bf16_f32 v29, v26, v27
  v_accvgpr_read_b32 v24, a184
  v_mfma_f32_16x16x32_bf16 v[220:223], v[72:75], v[60:63], v[220:223]
  ds_read_b128 v[104:107], v14 offset:12288
  v_accvgpr_read_b32 v25, a185
  v_mfma_f32_16x16x32_bf16 v[252:255], v[76:79], v[60:63], v[252:255]
  v_accvgpr_read_b32 v26, a186
  v_accvgpr_read_b32 v27, a187
  v_mfma_f32_16x16x32_bf16 v[248:251], v[76:79], v[56:59], v[248:251]
  ds_read_b128 v[108:111], v14 offset:14336
  v_cvt_pk_bf16_f32 v30, v24, v25
  v_mfma_f32_16x16x32_bf16 v[244:247], v[76:79], v[52:55], v[244:247]
  v_cvt_pk_bf16_f32 v31, v26, v27
  v_mfma_f32_16x16x32_bf16 v[240:243], v[76:79], v[48:51], v[240:243]
  buffer_store_dwordx4 v[28:31], v20, s[16:19], s36 offen sc1
  v_mfma_f32_16x16x32_bf16 v[236:239], v[76:79], v[44:47], v[236:239]
  s_add_u32 s36, s36, s39
  v_accvgpr_read_b32 v24, a156
  v_accvgpr_read_b32 v25, a157
  v_mfma_f32_16x16x32_bf16 v[232:235], v[76:79], v[40:43], v[232:235]
  v_accvgpr_read_b32 v26, a158
  v_accvgpr_read_b32 v27, a159
  v_mfma_f32_16x16x32_bf16 v[228:231], v[76:79], v[36:39], v[228:231]
  v_cvt_pk_bf16_f32 v28, v24, v25
  v_cvt_pk_bf16_f32 v29, v26, v27
  v_mfma_f32_16x16x32_bf16 v[224:227], v[76:79], v[32:35], v[224:227]
  v_accvgpr_read_b32 v24, a188
  v_accvgpr_read_b32 v25, a189
  s_waitcnt vmcnt(17) lgkmcnt(0)
  s_barrier
  v_mfma_f32_16x16x32_bf16 v[128:131], v[112:115], v[80:83], v[128:131]
  s_add_u32 m0, s43, 65536
  v_add_u32 v14, 0x8000, v12
  ds_read_b64_tr_b16 v[64:65], v16 offset:0
  v_mfma_f32_16x16x32_bf16 v[132:135], v[112:115], v[84:87], v[132:135]
  buffer_load_dwordx4 v21, s[20:23], s42 offen offset:0  lds
  v_mfma_f32_16x16x32_bf16 v[136:139], v[112:115], v[88:91], v[136:139]
  ds_read_b64_tr_b16 v[66:67], v16 offset:512
  v_accvgpr_read_b32 v26, a190
  v_mfma_f32_16x16x32_bf16 v[140:143], v[112:115], v[92:95], v[140:143]
  buffer_load_dwordx4 v22, s[20:23], s42 offen offset:1024  lds
  v_mfma_f32_16x16x32_bf16 v[144:147], v[112:115], v[96:99], v[144:147]
  s_add_u32 s42, s42, 128
  ds_read_b128 v[32:35], v14 offset:0
  v_accvgpr_read_b32 v27, a191
  v_mfma_f32_16x16x32_bf16 v[148:151], v[112:115], v[100:103], v[148:151]
  ds_read_b128 v[36:39], v14 offset:2048
  v_cvt_pk_bf16_f32 v30, v24, v25
  v_mfma_f32_16x16x32_bf16 v[152:155], v[112:115], v[104:107], v[152:155]
  ds_read_b64_tr_b16 v[68:69], v17 offset:0
  v_cvt_pk_bf16_f32 v31, v26, v27
  v_mfma_f32_16x16x32_bf16 v[156:159], v[112:115], v[108:111], v[156:159]
  buffer_store_dwordx4 v[28:31], v20, s[16:19], s36 offen sc1
  v_mfma_f32_16x16x32_bf16 v[188:191], v[116:119], v[108:111], v[188:191]
  s_add_u32 s37, s37, s38
  ds_read_b64_tr_b16 v[70:71], v17 offset:512
  v_mfma_f32_16x16x32_bf16 v[184:187], v[116:119], v[104:107], v[184:187]
  s_mov_b32 s36, s37
  v_accvgpr_read_b32 v24, a192
  v_accvgpr_read_b32 v25, a193
  v_mfma_f32_16x16x32_bf16 v[180:183], v[116:119], v[100:103], v[180:183]
  ds_read_b128 v[40:43], v14 offset:4096
  v_accvgpr_read_b32 v26, a194
  v_mfma_f32_16x16x32_bf16 v[176:179], v[116:119], v[96:99], v[176:179]
  ds_read_b128 v[44:47], v14 offset:6144
  v_accvgpr_read_b32 v27, a195
  v_mfma_f32_16x16x32_bf16 v[172:175], v[116:119], v[92:95], v[172:175]
  v_cvt_pk_bf16_f32 v28, v24, v25
  v_cvt_pk_bf16_f32 v29, v26, v27
  v_mfma_f32_16x16x32_bf16 v[168:171], v[116:119], v[88:91], v[168:171]
  ds_read_b64_tr_b16 v[72:73], v18 offset:0
  v_accvgpr_read_b32 v24, a224
  v_mfma_f32_16x16x32_bf16 v[164:167], v[116:119], v[84:87], v[164:167]
  v_accvgpr_read_b32 v25, a225
  v_accvgpr_read_b32 v26, a226
  v_mfma_f32_16x16x32_bf16 v[160:163], v[116:119], v[80:83], v[160:163]
  ds_read_b64_tr_b16 v[74:75], v18 offset:512
  v_accvgpr_read_b32 v27, a227
  v_mfma_f32_16x16x32_bf16 v[192:195], v[120:123], v[80:83], v[192:195]
  ds_read_b128 v[48:51], v14 offset:8192
  v_cvt_pk_bf16_f32 v30, v24, v25
  v_mfma_f32_16x16x32_bf16 v[196:199], v[120:123], v[84:87], v[196:199]
  v_cvt_pk_bf16_f32 v31, v26, v27
  v_mfma_f32_16x16x32_bf16 v[200:203], v[120:123], v[88:91], v[200:203]
  ds_read_b128 v[52:55], v14 offset:10240
  v_mfma_f32_16x16x32_bf16 v[204:207], v[120:123], v[92:95], v[204:207]
  buffer_store_dwordx4 v[28:31], v20, s[16:19], s36 offen sc1
  v_mfma_f32_16x16x32_bf16 v[208:211], v[120:123], v[96:99], v[208:211]
  s_add_u32 s36, s36, s39
  ds_read_b64_tr_b16 v[76:77], v19 offset:0
  v_accvgpr_read_b32 v24, a196
  v_mfma_f32_16x16x32_bf16 v[212:215], v[120:123], v[100:103], v[212:215]
  ds_read_b64_tr_b16 v[78:79], v19 offset:512
  v_accvgpr_read_b32 v25, a197
  v_mfma_f32_16x16x32_bf16 v[216:219], v[120:123], v[104:107], v[216:219]
  v_accvgpr_read_b32 v26, a198
  v_accvgpr_read_b32 v27, a199
  v_mfma_f32_16x16x32_bf16 v[220:223], v[120:123], v[108:111], v[220:223]
  ds_read_b128 v[56:59], v14 offset:12288
  v_cvt_pk_bf16_f32 v28, v24, v25
  v_mfma_f32_16x16x32_bf16 v[252:255], v[124:127], v[108:111], v[252:255]
  v_cvt_pk_bf16_f32 v29, v26, v27
  v_accvgpr_read_b32 v24, a228
  v_mfma_f32_16x16x32_bf16 v[248:251], v[124:127], v[104:107], v[248:251]
  ds_read_b128 v[60:63], v14 offset:14336
  v_accvgpr_read_b32 v25, a229
  v_mfma_f32_16x16x32_bf16 v[244:247], v[124:127], v[100:103], v[244:247]
  v_accvgpr_read_b32 v26, a230
  v_accvgpr_read_b32 v27, a231
  v_mfma_f32_16x16x32_bf16 v[240:243], v[124:127], v[96:99], v[240:243]
  v_cvt_pk_bf16_f32 v30, v24, v25
  v_cvt_pk_bf16_f32 v31, v26, v27
  v_mfma_f32_16x16x32_bf16 v[236:239], v[124:127], v[92:95], v[236:239]
  buffer_store_dwordx4 v[28:31], v20, s[16:19], s36 offen sc1
  v_mfma_f32_16x16x32_bf16 v[232:235], v[124:127], v[88:91], v[232:235]
  s_add_u32 s36, s36, s44
  v_accvgpr_read_b32 v24, a200
  v_accvgpr_read_b32 v25, a201
  v_mfma_f32_16x16x32_bf16 v[228:231], v[124:127], v[84:87], v[228:231]
  v_accvgpr_read_b32 v26, a202
  v_accvgpr_read_b32 v27, a203
  v_mfma_f32_16x16x32_bf16 v[224:227], v[124:127], v[80:83], v[224:227]
  v_cvt_pk_bf16_f32 v28, v24, v25
  v_cvt_pk_bf16_f32 v29, v26, v27
  s_waitcnt vmcnt(14) lgkmcnt(0)
  s_barrier
  v_mfma_f32_16x16x32_bf16 v[128:131], v[64:67], v[32:35], v[128:131]
  v_add_u32 v14, 0x8000, v13
  ds_read_b64_tr_b16 v[112:113], v16 offset:16384
  v_mfma_f32_16x16x32_bf16 v[132:135], v[64:67], v[36:39], v[132:135]
  ds_read_b64_tr_b16 v[114:115], v16 offset:16896
  v_accvgpr_read_b32 v24, a232
  v_mfma_f32_16x16x32_bf16 v[136:139], v[64:67], v[40:43], v[136:139]
  v_accvgpr_read_b32 v25, a233
  v_accvgpr_read_b32 v26, a234
  v_mfma_f32_16x16x32_bf16 v[140:143], v[64:67], v[44:47], v[140:143]
  ds_read_b128 v[80:83], v14 offset:0
  v_accvgpr_read_b32 v27, a235
  v_mfma_f32_16x16x32_bf16 v[144:147], v[64:67], v[48:51], v[144:147]
  v_cvt_pk_bf16_f32 v30, v24, v25
  v_cvt_pk_bf16_f32 v31, v26, v27
  v_mfma_f32_16x16x32_bf16 v[148:151], v[64:67], v[52:55], v[148:151]
  ds_read_b128 v[84:87], v14 offset:2048
  v_mfma_f32_16x16x32_bf16 v[152:155], v[64:67], v[56:59], v[152:155]
  ds_read_b64_tr_b16 v[116:117], v17 offset:16384
  v_mfma_f32_16x16x32_bf16 v[156:159], v[64:67], v[60:63], v[156:159]
  buffer_store_dwordx4 v[28:31], v20, s[16:19], s36 offen sc1
  v_mfma_f32_16x16x32_bf16 v[188:191], v[68:71], v[60:63], v[188:191]
  s_add_u32 s36, s36, s39
  ds_read_b64_tr_b16 v[118:119], v17 offset:16896
  v_accvgpr_read_b32 v24, a204
  v_mfma_f32_16x16x32_bf16 v[184:187], v[68:71], v[56:59], v[184:187]
  v_accvgpr_read_b32 v25, a205
  v_accvgpr_read_b32 v26, a206
  v_mfma_f32_16x16x32_bf16 v[180:183], v[68:71], v[52:55], v[180:183]
  ds_read_b128 v[88:91], v14 offset:4096
  v_accvgpr_read_b32 v27, a207
  v_mfma_f32_16x16x32_bf16 v[176:179], v[68:71], v[48:51], v[176:179]
  ds_read_b128 v[92:95], v14 offset:6144
  v_cvt_pk_bf16_f32 v28, v24, v25
  v_mfma_f32_16x16x32_bf16 v[172:175], v[68:71], v[44:47], v[172:175]
  v_cvt_pk_bf16_f32 v29, v26, v27
  v_accvgpr_read_b32 v24, a236
  v_mfma_f32_16x16x32_bf16 v[168:171], v[68:71], v[40:43], v[168:171]
  ds_read_b64_tr_b16 v[120:121], v18 offset:16384
  v_accvgpr_read_b32 v25, a237
  v_mfma_f32_16x16x32_bf16 v[164:167], v[68:71], v[36:39], v[164:167]
  v_accvgpr_read_b32 v26, a238
  v_accvgpr_read_b32 v27, a239
  v_mfma_f32_16x16x32_bf16 v[160:163], v[68:71], v[32:35], v[160:163]
  ds_read_b64_tr_b16 v[122:123], v18 offset:16896
  v_cvt_pk_bf16_f32 v30, v24, v25
  v_mfma_f32_16x16x32_bf16 v[192:195], v[72:75], v[32:35], v[192:195]
  ds_read_b128 v[96:99], v14 offset:8192
  v_cvt_pk_bf16_f32 v31, v26, v27
  v_mfma_f32_16x16x32_bf16 v[196:199], v[72:75], v[36:39], v[196:199]
  buffer_store_dwordx4 v[28:31], v20, s[16:19], s36 offen sc1
  v_mfma_f32_16x16x32_bf16 v[200:203], v[72:75], v[40:43], v[200:203]
  s_add_u32 s36, s36, s44
  ds_read_b128 v[100:103], v14 offset:10240
  v_accvgpr_read_b32 v24, a208
  v_mfma_f32_16x16x32_bf16 v[204:207], v[72:75], v[44:47], v[204:207]
  v_accvgpr_read_b32 v25, a209
  v_accvgpr_read_b32 v26, a210
  v_mfma_f32_16x16x32_bf16 v[208:211], v[72:75], v[48:51], v[208:211]
  ds_read_b64_tr_b16 v[124:125], v19 offset:16384
  v_accvgpr_read_b32 v27, a211
  v_mfma_f32_16x16x32_bf16 v[212:215], v[72:75], v[52:55], v[212:215]
  ds_read_b64_tr_b16 v[126:127], v19 offset:16896
  v_cvt_pk_bf16_f32 v28, v24, v25
  v_mfma_f32_16x16x32_bf16 v[216:219], v[72:75], v[56:59], v[216:219]
  v_cvt_pk_bf16_f32 v29, v26, v27
  v_accvgpr_read_b32 v24, a240
  v_mfma_f32_16x16x32_bf16 v[220:223], v[72:75], v[60:63], v[220:223]
  ds_read_b128 v[104:107], v14 offset:12288
  v_accvgpr_read_b32 v25, a241
  v_mfma_f32_16x16x32_bf16 v[252:255], v[76:79], v[60:63], v[252:255]
  v_accvgpr_read_b32 v26, a242
  v_accvgpr_read_b32 v27, a243
  v_mfma_f32_16x16x32_bf16 v[248:251], v[76:79], v[56:59], v[248:251]
  ds_read_b128 v[108:111], v14 offset:14336
  v_cvt_pk_bf16_f32 v30, v24, v25
  v_mfma_f32_16x16x32_bf16 v[244:247], v[76:79], v[52:55], v[244:247]
  v_cvt_pk_bf16_f32 v31, v26, v27
  v_mfma_f32_16x16x32_bf16 v[240:243], v[76:79], v[48:51], v[240:243]
  buffer_store_dwordx4 v[28:31], v20, s[16:19], s36 offen sc1
  v_mfma_f32_16x16x32_bf16 v[236:239], v[76:79], v[44:47], v[236:239]
  s_add_u32 s36, s36, s39
  v_accvgpr_read_b32 v24, a212
  v_accvgpr_read_b32 v25, a213
  v_mfma_f32_16x16x32_bf16 v[232:235], v[76:79], v[40:43], v[232:235]
  v_accvgpr_read_b32 v26, a214
  v_accvgpr_read_b32 v27, a215
  v_mfma_f32_16x16x32_bf16 v[228:231], v[76:79], v[36:39], v[228:231]
  v_cvt_pk_bf16_f32 v28, v24, v25
  v_cvt_pk_bf16_f32 v29, v26, v27
  v_mfma_f32_16x16x32_bf16 v[224:227], v[76:79], v[32:35], v[224:227]
  v_accvgpr_read_b32 v24, a244
  v_accvgpr_read_b32 v25, a245
  s_waitcnt lgkmcnt(0)
  s_barrier
  v_mfma_f32_16x16x32_bf16 v[128:131], v[112:115], v[80:83], v[128:131]
  v_accvgpr_read_b32 v26, a246
  v_accvgpr_read_b32 v27, a247
  v_mfma_f32_16x16x32_bf16 v[132:135], v[112:115], v[84:87], v[132:135]
  v_cvt_pk_bf16_f32 v30, v24, v25
  v_cvt_pk_bf16_f32 v31, v26, v27
  v_mfma_f32_16x16x32_bf16 v[136:139], v[112:115], v[88:91], v[136:139]
  buffer_store_dwordx4 v[28:31], v20, s[16:19], s36 offen sc1
  v_mfma_f32_16x16x32_bf16 v[140:143], v[112:115], v[92:95], v[140:143]
  s_add_u32 s36, s36, s44
  v_accvgpr_read_b32 v24, a216
  v_accvgpr_read_b32 v25, a217
  v_mfma_f32_16x16x32_bf16 v[144:147], v[112:115], v[96:99], v[144:147]
  v_accvgpr_read_b32 v26, a218
  v_accvgpr_read_b32 v27, a219
  v_mfma_f32_16x16x32_bf16 v[148:151], v[112:115], v[100:103], v[148:151]
  v_cvt_pk_bf16_f32 v28, v24, v25
  v_cvt_pk_bf16_f32 v29, v26, v27
  v_mfma_f32_16x16x32_bf16 v[152:155], v[112:115], v[104:107], v[152:155]
  v_accvgpr_read_b32 v24, a248
  v_accvgpr_read_b32 v25, a249
  v_mfma_f32_16x16x32_bf16 v[156:159], v[112:115], v[108:111], v[156:159]
  v_accvgpr_read_b32 v26, a250
  v_accvgpr_read_b32 v27, a251
  v_mfma_f32_16x16x32_bf16 v[188:191], v[116:119], v[108:111], v[188:191]
  v_cvt_pk_bf16_f32 v30, v24, v25
  v_cvt_pk_bf16_f32 v31, v26, v27
  v_mfma_f32_16x16x32_bf16 v[184:187], v[116:119], v[104:107], v[184:187]
  buffer_store_dwordx4 v[28:31], v20, s[16:19], s36 offen sc1
  v_mfma_f32_16x16x32_bf16 v[180:183], v[116:119], v[100:103], v[180:183]
  s_add_u32 s36, s36, s39
  v_accvgpr_read_b32 v24, a220
  v_accvgpr_read_b32 v25, a221
  v_mfma_f32_16x16x32_bf16 v[176:179], v[116:119], v[96:99], v[176:179]
  v_accvgpr_read_b32 v26, a222
  v_accvgpr_read_b32 v27, a223
  v_mfma_f32_16x16x32_bf16 v[172:175], v[116:119], v[92:95], v[172:175]
  v_cvt_pk_bf16_f32 v28, v24, v25
  v_cvt_pk_bf16_f32 v29, v26, v27
  v_mfma_f32_16x16x32_bf16 v[168:171], v[116:119], v[88:91], v[168:171]
  v_accvgpr_read_b32 v24, a252
  v_accvgpr_read_b32 v25, a253
  v_mfma_f32_16x16x32_bf16 v[164:167], v[116:119], v[84:87], v[164:167]
  v_accvgpr_read_b32 v26, a254
  v_accvgpr_read_b32 v27, a255
  v_mfma_f32_16x16x32_bf16 v[160:163], v[116:119], v[80:83], v[160:163]
  v_cvt_pk_bf16_f32 v30, v24, v25
  v_cvt_pk_bf16_f32 v31, v26, v27
  v_mfma_f32_16x16x32_bf16 v[192:195], v[120:123], v[80:83], v[192:195]
  buffer_store_dwordx4 v[28:31], v20, s[16:19], s36 offen sc1
  v_mfma_f32_16x16x32_bf16 v[196:199], v[120:123], v[84:87], v[196:199]
  s_add_u32 s37, s37, s38
  v_mfma_f32_16x16x32_bf16 v[200:203], v[120:123], v[88:91], v[200:203]
  s_mov_b32 s36, s37
  v_mfma_f32_16x16x32_bf16 v[204:207], v[120:123], v[92:95], v[204:207]
  v_mfma_f32_16x16x32_bf16 v[208:211], v[120:123], v[96:99], v[208:211]
  v_mfma_f32_16x16x32_bf16 v[212:215], v[120:123], v[100:103], v[212:215]
  v_mfma_f32_16x16x32_bf16 v[216:219], v[120:123], v[104:107], v[216:219]
  v_mfma_f32_16x16x32_bf16 v[220:223], v[120:123], v[108:111], v[220:223]
  v_mfma_f32_16x16x32_bf16 v[252:255], v[124:127], v[108:111], v[252:255]
  v_mfma_f32_16x16x32_bf16 v[248:251], v[124:127], v[104:107], v[248:251]
  v_mfma_f32_16x16x32_bf16 v[244:247], v[124:127], v[100:103], v[244:247]
  v_mfma_f32_16x16x32_bf16 v[240:243], v[124:127], v[96:99], v[240:243]
  v_mfma_f32_16x16x32_bf16 v[236:239], v[124:127], v[92:95], v[236:239]
  v_mfma_f32_16x16x32_bf16 v[232:235], v[124:127], v[88:91], v[232:235]
  v_mfma_f32_16x16x32_bf16 v[228:231], v[124:127], v[84:87], v[228:231]
  v_mfma_f32_16x16x32_bf16 v[224:227], v[124:127], v[80:83], v[224:227]
  s_lshl_b32 s36, s54, 3
  s_bfe_u32 s3, s55, 0x30001
  s_add_u32 s36, s36, s3
  s_mul_i32 s36, s36, 65536
  s_add_u32 s36, s36, 0x2000000
  s_mov_b32 s96, s36
  s_lshl_b32 s3, s24, 14
  s_add_u32 s96, s96, s3
  s_lshl_b32 s3, s24, 12
  s_add_u32 s36, s36, s3
  s_mov_b32 s4, 0x3db8aa3b
  s_mov_b32 s5, s4
  s_lshl_b32 s3, s24, 12
  v_add_u32 v2, s3, v20
  v_add_u32 v3, 0x10000, v2
  v_add_u32 v126, 0x20000, v2
  v_pk_mul_f32 v[128:129], v[128:129], s[4:5]
  v_pk_mul_f32 v[130:131], v[130:131], s[4:5]
  v_pk_mul_f32 v[160:161], v[160:161], s[4:5]
  v_pk_mul_f32 v[162:163], v[162:163], s[4:5]
  v_cvt_pk_bf16_f32 v64, v128, v129
  v_cvt_pk_bf16_f32 v65, v130, v131
  v_cvt_pk_bf16_f32 v66, v160, v161
  v_cvt_pk_bf16_f32 v67, v162, v163
  ds_write_b128 v3, v[64:67] offset:32768
  v_pk_mul_f32 v[192:193], v[192:193], s[4:5]
  v_pk_mul_f32 v[194:195], v[194:195], s[4:5]
  v_pk_mul_f32 v[224:225], v[224:225], s[4:5]
  v_pk_mul_f32 v[226:227], v[226:227], s[4:5]
  v_cvt_pk_bf16_f32 v68, v192, v193
  v_cvt_pk_bf16_f32 v69, v194, v195
  v_cvt_pk_bf16_f32 v70, v224, v225
  v_cvt_pk_bf16_f32 v71, v226, v227
  ds_write_b128 v3, v[68:71] offset:34816
  v_pk_mul_f32 v[132:133], v[132:133], s[4:5]
  v_pk_mul_f32 v[134:135], v[134:135], s[4:5]
  v_pk_mul_f32 v[164:165], v[164:165], s[4:5]
  v_pk_mul_f32 v[166:167], v[166:167], s[4:5]
  v_cvt_pk_bf16_f32 v72, v132, v133
  v_cvt_pk_bf16_f32 v73, v134, v135
  v_cvt_pk_bf16_f32 v74, v164, v165
  v_cvt_pk_bf16_f32 v75, v166, v167
  ds_write_b128 v3, v[72:75] offset:33792
  v_pk_mul_f32 v[196:197], v[196:197], s[4:5]
  v_pk_mul_f32 v[198:199], v[198:199], s[4:5]
  v_pk_mul_f32 v[228:229], v[228:229], s[4:5]
  v_pk_mul_f32 v[230:231], v[230:231], s[4:5]
  v_cvt_pk_bf16_f32 v76, v196, v197
  v_cvt_pk_bf16_f32 v77, v198, v199
  v_cvt_pk_bf16_f32 v78, v228, v229
  v_cvt_pk_bf16_f32 v79, v230, v231
  ds_write_b128 v3, v[76:79] offset:35840
  v_pk_mul_f32 v[136:137], v[136:137], s[4:5]
  v_pk_mul_f32 v[138:139], v[138:139], s[4:5]
  v_pk_mul_f32 v[168:169], v[168:169], s[4:5]
  v_pk_mul_f32 v[170:171], v[170:171], s[4:5]
  v_cvt_pk_bf16_f32 v80, v136, v137
  v_cvt_pk_bf16_f32 v81, v138, v139
  v_cvt_pk_bf16_f32 v82, v168, v169
  v_cvt_pk_bf16_f32 v83, v170, v171
  ds_write_b128 v3, v[80:83] offset:49152
  v_pk_mul_f32 v[200:201], v[200:201], s[4:5]
  v_pk_mul_f32 v[202:203], v[202:203], s[4:5]
  v_pk_mul_f32 v[232:233], v[232:233], s[4:5]
  v_pk_mul_f32 v[234:235], v[234:235], s[4:5]
  v_cvt_pk_bf16_f32 v84, v200, v201
  v_cvt_pk_bf16_f32 v85, v202, v203
  v_cvt_pk_bf16_f32 v86, v232, v233
  v_cvt_pk_bf16_f32 v87, v234, v235
  ds_write_b128 v3, v[84:87] offset:51200
  v_pk_mul_f32 v[140:141], v[140:141], s[4:5]
  v_pk_mul_f32 v[142:143], v[142:143], s[4:5]
  v_pk_mul_f32 v[172:173], v[172:173], s[4:5]
  v_pk_mul_f32 v[174:175], v[174:175], s[4:5]
  v_cvt_pk_bf16_f32 v88, v140, v141
  v_cvt_pk_bf16_f32 v89, v142, v143
  v_cvt_pk_bf16_f32 v90, v172, v173
  v_cvt_pk_bf16_f32 v91, v174, v175
  ds_write_b128 v3, v[88:91] offset:50176
  v_pk_mul_f32 v[204:205], v[204:205], s[4:5]
  v_pk_mul_f32 v[206:207], v[206:207], s[4:5]
  v_pk_mul_f32 v[236:237], v[236:237], s[4:5]
  v_pk_mul_f32 v[238:239], v[238:239], s[4:5]
  v_cvt_pk_bf16_f32 v92, v204, v205
  v_cvt_pk_bf16_f32 v93, v206, v207
  v_cvt_pk_bf16_f32 v94, v236, v237
  v_cvt_pk_bf16_f32 v95, v238, v239
  ds_write_b128 v3, v[92:95] offset:52224
  v_pk_mul_f32 v[144:145], v[144:145], s[4:5]
  v_pk_mul_f32 v[146:147], v[146:147], s[4:5]
  v_pk_mul_f32 v[176:177], v[176:177], s[4:5]
  v_pk_mul_f32 v[178:179], v[178:179], s[4:5]
  v_cvt_pk_bf16_f32 v96, v144, v145
  v_cvt_pk_bf16_f32 v97, v146, v147
  v_cvt_pk_bf16_f32 v98, v176, v177
  v_cvt_pk_bf16_f32 v99, v178, v179
  ds_write_b128 v126, v[96:99] offset:0
  v_pk_mul_f32 v[208:209], v[208:209], s[4:5]
  v_pk_mul_f32 v[210:211], v[210:211], s[4:5]
  v_pk_mul_f32 v[240:241], v[240:241], s[4:5]
  v_pk_mul_f32 v[242:243], v[242:243], s[4:5]
  v_cvt_pk_bf16_f32 v100, v208, v209
  v_cvt_pk_bf16_f32 v101, v210, v211
  v_cvt_pk_bf16_f32 v102, v240, v241
  v_cvt_pk_bf16_f32 v103, v242, v243
  ds_write_b128 v126, v[100:103] offset:2048
  v_pk_mul_f32 v[148:149], v[148:149], s[4:5]
  v_pk_mul_f32 v[150:151], v[150:151], s[4:5]
  v_pk_mul_f32 v[180:181], v[180:181], s[4:5]
  v_pk_mul_f32 v[182:183], v[182:183], s[4:5]
  v_cvt_pk_bf16_f32 v104, v148, v149
  v_cvt_pk_bf16_f32 v105, v150, v151
  v_cvt_pk_bf16_f32 v106, v180, v181
  v_cvt_pk_bf16_f32 v107, v182, v183
  ds_write_b128 v126, v[104:107] offset:1024
  v_pk_mul_f32 v[212:213], v[212:213], s[4:5]
  v_pk_mul_f32 v[214:215], v[214:215], s[4:5]
  v_pk_mul_f32 v[244:245], v[244:245], s[4:5]
  v_pk_mul_f32 v[246:247], v[246:247], s[4:5]
  v_cvt_pk_bf16_f32 v108, v212, v213
  v_cvt_pk_bf16_f32 v109, v214, v215
  v_cvt_pk_bf16_f32 v110, v244, v245
  v_cvt_pk_bf16_f32 v111, v246, v247
  ds_write_b128 v126, v[108:111] offset:3072
  v_pk_mul_f32 v[152:153], v[152:153], s[4:5]
  v_pk_mul_f32 v[154:155], v[154:155], s[4:5]
  v_pk_mul_f32 v[184:185], v[184:185], s[4:5]
  v_pk_mul_f32 v[186:187], v[186:187], s[4:5]
  v_cvt_pk_bf16_f32 v112, v152, v153
  v_cvt_pk_bf16_f32 v113, v154, v155
  v_cvt_pk_bf16_f32 v114, v184, v185
  v_cvt_pk_bf16_f32 v115, v186, v187
  ds_write_b128 v126, v[112:115] offset:16384
  v_pk_mul_f32 v[216:217], v[216:217], s[4:5]
  v_pk_mul_f32 v[218:219], v[218:219], s[4:5]
  v_pk_mul_f32 v[248:249], v[248:249], s[4:5]
  v_pk_mul_f32 v[250:251], v[250:251], s[4:5]
  v_cvt_pk_bf16_f32 v116, v216, v217
  v_cvt_pk_bf16_f32 v117, v218, v219
  v_cvt_pk_bf16_f32 v118, v248, v249
  v_cvt_pk_bf16_f32 v119, v250, v251
  ds_write_b128 v126, v[116:119] offset:18432
  v_pk_mul_f32 v[156:157], v[156:157], s[4:5]
  v_pk_mul_f32 v[158:159], v[158:159], s[4:5]
  v_pk_mul_f32 v[188:189], v[188:189], s[4:5]
  v_pk_mul_f32 v[190:191], v[190:191], s[4:5]
  v_cvt_pk_bf16_f32 v120, v156, v157
  v_cvt_pk_bf16_f32 v121, v158, v159
  v_cvt_pk_bf16_f32 v122, v188, v189
  v_cvt_pk_bf16_f32 v123, v190, v191
  ds_write_b128 v126, v[120:123] offset:17408
  v_pk_mul_f32 v[220:221], v[220:221], s[4:5]
  v_pk_mul_f32 v[222:223], v[222:223], s[4:5]
  v_pk_mul_f32 v[252:253], v[252:253], s[4:5]
  v_pk_mul_f32 v[254:255], v[254:255], s[4:5]
  v_cvt_pk_bf16_f32 v32, v220, v221
  v_cvt_pk_bf16_f32 v33, v222, v223
  v_cvt_pk_bf16_f32 v34, v252, v253
  v_cvt_pk_bf16_f32 v35, v254, v255
  ds_write_b128 v126, v[32:35] offset:19456
  s_lshl_b32 s3, s24, 14
  s_add_u32 s3, s3, 98304
  v_add_u32 v1, s3, v20
  s_mov_b32 s8, s98
  s_and_b32 s9, s99, 0xffff
  s_mov_b32 s10, 0xe1000
  s_mov_b32 s11, 0x20000
  s_mov_b32 s12, s100
  s_and_b32 s13, s101, 0xffff
  s_mov_b32 s14, 0xe1000
  s_mov_b32 s15, 0x20000
  v_bfe_u32 v24, v0, 3, 5
  s_lshl_b32 s3, s41, 5
  v_add_u32 v24, s3, v24
  v_and_b32 v2, 7, v0
  v_lshlrev_b32 v22, 13, v24
  v_lshl_add_u32 v22, v2, 4, v22
  s_lshl_b32 s3, s40, 8
  v_add_u32 v22, s3, v22
  v_and_b32 v3, 1, v2
  v_lshlrev_b32 v3, 4, v3
  v_and_b32 v2, 6, v2
  v_add_u32 v2, v2, v3
  v_mul_u32_u24 v2, 28800, v2
  v_lshl_add_u32 v3, v24, 1, v2
  v_mov_b32 v2, 0x7fff0000
  v_cmp_gt_u32 vcc, 225, v24
  s_mul_i32 s4, s40, 900
  s_nop 0
  v_cndmask_b32 v3, v2, v3, vcc
  s_add_u32 s3, s4, 0
  buffer_load_ushort v144, v3, s[8:11], s3 offen
  buffer_load_ushort v152, v3, s[12:15], s3 offen
  s_add_u32 s3, s4, 28800
  buffer_load_ushort v145, v3, s[8:11], s3 offen
  buffer_load_ushort v153, v3, s[12:15], s3 offen
  s_add_u32 s3, s4, 230400
  buffer_load_ushort v146, v3, s[8:11], s3 offen
  buffer_load_ushort v154, v3, s[12:15], s3 offen
  s_add_u32 s3, s4, 259200
  buffer_load_ushort v147, v3, s[8:11], s3 offen
  buffer_load_ushort v155, v3, s[12:15], s3 offen
  s_add_u32 s3, s4, 450
  buffer_load_ushort v148, v3, s[8:11], s3 offen
  buffer_load_ushort v156, v3, s[12:15], s3 offen
  s_add_u32 s3, s4, 29250
  buffer_load_ushort v149, v3, s[8:11], s3 offen
  buffer_load_ushort v157, v3, s[12:15], s3 offen
  s_add_u32 s3, s4, 230850
  buffer_load_ushort v150, v3, s[8:11], s3 offen
  buffer_load_ushort v158, v3, s[12:15], s3 offen
  s_add_u32 s3, s4, 259650
  buffer_load_ushort v151, v3, s[8:11], s3 offen
  buffer_load_ushort v159, v3, s[12:15], s3 offen
  v_lshrrev_b32 v2, 2, v20
  buffer_load_dword v127, v2, s[92:95], 0 offen sc1
  s_add_u32 s4, s52, 0x6008000
  s_addc_u32 s5, s53, 0
  s_and_b32 s5, s5, 0xffff
  s_mov_b32 s6, 0x2000
  s_mov_b32 s7, 0x20000
  s_and_b32 s3, s84, 0xffff
  v_lshlrev_b32 v15, 13, v0
  v_mov_b32 v31, 1
  s_waitcnt vmcnt(17) lgkmcnt(0)
  s_barrier
  buffer_store_dword v31, v15, s[4:7], s3 offen sc1
  s_bitcmp1_b32 s55, 0
  s_cbranch_scc1 K1_xa
  ds_read_b128 a[64:67], v1 offset:0
  ds_read_b128 a[68:71], v1 offset:1024
  ds_read_b128 a[72:75], v1 offset:2048
  ds_read_b128 a[76:79], v1 offset:3072
  ds_read_b128 a[80:83], v1 offset:4096
  ds_read_b128 a[84:87], v1 offset:5120
  ds_read_b128 a[88:91], v1 offset:6144
  ds_read_b128 a[92:95], v1 offset:7168
  ds_read_b128 a[96:99], v1 offset:8192
  ds_read_b128 a[100:103], v1 offset:9216
  ds_read_b128 a[104:107], v1 offset:10240
  ds_read_b128 a[108:111], v1 offset:11264
  ds_read_b128 a[112:115], v1 offset:12288
  ds_read_b128 a[116:119], v1 offset:13312
  ds_read_b128 a[120:123], v1 offset:14336
  ds_read_b128 a[124:127], v1 offset:15360
  s_branch K1_xd
K1_xa:
  ds_read_b128 a[0:3], v1 offset:0
  ds_read_b128 a[4:7], v1 offset:1024
  ds_read_b128 a[8:11], v1 offset:2048
  ds_read_b128 a[12:15], v1 offset:3072
  ds_read_b128 a[16:19], v1 offset:4096
  ds_read_b128 a[20:23], v1 offset:5120
  ds_read_b128 a[24:27], v1 offset:6144
  ds_read_b128 a[28:31], v1 offset:7168
  ds_read_b128 a[32:35], v1 offset:8192
  ds_read_b128 a[36:39], v1 offset:9216
  ds_read_b128 a[40:43], v1 offset:10240
  ds_read_b128 a[44:47], v1 offset:11264
  ds_read_b128 a[48:51], v1 offset:12288
  ds_read_b128 a[52:55], v1 offset:13312
  ds_read_b128 a[56:59], v1 offset:14336
  ds_read_b128 a[60:63], v1 offset:15360
  s_add_u32 s3, s36, 0
  buffer_store_dwordx4 v[64:67], v20, s[16:19], s3 offen offset:0 sc1
  s_add_u32 s3, s36, 0
  buffer_store_dwordx4 v[68:71], v20, s[16:19], s3 offen offset:2048 sc1
  s_add_u32 s3, s36, 0
  buffer_store_dwordx4 v[72:75], v20, s[16:19], s3 offen offset:1024 sc1
  s_add_u32 s3, s36, 0
  buffer_store_dwordx4 v[76:79], v20, s[16:19], s3 offen offset:3072 sc1
  s_add_u32 s3, s36, 16384
  buffer_store_dwordx4 v[80:83], v20, s[16:19], s3 offen offset:0 sc1
  s_add_u32 s3, s36, 16384
  buffer_store_dwordx4 v[84:87], v20, s[16:19], s3 offen offset:2048 sc1
  s_add_u32 s3, s36, 16384
  buffer_store_dwordx4 v[88:91], v20, s[16:19], s3 offen offset:1024 sc1
  s_add_u32 s3, s36, 16384
  buffer_store_dwordx4 v[92:95], v20, s[16:19], s3 offen offset:3072 sc1
  s_add_u32 s3, s36, 32768
  buffer_store_dwordx4 v[96:99], v20, s[16:19], s3 offen offset:0 sc1
  s_add_u32 s3, s36, 32768
  buffer_store_dwordx4 v[100:103], v20, s[16:19], s3 offen offset:2048 sc1
  s_add_u32 s3, s36, 32768
  buffer_store_dwordx4 v[104:107], v20, s[16:19], s3 offen offset:1024 sc1
  s_add_u32 s3, s36, 32768
  buffer_store_dwordx4 v[108:111], v20, s[16:19], s3 offen offset:3072 sc1
  s_add_u32 s3, s36, 49152
  buffer_store_dwordx4 v[112:115], v20, s[16:19], s3 offen offset:0 sc1
  s_add_u32 s3, s36, 49152
  buffer_store_dwordx4 v[116:119], v20, s[16:19], s3 offen offset:2048 sc1
  s_add_u32 s3, s36, 49152
  buffer_store_dwordx4 v[120:123], v20, s[16:19], s3 offen offset:1024 sc1
  s_add_u32 s3, s36, 49152
  buffer_store_dwordx4 v[32:35], v20, s[16:19], s3 offen offset:3072 sc1
K1_xd:
  v_and_b32 v1, 15, v0
  v_bfe_u32 v2, v0, 4, 2
  v_lshrrev_b32 v3, 1, v1
  s_lshl_b32 s3, s41, 5
  s_lshl_b32 s4, s24, 3
  s_add_u32 s4, s4, s3
  v_add_u32 v3, s4, v3
  v_cvt_f32_u32 v3, v3
  v_mul_f32 v160, 0x3b124925, v3
  v_and_b32 v1, 1, v1
  v_cvt_f32_u32 v1, v1
  v_mul_f32 v1, 0x3e800000, v1
  v_lshlrev_b32 v3, 3, v2
  v_cvt_f32_u32 v3, v3
  v_fma_f32 v161, v3, v160, v1
  v_mul_f32 v162, 0x42000000, v160
  v_cos_f32 v162, v162
  v_fmamk_f32 v168, v160, 0x0, v161
  v_fmamk_f32 v169, v160, 0x3f800000, v161
  v_fmamk_f32 v170, v160, 0x40000000, v161
  v_fmamk_f32 v171, v160, 0x40400000, v161
  v_fmamk_f32 v172, v160, 0x40800000, v161
  v_fmamk_f32 v173, v160, 0x40a00000, v161
  v_fmamk_f32 v174, v160, 0x40c00000, v161
  v_fmamk_f32 v175, v160, 0x40e00000, v161
  v_cos_f32 v168, v168
  v_cos_f32 v169, v169
  v_cos_f32 v170, v170
  v_cos_f32 v171, v171
  v_cos_f32 v172, v172
  v_cos_f32 v173, v173
  v_cos_f32 v174, v174
  v_cos_f32 v175, v175
  v_fmamk_f32 v176, v160, 0x42000000, v161
  v_fmamk_f32 v177, v160, 0x42040000, v161
  v_fmamk_f32 v178, v160, 0x42080000, v161
  v_fmamk_f32 v179, v160, 0x420c0000, v161
  v_fmamk_f32 v180, v160, 0x42100000, v161
  v_fmamk_f32 v181, v160, 0x42140000, v161
  v_fmamk_f32 v182, v160, 0x42180000, v161
  v_fmamk_f32 v183, v160, 0x421c0000, v161
  v_cos_f32 v176, v176
  v_cos_f32 v177, v177
  v_cos_f32 v178, v178
  v_cos_f32 v179, v179
  v_cos_f32 v180, v180
  v_cos_f32 v181, v181
  v_cos_f32 v182, v182
  v_cos_f32 v183, v183
  v_add_f32 v162, v162, v162
  ds_read_b128 v[192:195], v12 offset:49152
  ds_read_b128 v[196:199], v12 offset:51200
  ds_read_b128 v[200:203], v12 offset:53248
  ds_read_b128 v[204:207], v12 offset:55296
  ds_read_b128 v[208:211], v13 offset:49152
  ds_read_b128 v[212:215], v13 offset:51200
  ds_read_b128 v[216:219], v13 offset:53248
  ds_read_b128 v[220:223], v13 offset:55296
  v_cvt_pk_bf16_f32 v184, v168, v169
  v_cvt_pk_bf16_f32 v185, v170, v171
  v_cvt_pk_bf16_f32 v186, v172, v173
  v_cvt_pk_bf16_f32 v187, v174, v175
  v_fma_f32 v168, v176, v162, -v168
  v_fma_f32 v169, v177, v162, -v169
  v_fma_f32 v170, v178, v162, -v170
  v_fma_f32 v171, v179, v162, -v171
  v_fma_f32 v172, v180, v162, -v172
  v_fma_f32 v173, v181, v162, -v173
  v_fma_f32 v174, v182, v162, -v174
  v_fma_f32 v175, v183, v162, -v175
  s_waitcnt lgkmcnt(4)
  v_mfma_f32_16x16x32_bf16 v[128:131], v[184:187], v[192:195], 0
  v_cvt_pk_bf16_f32 v188, v176, v177
  v_cvt_pk_bf16_f32 v189, v178, v179
  v_cvt_pk_bf16_f32 v190, v180, v181
  v_cvt_pk_bf16_f32 v191, v182, v183
  v_mfma_f32_16x16x32_bf16 v[132:135], v[184:187], v[196:199], 0
  v_fma_f32 v176, v168, v162, -v176
  v_fma_f32 v177, v169, v162, -v177
  v_fma_f32 v178, v170, v162, -v178
  v_fma_f32 v179, v171, v162, -v179
  v_mfma_f32_16x16x32_bf16 v[136:139], v[184:187], v[200:203], 0
  v_fma_f32 v180, v172, v162, -v180
  v_fma_f32 v181, v173, v162, -v181
  v_fma_f32 v182, v174, v162, -v182
  v_fma_f32 v183, v175, v162, -v183
  v_mfma_f32_16x16x32_bf16 v[140:143], v[184:187], v[204:207], 0
  ds_read_b128 v[224:227], v12 offset:57344
  ds_read_b128 v[228:231], v12 offset:59392
  ds_read_b128 v[232:235], v12 offset:61440
  ds_read_b128 v[236:239], v12 offset:63488
  s_waitcnt lgkmcnt(4)
  v_mfma_f32_16x16x32_bf16 v[128:131], v[188:191], v[208:211], v[128:131]
  v_cvt_pk_bf16_f32 v184, v168, v169
  v_cvt_pk_bf16_f32 v185, v170, v171
  v_cvt_pk_bf16_f32 v186, v172, v173
  v_cvt_pk_bf16_f32 v187, v174, v175
  v_mfma_f32_16x16x32_bf16 v[132:135], v[188:191], v[212:215], v[132:135]
  v_fma_f32 v168, v176, v162, -v168
  v_fma_f32 v169, v177, v162, -v169
  v_fma_f32 v170, v178, v162, -v170
  v_fma_f32 v171, v179, v162, -v171
  v_mfma_f32_16x16x32_bf16 v[136:139], v[188:191], v[216:219], v[136:139]
  v_fma_f32 v172, v180, v162, -v172
  v_fma_f32 v173, v181, v162, -v173
  v_fma_f32 v174, v182, v162, -v174
  v_fma_f32 v175, v183, v162, -v175
  v_mfma_f32_16x16x32_bf16 v[140:143], v[188:191], v[220:223], v[140:143]
  ds_read_b128 v[192:195], v13 offset:57344
  ds_read_b128 v[196:199], v13 offset:59392
  ds_read_b128 v[200:203], v13 offset:61440
  ds_read_b128 v[204:207], v13 offset:63488
  s_waitcnt lgkmcnt(4)
  v_mfma_f32_16x16x32_bf16 v[128:131], v[184:187], v[224:227], v[128:131]
  v_cvt_pk_bf16_f32 v188, v176, v177
  v_cvt_pk_bf16_f32 v189, v178, v179
  v_cvt_pk_bf16_f32 v190, v180, v181
  v_cvt_pk_bf16_f32 v191, v182, v183
  v_mfma_f32_16x16x32_bf16 v[132:135], v[184:187], v[228:231], v[132:135]
  v_fma_f32 v176, v168, v162, -v176
  v_fma_f32 v177, v169, v162, -v177
  v_fma_f32 v178, v170, v162, -v178
  v_fma_f32 v179, v171, v162, -v179
  v_mfma_f32_16x16x32_bf16 v[136:139], v[184:187], v[232:235], v[136:139]
  v_fma_f32 v180, v172, v162, -v180
  v_fma_f32 v181, v173, v162, -v181
  v_fma_f32 v182, v174, v162, -v182
  v_fma_f32 v183, v175, v162, -v183
  v_mfma_f32_16x16x32_bf16 v[140:143], v[184:187], v[236:239], v[140:143]
  ds_read_b128 v[208:211], v12 offset:16384
  ds_read_b128 v[212:215], v12 offset:18432
  ds_read_b128 v[216:219], v12 offset:20480
  ds_read_b128 v[220:223], v12 offset:22528
  s_waitcnt lgkmcnt(4)
  v_mfma_f32_16x16x32_bf16 v[128:131], v[188:191], v[192:195], v[128:131]
  v_cvt_pk_bf16_f32 v184, v168, v169
  v_cvt_pk_bf16_f32 v185, v170, v171
  v_cvt_pk_bf16_f32 v186, v172, v173
  v_cvt_pk_bf16_f32 v187, v174, v175
  v_mfma_f32_16x16x32_bf16 v[132:135], v[188:191], v[196:199], v[132:135]
  v_fma_f32 v168, v176, v162, -v168
  v_fma_f32 v169, v177, v162, -v169
  v_fma_f32 v170, v178, v162, -v170
  v_fma_f32 v171, v179, v162, -v171
  v_mfma_f32_16x16x32_bf16 v[136:139], v[188:191], v[200:203], v[136:139]
  v_fma_f32 v172, v180, v162, -v172
  v_fma_f32 v173, v181, v162, -v173
  v_fma_f32 v174, v182, v162, -v174
  v_fma_f32 v175, v183, v162, -v175
  v_mfma_f32_16x16x32_bf16 v[140:143], v[188:191], v[204:207], v[140:143]
  ds_read_b128 v[224:227], v13 offset:16384
  ds_read_b128 v[228:231], v13 offset:18432
  ds_read_b128 v[232:235], v13 offset:20480
  ds_read_b128 v[236:239], v13 offset:22528
  s_waitcnt lgkmcnt(4)
  v_mfma_f32_16x16x32_bf16 v[128:131], v[184:187], v[208:211], v[128:131]
  v_cvt_pk_bf16_f32 v188, v176, v177
  v_cvt_pk_bf16_f32 v189, v178, v179
  v_cvt_pk_bf16_f32 v190, v180, v181
  v_cvt_pk_bf16_f32 v191, v182, v183
  v_mfma_f32_16x16x32_bf16 v[132:135], v[184:187], v[212:215], v[132:135]
  v_fma_f32 v176, v168, v162, -v176
  v_fma_f32 v177, v169, v162, -v177
  v_fma_f32 v178, v170, v162, -v178
  v_fma_f32 v179, v171, v162, -v179
  v_mfma_f32_16x16x32_bf16 v[136:139], v[184:187], v[216:219], v[136:139]
  v_fma_f32 v180, v172, v162, -v180
  v_fma_f32 v181, v173, v162, -v181
  v_fma_f32 v182, v174, v162, -v182
  v_fma_f32 v183, v175, v162, -v183
  v_mfma_f32_16x16x32_bf16 v[140:143], v[184:187], v[220:223], v[140:143]
  ds_read_b128 v[192:195], v12 offset:24576
  ds_read_b128 v[196:199], v12 offset:26624
  ds_read_b128 v[200:203], v12 offset:28672
  ds_read_b128 v[204:207], v12 offset:30720
  s_waitcnt lgkmcnt(4)
  v_mfma_f32_16x16x32_bf16 v[128:131], v[188:191], v[224:227], v[128:131]
  v_cvt_pk_bf16_f32 v184, v168, v169
  v_cvt_pk_bf16_f32 v185, v170, v171
  v_cvt_pk_bf16_f32 v186, v172, v173
  v_cvt_pk_bf16_f32 v187, v174, v175
  v_mfma_f32_16x16x32_bf16 v[132:135], v[188:191], v[228:231], v[132:135]
  v_fma_f32 v168, v176, v162, -v168
  v_fma_f32 v169, v177, v162, -v169
  v_fma_f32 v170, v178, v162, -v170
  v_fma_f32 v171, v179, v162, -v171
  v_mfma_f32_16x16x32_bf16 v[136:139], v[188:191], v[232:235], v[136:139]
  v_fma_f32 v172, v180, v162, -v172
  v_fma_f32 v173, v181, v162, -v173
  v_fma_f32 v174, v182, v162, -v174
  v_fma_f32 v175, v183, v162, -v175
  v_mfma_f32_16x16x32_bf16 v[140:143], v[188:191], v[236:239], v[140:143]
  ds_read_b128 v[208:211], v13 offset:24576
  ds_read_b128 v[212:215], v13 offset:26624
  ds_read_b128 v[216:219], v13 offset:28672
  ds_read_b128 v[220:223], v13 offset:30720
  s_waitcnt lgkmcnt(4)
  v_mfma_f32_16x16x32_bf16 v[128:131], v[184:187], v[192:195], v[128:131]
  v_cvt_pk_bf16_f32 v188, v176, v177
  v_cvt_pk_bf16_f32 v189, v178, v179
  v_cvt_pk_bf16_f32 v190, v180, v181
  v_cvt_pk_bf16_f32 v191, v182, v183
  v_mfma_f32_16x16x32_bf16 v[132:135], v[184:187], v[196:199], v[132:135]
  v_fma_f32 v176, v168, v162, -v176
  v_fma_f32 v177, v169, v162, -v177
  v_fma_f32 v178, v170, v162, -v178
  v_fma_f32 v179, v171, v162, -v179
  v_mfma_f32_16x16x32_bf16 v[136:139], v[184:187], v[200:203], v[136:139]
  v_fma_f32 v180, v172, v162, -v180
  v_fma_f32 v181, v173, v162, -v181
  v_fma_f32 v182, v174, v162, -v182
  v_fma_f32 v183, v175, v162, -v183
  v_mfma_f32_16x16x32_bf16 v[140:143], v[184:187], v[204:207], v[140:143]
  v_add_u32 v12, 0x10000, v12
  v_add_u32 v13, 0x10000, v13
  ds_read_b128 v[224:227], v12 offset:16384
  ds_read_b128 v[228:231], v12 offset:18432
  ds_read_b128 v[232:235], v12 offset:20480
  ds_read_b128 v[236:239], v12 offset:22528
  s_waitcnt lgkmcnt(4)
  v_mfma_f32_16x16x32_bf16 v[128:131], v[188:191], v[208:211], v[128:131]
  v_cvt_pk_bf16_f32 v184, v168, v169
  v_cvt_pk_bf16_f32 v185, v170, v171
  v_cvt_pk_bf16_f32 v186, v172, v173
  v_cvt_pk_bf16_f32 v187, v174, v175
  v_mfma_f32_16x16x32_bf16 v[132:135], v[188:191], v[212:215], v[132:135]
  v_fma_f32 v168, v176, v162, -v168
  v_fma_f32 v169, v177, v162, -v169
  v_fma_f32 v170, v178, v162, -v170
  v_fma_f32 v171, v179, v162, -v171
  v_mfma_f32_16x16x32_bf16 v[136:139], v[188:191], v[216:219], v[136:139]
  v_fma_f32 v172, v180, v162, -v172
  v_fma_f32 v173, v181, v162, -v173
  v_fma_f32 v174, v182, v162, -v174
  v_fma_f32 v175, v183, v162, -v175
  v_mfma_f32_16x16x32_bf16 v[140:143], v[188:191], v[220:223], v[140:143]
  ds_read_b128 v[192:195], v13 offset:16384
  ds_read_b128 v[196:199], v13 offset:18432
  ds_read_b128 v[200:203], v13 offset:20480
  ds_read_b128 v[204:207], v13 offset:22528
  s_waitcnt lgkmcnt(4)
  v_mfma_f32_16x16x32_bf16 v[128:131], v[184:187], v[224:227], v[128:131]
  v_cvt_pk_bf16_f32 v188, v176, v177
  v_cvt_pk_bf16_f32 v189, v178, v179
  v_cvt_pk_bf16_f32 v190, v180, v181
  v_cvt_pk_bf16_f32 v191, v182, v183
  v_mfma_f32_16x16x32_bf16 v[132:135], v[184:187], v[228:231], v[132:135]
  v_fma_f32 v176, v168, v162, -v176
  v_fma_f32 v177, v169, v162, -v177
  v_fma_f32 v178, v170, v162, -v178
  v_fma_f32 v179, v171, v162, -v179
  v_mfma_f32_16x16x32_bf16 v[136:139], v[184:187], v[232:235], v[136:139]
  v_fma_f32 v180, v172, v162, -v180
  v_fma_f32 v181, v173, v162, -v181
  v_fma_f32 v182, v174, v162, -v182
  v_fma_f32 v183, v175, v162, -v183
  v_mfma_f32_16x16x32_bf16 v[140:143], v[184:187], v[236:239], v[140:143]
  ds_read_b128 v[208:211], v12 offset:24576
  ds_read_b128 v[212:215], v12 offset:26624
  ds_read_b128 v[216:219], v12 offset:28672
  ds_read_b128 v[220:223], v12 offset:30720
  s_waitcnt lgkmcnt(4)
  v_mfma_f32_16x16x32_bf16 v[128:131], v[188:191], v[192:195], v[128:131]
  v_cvt_pk_bf16_f32 v184, v168, v169
  v_cvt_pk_bf16_f32 v185, v170, v171
  v_cvt_pk_bf16_f32 v186, v172, v173
  v_cvt_pk_bf16_f32 v187, v174, v175
  v_mfma_f32_16x16x32_bf16 v[132:135], v[188:191], v[196:199], v[132:135]
  v_fma_f32 v168, v176, v162, -v168
  v_fma_f32 v169, v177, v162, -v169
  v_fma_f32 v170, v178, v162, -v170
  v_fma_f32 v171, v179, v162, -v171
  v_mfma_f32_16x16x32_bf16 v[136:139], v[188:191], v[200:203], v[136:139]
  v_fma_f32 v172, v180, v162, -v172
  v_fma_f32 v173, v181, v162, -v173
  v_fma_f32 v174, v182, v162, -v174
  v_fma_f32 v175, v183, v162, -v175
  v_mfma_f32_16x16x32_bf16 v[140:143], v[188:191], v[204:207], v[140:143]
  ds_read_b128 v[224:227], v13 offset:24576
  ds_read_b128 v[228:231], v13 offset:26624
  ds_read_b128 v[232:235], v13 offset:28672
  ds_read_b128 v[236:239], v13 offset:30720
  s_waitcnt lgkmcnt(4)
  v_mfma_f32_16x16x32_bf16 v[128:131], v[184:187], v[208:211], v[128:131]
  v_cvt_pk_bf16_f32 v188, v176, v177
  v_cvt_pk_bf16_f32 v189, v178, v179
  v_cvt_pk_bf16_f32 v190, v180, v181
  v_cvt_pk_bf16_f32 v191, v182, v183
  v_mfma_f32_16x16x32_bf16 v[132:135], v[184:187], v[212:215], v[132:135]
  v_fma_f32 v176, v168, v162, -v176
  v_fma_f32 v177, v169, v162, -v177
  v_fma_f32 v178, v170, v162, -v178
  v_fma_f32 v179, v171, v162, -v179
  v_mfma_f32_16x16x32_bf16 v[136:139], v[184:187], v[216:219], v[136:139]
  v_fma_f32 v180, v172, v162, -v180
  v_fma_f32 v181, v173, v162, -v181
  v_fma_f32 v182, v174, v162, -v182
  v_fma_f32 v183, v175, v162, -v183
  v_mfma_f32_16x16x32_bf16 v[140:143], v[184:187], v[220:223], v[140:143]
  ds_read_b128 v[192:195], v12 offset:0
  ds_read_b128 v[196:199], v12 offset:2048
  ds_read_b128 v[200:203], v12 offset:4096
  ds_read_b128 v[204:207], v12 offset:6144
  s_waitcnt lgkmcnt(4)
  v_mfma_f32_16x16x32_bf16 v[128:131], v[188:191], v[224:227], v[128:131]
  v_cvt_pk_bf16_f32 v184, v168, v169
  v_cvt_pk_bf16_f32 v185, v170, v171
  v_cvt_pk_bf16_f32 v186, v172, v173
  v_cvt_pk_bf16_f32 v187, v174, v175
  v_mfma_f32_16x16x32_bf16 v[132:135], v[188:191], v[228:231], v[132:135]
  ds_read_b128 v[208:211], v13 offset:0
  ds_read_b128 v[212:215], v13 offset:2048
  ds_read_b128 v[216:219], v13 offset:4096
  ds_read_b128 v[220:223], v13 offset:6144
  v_mfma_f32_16x16x32_bf16 v[136:139], v[188:191], v[232:235], v[136:139]
  v_mfma_f32_16x16x32_bf16 v[140:143], v[188:191], v[236:239], v[140:143]
  s_waitcnt lgkmcnt(4)
  v_mfma_f32_16x16x32_bf16 v[128:131], v[184:187], v[192:195], v[128:131]
  v_cvt_pk_bf16_f32 v188, v176, v177
  v_cvt_pk_bf16_f32 v189, v178, v179
  v_cvt_pk_bf16_f32 v190, v180, v181
  v_cvt_pk_bf16_f32 v191, v182, v183
  v_mfma_f32_16x16x32_bf16 v[132:135], v[184:187], v[196:199], v[132:135]
  v_mfma_f32_16x16x32_bf16 v[136:139], v[184:187], v[200:203], v[136:139]
  v_mfma_f32_16x16x32_bf16 v[140:143], v[184:187], v[204:207], v[140:143]
  s_waitcnt lgkmcnt(0)
  v_mfma_f32_16x16x32_bf16 v[128:131], v[188:191], v[208:211], v[128:131]
  v_mfma_f32_16x16x32_bf16 v[132:135], v[188:191], v[212:215], v[132:135]
  v_mfma_f32_16x16x32_bf16 v[136:139], v[188:191], v[216:219], v[136:139]
  v_mfma_f32_16x16x32_bf16 v[140:143], v[188:191], v[220:223], v[140:143]
  v_and_b32 v1, 15, v0
  v_lshlrev_b32 v1, 4, v1
  v_lshl_add_u32 v21, v2, 14, v1
  s_lshl_b32 s4, s4, 13
  s_lshl_b32 s3, s40, 8
  s_add_u32 s98, s4, s3
  s_mov_b32 s47, s54
  s_bfe_u32 s46, s55, 0x30001
  s_and_b32 s39, s55, 1
  s_mul_i32 s37, s47, 1048576
  s_lshl_b32 s40, s24, 12
  s_add_u32 s56, s40, 0x28000
  s_add_u32 s35, s40, 0x0
  s_sub_u32 s5, 15, s46
  s_lshl_b32 s3, s47, 3
  s_add_u32 s3, s3, s46
  s_lshl_b32 s3, s3, 2
  s_add_u32 s3, s3, s24
  s_mul_i32 s42, s3, 0x4400
  s_lshl_b32 s43, s3, 6
  s_lshl_b32 s6, s5, 2
  s_add_u32 s7, s6, 4
  s_lshl_b32 s3, s46, 2
  s_lshr_b32 s3, 0x36777777, s3
  s_and_b32 s3, s3, 15
  s_add_u32 s3, s3, 32
  s_cmp_eq_u32 s39, 1
  s_cselect_b32 s50, 0, s3
  s_cselect_b32 s51, s3, s7
  s_lshl_b32 s3, s46, 2
  s_add_u32 s3, s3, 4
  s_cmp_eq_u32 s39, 1
  s_cselect_b32 s45, 0, s3
  s_sub_u32 s25, s51, s50
  s_mov_b32 s29, s25
  s_add_u32 s30, s29, s45
  s_add_u32 s30, s30, 1
  s_add_u32 s6, s6, s24
  s_add_u32 s6, s6, 1
  s_cmp_le_u32 s6, s51
  s_cselect_b32 s27, 1, 0
  s_min_u32 s6, s6, s51
  s_max_u32 s6, s6, s50
  s_sub_u32 s26, s6, s50
  s_cmp_eq_u32 s39, 1
  s_cselect_b32 s6, s5, s46
  s_lshl_b32 s6, s6, 2
  s_add_u32 s6, s6, s24
  s_lshl_b32 s3, s47, 6
  s_add_u32 s6, s6, s3
  s_mul_i32 s41, s6, 0x7000
  s_mul_i32 s31, s50, 16384
  s_add_u32 s31, s31, s37
  s_mov_b32 s33, 16384
  s_mov_b32 s34, 0x1000000
  s_mov_b32 s28, 0
  s_mov_b32 s36, 0x0
  v_and_b32 v1, 63, v0
  v_lshlrev_b32 v9, 4, v1
  v_add_u32 v8, s36, v9
  v_add_u32 v4, s40, v9
  v_mov_b32 v5, v4
  v_mov_b32 v6, v4
  v_mov_b32 v7, v4
  s_mov_b32 s8, s52
  s_and_b32 s9, s53, 0xffff
  s_mov_b32 s10, 0x2000000
  s_mov_b32 s11, 0x20000
  s_add_u32 s12, s52, 0x5000000
  s_addc_u32 s13, s53, 0
  s_and_b32 s13, s13, 0xffff
  s_mov_b32 s14, 0x880000
  s_mov_b32 s15, 0x20000
  s_add_u32 s16, s52, 0x3000000
  s_addc_u32 s17, s53, 0
  s_and_b32 s17, s17, 0xffff
  s_mov_b32 s18, 0x1c00000
  s_mov_b32 s19, 0x20000
  v_mov_b32 v238, v21
  v_mov_b32 v239, v22
  s_cmp_eq_u32 s39, 1
  s_cbranch_scc1 K1_notrig
  v_and_b32 v1, 63, v0
  v_and_b32 v2, 15, v1
  v_lshrrev_b32 v3, 4, v1
  s_lshl_b32 s3, s24, 4
  v_add_u32 v24, s3, v2
  v_cvt_f32_u32 v18, v24
  v_cvt_f32_u32 v19, v3
  v_mul_f32 v20, 0x3c800000, v18
  v_mul_f32 v21, v19, v20
  v_mul_f32 v21, 0x41000000, v21
  v_fmamk_f32 v200, v20, 0x0, v21
  v_fmamk_f32 v201, v20, 0x3f800000, v21
  v_fmamk_f32 v202, v20, 0x40000000, v21
  v_fmamk_f32 v203, v20, 0x40400000, v21
  v_fmamk_f32 v204, v20, 0x40800000, v21
  v_fmamk_f32 v205, v20, 0x40a00000, v21
  v_fmamk_f32 v206, v20, 0x40c00000, v21
  v_fmamk_f32 v207, v20, 0x40e00000, v21
  v_cos_f32 v208, v200
  v_sin_f32 v200, v200
  v_cos_f32 v209, v201
  v_sin_f32 v201, v201
  v_cos_f32 v210, v202
  v_sin_f32 v202, v202
  v_cos_f32 v211, v203
  v_sin_f32 v203, v203
  v_cos_f32 v212, v204
  v_sin_f32 v204, v204
  v_cos_f32 v213, v205
  v_sin_f32 v205, v205
  v_cos_f32 v214, v206
  v_sin_f32 v206, v206
  v_cos_f32 v215, v207
  v_sin_f32 v207, v207
  v_cvt_pk_bf16_f32 v40, v208, v209
  v_cvt_pk_bf16_f32 v41, v210, v211
  v_cvt_pk_bf16_f32 v42, v212, v213
  v_cvt_pk_bf16_f32 v43, v214, v215
  v_cvt_pk_bf16_f32 v48, v200, v201
  v_cvt_pk_bf16_f32 v49, v202, v203
  v_cvt_pk_bf16_f32 v50, v204, v205
  v_cvt_pk_bf16_f32 v51, v206, v207
  v_fmamk_f32 v200, v20, 0x42000000, v21
  v_fmamk_f32 v201, v20, 0x42040000, v21
  v_fmamk_f32 v202, v20, 0x42080000, v21
  v_fmamk_f32 v203, v20, 0x420c0000, v21
  v_fmamk_f32 v204, v20, 0x42100000, v21
  v_fmamk_f32 v205, v20, 0x42140000, v21
  v_fmamk_f32 v206, v20, 0x42180000, v21
  v_fmamk_f32 v207, v20, 0x421c0000, v21
  v_cos_f32 v208, v200
  v_sin_f32 v200, v200
  v_cos_f32 v209, v201
  v_sin_f32 v201, v201
  v_cos_f32 v210, v202
  v_sin_f32 v202, v202
  v_cos_f32 v211, v203
  v_sin_f32 v203, v203
  v_cos_f32 v212, v204
  v_sin_f32 v204, v204
  v_cos_f32 v213, v205
  v_sin_f32 v205, v205
  v_cos_f32 v214, v206
  v_sin_f32 v206, v206
  v_cos_f32 v215, v207
  v_sin_f32 v207, v207
  v_cvt_pk_bf16_f32 v44, v208, v209
  v_cvt_pk_bf16_f32 v45, v210, v211
  v_cvt_pk_bf16_f32 v46, v212, v213
  v_cvt_pk_bf16_f32 v47, v214, v215
  v_cvt_pk_bf16_f32 v52, v200, v201
  v_cvt_pk_bf16_f32 v53, v202, v203
  v_cvt_pk_bf16_f32 v54, v204, v205
  v_cvt_pk_bf16_f32 v55, v206, v207
  v_mul_f32 v20, 0x3a000000, v18
  v_mul_f32 v21, v19, v20
  v_add_f32 v21, v21, v21
  v_fmamk_f32 v88, v20, 0x0, v21
  v_fmamk_f32 v89, v20, 0x3f800000, v21
  v_fmamk_f32 v90, v20, 0x41000000, v21
  v_fmamk_f32 v91, v20, 0x41100000, v21
  v_fmamk_f32 v92, v20, 0x41800000, v21
  v_fmamk_f32 v93, v20, 0x41880000, v21
  v_fmamk_f32 v94, v20, 0x41c00000, v21
  v_fmamk_f32 v95, v20, 0x41c80000, v21
  v_cos_f32 v80, v88
  v_sin_f32 v88, v88
  v_cos_f32 v81, v89
  v_sin_f32 v89, v89
  v_cos_f32 v82, v90
  v_sin_f32 v90, v90
  v_cos_f32 v83, v91
  v_sin_f32 v91, v91
  v_cos_f32 v84, v92
  v_sin_f32 v92, v92
  v_cos_f32 v85, v93
  v_sin_f32 v93, v93
  v_cos_f32 v86, v94
  v_sin_f32 v94, v94
  v_cos_f32 v87, v95
  v_sin_f32 v95, v95
  v_bfe_u32 v22, v2, 1, 1
  v_lshlrev_b32 v22, 3, v22
  v_lshrrev_b32 v23, 2, v2
  v_lshl_add_u32 v22, v23, 1, v22
  v_and_b32 v23, 1, v2
  v_add_u32 v22, v22, v23
  v_cvt_f32_u32 v22, v22
  v_add_f32 v20, 0x0, v22
  v_mul_f32 v20, 0x3d000000, v20
  v_mul_f32 v21, v19, v20
  v_add_f32 v21, v21, v21
  v_fmamk_f32 v200, v20, 0x0, v21
  v_fmamk_f32 v201, v20, 0x3f800000, v21
  v_fmamk_f32 v202, v20, 0x41000000, v21
  v_fmamk_f32 v203, v20, 0x41100000, v21
  v_fmamk_f32 v204, v20, 0x41800000, v21
  v_fmamk_f32 v205, v20, 0x41880000, v21
  v_fmamk_f32 v206, v20, 0x41c00000, v21
  v_fmamk_f32 v207, v20, 0x41c80000, v21
  v_cos_f32 v208, v200
  v_sin_f32 v200, v200
  v_cos_f32 v209, v201
  v_sin_f32 v201, v201
  v_cos_f32 v210, v202
  v_sin_f32 v202, v202
  v_cos_f32 v211, v203
  v_sin_f32 v203, v203
  v_cos_f32 v212, v204
  v_sin_f32 v204, v204
  v_cos_f32 v213, v205
  v_sin_f32 v205, v205
  v_cos_f32 v214, v206
  v_sin_f32 v206, v206
  v_cos_f32 v215, v207
  v_sin_f32 v207, v207
  v_cvt_pk_bf16_f32 v56, v208, v209
  v_cvt_pk_bf16_f32 v57, v210, v211
  v_cvt_pk_bf16_f32 v58, v212, v213
  v_cvt_pk_bf16_f32 v59, v214, v215
  v_cvt_pk_bf16_f32 v64, v200, v201
  v_cvt_pk_bf16_f32 v65, v202, v203
  v_cvt_pk_bf16_f32 v66, v204, v205
  v_cvt_pk_bf16_f32 v67, v206, v207
  v_add_f32 v20, 0x41800000, v22
  v_mul_f32 v20, 0x3d000000, v20
  v_mul_f32 v21, v19, v20
  v_add_f32 v21, v21, v21
  v_fmamk_f32 v200, v20, 0x0, v21
  v_fmamk_f32 v201, v20, 0x3f800000, v21
  v_fmamk_f32 v202, v20, 0x41000000, v21
  v_fmamk_f32 v203, v20, 0x41100000, v21
  v_fmamk_f32 v204, v20, 0x41800000, v21
  v_fmamk_f32 v205, v20, 0x41880000, v21
  v_fmamk_f32 v206, v20, 0x41c00000, v21
  v_fmamk_f32 v207, v20, 0x41c80000, v21
  v_cos_f32 v208, v200
  v_sin_f32 v200, v200
  v_cos_f32 v209, v201
  v_sin_f32 v201, v201
  v_cos_f32 v210, v202
  v_sin_f32 v202, v202
  v_cos_f32 v211, v203
  v_sin_f32 v203, v203
  v_cos_f32 v212, v204
  v_sin_f32 v204, v204
  v_cos_f32 v213, v205
  v_sin_f32 v205, v205
  v_cos_f32 v214, v206
  v_sin_f32 v206, v206
  v_cos_f32 v215, v207
  v_sin_f32 v207, v207
  v_cvt_pk_bf16_f32 v60, v208, v209
  v_cvt_pk_bf16_f32 v61, v210, v211
  v_cvt_pk_bf16_f32 v62, v212, v213
  v_cvt_pk_bf16_f32 v63, v214, v215
  v_cvt_pk_bf16_f32 v68, v200, v201
  v_cvt_pk_bf16_f32 v69, v202, v203
  v_cvt_pk_bf16_f32 v70, v204, v205
  v_cvt_pk_bf16_f32 v71, v206, v207
  v_xor_b32 v72, 0x80008000, v64
  v_xor_b32 v73, 0x80008000, v65
  v_xor_b32 v74, 0x80008000, v66
  v_xor_b32 v75, 0x80008000, v67
  v_xor_b32 v76, 0x80008000, v68
  v_xor_b32 v77, 0x80008000, v69
  v_xor_b32 v78, 0x80008000, v70
  v_xor_b32 v79, 0x80008000, v71
  v_accvgpr_write_b32 a192, v40
  v_accvgpr_write_b32 a193, v41
  v_accvgpr_write_b32 a194, v42
  v_accvgpr_write_b32 a195, v43
  v_accvgpr_write_b32 a196, v44
  v_accvgpr_write_b32 a197, v45
  v_accvgpr_write_b32 a198, v46
  v_accvgpr_write_b32 a199, v47
  v_accvgpr_write_b32 a200, v48
  v_accvgpr_write_b32 a201, v49
  v_accvgpr_write_b32 a202, v50
  v_accvgpr_write_b32 a203, v51
  v_accvgpr_write_b32 a204, v52
  v_accvgpr_write_b32 a205, v53
  v_accvgpr_write_b32 a206, v54
  v_accvgpr_write_b32 a207, v55
  v_accvgpr_write_b32 a208, v56
  v_accvgpr_write_b32 a209, v57
  v_accvgpr_write_b32 a210, v58
  v_accvgpr_write_b32 a211, v59
  v_accvgpr_write_b32 a212, v60
  v_accvgpr_write_b32 a213, v61
  v_accvgpr_write_b32 a214, v62
  v_accvgpr_write_b32 a215, v63
  v_accvgpr_write_b32 a216, v64
  v_accvgpr_write_b32 a217, v65
  v_accvgpr_write_b32 a218, v66
  v_accvgpr_write_b32 a219, v67
  v_accvgpr_write_b32 a220, v68
  v_accvgpr_write_b32 a221, v69
  v_accvgpr_write_b32 a222, v70
  v_accvgpr_write_b32 a223, v71
  v_accvgpr_write_b32 a224, v72
  v_accvgpr_write_b32 a225, v73
  v_accvgpr_write_b32 a226, v74
  v_accvgpr_write_b32 a227, v75
  v_accvgpr_write_b32 a228, v76
  v_accvgpr_write_b32 a229, v77
  v_accvgpr_write_b32 a230, v78
  v_accvgpr_write_b32 a231, v79
  v_accvgpr_write_b32 a232, v80
  v_accvgpr_write_b32 a233, v81
  v_accvgpr_write_b32 a234, v82
  v_accvgpr_write_b32 a235, v83
  v_accvgpr_write_b32 a236, v84
  v_accvgpr_write_b32 a237, v85
  v_accvgpr_write_b32 a238, v86
  v_accvgpr_write_b32 a239, v87
  v_accvgpr_write_b32 a240, v88
  v_accvgpr_write_b32 a241, v89
  v_accvgpr_write_b32 a242, v90
  v_accvgpr_write_b32 a243, v91
  v_accvgpr_write_b32 a244, v92
  v_accvgpr_write_b32 a245, v93
  v_accvgpr_write_b32 a246, v94
  v_accvgpr_write_b32 a247, v95
K1_notrig:
  v_and_b32 v1, 63, v0
  v_and_b32 v2, 15, v1
  v_lshrrev_b32 v3, 4, v1
  v_lshlrev_b32 v3, 2, v3
  v_sub_u32 v17, v2, v3
  s_mov_b32 s99, -1
  s_mov_b32 s97, 0
  s_mov_b32 s101, 0
  v_lshrrev_b32 v2, 3, v1
  s_lshl_b32 s3, s24, 5
  v_add_u32 v2, s3, v2
  v_mul_u32_u24 v2, 896, v2
  v_lshrrev_b32 v3, 4, v1
  v_lshlrev_b32 v3, 1, v3
  v_and_b32 v16, 7, v1
  v_xor_b32 v3, v16, v3
  v_lshl_add_u32 v16, v3, 4, v2
  v_mov_b32 v76, 0
  s_cmp_eq_u32 s39, 0
  s_cselect_b32 s3, 1, s27
  s_cmp_eq_u32 s3, 0
  s_cselect_b32 s3, 0, 0xff800000
  v_mov_b32 v2, s3
  v_mov_b32 v29, 0
  v_cmp_gt_i32 s[4:5], 0, v17
  v_cmp_gt_i32 s[6:7], 1, v17
  v_cmp_gt_i32 s[20:21], 2, v17
  v_cmp_gt_i32 s[22:23], 3, v17
  v_mov_b32 v100, v2
  v_mov_b32 v104, 0
  v_cndmask_b32 v96, 0, v2, s[4:5]
  v_cndmask_b32 v108, 0, v2, s[4:5]
  v_mov_b32 v101, v2
  v_mov_b32 v105, 0
  v_cndmask_b32 v97, 0, v2, s[6:7]
  v_cndmask_b32 v109, 0, v2, s[6:7]
  v_mov_b32 v102, v2
  v_mov_b32 v106, 0
  v_cndmask_b32 v98, 0, v2, s[20:21]
  v_cndmask_b32 v110, 0, v2, s[20:21]
  v_mov_b32 v103, v2
  v_mov_b32 v107, 0
  v_cndmask_b32 v99, 0, v2, s[22:23]
  v_cndmask_b32 v111, 0, v2, s[22:23]
  v_lshrrev_b32 v2, 2, v1
  v_lshlrev_b32 v3, 7, v2
  v_and_b32 v18, 3, v1
  v_lshl_add_u32 v3, v18, 3, v3
  v_bfe_u32 v2, v2, 1, 2
  v_xor_b32 v18, 0, v2
  v_lshl_add_u32 v56, v18, 5, v3
  v_xor_b32 v18, 1, v2
  v_lshl_add_u32 v57, v18, 5, v3
  v_xor_b32 v18, 2, v2
  v_lshl_add_u32 v58, v18, 5, v3
  v_xor_b32 v18, 3, v2
  v_lshl_add_u32 v59, v18, 5, v3
  s_add_u32 s20, s52, 0x6000000
  s_addc_u32 s21, s53, 0
  s_and_b32 s21, s21, 0xffff
  s_mov_b32 s22, 0x8000
  s_mov_b32 s23, 0x20000
  v_mov_b32 v27, s43
  s_add_u32 s4, s52, 0x6000000
  s_addc_u32 s5, s53, 0
  s_and_b32 s5, s5, 0xffff
  s_mov_b32 s6, 0xa000
  s_mov_b32 s7, 0x20000
  s_cmp_eq_u32 s39, 1
  s_cbranch_scc0 K1_noq2
  v_mov_b32 v2, 0
  v_mov_b32 v31, 2
  s_waitcnt vmcnt(0)
  s_barrier
  s_mov_b64 exec, 1
  buffer_store_dword v31, v2, s[4:7], s43 offen sc1
  s_mov_b64 exec, -1
  s_branch K1_zp
K1_noq2:
  s_waitcnt vmcnt(1)
K1_zp:
  v_and_b32 v2, 0x10101010, v127
  v_cmp_ne_u32 vcc, 0x10101010, v2
  s_nop 4
  s_cbranch_vccnz K1_zwait
  v_cvt_pk_bf16_f32 v240, v128, v129
  v_cvt_pk_bf16_f32 v241, v132, v133
  v_cvt_pk_bf16_f32 v242, v136, v137
  v_cvt_pk_bf16_f32 v243, v140, v141
  v_cvt_pk_bf16_f32 v244, v130, v131
  v_cvt_pk_bf16_f32 v245, v134, v135
  v_cvt_pk_bf16_f32 v246, v138, v139
  v_cvt_pk_bf16_f32 v247, v142, v143
  v_lshl_or_b32 v248, v152, 16, v144
  v_lshl_or_b32 v249, v153, 16, v145
  v_lshl_or_b32 v250, v154, 16, v146
  v_lshl_or_b32 v251, v155, 16, v147
  v_lshl_or_b32 v252, v156, 16, v148
  v_lshl_or_b32 v253, v157, 16, v149
  v_lshl_or_b32 v254, v158, 16, v150
  v_lshl_or_b32 v255, v159, 16, v151
  v_mov_b64 v[128:129], 0
  v_mov_b64 v[130:131], 0
  v_mov_b64 v[132:133], 0
  v_mov_b64 v[134:135], 0
  v_mov_b64 v[136:137], 0
  v_mov_b64 v[138:139], 0
  v_mov_b64 v[140:141], 0
  v_mov_b64 v[142:143], 0
  v_mov_b64 v[144:145], 0
  v_mov_b64 v[146:147], 0
  v_mov_b64 v[148:149], 0
  v_mov_b64 v[150:151], 0
  v_mov_b64 v[152:153], 0
  v_mov_b64 v[154:155], 0
  v_mov_b64 v[156:157], 0
  v_mov_b64 v[158:159], 0
  v_mov_b64 v[160:161], 0
  v_mov_b64 v[162:163], 0
  v_mov_b64 v[164:165], 0
  v_mov_b64 v[166:167], 0
  v_mov_b64 v[168:169], 0
  v_mov_b64 v[170:171], 0
  v_mov_b64 v[172:173], 0
  v_mov_b64 v[174:175], 0
  v_mov_b64 v[176:177], 0
  v_mov_b64 v[178:179], 0
  v_mov_b64 v[180:181], 0
  v_mov_b64 v[182:183], 0
  v_mov_b64 v[184:185], 0
  v_mov_b64 v[186:187], 0
  v_mov_b64 v[188:189], 0
  v_mov_b64 v[190:191], 0
  v_mov_b64 v[192:193], 0
  v_mov_b64 v[194:195], 0
  v_mov_b64 v[196:197], 0
  v_mov_b64 v[198:199], 0
  v_mov_b64 v[200:201], 0
  v_mov_b64 v[202:203], 0
  v_mov_b64 v[204:205], 0
  v_mov_b64 v[206:207], 0
  v_mov_b64 v[208:209], 0
  v_mov_b64 v[210:211], 0
  v_mov_b64 v[212:213], 0
  v_mov_b64 v[214:215], 0
  v_mov_b64 v[216:217], 0
  v_mov_b64 v[218:219], 0
  v_mov_b64 v[220:221], 0
  v_mov_b64 v[222:223], 0
  v_mov_b64 v[224:225], 0
  v_mov_b64 v[226:227], 0
  v_mov_b64 v[228:229], 0
  v_mov_b64 v[230:231], 0
  v_mov_b64 v[232:233], 0
  v_mov_b64 v[234:235], 0
  v_mov_b64 v[236:237], 0
  s_cmp_eq_u32 s24, 0
  s_cbranch_scc0 K2_kv_ok
  v_lshrrev_b32 v1, 2, v9
  s_lshl_b32 s3, s47, 7
  s_add_u32 s3, s3, 0x8000
  v_and_b32 v1, 60, v1
  v_add_u32 v1, s3, v1
  v_mov_b32 v29, 1
K2_kv_poll:
  buffer_load_dword v28, v1, s[4:7], 0 offen sc1
  s_waitcnt vmcnt(0)
  v_cmp_ne_u32 vcc, v29, v28
  s_nop 4
  s_cbranch_vccz K2_kv_ok
  s_sleep 4
  s_branch K2_kv_poll
K2_kv_ok:
  s_barrier
  s_mov_b32 m0, s35
  s_add_u32 s28, s28, 1
  buffer_load_dwordx4 v4, s[8:11], s31 offen offset:0 sc1 lds
  buffer_load_dwordx4 v5, s[8:11], s31 offen offset:1024 sc1 lds
  buffer_load_dwordx4 v6, s[8:11], s31 offen offset:2048 sc1 lds
  buffer_load_dwordx4 v7, s[8:11], s31 offen offset:3072 sc1 lds
  s_add_u32 s35, s35, 0x8000
  s_cmp_eq_u32 s35, s56
  s_cselect_b32 s35, s40, s35
  s_add_u32 s32, s31, s34
  s_add_u32 s31, s31, s33
  s_cmp_eq_u32 s28, s29
  s_cselect_b32 s31, s37, s31
  s_mov_b32 m0, s35
  s_add_u32 s28, s28, 1
  buffer_load_dwordx4 v4, s[8:11], s31 offen offset:0 sc1 lds
  buffer_load_dwordx4 v5, s[8:11], s31 offen offset:1024 sc1 lds
  buffer_load_dwordx4 v6, s[8:11], s31 offen offset:2048 sc1 lds
  buffer_load_dwordx4 v7, s[8:11], s31 offen offset:3072 sc1 lds
  s_add_u32 m0, s35, 0x4000
  s_add_u32 s35, s35, 0x8000
  buffer_load_dwordx4 v4, s[8:11], s32 offen offset:0 sc1 lds
  buffer_load_dwordx4 v5, s[8:11], s32 offen offset:1024 sc1 lds
  buffer_load_dwordx4 v6, s[8:11], s32 offen offset:2048 sc1 lds
  buffer_load_dwordx4 v7, s[8:11], s32 offen offset:3072 sc1 lds
  s_cmp_eq_u32 s35, s56
  s_cselect_b32 s35, s40, s35
  s_add_u32 s32, s31, s34
  s_add_u32 s31, s31, s33
  s_cmp_eq_u32 s28, s29
  s_cselect_b32 s31, s37, s31
  s_cmp_eq_u32 s39, 1
  s_cbranch_scc1 K1_noq
  s_add_u32 s4, s52, 0x6000000
  s_addc_u32 s5, s53, 0
  s_and_b32 s5, s5, 0xffff
  s_mov_b32 s6, 0x8000
  s_mov_b32 s7, 0x20000
  v_mov_b32 v1, s43
K1_qpoll:
  buffer_load_dword v28, v1, s[4:7], 0 offen sc1
  s_waitcnt vmcnt(0)
  v_cmp_ne_u32 vcc, 2, v28
  s_nop 4
  s_cbranch_vccz K1_qok
  s_sleep 2
  s_branch K1_qpoll
K1_qok:
  s_mov_b32 s4, s52
  s_and_b32 s5, s53, 0xffff
  s_mov_b32 s6, 0x3000000
  s_mov_b32 s7, 0x20000
  buffer_load_dwordx4 a[0:3], v9, s[4:7], s96 offen offset:0 sc1
  buffer_load_dwordx4 a[4:7], v9, s[4:7], s96 offen offset:1024 sc1
  buffer_load_dwordx4 a[8:11], v9, s[4:7], s96 offen offset:2048 sc1
  buffer_load_dwordx4 a[12:15], v9, s[4:7], s96 offen offset:3072 sc1
  s_add_u32 s96, s96, 0x1000
  buffer_load_dwordx4 a[16:19], v9, s[4:7], s96 offen offset:0 sc1
  buffer_load_dwordx4 a[20:23], v9, s[4:7], s96 offen offset:1024 sc1
  buffer_load_dwordx4 a[24:27], v9, s[4:7], s96 offen offset:2048 sc1
  buffer_load_dwordx4 a[28:31], v9, s[4:7], s96 offen offset:3072 sc1
  s_add_u32 s96, s96, 0x1000
  buffer_load_dwordx4 a[32:35], v9, s[4:7], s96 offen offset:0 sc1
  buffer_load_dwordx4 a[36:39], v9, s[4:7], s96 offen offset:1024 sc1
  buffer_load_dwordx4 a[40:43], v9, s[4:7], s96 offen offset:2048 sc1
  buffer_load_dwordx4 a[44:47], v9, s[4:7], s96 offen offset:3072 sc1
  s_add_u32 s96, s96, 0x1000
  buffer_load_dwordx4 a[48:51], v9, s[4:7], s96 offen offset:0 sc1
  buffer_load_dwordx4 a[52:55], v9, s[4:7], s96 offen offset:1024 sc1
  buffer_load_dwordx4 a[56:59], v9, s[4:7], s96 offen offset:2048 sc1
  buffer_load_dwordx4 a[60:63], v9, s[4:7], s96 offen offset:3072 sc1
  s_add_u32 s4, s52, 0x6100000
  s_addc_u32 s5, s53, 0
  s_and_b32 s5, s5, 0xffff
  s_mov_b32 s6, 0x1c2000
  s_mov_b32 s7, 0x20000
  s_add_u32 s3, s98, 0x2000
  buffer_store_dwordx4 v[240:243], v238, s[4:7], s98 offen sc1
  buffer_store_dwordx4 v[244:247], v238, s[4:7], s3 offen sc1
  s_add_u32 s4, s52, 0x6400000
  s_addc_u32 s5, s53, 0
  s_and_b32 s5, s5, 0xffff
  s_mov_b32 s6, 0x1c2000
  s_mov_b32 s7, 0x20000
  buffer_store_dwordx4 v[248:251], v239, s[4:7], 0 offen sc1
  buffer_store_dwordx4 v[252:255], v239, s[4:7], 0 offen offset:128 sc1
  s_mov_b32 m0, s35
  s_add_u32 s28, s28, 1
  buffer_load_dwordx4 v4, s[8:11], s31 offen offset:0 sc1 lds
  buffer_load_dwordx4 v5, s[8:11], s31 offen offset:1024 sc1 lds
  buffer_load_dwordx4 v6, s[8:11], s31 offen offset:2048 sc1 lds
  buffer_load_dwordx4 v7, s[8:11], s31 offen offset:3072 sc1 lds
  s_add_u32 m0, s35, 0x4000
  s_add_u32 s35, s35, 0x8000
  buffer_load_dwordx4 v4, s[8:11], s32 offen offset:0 sc1 lds
  buffer_load_dwordx4 v5, s[8:11], s32 offen offset:1024 sc1 lds
  buffer_load_dwordx4 v6, s[8:11], s32 offen offset:2048 sc1 lds
  buffer_load_dwordx4 v7, s[8:11], s32 offen offset:3072 sc1 lds
  s_cmp_eq_u32 s35, s56
  s_cselect_b32 s35, s40, s35
  s_add_u32 s32, s31, s34
  s_add_u32 s31, s31, s33
  s_cmp_eq_u32 s28, s29
  s_cselect_b32 s31, s37, s31
  s_waitcnt vmcnt(12)
  s_branch K1_qd
K1_noq:
  s_add_u32 s4, s52, 0x6100000
  s_addc_u32 s5, s53, 0
  s_and_b32 s5, s5, 0xffff
  s_mov_b32 s6, 0x1c2000
  s_mov_b32 s7, 0x20000
  s_add_u32 s3, s98, 0x2000
  buffer_store_dwordx4 v[240:243], v238, s[4:7], s98 offen sc1
  buffer_store_dwordx4 v[244:247], v238, s[4:7], s3 offen sc1
  s_add_u32 s4, s52, 0x6400000
  s_addc_u32 s5, s53, 0
  s_and_b32 s5, s5, 0xffff
  s_mov_b32 s6, 0x1c2000
  s_mov_b32 s7, 0x20000
  buffer_store_dwordx4 v[248:251], v239, s[4:7], 0 offen sc1
  buffer_store_dwordx4 v[252:255], v239, s[4:7], 0 offen offset:128 sc1
  s_mov_b32 m0, s35
  s_add_u32 s28, s28, 1
  buffer_load_dwordx4 v4, s[8:11], s31 offen offset:0 sc1 lds
  buffer_load_dwordx4 v5, s[8:11], s31 offen offset:1024 sc1 lds
  buffer_load_dwordx4 v6, s[8:11], s31 offen offset:2048 sc1 lds
  buffer_load_dwordx4 v7, s[8:11], s31 offen offset:3072 sc1 lds
  s_add_u32 m0, s35, 0x4000
  s_add_u32 s35, s35, 0x8000
  buffer_load_dwordx4 v4, s[8:11], s32 offen offset:0 sc1 lds
  buffer_load_dwordx4 v5, s[8:11], s32 offen offset:1024 sc1 lds
  buffer_load_dwordx4 v6, s[8:11], s32 offen offset:2048 sc1 lds
  buffer_load_dwordx4 v7, s[8:11], s32 offen offset:3072 sc1 lds
  s_cmp_eq_u32 s35, s56
  s_cselect_b32 s35, s40, s35
  s_add_u32 s32, s31, s34
  s_add_u32 s31, s31, s33
  s_cmp_eq_u32 s28, s29
  s_cselect_b32 s31, s37, s31
K1_qd:
  v_mov_b32 v29, 0
  v_mov_b64 v[238:239], 0
  v_mov_b64 v[240:241], 0
  v_mov_b64 v[242:243], 0
  v_mov_b64 v[244:245], 0
  v_mov_b64 v[246:247], 0
  v_mov_b64 v[248:249], 0
  v_mov_b64 v[250:251], 0
  v_mov_b64 v[252:253], 0
  v_mov_b64 v[254:255], 0
  s_waitcnt vmcnt(16) lgkmcnt(0)
  s_barrier
  s_mov_b32 s85, 4
  s_lshr_b32 s83, s84, 16
  s_or_b32 s83, s83, 0x20000000
K2_seg:
  v_mov_b64 v[10:11], 0
  v_mov_b32 v12, 0xf149f2ca
  v_mov_b32 v13, 0xf149f2ca
  s_cmp_eq_u32 s26, 0
  s_cbranch_scc1 K2_empty
  ds_read_b128 a[128:131], v8 offset:0
  ds_read_b128 a[132:135], v8 offset:1024
  ds_read_b128 a[136:139], v8 offset:2048
  ds_read_b128 a[140:143], v8 offset:3072
  ds_read_b128 a[144:147], v8 offset:4096
  ds_read_b128 a[148:151], v8 offset:5120
  ds_read_b128 a[152:155], v8 offset:6144
  ds_read_b128 a[156:159], v8 offset:7168
  s_cmp_eq_u32 s26, 1
  s_cselect_b32 s4, -1, 0
  v_and_b32 v112, s4, v96
  v_and_b32 v113, s4, v97
  v_and_b32 v114, s4, v98
  v_and_b32 v115, s4, v99
  v_and_b32 v116, s4, v100
  v_and_b32 v117, s4, v101
  v_and_b32 v118, s4, v102
  v_and_b32 v119, s4, v103
  v_and_b32 v120, s4, v104
  v_and_b32 v121, s4, v105
  v_and_b32 v122, s4, v106
  v_and_b32 v123, s4, v107
  v_and_b32 v124, s4, v108
  v_and_b32 v125, s4, v109
  v_and_b32 v126, s4, v110
  v_and_b32 v127, s4, v111
  s_cmp_eq_u32 s28, s29
  s_cselect_b32 s31, s37, s31
  s_cmp_eq_u32 s28, s30
  s_cbranch_scc0 K2_swb_2
  s_getpc_b64 s[58:59]
  s_add_u32 s58, s58, 12
  s_addc_u32 s59, s59, 0
  s_branch K2_switch
K2_swb_2:
  s_waitcnt lgkmcnt(4)
  v_mfma_f32_16x16x32_bf16 v[80:83], a[128:131], a[0:3], v[112:115]
  s_mov_b32 m0, s35
  ds_read_b128 a[160:163], v8 offset:8192
  v_mfma_f32_16x16x32_bf16 v[88:91], a[128:131], a[4:7], v[120:123]
  v_mfma_f32_16x16x32_bf16 v[80:83], a[132:135], a[8:11], v[80:83]
  ds_read_b128 a[164:167], v8 offset:9216
  v_mfma_f32_16x16x32_bf16 v[88:91], a[132:135], a[12:15], v[88:91]
  buffer_load_dwordx4 v4, s[8:11], s31 offen offset:0 sc1 lds
  v_mfma_f32_16x16x32_bf16 v[80:83], a[136:139], a[16:19], v[80:83]
  ds_read_b128 a[168:171], v8 offset:10240
  v_mfma_f32_16x16x32_bf16 v[88:91], a[136:139], a[20:23], v[88:91]
  buffer_load_dwordx4 v5, s[8:11], s31 offen offset:1024 sc1 lds
  v_mfma_f32_16x16x32_bf16 v[80:83], a[140:143], a[24:27], v[80:83]
  ds_read_b128 a[172:175], v8 offset:11264
  v_mfma_f32_16x16x32_bf16 v[88:91], a[140:143], a[28:31], v[88:91]
  s_waitcnt lgkmcnt(4)
  v_mfma_f32_16x16x32_bf16 v[80:83], a[144:147], a[32:35], v[80:83]
  ds_read_b128 a[176:179], v8 offset:12288
  v_mfma_f32_16x16x32_bf16 v[88:91], a[144:147], a[36:39], v[88:91]
  buffer_load_dwordx4 v6, s[8:11], s31 offen offset:2048 sc1 lds
  v_mfma_f32_16x16x32_bf16 v[80:83], a[148:151], a[40:43], v[80:83]
  ds_read_b128 a[180:183], v8 offset:13312
  v_mfma_f32_16x16x32_bf16 v[88:91], a[148:151], a[44:47], v[88:91]
  buffer_load_dwordx4 v7, s[8:11], s31 offen offset:3072 sc1 lds
  v_mfma_f32_16x16x32_bf16 v[80:83], a[152:155], a[48:51], v[80:83]
  ds_read_b128 a[184:187], v8 offset:14336
  v_mfma_f32_16x16x32_bf16 v[88:91], a[152:155], a[52:55], v[88:91]
  s_add_u32 m0, s35, 0x4000
  v_mfma_f32_16x16x32_bf16 v[80:83], a[156:159], a[56:59], v[80:83]
  ds_read_b128 a[188:191], v8 offset:15360
  v_mfma_f32_16x16x32_bf16 v[88:91], a[156:159], a[60:63], v[88:91]
  s_waitcnt lgkmcnt(4)
  v_mfma_f32_16x16x32_bf16 v[84:87], a[160:163], a[0:3], v[116:119]
  buffer_load_dwordx4 v4, s[8:11], s32 offen offset:0 sc1 lds
  v_mfma_f32_16x16x32_bf16 v[92:95], a[160:163], a[4:7], v[124:127]
  v_mfma_f32_16x16x32_bf16 v[84:87], a[164:167], a[8:11], v[84:87]
  buffer_load_dwordx4 v5, s[8:11], s32 offen offset:1024 sc1 lds
  v_mfma_f32_16x16x32_bf16 v[92:95], a[164:167], a[12:15], v[92:95]
  v_mfma_f32_16x16x32_bf16 v[84:87], a[168:171], a[16:19], v[84:87]
  s_add_u32 s28, s28, 1
  s_add_u32 s35, s35, 0x8000
  v_mfma_f32_16x16x32_bf16 v[92:95], a[168:171], a[20:23], v[92:95]
  buffer_load_dwordx4 v6, s[8:11], s32 offen offset:2048 sc1 lds
  v_mfma_f32_16x16x32_bf16 v[84:87], a[172:175], a[24:27], v[84:87]
  v_mfma_f32_16x16x32_bf16 v[92:95], a[172:175], a[28:31], v[92:95]
  s_waitcnt lgkmcnt(0)
  v_mfma_f32_16x16x32_bf16 v[84:87], a[176:179], a[32:35], v[84:87]
  buffer_load_dwordx4 v7, s[8:11], s32 offen offset:3072 sc1 lds
  v_mfma_f32_16x16x32_bf16 v[92:95], a[176:179], a[36:39], v[92:95]
  v_mfma_f32_16x16x32_bf16 v[84:87], a[180:183], a[40:43], v[84:87]
  v_mfma_f32_16x16x32_bf16 v[92:95], a[180:183], a[44:47], v[92:95]
  v_mfma_f32_16x16x32_bf16 v[84:87], a[184:187], a[48:51], v[84:87]
  s_cmp_eq_u32 s35, s56
  s_cselect_b32 s35, s40, s35
  v_mfma_f32_16x16x32_bf16 v[92:95], a[184:187], a[52:55], v[92:95]
  s_add_u32 s32, s31, s34
  s_add_u32 s31, s31, s33
  v_mfma_f32_16x16x32_bf16 v[84:87], a[188:191], a[56:59], v[84:87]
  s_cmp_eq_u32 s28, s29
  s_cselect_b32 s31, s37, s31
  v_mfma_f32_16x16x32_bf16 v[92:95], a[188:191], a[60:63], v[92:95]
  s_add_u32 s54, s28, s26
  s_sub_u32 s54, s54, 2
  s_cmp_ge_u32 s46, 1
  s_addc_u32 s3, s28, 0
  s_cmp_eq_u32 s39, 2
  s_cselect_b32 s99, s3, -1
  s_or_b32 s99, s99, s101
  s_add_u32 s3, s28, 1
  s_cmp_eq_u32 s39, 2
  s_cselect_b32 s85, s3, s85
  s_cselect_b32 s83, s100, s83
  s_cbranch_scc1 K2_t0_w2
  s_waitcnt vmcnt(16)
K2_t0_w2:
  s_cselect_b32 s3, 0x2000, s83
  s_cselect_b32 s85, s85, -1
  s_and_b32 s3, s3, 0xffff
  v_mov_b32 v2, 1
  v_lshlrev_b32 v3, 13, v0
  s_add_u32 s4, s52, 0x6008000
  s_addc_u32 s5, s53, 0
  s_and_b32 s5, s5, 0xffff
  s_mov_b32 s6, 0x2000
  s_mov_b32 s7, 0x20000
  s_waitcnt vmcnt(33)
  s_barrier
  buffer_store_dword v2, v3, s[4:7], s3 offen sc1
  s_add_u32 s36, s36, 0x8000
  s_cmp_eq_u32 s36, 0x28000
  s_cselect_b32 s36, 0, s36
  v_add_u32 v8, s36, v9
  ds_read_b128 a[128:131], v8 offset:0
  ds_read_b128 a[132:135], v8 offset:1024
  ds_read_b128 a[136:139], v8 offset:2048
  ds_read_b128 a[140:143], v8 offset:3072
  ds_read_b128 a[144:147], v8 offset:4096
  ds_read_b128 a[148:151], v8 offset:5120
  ds_read_b128 a[152:155], v8 offset:6144
  ds_read_b128 a[156:159], v8 offset:7168
  v_max3_f32 v14, v80, v81, v82
  v_max3_f32 v14, v14, v83, v84
  v_max3_f32 v14, v14, v85, v86
  v_max_f32 v14, v14, v87
  v_max3_f32 v15, v88, v89, v90
  v_max3_f32 v15, v15, v91, v92
  v_max3_f32 v15, v15, v93, v94
  v_max_f32 v15, v15, v95
  v_mov_b32 v18, v14
  v_mov_b32 v19, v15
  s_nop 0
  v_permlane16_swap_b32 v14, v18
  v_permlane16_swap_b32 v15, v19
  s_nop 0
  v_max_f32 v14, v14, v18
  v_max_f32 v15, v15, v19
  v_mov_b32 v18, v14
  v_mov_b32 v19, v15
  s_nop 0
  v_permlane32_swap_b32 v14, v18
  v_permlane32_swap_b32 v15, v19
  s_nop 0
  v_max_f32 v14, v14, v18
  v_max_f32 v15, v15, v19
  v_mov_b64 v[12:13], v[14:15]
  v_sub_f32 v64, 0, v14
  v_sub_f32 v65, 0, v14
  v_sub_f32 v66, 0, v14
  v_sub_f32 v67, 0, v14
  v_sub_f32 v68, 0, v15
  v_sub_f32 v69, 0, v15
  v_sub_f32 v70, 0, v15
  v_sub_f32 v71, 0, v15
  v_pk_add_f32 v[32:33], v[80:81], v[64:65]
  v_pk_add_f32 v[34:35], v[82:83], v[64:65]
  v_pk_add_f32 v[36:37], v[84:85], v[64:65]
  v_pk_add_f32 v[38:39], v[86:87], v[64:65]
  v_pk_add_f32 v[40:41], v[88:89], v[68:69]
  v_pk_add_f32 v[42:43], v[90:91], v[68:69]
  v_pk_add_f32 v[44:45], v[92:93], v[68:69]
  v_pk_add_f32 v[46:47], v[94:95], v[68:69]
  v_exp_f32 v32, v32
  v_add_f32 v112, v64, v96
  v_exp_f32 v33, v33
  v_add_f32 v113, v64, v97
  v_exp_f32 v34, v34
  v_add_f32 v114, v64, v98
  v_exp_f32 v35, v35
  v_add_f32 v115, v64, v99
  v_exp_f32 v36, v36
  v_add_f32 v116, v64, v100
  v_exp_f32 v37, v37
  v_add_f32 v117, v64, v101
  v_exp_f32 v38, v38
  v_add_f32 v118, v64, v102
  v_exp_f32 v39, v39
  v_add_f32 v119, v64, v103
  v_exp_f32 v40, v40
  v_add_f32 v120, v68, v104
  v_exp_f32 v41, v41
  v_add_f32 v121, v68, v105
  v_exp_f32 v42, v42
  v_add_f32 v122, v68, v106
  v_exp_f32 v43, v43
  v_add_f32 v123, v68, v107
  v_exp_f32 v44, v44
  v_add_f32 v124, v68, v108
  v_exp_f32 v45, v45
  v_add_f32 v125, v68, v109
  v_exp_f32 v46, v46
  v_add_f32 v126, v68, v110
  v_exp_f32 v47, v47
  v_add_f32 v127, v68, v111
  s_cmp_eq_u32 s26, 1
  s_cbranch_scc1 K2_tail1
  s_branch K2_ev
.p2align 6
K2_top:
  s_waitcnt lgkmcnt(4)
  v_mfma_f32_16x16x32_bf16 v[80:83], a[128:131], a[0:3], v[64:67]
  s_mov_b32 m0, s35
  ds_read_b128 a[160:163], v8 offset:8192
  v_cvt_pk_bf16_f32 v48, v32, v33
  v_mfma_f32_16x16x32_bf16 v[80:83], a[132:135], a[8:11], v[80:83]
  buffer_load_dwordx4 v4, s[8:11], s31 offen offset:0 sc1 lds
  v_mfma_f32_16x16x32_bf16 v[80:83], a[136:139], a[16:19], v[80:83]
  ds_read_b128 a[164:167], v8 offset:9216
  v_cvt_pk_bf16_f32 v49, v34, v35
  v_mfma_f32_16x16x32_bf16 v[80:83], a[140:143], a[24:27], v[80:83]
  s_waitcnt lgkmcnt(2)
  v_cvt_pk_bf16_f32 v52, v40, v41
  v_cvt_pk_bf16_f32 v53, v42, v43
  v_mfma_f32_16x16x32_bf16 v[80:83], a[144:147], a[32:35], v[80:83]
  ds_read_b128 a[168:171], v8 offset:10240
  v_add_f32 v10, v10, v32
  v_mfma_f32_16x16x32_bf16 v[80:83], a[148:151], a[40:43], v[80:83]
  buffer_load_dwordx4 v5, s[8:11], s31 offen offset:1024 sc1 lds
  v_mfma_f32_16x16x32_bf16 v[80:83], a[152:155], a[48:51], v[80:83]
  ds_read_b128 a[172:175], v8 offset:11264
  v_add_f32 v11, v11, v40
  v_mfma_f32_16x16x32_bf16 v[80:83], a[156:159], a[56:59], v[80:83]
  v_add_f32 v10, v10, v33
  v_add_f32 v11, v11, v41
  v_mfma_f32_16x16x32_bf16 v[88:91], a[128:131], a[4:7], v[68:71]
  ds_read_b128 a[176:179], v8 offset:12288
  v_add_f32 v10, v10, v34
  v_mfma_f32_16x16x32_bf16 v[88:91], a[132:135], a[12:15], v[88:91]
  buffer_load_dwordx4 v6, s[8:11], s31 offen offset:2048 sc1 lds
  v_mfma_f32_16x16x32_bf16 v[88:91], a[136:139], a[20:23], v[88:91]
  ds_read_b128 a[180:183], v8 offset:13312
  v_add_f32 v11, v11, v42
  v_mfma_f32_16x16x32_bf16 v[88:91], a[140:143], a[28:31], v[88:91]
  v_add_f32 v10, v10, v35
  v_add_f32 v11, v11, v43
  v_mfma_f32_16x16x32_bf16 v[88:91], a[144:147], a[36:39], v[88:91]
  ds_read_b128 a[184:187], v8 offset:14336
  v_cvt_pk_bf16_f32 v50, v36, v37
  v_mfma_f32_16x16x32_bf16 v[88:91], a[148:151], a[44:47], v[88:91]
  buffer_load_dwordx4 v7, s[8:11], s31 offen offset:3072 sc1 lds
  v_mfma_f32_16x16x32_bf16 v[88:91], a[152:155], a[52:55], v[88:91]
  s_add_u32 m0, s35, 0x4000
  ds_read_b128 a[188:191], v8 offset:15360
  v_cvt_pk_bf16_f32 v51, v38, v39
  v_mfma_f32_16x16x32_bf16 v[88:91], a[156:159], a[60:63], v[88:91]
  s_waitcnt lgkmcnt(4)
  v_cvt_pk_bf16_f32 v54, v44, v45
  v_cvt_pk_bf16_f32 v55, v46, v47
  v_mfma_f32_16x16x32_bf16 v[84:87], a[160:163], a[0:3], v[64:67]
  ds_read_b128 a[128:131], v8 offset:16384
  v_add_f32 v10, v10, v36
  v_mfma_f32_16x16x32_bf16 v[84:87], a[164:167], a[8:11], v[84:87]
  buffer_load_dwordx4 v4, s[8:11], s32 offen offset:0 sc1 lds
  v_mfma_f32_16x16x32_bf16 v[84:87], a[168:171], a[16:19], v[84:87]
  ds_read_b128 a[132:135], v8 offset:17408
  v_add_f32 v11, v11, v44
  v_mfma_f32_16x16x32_bf16 v[84:87], a[172:175], a[24:27], v[84:87]
  s_waitcnt lgkmcnt(2)
  v_exp_f32 v32, v80
  v_mfma_f32_16x16x32_bf16 v[84:87], a[176:179], a[32:35], v[84:87]
  ds_read_b128 a[136:139], v8 offset:18432
  v_add_f32 v10, v10, v37
  v_mfma_f32_16x16x32_bf16 v[84:87], a[180:183], a[40:43], v[84:87]
  buffer_load_dwordx4 v5, s[8:11], s32 offen offset:1024 sc1 lds
  v_mfma_f32_16x16x32_bf16 v[84:87], a[184:187], a[48:51], v[84:87]
  ds_read_b128 a[140:143], v8 offset:19456
  v_add_f32 v11, v11, v45
  v_mfma_f32_16x16x32_bf16 v[84:87], a[188:191], a[56:59], v[84:87]
  v_exp_f32 v33, v81
  v_mfma_f32_16x16x32_bf16 v[92:95], a[160:163], a[4:7], v[68:71]
  ds_read_b128 a[144:147], v8 offset:20480
  v_add_f32 v10, v10, v38
  v_mfma_f32_16x16x32_bf16 v[92:95], a[164:167], a[12:15], v[92:95]
  buffer_load_dwordx4 v6, s[8:11], s32 offen offset:2048 sc1 lds
  v_mfma_f32_16x16x32_bf16 v[92:95], a[168:171], a[20:23], v[92:95]
  ds_read_b128 a[148:151], v8 offset:21504
  v_add_f32 v11, v11, v46
  v_mfma_f32_16x16x32_bf16 v[92:95], a[172:175], a[28:31], v[92:95]
  v_exp_f32 v34, v82
  v_mfma_f32_16x16x32_bf16 v[92:95], a[176:179], a[36:39], v[92:95]
  ds_read_b128 a[152:155], v8 offset:22528
  v_add_f32 v10, v10, v39
  v_mfma_f32_16x16x32_bf16 v[92:95], a[180:183], a[44:47], v[92:95]
  buffer_load_dwordx4 v7, s[8:11], s32 offen offset:3072 sc1 lds
  v_mfma_f32_16x16x32_bf16 v[92:95], a[184:187], a[52:55], v[92:95]
  s_add_u32 s28, s28, 1
  ds_read_b128 a[156:159], v8 offset:23552
  v_add_f32 v11, v11, v47
  v_mfma_f32_16x16x32_bf16 v[92:95], a[188:191], a[60:63], v[92:95]
  s_waitcnt lgkmcnt(4)
  v_exp_f32 v35, v83
  v_mfma_f32_16x16x32_bf16 v[128:131], a[128:131], v[48:51], v[128:131]
  s_add_u32 s35, s35, 0x8000
  ds_read_b128 a[160:163], v8 offset:24576
  v_mfma_f32_16x16x32_bf16 v[136:139], a[128:131], v[52:55], v[136:139]
  s_cmp_eq_u32 s35, s56
  v_exp_f32 v40, v88
  v_mfma_f32_16x16x32_bf16 v[132:135], a[132:135], v[48:51], v[132:135]
  s_cselect_b32 s35, s40, s35
  ds_read_b128 a[164:167], v8 offset:25600
  v_max3_f32 v14, v80, v81, v82
  v_mfma_f32_16x16x32_bf16 v[140:143], a[132:135], v[52:55], v[140:143]
  s_add_u32 s32, s31, s34
  v_exp_f32 v41, v89
  v_mfma_f32_16x16x32_bf16 v[144:147], a[136:139], v[48:51], v[144:147]
  s_add_u32 s31, s31, s33
  ds_read_b128 a[168:171], v8 offset:26624
  v_max3_f32 v14, v14, v83, v88
  v_mfma_f32_16x16x32_bf16 v[152:155], a[136:139], v[52:55], v[152:155]
  s_cmp_eq_u32 s28, s29
  v_exp_f32 v42, v90
  v_mfma_f32_16x16x32_bf16 v[148:151], a[140:143], v[48:51], v[148:151]
  s_cselect_b32 s31, s37, s31
  ds_read_b128 a[172:175], v8 offset:27648
  v_max3_f32 v14, v14, v89, v90
  v_mfma_f32_16x16x32_bf16 v[156:159], a[140:143], v[52:55], v[156:159]
  s_waitcnt lgkmcnt(4)
  v_exp_f32 v43, v91
  v_mfma_f32_16x16x32_bf16 v[160:163], a[144:147], v[48:51], v[160:163]
  s_add_u32 s36, s36, 0x8000
  ds_read_b128 a[176:179], v8 offset:28672
  v_max_f32 v14, v14, v91
  v_mfma_f32_16x16x32_bf16 v[168:171], a[144:147], v[52:55], v[168:171]
  s_cmp_eq_u32 s36, 0x28000
  v_exp_f32 v36, v84
  v_mfma_f32_16x16x32_bf16 v[164:167], a[148:151], v[48:51], v[164:167]
  s_cselect_b32 s36, 0, s36
  ds_read_b128 a[180:183], v8 offset:29696
  v_max3_f32 v14, v14, v84, v85
  v_mfma_f32_16x16x32_bf16 v[172:175], a[148:151], v[52:55], v[172:175]
  v_exp_f32 v37, v85
  v_mfma_f32_16x16x32_bf16 v[176:179], a[152:155], v[48:51], v[176:179]
  ds_read_b128 a[184:187], v8 offset:30720
  v_max3_f32 v14, v14, v86, v87
  v_mfma_f32_16x16x32_bf16 v[184:187], a[152:155], v[52:55], v[184:187]
  v_exp_f32 v38, v86
  v_mfma_f32_16x16x32_bf16 v[180:183], a[156:159], v[48:51], v[180:183]
  ds_read_b128 a[188:191], v8 offset:31744
  v_max3_f32 v14, v14, v92, v93
  v_mfma_f32_16x16x32_bf16 v[188:191], a[156:159], v[52:55], v[188:191]
  s_waitcnt vmcnt(16) lgkmcnt(4)
  s_barrier
  v_add_u32 v8, s36, v9
  v_mfma_f32_16x16x32_bf16 v[192:195], a[160:163], v[48:51], v[192:195]
  ds_read_b128 a[128:131], v8 offset:0
  v_max3_f32 v14, v14, v94, v95
  v_mfma_f32_16x16x32_bf16 v[200:203], a[160:163], v[52:55], v[200:203]
  v_exp_f32 v39, v87
  v_mfma_f32_16x16x32_bf16 v[196:199], a[164:167], v[48:51], v[196:199]
  ds_read_b128 a[132:135], v8 offset:1024
  v_cmp_lt_f32 vcc, 0x41000000, v14
  v_mfma_f32_16x16x32_bf16 v[204:207], a[164:167], v[52:55], v[204:207]
  v_exp_f32 v44, v92
  v_mfma_f32_16x16x32_bf16 v[208:211], a[168:171], v[48:51], v[208:211]
  ds_read_b128 a[136:139], v8 offset:2048
  v_mfma_f32_16x16x32_bf16 v[216:219], a[168:171], v[52:55], v[216:219]
  v_exp_f32 v45, v93
  v_mfma_f32_16x16x32_bf16 v[212:215], a[172:175], v[48:51], v[212:215]
  ds_read_b128 a[140:143], v8 offset:3072
  v_mfma_f32_16x16x32_bf16 v[220:223], a[172:175], v[52:55], v[220:223]
  s_waitcnt lgkmcnt(4)
  v_exp_f32 v46, v94
  v_mfma_f32_16x16x32_bf16 v[224:227], a[176:179], v[48:51], v[224:227]
  ds_read_b128 a[144:147], v8 offset:4096
  v_mfma_f32_16x16x32_bf16 v[232:235], a[176:179], v[52:55], v[232:235]
  v_exp_f32 v47, v95
  v_mfma_f32_16x16x32_bf16 v[228:231], a[180:183], v[48:51], v[228:231]
  ds_read_b128 a[148:151], v8 offset:5120
  v_mfma_f32_16x16x32_bf16 v[236:239], a[180:183], v[52:55], v[236:239]
  v_mfma_f32_16x16x32_bf16 v[240:243], a[184:187], v[48:51], v[240:243]
  s_cmp_eq_u32 s28, s50
  ds_read_b128 a[152:155], v8 offset:6144
  v_mfma_f32_16x16x32_bf16 v[248:251], a[184:187], v[52:55], v[248:251]
  v_mfma_f32_16x16x32_bf16 v[244:247], a[188:191], v[48:51], v[244:247]
  ds_read_b128 a[156:159], v8 offset:7168
  v_mfma_f32_16x16x32_bf16 v[252:255], a[188:191], v[52:55], v[252:255]
  s_cbranch_vccnz K2_rare_0
K2_rb_0:
  s_cbranch_scc0 K2_top
K2_ev:
  s_cmp_eq_u32 s28, s30
  s_cbranch_scc1 K2_act_sw
K2_ev1:
  s_cmp_ge_u32 s28, s85
  s_cbranch_scc1 K2_act_pub
K2_ev1b:
  s_cmp_eq_u32 s28, s99
  s_cbranch_scc1 K2_act_ff
K2_ev2:
  s_cmp_eq_u32 s28, s54
  s_cbranch_scc0 K2_next
  buffer_load_dword v29, v27, s[20:23], 0 offen sc1
  s_waitcnt lgkmcnt(4)
  v_mfma_f32_16x16x32_bf16 v[80:83], a[128:131], a[0:3], v[112:115]
  s_mov_b32 m0, s35
  ds_read_b128 a[160:163], v8 offset:8192
  v_cvt_pk_bf16_f32 v48, v32, v33
  v_mfma_f32_16x16x32_bf16 v[80:83], a[132:135], a[8:11], v[80:83]
  buffer_load_dwordx4 v4, s[8:11], s31 offen offset:0 sc1 lds
  v_mfma_f32_16x16x32_bf16 v[80:83], a[136:139], a[16:19], v[80:83]
  ds_read_b128 a[164:167], v8 offset:9216
  v_cvt_pk_bf16_f32 v49, v34, v35
  v_mfma_f32_16x16x32_bf16 v[80:83], a[140:143], a[24:27], v[80:83]
  s_waitcnt lgkmcnt(2)
  v_cvt_pk_bf16_f32 v52, v40, v41
  v_cvt_pk_bf16_f32 v53, v42, v43
  v_mfma_f32_16x16x32_bf16 v[80:83], a[144:147], a[32:35], v[80:83]
  ds_read_b128 a[168:171], v8 offset:10240
  v_add_f32 v10, v10, v32
  v_mfma_f32_16x16x32_bf16 v[80:83], a[148:151], a[40:43], v[80:83]
  buffer_load_dwordx4 v5, s[8:11], s31 offen offset:1024 sc1 lds
  v_mfma_f32_16x16x32_bf16 v[80:83], a[152:155], a[48:51], v[80:83]
  ds_read_b128 a[172:175], v8 offset:11264
  v_add_f32 v11, v11, v40
  v_mfma_f32_16x16x32_bf16 v[80:83], a[156:159], a[56:59], v[80:83]
  v_add_f32 v10, v10, v33
  v_add_f32 v11, v11, v41
  v_mfma_f32_16x16x32_bf16 v[88:91], a[128:131], a[4:7], v[120:123]
  ds_read_b128 a[176:179], v8 offset:12288
  v_add_f32 v10, v10, v34
  v_mfma_f32_16x16x32_bf16 v[88:91], a[132:135], a[12:15], v[88:91]
  buffer_load_dwordx4 v6, s[8:11], s31 offen offset:2048 sc1 lds
  v_mfma_f32_16x16x32_bf16 v[88:91], a[136:139], a[20:23], v[88:91]
  ds_read_b128 a[180:183], v8 offset:13312
  v_add_f32 v11, v11, v42
  v_mfma_f32_16x16x32_bf16 v[88:91], a[140:143], a[28:31], v[88:91]
  v_add_f32 v10, v10, v35
  v_add_f32 v11, v11, v43
  v_mfma_f32_16x16x32_bf16 v[88:91], a[144:147], a[36:39], v[88:91]
  ds_read_b128 a[184:187], v8 offset:14336
  v_cvt_pk_bf16_f32 v50, v36, v37
  v_mfma_f32_16x16x32_bf16 v[88:91], a[148:151], a[44:47], v[88:91]
  buffer_load_dwordx4 v7, s[8:11], s31 offen offset:3072 sc1 lds
  v_mfma_f32_16x16x32_bf16 v[88:91], a[152:155], a[52:55], v[88:91]
  s_add_u32 m0, s35, 0x4000
  ds_read_b128 a[188:191], v8 offset:15360
  v_cvt_pk_bf16_f32 v51, v38, v39
  v_mfma_f32_16x16x32_bf16 v[88:91], a[156:159], a[60:63], v[88:91]
  s_waitcnt lgkmcnt(4)
  v_cvt_pk_bf16_f32 v54, v44, v45
  v_cvt_pk_bf16_f32 v55, v46, v47
  v_mfma_f32_16x16x32_bf16 v[84:87], a[160:163], a[0:3], v[116:119]
  ds_read_b128 a[128:131], v8 offset:16384
  v_add_f32 v10, v10, v36
  v_mfma_f32_16x16x32_bf16 v[84:87], a[164:167], a[8:11], v[84:87]
  buffer_load_dwordx4 v4, s[8:11], s32 offen offset:0 sc1 lds
  v_mfma_f32_16x16x32_bf16 v[84:87], a[168:171], a[16:19], v[84:87]
  ds_read_b128 a[132:135], v8 offset:17408
  v_add_f32 v11, v11, v44
  v_mfma_f32_16x16x32_bf16 v[84:87], a[172:175], a[24:27], v[84:87]
  s_waitcnt lgkmcnt(2)
  v_exp_f32 v32, v80
  v_mfma_f32_16x16x32_bf16 v[84:87], a[176:179], a[32:35], v[84:87]
  ds_read_b128 a[136:139], v8 offset:18432
  v_add_f32 v10, v10, v37
  v_mfma_f32_16x16x32_bf16 v[84:87], a[180:183], a[40:43], v[84:87]
  buffer_load_dwordx4 v5, s[8:11], s32 offen offset:1024 sc1 lds
  v_mfma_f32_16x16x32_bf16 v[84:87], a[184:187], a[48:51], v[84:87]
  ds_read_b128 a[140:143], v8 offset:19456
  v_add_f32 v11, v11, v45
  v_mfma_f32_16x16x32_bf16 v[84:87], a[188:191], a[56:59], v[84:87]
  v_exp_f32 v33, v81
  v_mfma_f32_16x16x32_bf16 v[92:95], a[160:163], a[4:7], v[124:127]
  ds_read_b128 a[144:147], v8 offset:20480
  v_add_f32 v10, v10, v38
  v_mfma_f32_16x16x32_bf16 v[92:95], a[164:167], a[12:15], v[92:95]
  buffer_load_dwordx4 v6, s[8:11], s32 offen offset:2048 sc1 lds
  v_mfma_f32_16x16x32_bf16 v[92:95], a[168:171], a[20:23], v[92:95]
  ds_read_b128 a[148:151], v8 offset:21504
  v_add_f32 v11, v11, v46
  v_mfma_f32_16x16x32_bf16 v[92:95], a[172:175], a[28:31], v[92:95]
  v_exp_f32 v34, v82
  v_mfma_f32_16x16x32_bf16 v[92:95], a[176:179], a[36:39], v[92:95]
  ds_read_b128 a[152:155], v8 offset:22528
  v_add_f32 v10, v10, v39
  v_mfma_f32_16x16x32_bf16 v[92:95], a[180:183], a[44:47], v[92:95]
  buffer_load_dwordx4 v7, s[8:11], s32 offen offset:3072 sc1 lds
  v_mfma_f32_16x16x32_bf16 v[92:95], a[184:187], a[52:55], v[92:95]
  s_add_u32 s28, s28, 1
  ds_read_b128 a[156:159], v8 offset:23552
  v_add_f32 v11, v11, v47
  v_mfma_f32_16x16x32_bf16 v[92:95], a[188:191], a[60:63], v[92:95]
  s_waitcnt lgkmcnt(4)
  v_exp_f32 v35, v83
  v_mfma_f32_16x16x32_bf16 v[128:131], a[128:131], v[48:51], v[128:131]
  s_add_u32 s35, s35, 0x8000
  ds_read_b128 a[160:163], v8 offset:24576
  v_mfma_f32_16x16x32_bf16 v[136:139], a[128:131], v[52:55], v[136:139]
  s_cmp_eq_u32 s35, s56
  v_exp_f32 v40, v88
  v_mfma_f32_16x16x32_bf16 v[132:135], a[132:135], v[48:51], v[132:135]
  s_cselect_b32 s35, s40, s35
  ds_read_b128 a[164:167], v8 offset:25600
  v_max3_f32 v14, v80, v81, v82
  v_mfma_f32_16x16x32_bf16 v[140:143], a[132:135], v[52:55], v[140:143]
  s_add_u32 s32, s31, s34
  v_exp_f32 v41, v89
  v_mfma_f32_16x16x32_bf16 v[144:147], a[136:139], v[48:51], v[144:147]
  s_add_u32 s31, s31, s33
  ds_read_b128 a[168:171], v8 offset:26624
  v_max3_f32 v14, v14, v83, v88
  v_mfma_f32_16x16x32_bf16 v[152:155], a[136:139], v[52:55], v[152:155]
  s_cmp_eq_u32 s28, s29
  v_exp_f32 v42, v90
  v_mfma_f32_16x16x32_bf16 v[148:151], a[140:143], v[48:51], v[148:151]
  s_cselect_b32 s31, s37, s31
  ds_read_b128 a[172:175], v8 offset:27648
  v_max3_f32 v14, v14, v89, v90
  v_mfma_f32_16x16x32_bf16 v[156:159], a[140:143], v[52:55], v[156:159]
  s_waitcnt lgkmcnt(4)
  v_exp_f32 v43, v91
  v_mfma_f32_16x16x32_bf16 v[160:163], a[144:147], v[48:51], v[160:163]
  s_add_u32 s36, s36, 0x8000
  ds_read_b128 a[176:179], v8 offset:28672
  v_max_f32 v14, v14, v91
  v_mfma_f32_16x16x32_bf16 v[168:171], a[144:147], v[52:55], v[168:171]
  s_cmp_eq_u32 s36, 0x28000
  v_exp_f32 v36, v84
  v_mfma_f32_16x16x32_bf16 v[164:167], a[148:151], v[48:51], v[164:167]
  s_cselect_b32 s36, 0, s36
  ds_read_b128 a[180:183], v8 offset:29696
  v_max3_f32 v14, v14, v84, v85
  v_mfma_f32_16x16x32_bf16 v[172:175], a[148:151], v[52:55], v[172:175]
  v_exp_f32 v37, v85
  v_mfma_f32_16x16x32_bf16 v[176:179], a[152:155], v[48:51], v[176:179]
  ds_read_b128 a[184:187], v8 offset:30720
  v_max3_f32 v14, v14, v86, v87
  v_mfma_f32_16x16x32_bf16 v[184:187], a[152:155], v[52:55], v[184:187]
  v_exp_f32 v38, v86
  v_mfma_f32_16x16x32_bf16 v[180:183], a[156:159], v[48:51], v[180:183]
  ds_read_b128 a[188:191], v8 offset:31744
  v_max3_f32 v14, v14, v92, v93
  v_mfma_f32_16x16x32_bf16 v[188:191], a[156:159], v[52:55], v[188:191]
  s_waitcnt vmcnt(16) lgkmcnt(4)
  s_barrier
  v_add_u32 v8, s36, v9
  v_mfma_f32_16x16x32_bf16 v[192:195], a[160:163], v[48:51], v[192:195]
  ds_read_b128 a[128:131], v8 offset:16384
  v_max3_f32 v14, v14, v94, v95
  v_mfma_f32_16x16x32_bf16 v[200:203], a[160:163], v[52:55], v[200:203]
  v_exp_f32 v39, v87
  v_mfma_f32_16x16x32_bf16 v[196:199], a[164:167], v[48:51], v[196:199]
  ds_read_b128 a[132:135], v8 offset:17408
  v_cmp_lt_f32 vcc, 0x41000000, v14
  v_mfma_f32_16x16x32_bf16 v[204:207], a[164:167], v[52:55], v[204:207]
  v_exp_f32 v44, v92
  v_mfma_f32_16x16x32_bf16 v[208:211], a[168:171], v[48:51], v[208:211]
  ds_read_b128 a[136:139], v8 offset:18432
  v_mfma_f32_16x16x32_bf16 v[216:219], a[168:171], v[52:55], v[216:219]
  v_exp_f32 v45, v93
  v_mfma_f32_16x16x32_bf16 v[212:215], a[172:175], v[48:51], v[212:215]
  ds_read_b128 a[140:143], v8 offset:19456
  v_mfma_f32_16x16x32_bf16 v[220:223], a[172:175], v[52:55], v[220:223]
  s_waitcnt lgkmcnt(4)
  v_exp_f32 v46, v94
  v_mfma_f32_16x16x32_bf16 v[224:227], a[176:179], v[48:51], v[224:227]
  ds_read_b128 a[144:147], v8 offset:20480
  v_mfma_f32_16x16x32_bf16 v[232:235], a[176:179], v[52:55], v[232:235]
  v_exp_f32 v47, v95
  v_mfma_f32_16x16x32_bf16 v[228:231], a[180:183], v[48:51], v[228:231]
  ds_read_b128 a[148:151], v8 offset:21504
  v_mfma_f32_16x16x32_bf16 v[236:239], a[180:183], v[52:55], v[236:239]
  s_waitcnt vmcnt(8)
  v_readfirstlane_b32 s96, v29
  v_mfma_f32_16x16x32_bf16 v[240:243], a[184:187], v[48:51], v[240:243]
  s_cmp_eq_u32 s39, 2
  ds_read_b128 a[152:155], v8 offset:22528
  v_mfma_f32_16x16x32_bf16 v[248:251], a[184:187], v[52:55], v[248:251]
  v_mfma_f32_16x16x32_bf16 v[244:247], a[188:191], v[48:51], v[244:247]
  ds_read_b128 a[156:159], v8 offset:23552
  v_mfma_f32_16x16x32_bf16 v[252:255], a[188:191], v[52:55], v[252:255]
  s_cbranch_vccnz K2_rare_1
K2_rb_1:
  s_cbranch_scc0 K2_aux
K2_tailsel:
  s_cmp_eq_u32 s25, s26
  s_cbranch_scc0 K2_tail
  v_cvt_pk_bf16_f32 v48, v32, v33
  v_cvt_pk_bf16_f32 v49, v34, v35
  v_cvt_pk_bf16_f32 v52, v40, v41
  v_cvt_pk_bf16_f32 v53, v42, v43
  v_cvt_pk_bf16_f32 v50, v36, v37
  v_cvt_pk_bf16_f32 v51, v38, v39
  v_cvt_pk_bf16_f32 v54, v44, v45
  v_cvt_pk_bf16_f32 v55, v46, v47
  s_waitcnt lgkmcnt(4)
  v_mfma_f32_16x16x32_bf16 v[128:131], a[128:131], v[48:51], v[128:131]
  s_mov_b32 m0, s35
  ds_read_b128 a[160:163], v8 offset:24576
  v_add_f32 v10, v10, v32
  v_mfma_f32_16x16x32_bf16 v[136:139], a[128:131], v[52:55], v[136:139]
  buffer_load_dwordx4 v4, s[8:11], s31 offen offset:0 sc1 lds
  v_mfma_f32_16x16x32_bf16 v[132:135], a[132:135], v[48:51], v[132:135]
  s_add_u32 s28, s28, 1
  ds_read_b128 a[164:167], v8 offset:25600
  v_add_f32 v11, v11, v40
  v_mfma_f32_16x16x32_bf16 v[140:143], a[132:135], v[52:55], v[140:143]
  buffer_load_dwordx4 v5, s[8:11], s31 offen offset:1024 sc1 lds
  v_mfma_f32_16x16x32_bf16 v[144:147], a[136:139], v[48:51], v[144:147]
  s_add_u32 s36, s36, 0x8000
  ds_read_b128 a[168:171], v8 offset:26624
  v_add_f32 v10, v10, v33
  v_mfma_f32_16x16x32_bf16 v[152:155], a[136:139], v[52:55], v[152:155]
  s_cmp_eq_u32 s36, 0x28000
  buffer_load_dwordx4 v6, s[8:11], s31 offen offset:2048 sc1 lds
  v_mfma_f32_16x16x32_bf16 v[148:151], a[140:143], v[48:51], v[148:151]
  s_cselect_b32 s36, 0, s36
  ds_read_b128 a[172:175], v8 offset:27648
  v_add_f32 v11, v11, v41
  v_mfma_f32_16x16x32_bf16 v[156:159], a[140:143], v[52:55], v[156:159]
  s_waitcnt lgkmcnt(4)
  v_add_f32 v10, v10, v34
  v_add_f32 v11, v11, v42
  v_mfma_f32_16x16x32_bf16 v[160:163], a[144:147], v[48:51], v[160:163]
  ds_read_b128 a[176:179], v8 offset:28672
  v_add_f32 v10, v10, v35
  v_mfma_f32_16x16x32_bf16 v[168:171], a[144:147], v[52:55], v[168:171]
  buffer_load_dwordx4 v7, s[8:11], s31 offen offset:3072 sc1 lds
  v_mfma_f32_16x16x32_bf16 v[164:167], a[148:151], v[48:51], v[164:167]
  s_add_u32 m0, s35, 0x4000
  ds_read_b128 a[180:183], v8 offset:29696
  v_add_f32 v11, v11, v43
  v_mfma_f32_16x16x32_bf16 v[172:175], a[148:151], v[52:55], v[172:175]
  buffer_load_dwordx4 v4, s[8:11], s32 offen offset:0 sc1 lds
  v_mfma_f32_16x16x32_bf16 v[176:179], a[152:155], v[48:51], v[176:179]
  s_add_u32 s35, s35, 0x8000
  ds_read_b128 a[184:187], v8 offset:30720
  v_add_f32 v10, v10, v36
  v_mfma_f32_16x16x32_bf16 v[184:187], a[152:155], v[52:55], v[184:187]
  s_cmp_eq_u32 s35, s56
  buffer_load_dwordx4 v5, s[8:11], s32 offen offset:1024 sc1 lds
  v_mfma_f32_16x16x32_bf16 v[180:183], a[156:159], v[48:51], v[180:183]
  s_cselect_b32 s35, s40, s35
  ds_read_b128 a[188:191], v8 offset:31744
  v_add_f32 v11, v11, v44
  v_mfma_f32_16x16x32_bf16 v[188:191], a[156:159], v[52:55], v[188:191]
  s_waitcnt lgkmcnt(4)
  buffer_load_dwordx4 v6, s[8:11], s32 offen offset:2048 sc1 lds
  v_mfma_f32_16x16x32_bf16 v[192:195], a[160:163], v[48:51], v[192:195]
  buffer_load_dwordx4 v7, s[8:11], s32 offen offset:3072 sc1 lds
  v_mfma_f32_16x16x32_bf16 v[200:203], a[160:163], v[52:55], v[200:203]
  s_add_u32 s32, s31, s34
  v_add_u32 v60, s36, v56
  v_add_u32 v61, s36, v57
  v_mfma_f32_16x16x32_bf16 v[196:199], a[164:167], v[48:51], v[196:199]
  s_waitcnt vmcnt(16)
  s_barrier
  v_add_u32 v62, s36, v58
  v_add_u32 v63, s36, v59
  v_mfma_f32_16x16x32_bf16 v[204:207], a[164:167], v[52:55], v[204:207]
  s_waitcnt lgkmcnt(0)
  ds_read_b64_tr_b16 a[128:129], v60 offset:0
  ds_read_b64_tr_b16 a[130:131], v60 offset:2048
  v_mfma_f32_16x16x32_bf16 v[208:211], a[168:171], v[48:51], v[208:211]
  s_add_u32 s31, s31, s33
  ds_read_b64_tr_b16 a[132:133], v60 offset:4096
  v_add_f32 v10, v10, v37
  v_add_f32 v11, v11, v45
  v_add_f32 v10, v10, v38
  v_add_f32 v11, v11, v46
  v_add_f32 v10, v10, v39
  v_add_f32 v11, v11, v47
  v_mfma_f32_16x16x32_bf16 v[216:219], a[168:171], v[52:55], v[216:219]
  ds_read_b64_tr_b16 a[134:135], v60 offset:6144
  v_mov_b32 v18, v10
  v_mov_b32 v19, v11
  v_mfma_f32_16x16x32_bf16 v[212:215], a[172:175], v[48:51], v[212:215]
  ds_read_b64_tr_b16 a[136:137], v61 offset:0
  v_mfma_f32_16x16x32_bf16 v[220:223], a[172:175], v[52:55], v[220:223]
  ds_read_b64_tr_b16 a[138:139], v61 offset:2048
  v_permlane16_swap_b32 v10, v18
  v_permlane16_swap_b32 v11, v19
  v_mfma_f32_16x16x32_bf16 v[224:227], a[176:179], v[48:51], v[224:227]
  ds_read_b64_tr_b16 a[140:141], v61 offset:4096
  v_add_f32 v10, v10, v18
  v_add_f32 v11, v11, v19
  v_mfma_f32_16x16x32_bf16 v[232:235], a[176:179], v[52:55], v[232:235]
  ds_read_b64_tr_b16 a[142:143], v61 offset:6144
  v_mov_b32 v18, v10
  v_mov_b32 v19, v11
  v_mfma_f32_16x16x32_bf16 v[228:231], a[180:183], v[48:51], v[228:231]
  ds_read_b64_tr_b16 a[144:145], v62 offset:0
  v_mfma_f32_16x16x32_bf16 v[236:239], a[180:183], v[52:55], v[236:239]
  ds_read_b64_tr_b16 a[146:147], v62 offset:2048
  v_permlane32_swap_b32 v10, v18
  v_permlane32_swap_b32 v11, v19
  v_mfma_f32_16x16x32_bf16 v[240:243], a[184:187], v[48:51], v[240:243]
  ds_read_b64_tr_b16 a[148:149], v62 offset:4096
  v_add_f32 v10, v10, v18
  v_add_f32 v11, v11, v19
  v_mfma_f32_16x16x32_bf16 v[248:251], a[184:187], v[52:55], v[248:251]
  ds_read_b64_tr_b16 a[150:151], v62 offset:6144
  v_mfma_f32_16x16x32_bf16 v[244:247], a[188:191], v[48:51], v[244:247]
  s_cmp_eq_u32 s39, 1
  ds_read_b64_tr_b16 a[152:153], v63 offset:0
  v_mfma_f32_16x16x32_bf16 v[252:255], a[188:191], v[52:55], v[252:255]
  ds_read_b64_tr_b16 a[154:155], v63 offset:2048
  s_cbranch_scc1 K2_merge2
  s_branch K2_norm2
K2_tail:
  v_cvt_pk_bf16_f32 v48, v32, v33
  v_cvt_pk_bf16_f32 v49, v34, v35
  v_cvt_pk_bf16_f32 v52, v40, v41
  v_cvt_pk_bf16_f32 v53, v42, v43
  v_cvt_pk_bf16_f32 v50, v36, v37
  v_cvt_pk_bf16_f32 v51, v38, v39
  v_cvt_pk_bf16_f32 v54, v44, v45
  v_cvt_pk_bf16_f32 v55, v46, v47
  s_waitcnt lgkmcnt(4)
  v_mfma_f32_16x16x32_bf16 v[128:131], a[128:131], v[48:51], v[128:131]
  ds_read_b128 a[160:163], v8 offset:24576
  v_add_f32 v10, v10, v32
  v_mfma_f32_16x16x32_bf16 v[136:139], a[128:131], v[52:55], v[136:139]
  v_add_f32 v11, v11, v40
  v_add_f32 v10, v10, v33
  v_mfma_f32_16x16x32_bf16 v[132:135], a[132:135], v[48:51], v[132:135]
  ds_read_b128 a[164:167], v8 offset:25600
  v_add_f32 v11, v11, v41
  v_mfma_f32_16x16x32_bf16 v[140:143], a[132:135], v[52:55], v[140:143]
  v_add_f32 v10, v10, v34
  v_add_f32 v11, v11, v42
  v_mfma_f32_16x16x32_bf16 v[144:147], a[136:139], v[48:51], v[144:147]
  ds_read_b128 a[168:171], v8 offset:26624
  v_add_f32 v10, v10, v35
  v_mfma_f32_16x16x32_bf16 v[152:155], a[136:139], v[52:55], v[152:155]
  v_add_f32 v11, v11, v43
  v_add_f32 v10, v10, v36
  v_mfma_f32_16x16x32_bf16 v[148:151], a[140:143], v[48:51], v[148:151]
  ds_read_b128 a[172:175], v8 offset:27648
  v_add_f32 v11, v11, v44
  v_mfma_f32_16x16x32_bf16 v[156:159], a[140:143], v[52:55], v[156:159]
  s_waitcnt lgkmcnt(4)
  v_add_f32 v10, v10, v37
  v_add_f32 v11, v11, v45
  v_mfma_f32_16x16x32_bf16 v[160:163], a[144:147], v[48:51], v[160:163]
  ds_read_b128 a[176:179], v8 offset:28672
  v_add_f32 v10, v10, v38
  v_mfma_f32_16x16x32_bf16 v[168:171], a[144:147], v[52:55], v[168:171]
  v_add_f32 v11, v11, v46
  v_add_f32 v10, v10, v39
  v_mfma_f32_16x16x32_bf16 v[164:167], a[148:151], v[48:51], v[164:167]
  ds_read_b128 a[180:183], v8 offset:29696
  v_add_f32 v11, v11, v47
  v_mfma_f32_16x16x32_bf16 v[172:175], a[148:151], v[52:55], v[172:175]
  v_mov_b32 v18, v10
  v_mov_b32 v19, v11
  v_mfma_f32_16x16x32_bf16 v[176:179], a[152:155], v[48:51], v[176:179]
  ds_read_b128 a[184:187], v8 offset:30720
  v_mfma_f32_16x16x32_bf16 v[184:187], a[152:155], v[52:55], v[184:187]
  v_permlane16_swap_b32 v10, v18
  v_permlane16_swap_b32 v11, v19
  v_mfma_f32_16x16x32_bf16 v[180:183], a[156:159], v[48:51], v[180:183]
  ds_read_b128 a[188:191], v8 offset:31744
  v_add_f32 v10, v10, v18
  v_mfma_f32_16x16x32_bf16 v[188:191], a[156:159], v[52:55], v[188:191]
  s_waitcnt lgkmcnt(4)
  v_add_f32 v11, v11, v19
  v_mov_b32 v18, v10
  v_mfma_f32_16x16x32_bf16 v[192:195], a[160:163], v[48:51], v[192:195]
  v_mov_b32 v19, v11
  v_mfma_f32_16x16x32_bf16 v[200:203], a[160:163], v[52:55], v[200:203]
  v_mfma_f32_16x16x32_bf16 v[196:199], a[164:167], v[48:51], v[196:199]
  v_permlane32_swap_b32 v10, v18
  v_permlane32_swap_b32 v11, v19
  v_mfma_f32_16x16x32_bf16 v[204:207], a[164:167], v[52:55], v[204:207]
  v_add_f32 v10, v10, v18
  v_add_f32 v11, v11, v19
  v_mfma_f32_16x16x32_bf16 v[208:211], a[168:171], v[48:51], v[208:211]
  v_mfma_f32_16x16x32_bf16 v[216:219], a[168:171], v[52:55], v[216:219]
  v_mfma_f32_16x16x32_bf16 v[212:215], a[172:175], v[48:51], v[212:215]
  v_mfma_f32_16x16x32_bf16 v[220:223], a[172:175], v[52:55], v[220:223]
  s_waitcnt lgkmcnt(0)
  v_mfma_f32_16x16x32_bf16 v[224:227], a[176:179], v[48:51], v[224:227]
  v_mfma_f32_16x16x32_bf16 v[232:235], a[176:179], v[52:55], v[232:235]
  v_mfma_f32_16x16x32_bf16 v[228:231], a[180:183], v[48:51], v[228:231]
  s_sub_u32 s38, s25, s26
  v_mfma_f32_16x16x32_bf16 v[236:239], a[180:183], v[52:55], v[236:239]
  s_cmp_eq_u32 s38, 0
  v_mfma_f32_16x16x32_bf16 v[240:243], a[184:187], v[48:51], v[240:243]
  v_mfma_f32_16x16x32_bf16 v[248:251], a[184:187], v[52:55], v[248:251]
  v_mfma_f32_16x16x32_bf16 v[244:247], a[188:191], v[48:51], v[244:247]
  v_mfma_f32_16x16x32_bf16 v[252:255], a[188:191], v[52:55], v[252:255]
  s_cbranch_scc0 K2_idle
K2_segend:
  s_cmp_eq_u32 s39, 0
  s_cbranch_scc1 K2_partial
  s_cmp_eq_u32 s28, s29
  s_cselect_b32 s31, s37, s31
  s_cmp_eq_u32 s28, s30
  s_cbranch_scc0 K2_swb_3
  s_getpc_b64 s[58:59]
  s_add_u32 s58, s58, 12
  s_addc_u32 s59, s59, 0
  s_branch K2_switch
K2_swb_3:
  s_mov_b32 m0, s35
  s_add_u32 s28, s28, 1
  buffer_load_dwordx4 v4, s[8:11], s31 offen offset:0 sc1 lds
  buffer_load_dwordx4 v5, s[8:11], s31 offen offset:1024 sc1 lds
  buffer_load_dwordx4 v6, s[8:11], s31 offen offset:2048 sc1 lds
  buffer_load_dwordx4 v7, s[8:11], s31 offen offset:3072 sc1 lds
  s_add_u32 m0, s35, 0x4000
  s_add_u32 s35, s35, 0x8000
  buffer_load_dwordx4 v4, s[8:11], s32 offen offset:0 sc1 lds
  buffer_load_dwordx4 v5, s[8:11], s32 offen offset:1024 sc1 lds
  buffer_load_dwordx4 v6, s[8:11], s32 offen offset:2048 sc1 lds
  buffer_load_dwordx4 v7, s[8:11], s32 offen offset:3072 sc1 lds
  s_cmp_eq_u32 s35, s56
  s_cselect_b32 s35, s40, s35
  s_add_u32 s32, s31, s34
  s_add_u32 s31, s31, s33
  s_cmp_eq_u32 s28, s29
  s_cselect_b32 s31, s37, s31
K2_projs:
  s_waitcnt vmcnt(16)
  s_barrier
  s_add_u32 s36, s36, 0x8000
  s_cmp_eq_u32 s36, 0x28000
  s_cselect_b32 s36, 0, s36
  v_add_u32 v60, s36, v56
  v_add_u32 v61, s36, v57
  v_add_u32 v62, s36, v58
  v_add_u32 v63, s36, v59
  ds_read_b64_tr_b16 a[128:129], v60 offset:0
  ds_read_b64_tr_b16 a[130:131], v60 offset:2048
  ds_read_b64_tr_b16 a[132:133], v60 offset:4096
  ds_read_b64_tr_b16 a[134:135], v60 offset:6144
  ds_read_b64_tr_b16 a[136:137], v61 offset:0
  ds_read_b64_tr_b16 a[138:139], v61 offset:2048
  ds_read_b64_tr_b16 a[140:141], v61 offset:4096
  ds_read_b64_tr_b16 a[142:143], v61 offset:6144
  ds_read_b64_tr_b16 a[144:145], v62 offset:0
  ds_read_b64_tr_b16 a[146:147], v62 offset:2048
  ds_read_b64_tr_b16 a[148:149], v62 offset:4096
  ds_read_b64_tr_b16 a[150:151], v62 offset:6144
  ds_read_b64_tr_b16 a[152:153], v63 offset:0
  ds_read_b64_tr_b16 a[154:155], v63 offset:2048
  s_cmp_eq_u32 s39, 1
  s_cbranch_scc1 K2_merge2
K2_norm2:
  v_rcp_f32 v72, v10
  v_rcp_f32 v73, v11
  v_cvt_pk_bf16_f32 v128, v128, v129
  v_cvt_pk_bf16_f32 v129, v130, v131
  v_cvt_pk_bf16_f32 v130, v132, v133
  v_cvt_pk_bf16_f32 v131, v134, v135
  v_cvt_pk_bf16_f32 v132, v136, v137
  v_cvt_pk_bf16_f32 v133, v138, v139
  v_cvt_pk_bf16_f32 v134, v140, v141
  v_cvt_pk_bf16_f32 v135, v142, v143
  v_cvt_pk_bf16_f32 v136, v144, v145
  v_cvt_pk_bf16_f32 v137, v146, v147
  v_cvt_pk_bf16_f32 v138, v148, v149
  v_cvt_pk_bf16_f32 v139, v150, v151
  v_cvt_pk_bf16_f32 v140, v152, v153
  v_cvt_pk_bf16_f32 v141, v154, v155
  v_cvt_pk_bf16_f32 v142, v156, v157
  v_cvt_pk_bf16_f32 v143, v158, v159
  s_waitcnt lgkmcnt(6)
  v_mfma_f32_16x16x32_bf16 v[96:99], a[128:131], v[128:131], 0
  s_mov_b32 m0, s35
  ds_read_b64_tr_b16 a[156:157], v63 offset:4096
  ds_read_b64_tr_b16 a[158:159], v63 offset:6144
  v_cvt_pk_bf16_f32 v144, v160, v161
  v_cvt_pk_bf16_f32 v145, v162, v163
  v_mfma_f32_16x16x32_bf16 v[96:99], a[132:135], v[136:139], v[96:99]
  buffer_load_dwordx4 v4, s[8:11], s31 offen offset:0 sc1 lds
  v_cvt_pk_bf16_f32 v146, v164, v165
  v_mfma_f32_16x16x32_bf16 v[104:107], a[128:131], v[132:135], 0
  ds_read_b64_tr_b16 a[160:161], v60 offset:8192
  v_cvt_pk_bf16_f32 v147, v166, v167
  v_mfma_f32_16x16x32_bf16 v[104:107], a[132:135], v[140:143], v[104:107]
  ds_read_b64_tr_b16 a[162:163], v60 offset:10240
  v_cvt_pk_bf16_f32 v148, v168, v169
  v_mfma_f32_16x16x32_bf16 v[100:103], a[136:139], v[128:131], 0
  ds_read_b64_tr_b16 a[164:165], v60 offset:12288
  ds_read_b64_tr_b16 a[166:167], v60 offset:14336
  v_cvt_pk_bf16_f32 v149, v170, v171
  v_mfma_f32_16x16x32_bf16 v[100:103], a[140:143], v[136:139], v[100:103]
  buffer_load_dwordx4 v5, s[8:11], s31 offen offset:1024 sc1 lds
  v_cvt_pk_bf16_f32 v150, v172, v173
  v_mfma_f32_16x16x32_bf16 v[108:111], a[136:139], v[132:135], 0
  ds_read_b64_tr_b16 a[168:169], v61 offset:8192
  v_cvt_pk_bf16_f32 v151, v174, v175
  v_mfma_f32_16x16x32_bf16 v[108:111], a[140:143], v[140:143], v[108:111]
  s_waitcnt lgkmcnt(5)
  ds_read_b64_tr_b16 a[170:171], v61 offset:10240
  v_cvt_pk_bf16_f32 v152, v176, v177
  v_cvt_pk_bf16_f32 v153, v178, v179
  v_mfma_f32_16x16x32_bf16 v[112:115], a[144:147], v[128:131], 0
  ds_read_b64_tr_b16 a[172:173], v61 offset:12288
  ds_read_b64_tr_b16 a[174:175], v61 offset:14336
  v_cvt_pk_bf16_f32 v154, v180, v181
  v_mfma_f32_16x16x32_bf16 v[112:115], a[148:151], v[136:139], v[112:115]
  buffer_load_dwordx4 v6, s[8:11], s31 offen offset:2048 sc1 lds
  v_cvt_pk_bf16_f32 v155, v182, v183
  v_mfma_f32_16x16x32_bf16 v[120:123], a[144:147], v[132:135], 0
  ds_read_b64_tr_b16 a[176:177], v62 offset:8192
  v_cvt_pk_bf16_f32 v156, v184, v185
  v_mfma_f32_16x16x32_bf16 v[120:123], a[148:151], v[140:143], v[120:123]
  ds_read_b64_tr_b16 a[178:179], v62 offset:10240
  v_cvt_pk_bf16_f32 v157, v186, v187
  v_mfma_f32_16x16x32_bf16 v[116:119], a[152:155], v[128:131], 0
  ds_read_b64_tr_b16 a[180:181], v62 offset:12288
  ds_read_b64_tr_b16 a[182:183], v62 offset:14336
  v_cvt_pk_bf16_f32 v158, v188, v189
  v_mfma_f32_16x16x32_bf16 v[116:119], a[156:159], v[136:139], v[116:119]
  buffer_load_dwordx4 v7, s[8:11], s31 offen offset:3072 sc1 lds
  v_cvt_pk_bf16_f32 v159, v190, v191
  v_mfma_f32_16x16x32_bf16 v[124:127], a[152:155], v[132:135], 0
  s_add_u32 m0, s35, 0x4000
  ds_read_b64_tr_b16 a[184:185], v63 offset:8192
  v_mfma_f32_16x16x32_bf16 v[124:127], a[156:159], v[140:143], v[124:127]
  s_waitcnt lgkmcnt(5)
  ds_read_b64_tr_b16 a[186:187], v63 offset:10240
  v_mfma_f32_16x16x32_bf16 v[96:99], a[160:163], v[144:147], v[96:99]
  ds_read_b64_tr_b16 a[188:189], v63 offset:12288
  ds_read_b64_tr_b16 a[190:191], v63 offset:14336
  v_cvt_pk_bf16_f32 v160, v192, v193
  v_cvt_pk_bf16_f32 v161, v194, v195
  v_mfma_f32_16x16x32_bf16 v[96:99], a[164:167], v[152:155], v[96:99]
  buffer_load_dwordx4 v4, s[8:11], s32 offen offset:0 sc1 lds
  v_cvt_pk_bf16_f32 v162, v196, v197
  v_mfma_f32_16x16x32_bf16 v[104:107], a[160:163], v[148:151], v[104:107]
  ds_read_b64_tr_b16 a[128:129], v60 offset:16384
  v_cvt_pk_bf16_f32 v163, v198, v199
  v_mfma_f32_16x16x32_bf16 v[104:107], a[164:167], v[156:159], v[104:107]
  ds_read_b64_tr_b16 a[130:131], v60 offset:18432
  v_cvt_pk_bf16_f32 v164, v200, v201
  v_mfma_f32_16x16x32_bf16 v[100:103], a[168:171], v[144:147], v[100:103]
  ds_read_b64_tr_b16 a[132:133], v60 offset:20480
  ds_read_b64_tr_b16 a[134:135], v60 offset:22528
  v_cvt_pk_bf16_f32 v165, v202, v203
  v_mfma_f32_16x16x32_bf16 v[100:103], a[172:175], v[152:155], v[100:103]
  buffer_load_dwordx4 v5, s[8:11], s32 offen offset:1024 sc1 lds
  v_cvt_pk_bf16_f32 v166, v204, v205
  v_mfma_f32_16x16x32_bf16 v[108:111], a[168:171], v[148:151], v[108:111]
  ds_read_b64_tr_b16 a[136:137], v61 offset:16384
  v_cvt_pk_bf16_f32 v167, v206, v207
  v_mfma_f32_16x16x32_bf16 v[108:111], a[172:175], v[156:159], v[108:111]
  s_waitcnt lgkmcnt(5)
  ds_read_b64_tr_b16 a[138:139], v61 offset:18432
  v_cvt_pk_bf16_f32 v168, v208, v209
  v_cvt_pk_bf16_f32 v169, v210, v211
  v_mfma_f32_16x16x32_bf16 v[112:115], a[176:179], v[144:147], v[112:115]
  ds_read_b64_tr_b16 a[140:141], v61 offset:20480
  ds_read_b64_tr_b16 a[142:143], v61 offset:22528
  v_cvt_pk_bf16_f32 v170, v212, v213
  v_mfma_f32_16x16x32_bf16 v[112:115], a[180:183], v[152:155], v[112:115]
  buffer_load_dwordx4 v6, s[8:11], s32 offen offset:2048 sc1 lds
  v_cvt_pk_bf16_f32 v171, v214, v215
  v_mfma_f32_16x16x32_bf16 v[120:123], a[176:179], v[148:151], v[120:123]
  ds_read_b64_tr_b16 a[144:145], v62 offset:16384
  v_cvt_pk_bf16_f32 v172, v216, v217
  v_mfma_f32_16x16x32_bf16 v[120:123], a[180:183], v[156:159], v[120:123]
  ds_read_b64_tr_b16 a[146:147], v62 offset:18432
  v_cvt_pk_bf16_f32 v173, v218, v219
  v_mfma_f32_16x16x32_bf16 v[116:119], a[184:187], v[144:147], v[116:119]
  ds_read_b64_tr_b16 a[148:149], v62 offset:20480
  ds_read_b64_tr_b16 a[150:151], v62 offset:22528
  v_cvt_pk_bf16_f32 v174, v220, v221
  v_mfma_f32_16x16x32_bf16 v[116:119], a[188:191], v[152:155], v[116:119]
  buffer_load_dwordx4 v7, s[8:11], s32 offen offset:3072 sc1 lds
  v_cvt_pk_bf16_f32 v175, v222, v223
  v_mfma_f32_16x16x32_bf16 v[124:127], a[184:187], v[148:151], v[124:127]
  s_add_u32 s35, s35, 0x8000
  ds_read_b64_tr_b16 a[152:153], v63 offset:16384
  v_mfma_f32_16x16x32_bf16 v[124:127], a[188:191], v[156:159], v[124:127]
  s_waitcnt lgkmcnt(5)
  ds_read_b64_tr_b16 a[154:155], v63 offset:18432
  v_mfma_f32_16x16x32_bf16 v[96:99], a[128:131], v[160:163], v[96:99]
  s_cmp_eq_u32 s35, s56
  ds_read_b64_tr_b16 a[156:157], v63 offset:20480
  v_cvt_pk_bf16_f32 v176, v224, v225
  v_cvt_pk_bf16_f32 v177, v226, v227
  v_mfma_f32_16x16x32_bf16 v[96:99], a[132:135], v[168:171], v[96:99]
  s_cselect_b32 s35, s40, s35
  ds_read_b64_tr_b16 a[158:159], v63 offset:22528
  v_cvt_pk_bf16_f32 v178, v228, v229
  v_mfma_f32_16x16x32_bf16 v[104:107], a[128:131], v[164:167], v[104:107]
  s_add_u32 s32, s31, s34
  ds_read_b64_tr_b16 a[160:161], v60 offset:24576
  v_cvt_pk_bf16_f32 v179, v230, v231
  v_mfma_f32_16x16x32_bf16 v[104:107], a[132:135], v[172:175], v[104:107]
  s_add_u32 s31, s31, s33
  ds_read_b64_tr_b16 a[162:163], v60 offset:26624
  v_cvt_pk_bf16_f32 v180, v232, v233
  v_mfma_f32_16x16x32_bf16 v[100:103], a[136:139], v[160:163], v[100:103]
  ds_read_b64_tr_b16 a[164:165], v60 offset:28672
  v_cvt_pk_bf16_f32 v181, v234, v235
  v_mfma_f32_16x16x32_bf16 v[100:103], a[140:143], v[168:171], v[100:103]
  ds_read_b64_tr_b16 a[166:167], v60 offset:30720
  v_cvt_pk_bf16_f32 v182, v236, v237
  v_mfma_f32_16x16x32_bf16 v[108:111], a[136:139], v[164:167], v[108:111]
  ds_read_b64_tr_b16 a[168:169], v61 offset:24576
  v_cvt_pk_bf16_f32 v183, v238, v239
  v_mfma_f32_16x16x32_bf16 v[108:111], a[140:143], v[172:175], v[108:111]
  s_waitcnt lgkmcnt(5)
  ds_read_b64_tr_b16 a[170:171], v61 offset:26624
  v_cvt_pk_bf16_f32 v184, v240, v241
  v_cvt_pk_bf16_f32 v185, v242, v243
  v_mfma_f32_16x16x32_bf16 v[112:115], a[144:147], v[160:163], v[112:115]
  ds_read_b64_tr_b16 a[172:173], v61 offset:28672
  v_cvt_pk_bf16_f32 v186, v244, v245
  v_mfma_f32_16x16x32_bf16 v[112:115], a[148:151], v[168:171], v[112:115]
  ds_read_b64_tr_b16 a[174:175], v61 offset:30720
  v_cvt_pk_bf16_f32 v187, v246, v247
  v_mfma_f32_16x16x32_bf16 v[120:123], a[144:147], v[164:167], v[120:123]
  ds_read_b64_tr_b16 a[176:177], v62 offset:24576
  v_cvt_pk_bf16_f32 v188, v248, v249
  v_mfma_f32_16x16x32_bf16 v[120:123], a[148:151], v[172:175], v[120:123]
  ds_read_b64_tr_b16 a[178:179], v62 offset:26624
  v_cvt_pk_bf16_f32 v189, v250, v251
  v_mfma_f32_16x16x32_bf16 v[116:119], a[152:155], v[160:163], v[116:119]
  s_add_u32 s36, s36, 0x8000
  ds_read_b64_tr_b16 a[180:181], v62 offset:28672
  v_cvt_pk_bf16_f32 v190, v252, v253
  v_mfma_f32_16x16x32_bf16 v[116:119], a[156:159], v[168:171], v[116:119]
  s_cmp_eq_u32 s36, 0x28000
  ds_read_b64_tr_b16 a[182:183], v62 offset:30720
  v_cvt_pk_bf16_f32 v191, v254, v255
  v_mfma_f32_16x16x32_bf16 v[124:127], a[152:155], v[164:167], v[124:127]
  s_cselect_b32 s36, 0, s36
  ds_read_b64_tr_b16 a[184:185], v63 offset:24576
  v_mfma_f32_16x16x32_bf16 v[124:127], a[156:159], v[172:175], v[124:127]
  s_waitcnt lgkmcnt(5)
  ds_read_b64_tr_b16 a[186:187], v63 offset:26624
  v_mfma_f32_16x16x32_bf16 v[96:99], a[160:163], v[176:179], v[96:99]
  ds_read_b64_tr_b16 a[188:189], v63 offset:28672
  v_mfma_f32_16x16x32_bf16 v[96:99], a[164:167], v[184:187], v[96:99]
  s_waitcnt vmcnt(16)
  s_barrier
  ds_read_b64_tr_b16 a[190:191], v63 offset:30720
  v_add_u32 v60, s36, v56
  v_add_u32 v61, s36, v57
  v_add_u32 v62, s36, v58
  v_add_u32 v63, s36, v59
  v_mfma_f32_16x16x32_bf16 v[104:107], a[160:163], v[180:183], v[104:107]
  ds_read_b64_tr_b16 a[128:129], v60 offset:0
  v_mfma_f32_16x16x32_bf16 v[104:107], a[164:167], v[188:191], v[104:107]
  ds_read_b64_tr_b16 a[130:131], v60 offset:2048
  v_mfma_f32_16x16x32_bf16 v[100:103], a[168:171], v[176:179], v[100:103]
  ds_read_b64_tr_b16 a[132:133], v60 offset:4096
  v_mfma_f32_16x16x32_bf16 v[100:103], a[172:175], v[184:187], v[100:103]
  ds_read_b64_tr_b16 a[134:135], v60 offset:6144
  v_mfma_f32_16x16x32_bf16 v[108:111], a[168:171], v[180:183], v[108:111]
  ds_read_b64_tr_b16 a[136:137], v61 offset:0
  v_mfma_f32_16x16x32_bf16 v[108:111], a[172:175], v[188:191], v[108:111]
  s_waitcnt lgkmcnt(5)
  ds_read_b64_tr_b16 a[138:139], v61 offset:2048
  v_mfma_f32_16x16x32_bf16 v[112:115], a[176:179], v[176:179], v[112:115]
  ds_read_b64_tr_b16 a[140:141], v61 offset:4096
  v_mfma_f32_16x16x32_bf16 v[112:115], a[180:183], v[184:187], v[112:115]
  ds_read_b64_tr_b16 a[142:143], v61 offset:6144
  v_mfma_f32_16x16x32_bf16 v[120:123], a[176:179], v[180:183], v[120:123]
  ds_read_b64_tr_b16 a[144:145], v62 offset:0
  v_mfma_f32_16x16x32_bf16 v[120:123], a[180:183], v[188:191], v[120:123]
  ds_read_b64_tr_b16 a[146:147], v62 offset:2048
  v_mfma_f32_16x16x32_bf16 v[116:119], a[184:187], v[176:179], v[116:119]
  ds_read_b64_tr_b16 a[148:149], v62 offset:4096
  v_mfma_f32_16x16x32_bf16 v[116:119], a[188:191], v[184:187], v[116:119]
  ds_read_b64_tr_b16 a[150:151], v62 offset:6144
  v_mfma_f32_16x16x32_bf16 v[124:127], a[184:187], v[180:183], v[124:127]
  ds_read_b64_tr_b16 a[152:153], v63 offset:0
  v_mfma_f32_16x16x32_bf16 v[124:127], a[188:191], v[188:191], v[124:127]
  ds_read_b64_tr_b16 a[154:155], v63 offset:2048
K2_proj1:
  s_waitcnt lgkmcnt(6)
  v_mfma_f32_16x16x32_bf16 v[224:227], a[128:131], v[128:131], 0
  s_mov_b32 m0, s35
  ds_read_b64_tr_b16 a[156:157], v63 offset:4096
  ds_read_b64_tr_b16 a[158:159], v63 offset:6144
  v_mfma_f32_16x16x32_bf16 v[224:227], a[132:135], v[136:139], v[224:227]
  buffer_load_dwordx4 v4, s[8:11], s31 offen offset:0 sc1 lds
  v_mfma_f32_16x16x32_bf16 v[232:235], a[128:131], v[132:135], 0
  ds_read_b64_tr_b16 a[160:161], v60 offset:8192
  v_mfma_f32_16x16x32_bf16 v[232:235], a[132:135], v[140:143], v[232:235]
  ds_read_b64_tr_b16 a[162:163], v60 offset:10240
  v_mul_f32 v96, v96, v72
  v_mul_f32 v97, v97, v72
  v_mfma_f32_16x16x32_bf16 v[228:231], a[136:139], v[128:131], 0
  ds_read_b64_tr_b16 a[164:165], v60 offset:12288
  ds_read_b64_tr_b16 a[166:167], v60 offset:14336
  v_mfma_f32_16x16x32_bf16 v[228:231], a[140:143], v[136:139], v[228:231]
  buffer_load_dwordx4 v5, s[8:11], s31 offen offset:1024 sc1 lds
  v_mfma_f32_16x16x32_bf16 v[236:239], a[136:139], v[132:135], 0
  ds_read_b64_tr_b16 a[168:169], v61 offset:8192
  v_cvt_pk_bf16_f32 v32, v96, v97
  v_mfma_f32_16x16x32_bf16 v[236:239], a[140:143], v[140:143], v[236:239]
  s_waitcnt lgkmcnt(5)
  ds_read_b64_tr_b16 a[170:171], v61 offset:10240
  v_mul_f32 v98, v98, v72
  v_mfma_f32_16x16x32_bf16 v[240:243], a[144:147], v[128:131], 0
  ds_read_b64_tr_b16 a[172:173], v61 offset:12288
  ds_read_b64_tr_b16 a[174:175], v61 offset:14336
  v_mfma_f32_16x16x32_bf16 v[240:243], a[148:151], v[136:139], v[240:243]
  buffer_load_dwordx4 v6, s[8:11], s31 offen offset:2048 sc1 lds
  v_mfma_f32_16x16x32_bf16 v[248:251], a[144:147], v[132:135], 0
  ds_read_b64_tr_b16 a[176:177], v62 offset:8192
  v_mul_f32 v99, v99, v72
  v_cvt_pk_bf16_f32 v33, v98, v99
  v_mfma_f32_16x16x32_bf16 v[248:251], a[148:151], v[140:143], v[248:251]
  ds_read_b64_tr_b16 a[178:179], v62 offset:10240
  v_mul_f32 v100, v100, v72
  v_mfma_f32_16x16x32_bf16 v[244:247], a[152:155], v[128:131], 0
  ds_read_b64_tr_b16 a[180:181], v62 offset:12288
  ds_read_b64_tr_b16 a[182:183], v62 offset:14336
  v_mfma_f32_16x16x32_bf16 v[244:247], a[156:159], v[136:139], v[244:247]
  buffer_load_dwordx4 v7, s[8:11], s31 offen offset:3072 sc1 lds
  v_mfma_f32_16x16x32_bf16 v[252:255], a[152:155], v[132:135], 0
  s_add_u32 m0, s35, 0x4000
  ds_read_b64_tr_b16 a[184:185], v63 offset:8192
  v_mul_f32 v101, v101, v72
  v_mfma_f32_16x16x32_bf16 v[252:255], a[156:159], v[140:143], v[252:255]
  s_waitcnt lgkmcnt(5)
  ds_read_b64_tr_b16 a[186:187], v63 offset:10240
  v_cvt_pk_bf16_f32 v34, v100, v101
  v_mul_f32 v102, v102, v72
  v_mfma_f32_16x16x32_bf16 v[224:227], a[160:163], v[144:147], v[224:227]
  ds_read_b64_tr_b16 a[188:189], v63 offset:12288
  ds_read_b64_tr_b16 a[190:191], v63 offset:14336
  v_mfma_f32_16x16x32_bf16 v[224:227], a[164:167], v[152:155], v[224:227]
  buffer_load_dwordx4 v4, s[8:11], s32 offen offset:0 sc1 lds
  v_mfma_f32_16x16x32_bf16 v[232:235], a[160:163], v[148:151], v[232:235]
  ds_read_b64_tr_b16 a[128:129], v60 offset:16384
  v_mul_f32 v103, v103, v72
  v_mfma_f32_16x16x32_bf16 v[232:235], a[164:167], v[156:159], v[232:235]
  ds_read_b64_tr_b16 a[130:131], v60 offset:18432
  v_cvt_pk_bf16_f32 v35, v102, v103
  v_mfma_f32_16x16x32_bf16 v[228:231], a[168:171], v[144:147], v[228:231]
  ds_read_b64_tr_b16 a[132:133], v60 offset:20480
  ds_read_b64_tr_b16 a[134:135], v60 offset:22528
  v_mfma_f32_16x16x32_bf16 v[228:231], a[172:175], v[152:155], v[228:231]
  buffer_load_dwordx4 v5, s[8:11], s32 offen offset:1024 sc1 lds
  v_mfma_f32_16x16x32_bf16 v[236:239], a[168:171], v[148:151], v[236:239]
  ds_read_b64_tr_b16 a[136:137], v61 offset:16384
  ds_read_b64_tr_b16 a[138:139], v61 offset:18432
  v_mfma_f32_16x16x32_bf16 v[236:239], a[172:175], v[156:159], v[236:239]
  s_waitcnt lgkmcnt(6)
  buffer_store_dwordx4 v[32:35], v9, s[16:19], s41 offen offset:0 sc1
  v_mfma_f32_16x16x32_bf16 v[240:243], a[176:179], v[144:147], v[240:243]
  ds_read_b64_tr_b16 a[140:141], v61 offset:20480
  ds_read_b64_tr_b16 a[142:143], v61 offset:22528
  v_mfma_f32_16x16x32_bf16 v[240:243], a[180:183], v[152:155], v[240:243]
  buffer_load_dwordx4 v6, s[8:11], s32 offen offset:2048 sc1 lds
  v_mfma_f32_16x16x32_bf16 v[248:251], a[176:179], v[148:151], v[248:251]
  ds_read_b64_tr_b16 a[144:145], v62 offset:16384
  v_mul_f32 v104, v104, v73
  v_mul_f32 v105, v105, v73
  v_mfma_f32_16x16x32_bf16 v[248:251], a[180:183], v[156:159], v[248:251]
  ds_read_b64_tr_b16 a[146:147], v62 offset:18432
  v_cvt_pk_bf16_f32 v36, v104, v105
  v_mfma_f32_16x16x32_bf16 v[244:247], a[184:187], v[144:147], v[244:247]
  ds_read_b64_tr_b16 a[148:149], v62 offset:20480
  ds_read_b64_tr_b16 a[150:151], v62 offset:22528
  v_mfma_f32_16x16x32_bf16 v[244:247], a[188:191], v[152:155], v[244:247]
  buffer_load_dwordx4 v7, s[8:11], s32 offen offset:3072 sc1 lds
  v_mfma_f32_16x16x32_bf16 v[252:255], a[184:187], v[148:151], v[252:255]
  s_add_u32 s35, s35, 0x8000
  ds_read_b64_tr_b16 a[152:153], v63 offset:16384
  v_mul_f32 v106, v106, v73
  v_mul_f32 v107, v107, v73
  v_mfma_f32_16x16x32_bf16 v[252:255], a[188:191], v[156:159], v[252:255]
  s_waitcnt lgkmcnt(5)
  ds_read_b64_tr_b16 a[154:155], v63 offset:18432
  v_cvt_pk_bf16_f32 v37, v106, v107
  v_mfma_f32_16x16x32_bf16 v[224:227], a[128:131], v[160:163], v[224:227]
  s_cmp_eq_u32 s35, s56
  ds_read_b64_tr_b16 a[156:157], v63 offset:20480
  v_mul_f32 v108, v108, v73
  v_mul_f32 v109, v109, v73
  v_mfma_f32_16x16x32_bf16 v[224:227], a[132:135], v[168:171], v[224:227]
  s_cselect_b32 s35, s40, s35
  ds_read_b64_tr_b16 a[158:159], v63 offset:22528
  v_cvt_pk_bf16_f32 v38, v108, v109
  v_mfma_f32_16x16x32_bf16 v[232:235], a[128:131], v[164:167], v[232:235]
  s_add_u32 s32, s31, s34
  ds_read_b64_tr_b16 a[160:161], v60 offset:24576
  v_mul_f32 v110, v110, v73
  v_mul_f32 v111, v111, v73
  v_mfma_f32_16x16x32_bf16 v[232:235], a[132:135], v[172:175], v[232:235]
  s_add_u32 s31, s31, s33
  ds_read_b64_tr_b16 a[162:163], v60 offset:26624
  v_cvt_pk_bf16_f32 v39, v110, v111
  v_mfma_f32_16x16x32_bf16 v[228:231], a[136:139], v[160:163], v[228:231]
  ds_read_b64_tr_b16 a[164:165], v60 offset:28672
  ds_read_b64_tr_b16 a[166:167], v60 offset:30720
  v_mfma_f32_16x16x32_bf16 v[228:231], a[140:143], v[168:171], v[228:231]
  buffer_store_dwordx4 v[36:39], v9, s[16:19], s41 offen offset:1024 sc1
  v_mfma_f32_16x16x32_bf16 v[236:239], a[136:139], v[164:167], v[236:239]
  ds_read_b64_tr_b16 a[168:169], v61 offset:24576
  v_mul_f32 v112, v112, v72
  v_mul_f32 v113, v113, v72
  v_mfma_f32_16x16x32_bf16 v[236:239], a[140:143], v[172:175], v[236:239]
  s_waitcnt lgkmcnt(5)
  ds_read_b64_tr_b16 a[170:171], v61 offset:26624
  v_cvt_pk_bf16_f32 v40, v112, v113
  v_mfma_f32_16x16x32_bf16 v[240:243], a[144:147], v[160:163], v[240:243]
  ds_read_b64_tr_b16 a[172:173], v61 offset:28672
  v_mul_f32 v114, v114, v72
  v_mul_f32 v115, v115, v72
  v_mfma_f32_16x16x32_bf16 v[240:243], a[148:151], v[168:171], v[240:243]
  ds_read_b64_tr_b16 a[174:175], v61 offset:30720
  v_cvt_pk_bf16_f32 v41, v114, v115
  v_mfma_f32_16x16x32_bf16 v[248:251], a[144:147], v[164:167], v[248:251]
  ds_read_b64_tr_b16 a[176:177], v62 offset:24576
  v_mul_f32 v116, v116, v72
  v_mul_f32 v117, v117, v72
  v_mfma_f32_16x16x32_bf16 v[248:251], a[148:151], v[172:175], v[248:251]
  ds_read_b64_tr_b16 a[178:179], v62 offset:26624
  v_cvt_pk_bf16_f32 v42, v116, v117
  v_mfma_f32_16x16x32_bf16 v[244:247], a[152:155], v[160:163], v[244:247]
  s_add_u32 s36, s36, 0x8000
  ds_read_b64_tr_b16 a[180:181], v62 offset:28672
  v_mul_f32 v118, v118, v72
  v_mul_f32 v119, v119, v72
  v_mfma_f32_16x16x32_bf16 v[244:247], a[156:159], v[168:171], v[244:247]
  s_cmp_eq_u32 s36, 0x28000
  ds_read_b64_tr_b16 a[182:183], v62 offset:30720
  v_cvt_pk_bf16_f32 v43, v118, v119
  v_mfma_f32_16x16x32_bf16 v[252:255], a[152:155], v[164:167], v[252:255]
  s_cselect_b32 s36, 0, s36
  ds_read_b64_tr_b16 a[184:185], v63 offset:24576
  ds_read_b64_tr_b16 a[186:187], v63 offset:26624
  v_mfma_f32_16x16x32_bf16 v[252:255], a[156:159], v[172:175], v[252:255]
  s_waitcnt lgkmcnt(6)
  buffer_store_dwordx4 v[40:43], v9, s[16:19], s41 offen offset:2048 sc1
  v_mfma_f32_16x16x32_bf16 v[224:227], a[160:163], v[176:179], v[224:227]
  ds_read_b64_tr_b16 a[188:189], v63 offset:28672
  v_mul_f32 v120, v120, v73
  v_mul_f32 v121, v121, v73
  v_mfma_f32_16x16x32_bf16 v[224:227], a[164:167], v[184:187], v[224:227]
  s_waitcnt vmcnt(19)
  s_barrier
  ds_read_b64_tr_b16 a[190:191], v63 offset:30720
  v_add_u32 v60, s36, v56
  v_add_u32 v61, s36, v57
  v_add_u32 v62, s36, v58
  v_add_u32 v63, s36, v59
  v_mfma_f32_16x16x32_bf16 v[232:235], a[160:163], v[180:183], v[232:235]
  ds_read_b64_tr_b16 a[128:129], v60 offset:0
  v_cvt_pk_bf16_f32 v44, v120, v121
  v_mfma_f32_16x16x32_bf16 v[232:235], a[164:167], v[188:191], v[232:235]
  ds_read_b64_tr_b16 a[130:131], v60 offset:2048
  v_mul_f32 v122, v122, v73
  v_mfma_f32_16x16x32_bf16 v[228:231], a[168:171], v[176:179], v[228:231]
  ds_read_b64_tr_b16 a[132:133], v60 offset:4096
  v_mul_f32 v123, v123, v73
  v_mfma_f32_16x16x32_bf16 v[228:231], a[172:175], v[184:187], v[228:231]
  ds_read_b64_tr_b16 a[134:135], v60 offset:6144
  v_cvt_pk_bf16_f32 v45, v122, v123
  v_mfma_f32_16x16x32_bf16 v[236:239], a[168:171], v[180:183], v[236:239]
  ds_read_b64_tr_b16 a[136:137], v61 offset:0
  v_mul_f32 v124, v124, v73
  v_mfma_f32_16x16x32_bf16 v[236:239], a[172:175], v[188:191], v[236:239]
  s_waitcnt lgkmcnt(5)
  ds_read_b64_tr_b16 a[138:139], v61 offset:2048
  v_mul_f32 v125, v125, v73
  v_mfma_f32_16x16x32_bf16 v[240:243], a[176:179], v[176:179], v[240:243]
  ds_read_b64_tr_b16 a[140:141], v61 offset:4096
  v_cvt_pk_bf16_f32 v46, v124, v125
  v_mfma_f32_16x16x32_bf16 v[240:243], a[180:183], v[184:187], v[240:243]
  ds_read_b64_tr_b16 a[142:143], v61 offset:6144
  v_mul_f32 v126, v126, v73
  v_mfma_f32_16x16x32_bf16 v[248:251], a[176:179], v[180:183], v[248:251]
  ds_read_b64_tr_b16 a[144:145], v62 offset:0
  v_mul_f32 v127, v127, v73
  v_mfma_f32_16x16x32_bf16 v[248:251], a[180:183], v[188:191], v[248:251]
  ds_read_b64_tr_b16 a[146:147], v62 offset:2048
  v_cvt_pk_bf16_f32 v47, v126, v127
  v_mfma_f32_16x16x32_bf16 v[244:247], a[184:187], v[176:179], v[244:247]
  ds_read_b64_tr_b16 a[148:149], v62 offset:4096
  ds_read_b64_tr_b16 a[150:151], v62 offset:6144
  v_mfma_f32_16x16x32_bf16 v[244:247], a[188:191], v[184:187], v[244:247]
  buffer_store_dwordx4 v[44:47], v9, s[16:19], s41 offen offset:3072 sc1
  v_mfma_f32_16x16x32_bf16 v[252:255], a[184:187], v[180:183], v[252:255]
  s_add_u32 s41, s41, 0x1000
  ds_read_b64_tr_b16 a[152:153], v63 offset:0
  v_mfma_f32_16x16x32_bf16 v[252:255], a[188:191], v[188:191], v[252:255]
  ds_read_b64_tr_b16 a[154:155], v63 offset:2048
  s_waitcnt lgkmcnt(6)
  v_mfma_f32_16x16x32_bf16 v[192:195], a[128:131], v[128:131], 0
  s_mov_b32 m0, s35
  ds_read_b64_tr_b16 a[156:157], v63 offset:4096
  ds_read_b64_tr_b16 a[158:159], v63 offset:6144
  v_mfma_f32_16x16x32_bf16 v[192:195], a[132:135], v[136:139], v[192:195]
  buffer_load_dwordx4 v4, s[8:11], s31 offen offset:0 sc1 lds
  v_mfma_f32_16x16x32_bf16 v[200:203], a[128:131], v[132:135], 0
  ds_read_b64_tr_b16 a[160:161], v60 offset:8192
  v_mfma_f32_16x16x32_bf16 v[200:203], a[132:135], v[140:143], v[200:203]
  ds_read_b64_tr_b16 a[162:163], v60 offset:10240
  v_mul_f32 v224, v224, v72
  v_mul_f32 v225, v225, v72
  v_mfma_f32_16x16x32_bf16 v[196:199], a[136:139], v[128:131], 0
  ds_read_b64_tr_b16 a[164:165], v60 offset:12288
  ds_read_b64_tr_b16 a[166:167], v60 offset:14336
  v_mfma_f32_16x16x32_bf16 v[196:199], a[140:143], v[136:139], v[196:199]
  buffer_load_dwordx4 v5, s[8:11], s31 offen offset:1024 sc1 lds
  v_mfma_f32_16x16x32_bf16 v[204:207], a[136:139], v[132:135], 0
  ds_read_b64_tr_b16 a[168:169], v61 offset:8192
  v_cvt_pk_bf16_f32 v32, v224, v225
  v_mfma_f32_16x16x32_bf16 v[204:207], a[140:143], v[140:143], v[204:207]
  s_waitcnt lgkmcnt(5)
  ds_read_b64_tr_b16 a[170:171], v61 offset:10240
  v_mul_f32 v226, v226, v72
  v_mfma_f32_16x16x32_bf16 v[208:211], a[144:147], v[128:131], 0
  ds_read_b64_tr_b16 a[172:173], v61 offset:12288
  ds_read_b64_tr_b16 a[174:175], v61 offset:14336
  v_mfma_f32_16x16x32_bf16 v[208:211], a[148:151], v[136:139], v[208:211]
  buffer_load_dwordx4 v6, s[8:11], s31 offen offset:2048 sc1 lds
  v_mfma_f32_16x16x32_bf16 v[216:219], a[144:147], v[132:135], 0
  ds_read_b64_tr_b16 a[176:177], v62 offset:8192
  v_mul_f32 v227, v227, v72
  v_cvt_pk_bf16_f32 v33, v226, v227
  v_mfma_f32_16x16x32_bf16 v[216:219], a[148:151], v[140:143], v[216:219]
  ds_read_b64_tr_b16 a[178:179], v62 offset:10240
  v_mul_f32 v228, v228, v72
  v_mfma_f32_16x16x32_bf16 v[212:215], a[152:155], v[128:131], 0
  ds_read_b64_tr_b16 a[180:181], v62 offset:12288
  ds_read_b64_tr_b16 a[182:183], v62 offset:14336
  v_mfma_f32_16x16x32_bf16 v[212:215], a[156:159], v[136:139], v[212:215]
  buffer_load_dwordx4 v7, s[8:11], s31 offen offset:3072 sc1 lds
  v_mfma_f32_16x16x32_bf16 v[220:223], a[152:155], v[132:135], 0
  s_add_u32 m0, s35, 0x4000
  ds_read_b64_tr_b16 a[184:185], v63 offset:8192
  v_mul_f32 v229, v229, v72
  v_mfma_f32_16x16x32_bf16 v[220:223], a[156:159], v[140:143], v[220:223]
  s_waitcnt lgkmcnt(5)
  ds_read_b64_tr_b16 a[186:187], v63 offset:10240
  v_cvt_pk_bf16_f32 v34, v228, v229
  v_mul_f32 v230, v230, v72
  v_mfma_f32_16x16x32_bf16 v[192:195], a[160:163], v[144:147], v[192:195]
  ds_read_b64_tr_b16 a[188:189], v63 offset:12288
  ds_read_b64_tr_b16 a[190:191], v63 offset:14336
  v_mfma_f32_16x16x32_bf16 v[192:195], a[164:167], v[152:155], v[192:195]
  buffer_load_dwordx4 v4, s[8:11], s32 offen offset:0 sc1 lds
  v_mfma_f32_16x16x32_bf16 v[200:203], a[160:163], v[148:151], v[200:203]
  ds_read_b64_tr_b16 a[128:129], v60 offset:16384
  v_mul_f32 v231, v231, v72
  v_mfma_f32_16x16x32_bf16 v[200:203], a[164:167], v[156:159], v[200:203]
  ds_read_b64_tr_b16 a[130:131], v60 offset:18432
  v_cvt_pk_bf16_f32 v35, v230, v231
  v_mfma_f32_16x16x32_bf16 v[196:199], a[168:171], v[144:147], v[196:199]
  ds_read_b64_tr_b16 a[132:133], v60 offset:20480
  ds_read_b64_tr_b16 a[134:135], v60 offset:22528
  v_mfma_f32_16x16x32_bf16 v[196:199], a[172:175], v[152:155], v[196:199]
  buffer_load_dwordx4 v5, s[8:11], s32 offen offset:1024 sc1 lds
  v_mfma_f32_16x16x32_bf16 v[204:207], a[168:171], v[148:151], v[204:207]
  ds_read_b64_tr_b16 a[136:137], v61 offset:16384
  ds_read_b64_tr_b16 a[138:139], v61 offset:18432
  v_mfma_f32_16x16x32_bf16 v[204:207], a[172:175], v[156:159], v[204:207]
  s_waitcnt lgkmcnt(6)
  buffer_store_dwordx4 v[32:35], v9, s[16:19], s41 offen offset:0 sc1
  v_mfma_f32_16x16x32_bf16 v[208:211], a[176:179], v[144:147], v[208:211]
  ds_read_b64_tr_b16 a[140:141], v61 offset:20480
  ds_read_b64_tr_b16 a[142:143], v61 offset:22528
  v_mfma_f32_16x16x32_bf16 v[208:211], a[180:183], v[152:155], v[208:211]
  buffer_load_dwordx4 v6, s[8:11], s32 offen offset:2048 sc1 lds
  v_mfma_f32_16x16x32_bf16 v[216:219], a[176:179], v[148:151], v[216:219]
  ds_read_b64_tr_b16 a[144:145], v62 offset:16384
  v_mul_f32 v232, v232, v73
  v_mul_f32 v233, v233, v73
  v_mfma_f32_16x16x32_bf16 v[216:219], a[180:183], v[156:159], v[216:219]
  ds_read_b64_tr_b16 a[146:147], v62 offset:18432
  v_cvt_pk_bf16_f32 v36, v232, v233
  v_mfma_f32_16x16x32_bf16 v[212:215], a[184:187], v[144:147], v[212:215]
  ds_read_b64_tr_b16 a[148:149], v62 offset:20480
  ds_read_b64_tr_b16 a[150:151], v62 offset:22528
  v_mfma_f32_16x16x32_bf16 v[212:215], a[188:191], v[152:155], v[212:215]
  buffer_load_dwordx4 v7, s[8:11], s32 offen offset:3072 sc1 lds
  v_mfma_f32_16x16x32_bf16 v[220:223], a[184:187], v[148:151], v[220:223]
  s_add_u32 s35, s35, 0x8000
  ds_read_b64_tr_b16 a[152:153], v63 offset:16384
  v_mul_f32 v234, v234, v73
  v_mul_f32 v235, v235, v73
  v_mfma_f32_16x16x32_bf16 v[220:223], a[188:191], v[156:159], v[220:223]
  s_waitcnt lgkmcnt(5)
  ds_read_b64_tr_b16 a[154:155], v63 offset:18432
  v_cvt_pk_bf16_f32 v37, v234, v235
  v_mfma_f32_16x16x32_bf16 v[192:195], a[128:131], v[160:163], v[192:195]
  s_cmp_eq_u32 s35, s56
  ds_read_b64_tr_b16 a[156:157], v63 offset:20480
  v_mul_f32 v236, v236, v73
  v_mul_f32 v237, v237, v73
  v_mfma_f32_16x16x32_bf16 v[192:195], a[132:135], v[168:171], v[192:195]
  s_cselect_b32 s35, s40, s35
  ds_read_b64_tr_b16 a[158:159], v63 offset:22528
  v_cvt_pk_bf16_f32 v38, v236, v237
  v_mfma_f32_16x16x32_bf16 v[200:203], a[128:131], v[164:167], v[200:203]
  s_add_u32 s32, s31, s34
  ds_read_b64_tr_b16 a[160:161], v60 offset:24576
  v_mul_f32 v238, v238, v73
  v_mul_f32 v239, v239, v73
  v_mfma_f32_16x16x32_bf16 v[200:203], a[132:135], v[172:175], v[200:203]
  s_add_u32 s31, s31, s33
  ds_read_b64_tr_b16 a[162:163], v60 offset:26624
  v_cvt_pk_bf16_f32 v39, v238, v239
  v_mfma_f32_16x16x32_bf16 v[196:199], a[136:139], v[160:163], v[196:199]
  ds_read_b64_tr_b16 a[164:165], v60 offset:28672
  ds_read_b64_tr_b16 a[166:167], v60 offset:30720
  v_mfma_f32_16x16x32_bf16 v[196:199], a[140:143], v[168:171], v[196:199]
  buffer_store_dwordx4 v[36:39], v9, s[16:19], s41 offen offset:1024 sc1
  v_mfma_f32_16x16x32_bf16 v[204:207], a[136:139], v[164:167], v[204:207]
  ds_read_b64_tr_b16 a[168:169], v61 offset:24576
  v_mul_f32 v240, v240, v72
  v_mul_f32 v241, v241, v72
  v_mfma_f32_16x16x32_bf16 v[204:207], a[140:143], v[172:175], v[204:207]
  s_waitcnt lgkmcnt(5)
  ds_read_b64_tr_b16 a[170:171], v61 offset:26624
  v_cvt_pk_bf16_f32 v40, v240, v241
  v_mfma_f32_16x16x32_bf16 v[208:211], a[144:147], v[160:163], v[208:211]
  ds_read_b64_tr_b16 a[172:173], v61 offset:28672
  v_mul_f32 v242, v242, v72
  v_mul_f32 v243, v243, v72
  v_mfma_f32_16x16x32_bf16 v[208:211], a[148:151], v[168:171], v[208:211]
  ds_read_b64_tr_b16 a[174:175], v61 offset:30720
  v_cvt_pk_bf16_f32 v41, v242, v243
  v_mfma_f32_16x16x32_bf16 v[216:219], a[144:147], v[164:167], v[216:219]
  ds_read_b64_tr_b16 a[176:177], v62 offset:24576
  v_mul_f32 v244, v244, v72
  v_mul_f32 v245, v245, v72
  v_mfma_f32_16x16x32_bf16 v[216:219], a[148:151], v[172:175], v[216:219]
  ds_read_b64_tr_b16 a[178:179], v62 offset:26624
  v_cvt_pk_bf16_f32 v42, v244, v245
  v_mfma_f32_16x16x32_bf16 v[212:215], a[152:155], v[160:163], v[212:215]
  s_add_u32 s36, s36, 0x8000
  ds_read_b64_tr_b16 a[180:181], v62 offset:28672
  v_mul_f32 v246, v246, v72
  v_mul_f32 v247, v247, v72
  v_mfma_f32_16x16x32_bf16 v[212:215], a[156:159], v[168:171], v[212:215]
  s_cmp_eq_u32 s36, 0x28000
  ds_read_b64_tr_b16 a[182:183], v62 offset:30720
  v_cvt_pk_bf16_f32 v43, v246, v247
  v_mfma_f32_16x16x32_bf16 v[220:223], a[152:155], v[164:167], v[220:223]
  s_cselect_b32 s36, 0, s36
  ds_read_b64_tr_b16 a[184:185], v63 offset:24576
  ds_read_b64_tr_b16 a[186:187], v63 offset:26624
  v_mfma_f32_16x16x32_bf16 v[220:223], a[156:159], v[172:175], v[220:223]
  s_waitcnt lgkmcnt(6)
  buffer_store_dwordx4 v[40:43], v9, s[16:19], s41 offen offset:2048 sc1
  v_mfma_f32_16x16x32_bf16 v[192:195], a[160:163], v[176:179], v[192:195]
  ds_read_b64_tr_b16 a[188:189], v63 offset:28672
  v_mul_f32 v248, v248, v73
  v_mul_f32 v249, v249, v73
  v_mfma_f32_16x16x32_bf16 v[192:195], a[164:167], v[184:187], v[192:195]
  s_waitcnt vmcnt(23)
  s_barrier
  ds_read_b64_tr_b16 a[190:191], v63 offset:30720
  v_add_u32 v60, s36, v56
  v_add_u32 v61, s36, v57
  v_add_u32 v62, s36, v58
  v_add_u32 v63, s36, v59
  v_mfma_f32_16x16x32_bf16 v[200:203], a[160:163], v[180:183], v[200:203]
  ds_read_b64_tr_b16 a[128:129], v60 offset:0
  v_cvt_pk_bf16_f32 v44, v248, v249
  v_mfma_f32_16x16x32_bf16 v[200:203], a[164:167], v[188:191], v[200:203]
  ds_read_b64_tr_b16 a[130:131], v60 offset:2048
  v_mul_f32 v250, v250, v73
  v_mfma_f32_16x16x32_bf16 v[196:199], a[168:171], v[176:179], v[196:199]
  ds_read_b64_tr_b16 a[132:133], v60 offset:4096
  v_mul_f32 v251, v251, v73
  v_mfma_f32_16x16x32_bf16 v[196:199], a[172:175], v[184:187], v[196:199]
  ds_read_b64_tr_b16 a[134:135], v60 offset:6144
  v_cvt_pk_bf16_f32 v45, v250, v251
  v_mfma_f32_16x16x32_bf16 v[204:207], a[168:171], v[180:183], v[204:207]
  ds_read_b64_tr_b16 a[136:137], v61 offset:0
  v_mul_f32 v252, v252, v73
  v_mfma_f32_16x16x32_bf16 v[204:207], a[172:175], v[188:191], v[204:207]
  s_waitcnt lgkmcnt(5)
  ds_read_b64_tr_b16 a[138:139], v61 offset:2048
  v_mul_f32 v253, v253, v73
  v_mfma_f32_16x16x32_bf16 v[208:211], a[176:179], v[176:179], v[208:211]
  ds_read_b64_tr_b16 a[140:141], v61 offset:4096
  v_cvt_pk_bf16_f32 v46, v252, v253
  v_mfma_f32_16x16x32_bf16 v[208:211], a[180:183], v[184:187], v[208:211]
  ds_read_b64_tr_b16 a[142:143], v61 offset:6144
  v_mul_f32 v254, v254, v73
  v_mfma_f32_16x16x32_bf16 v[216:219], a[176:179], v[180:183], v[216:219]
  ds_read_b64_tr_b16 a[144:145], v62 offset:0
  v_mul_f32 v255, v255, v73
  v_mfma_f32_16x16x32_bf16 v[216:219], a[180:183], v[188:191], v[216:219]
  ds_read_b64_tr_b16 a[146:147], v62 offset:2048
  v_cvt_pk_bf16_f32 v47, v254, v255
  v_mfma_f32_16x16x32_bf16 v[212:215], a[184:187], v[176:179], v[212:215]
  ds_read_b64_tr_b16 a[148:149], v62 offset:4096
  ds_read_b64_tr_b16 a[150:151], v62 offset:6144
  v_mfma_f32_16x16x32_bf16 v[212:215], a[188:191], v[184:187], v[212:215]
  buffer_store_dwordx4 v[44:47], v9, s[16:19], s41 offen offset:3072 sc1
  v_mfma_f32_16x16x32_bf16 v[220:223], a[184:187], v[180:183], v[220:223]
  s_add_u32 s41, s41, 0x1000
  ds_read_b64_tr_b16 a[152:153], v63 offset:0
  v_mfma_f32_16x16x32_bf16 v[220:223], a[188:191], v[188:191], v[220:223]
  ds_read_b64_tr_b16 a[154:155], v63 offset:2048
  s_waitcnt lgkmcnt(6)
  v_mfma_f32_16x16x32_bf16 v[224:227], a[128:131], v[128:131], 0
  s_mov_b32 m0, s35
  ds_read_b64_tr_b16 a[156:157], v63 offset:4096
  ds_read_b64_tr_b16 a[158:159], v63 offset:6144
  v_mfma_f32_16x16x32_bf16 v[224:227], a[132:135], v[136:139], v[224:227]
  buffer_load_dwordx4 v4, s[8:11], s31 offen offset:0 sc1 lds
  v_mfma_f32_16x16x32_bf16 v[232:235], a[128:131], v[132:135], 0
  ds_read_b64_tr_b16 a[160:161], v60 offset:8192
  v_mfma_f32_16x16x32_bf16 v[232:235], a[132:135], v[140:143], v[232:235]
  ds_read_b64_tr_b16 a[162:163], v60 offset:10240
  v_mul_f32 v192, v192, v72
  v_mul_f32 v193, v193, v72
  v_mfma_f32_16x16x32_bf16 v[228:231], a[136:139], v[128:131], 0
  ds_read_b64_tr_b16 a[164:165], v60 offset:12288
  ds_read_b64_tr_b16 a[166:167], v60 offset:14336
  v_mfma_f32_16x16x32_bf16 v[228:231], a[140:143], v[136:139], v[228:231]
  buffer_load_dwordx4 v5, s[8:11], s31 offen offset:1024 sc1 lds
  v_mfma_f32_16x16x32_bf16 v[236:239], a[136:139], v[132:135], 0
  ds_read_b64_tr_b16 a[168:169], v61 offset:8192
  v_cvt_pk_bf16_f32 v32, v192, v193
  v_mfma_f32_16x16x32_bf16 v[236:239], a[140:143], v[140:143], v[236:239]
  s_waitcnt lgkmcnt(5)
  ds_read_b64_tr_b16 a[170:171], v61 offset:10240
  v_mul_f32 v194, v194, v72
  v_mfma_f32_16x16x32_bf16 v[240:243], a[144:147], v[128:131], 0
  ds_read_b64_tr_b16 a[172:173], v61 offset:12288
  ds_read_b64_tr_b16 a[174:175], v61 offset:14336
  v_mfma_f32_16x16x32_bf16 v[240:243], a[148:151], v[136:139], v[240:243]
  buffer_load_dwordx4 v6, s[8:11], s31 offen offset:2048 sc1 lds
  v_mfma_f32_16x16x32_bf16 v[248:251], a[144:147], v[132:135], 0
  ds_read_b64_tr_b16 a[176:177], v62 offset:8192
  v_mul_f32 v195, v195, v72
  v_cvt_pk_bf16_f32 v33, v194, v195
  v_mfma_f32_16x16x32_bf16 v[248:251], a[148:151], v[140:143], v[248:251]
  ds_read_b64_tr_b16 a[178:179], v62 offset:10240
  v_mul_f32 v196, v196, v72
  v_mfma_f32_16x16x32_bf16 v[244:247], a[152:155], v[128:131], 0
  ds_read_b64_tr_b16 a[180:181], v62 offset:12288
  ds_read_b64_tr_b16 a[182:183], v62 offset:14336
  v_mfma_f32_16x16x32_bf16 v[244:247], a[156:159], v[136:139], v[244:247]
  buffer_load_dwordx4 v7, s[8:11], s31 offen offset:3072 sc1 lds
  v_mfma_f32_16x16x32_bf16 v[252:255], a[152:155], v[132:135], 0
  s_add_u32 m0, s35, 0x4000
  ds_read_b64_tr_b16 a[184:185], v63 offset:8192
  v_mul_f32 v197, v197, v72
  v_mfma_f32_16x16x32_bf16 v[252:255], a[156:159], v[140:143], v[252:255]
  s_waitcnt lgkmcnt(5)
  ds_read_b64_tr_b16 a[186:187], v63 offset:10240
  v_cvt_pk_bf16_f32 v34, v196, v197
  v_mul_f32 v198, v198, v72
  v_mfma_f32_16x16x32_bf16 v[224:227], a[160:163], v[144:147], v[224:227]
  ds_read_b64_tr_b16 a[188:189], v63 offset:12288
  ds_read_b64_tr_b16 a[190:191], v63 offset:14336
  v_mfma_f32_16x16x32_bf16 v[224:227], a[164:167], v[152:155], v[224:227]
  buffer_load_dwordx4 v4, s[8:11], s32 offen offset:0 sc1 lds
  v_mfma_f32_16x16x32_bf16 v[232:235], a[160:163], v[148:151], v[232:235]
  ds_read_b64_tr_b16 a[128:129], v60 offset:16384
  v_mul_f32 v199, v199, v72
  v_mfma_f32_16x16x32_bf16 v[232:235], a[164:167], v[156:159], v[232:235]
  ds_read_b64_tr_b16 a[130:131], v60 offset:18432
  v_cvt_pk_bf16_f32 v35, v198, v199
  v_mfma_f32_16x16x32_bf16 v[228:231], a[168:171], v[144:147], v[228:231]
  ds_read_b64_tr_b16 a[132:133], v60 offset:20480
  ds_read_b64_tr_b16 a[134:135], v60 offset:22528
  v_mfma_f32_16x16x32_bf16 v[228:231], a[172:175], v[152:155], v[228:231]
  buffer_load_dwordx4 v5, s[8:11], s32 offen offset:1024 sc1 lds
  v_mfma_f32_16x16x32_bf16 v[236:239], a[168:171], v[148:151], v[236:239]
  ds_read_b64_tr_b16 a[136:137], v61 offset:16384
  ds_read_b64_tr_b16 a[138:139], v61 offset:18432
  v_mfma_f32_16x16x32_bf16 v[236:239], a[172:175], v[156:159], v[236:239]
  s_waitcnt lgkmcnt(6)
  buffer_store_dwordx4 v[32:35], v9, s[16:19], s41 offen offset:0 sc1
  v_mfma_f32_16x16x32_bf16 v[240:243], a[176:179], v[144:147], v[240:243]
  ds_read_b64_tr_b16 a[140:141], v61 offset:20480
  ds_read_b64_tr_b16 a[142:143], v61 offset:22528
  v_mfma_f32_16x16x32_bf16 v[240:243], a[180:183], v[152:155], v[240:243]
  buffer_load_dwordx4 v6, s[8:11], s32 offen offset:2048 sc1 lds
  v_mfma_f32_16x16x32_bf16 v[248:251], a[176:179], v[148:151], v[248:251]
  ds_read_b64_tr_b16 a[144:145], v62 offset:16384
  v_mul_f32 v200, v200, v73
  v_mul_f32 v201, v201, v73
  v_mfma_f32_16x16x32_bf16 v[248:251], a[180:183], v[156:159], v[248:251]
  ds_read_b64_tr_b16 a[146:147], v62 offset:18432
  v_cvt_pk_bf16_f32 v36, v200, v201
  v_mfma_f32_16x16x32_bf16 v[244:247], a[184:187], v[144:147], v[244:247]
  ds_read_b64_tr_b16 a[148:149], v62 offset:20480
  ds_read_b64_tr_b16 a[150:151], v62 offset:22528
  v_mfma_f32_16x16x32_bf16 v[244:247], a[188:191], v[152:155], v[244:247]
  buffer_load_dwordx4 v7, s[8:11], s32 offen offset:3072 sc1 lds
  v_mfma_f32_16x16x32_bf16 v[252:255], a[184:187], v[148:151], v[252:255]
  s_add_u32 s35, s35, 0x8000
  ds_read_b64_tr_b16 a[152:153], v63 offset:16384
  v_mul_f32 v202, v202, v73
  v_mul_f32 v203, v203, v73
  v_mfma_f32_16x16x32_bf16 v[252:255], a[188:191], v[156:159], v[252:255]
  s_waitcnt lgkmcnt(5)
  ds_read_b64_tr_b16 a[154:155], v63 offset:18432
  v_cvt_pk_bf16_f32 v37, v202, v203
  v_mfma_f32_16x16x32_bf16 v[224:227], a[128:131], v[160:163], v[224:227]
  s_cmp_eq_u32 s35, s56
  ds_read_b64_tr_b16 a[156:157], v63 offset:20480
  v_mul_f32 v204, v204, v73
  v_mul_f32 v205, v205, v73
  v_mfma_f32_16x16x32_bf16 v[224:227], a[132:135], v[168:171], v[224:227]
  s_cselect_b32 s35, s40, s35
  ds_read_b64_tr_b16 a[158:159], v63 offset:22528
  v_cvt_pk_bf16_f32 v38, v204, v205
  v_mfma_f32_16x16x32_bf16 v[232:235], a[128:131], v[164:167], v[232:235]
  s_add_u32 s32, s31, s34
  ds_read_b64_tr_b16 a[160:161], v60 offset:24576
  v_mul_f32 v206, v206, v73
  v_mul_f32 v207, v207, v73
  v_mfma_f32_16x16x32_bf16 v[232:235], a[132:135], v[172:175], v[232:235]
  s_add_u32 s31, s31, s33
  ds_read_b64_tr_b16 a[162:163], v60 offset:26624
  v_cvt_pk_bf16_f32 v39, v206, v207
  v_mfma_f32_16x16x32_bf16 v[228:231], a[136:139], v[160:163], v[228:231]
  ds_read_b64_tr_b16 a[164:165], v60 offset:28672
  ds_read_b64_tr_b16 a[166:167], v60 offset:30720
  v_mfma_f32_16x16x32_bf16 v[228:231], a[140:143], v[168:171], v[228:231]
  buffer_store_dwordx4 v[36:39], v9, s[16:19], s41 offen offset:1024 sc1
  v_mfma_f32_16x16x32_bf16 v[236:239], a[136:139], v[164:167], v[236:239]
  ds_read_b64_tr_b16 a[168:169], v61 offset:24576
  v_mul_f32 v208, v208, v72
  v_mul_f32 v209, v209, v72
  v_mfma_f32_16x16x32_bf16 v[236:239], a[140:143], v[172:175], v[236:239]
  s_waitcnt lgkmcnt(5)
  ds_read_b64_tr_b16 a[170:171], v61 offset:26624
  v_cvt_pk_bf16_f32 v40, v208, v209
  v_mfma_f32_16x16x32_bf16 v[240:243], a[144:147], v[160:163], v[240:243]
  ds_read_b64_tr_b16 a[172:173], v61 offset:28672
  v_mul_f32 v210, v210, v72
  v_mul_f32 v211, v211, v72
  v_mfma_f32_16x16x32_bf16 v[240:243], a[148:151], v[168:171], v[240:243]
  ds_read_b64_tr_b16 a[174:175], v61 offset:30720
  v_cvt_pk_bf16_f32 v41, v210, v211
  v_mfma_f32_16x16x32_bf16 v[248:251], a[144:147], v[164:167], v[248:251]
  ds_read_b64_tr_b16 a[176:177], v62 offset:24576
  v_mul_f32 v212, v212, v72
  v_mul_f32 v213, v213, v72
  v_mfma_f32_16x16x32_bf16 v[248:251], a[148:151], v[172:175], v[248:251]
  ds_read_b64_tr_b16 a[178:179], v62 offset:26624
  v_cvt_pk_bf16_f32 v42, v212, v213
  v_mfma_f32_16x16x32_bf16 v[244:247], a[152:155], v[160:163], v[244:247]
  s_add_u32 s36, s36, 0x8000
  ds_read_b64_tr_b16 a[180:181], v62 offset:28672
  v_mul_f32 v214, v214, v72
  v_mul_f32 v215, v215, v72
  v_mfma_f32_16x16x32_bf16 v[244:247], a[156:159], v[168:171], v[244:247]
  s_cmp_eq_u32 s36, 0x28000
  ds_read_b64_tr_b16 a[182:183], v62 offset:30720
  v_cvt_pk_bf16_f32 v43, v214, v215
  v_mfma_f32_16x16x32_bf16 v[252:255], a[152:155], v[164:167], v[252:255]
  s_cselect_b32 s36, 0, s36
  ds_read_b64_tr_b16 a[184:185], v63 offset:24576
  ds_read_b64_tr_b16 a[186:187], v63 offset:26624
  v_mfma_f32_16x16x32_bf16 v[252:255], a[156:159], v[172:175], v[252:255]
  s_waitcnt lgkmcnt(6)
  buffer_store_dwordx4 v[40:43], v9, s[16:19], s41 offen offset:2048 sc1
  v_mfma_f32_16x16x32_bf16 v[224:227], a[160:163], v[176:179], v[224:227]
  ds_read_b64_tr_b16 a[188:189], v63 offset:28672
  v_mul_f32 v216, v216, v73
  v_mul_f32 v217, v217, v73
  v_mfma_f32_16x16x32_bf16 v[224:227], a[164:167], v[184:187], v[224:227]
  s_waitcnt vmcnt(26)
  s_barrier
  ds_read_b64_tr_b16 a[190:191], v63 offset:30720
  v_add_u32 v60, s36, v56
  v_add_u32 v61, s36, v57
  v_add_u32 v62, s36, v58
  v_add_u32 v63, s36, v59
  v_mfma_f32_16x16x32_bf16 v[232:235], a[160:163], v[180:183], v[232:235]
  ds_read_b64_tr_b16 a[128:129], v60 offset:0
  v_cvt_pk_bf16_f32 v44, v216, v217
  v_mfma_f32_16x16x32_bf16 v[232:235], a[164:167], v[188:191], v[232:235]
  ds_read_b64_tr_b16 a[130:131], v60 offset:2048
  v_mul_f32 v218, v218, v73
  v_mfma_f32_16x16x32_bf16 v[228:231], a[168:171], v[176:179], v[228:231]
  ds_read_b64_tr_b16 a[132:133], v60 offset:4096
  v_mul_f32 v219, v219, v73
  v_mfma_f32_16x16x32_bf16 v[228:231], a[172:175], v[184:187], v[228:231]
  ds_read_b64_tr_b16 a[134:135], v60 offset:6144
  v_cvt_pk_bf16_f32 v45, v218, v219
  v_mfma_f32_16x16x32_bf16 v[236:239], a[168:171], v[180:183], v[236:239]
  ds_read_b64_tr_b16 a[136:137], v61 offset:0
  v_mul_f32 v220, v220, v73
  v_mfma_f32_16x16x32_bf16 v[236:239], a[172:175], v[188:191], v[236:239]
  s_waitcnt lgkmcnt(5)
  ds_read_b64_tr_b16 a[138:139], v61 offset:2048
  v_mul_f32 v221, v221, v73
  v_mfma_f32_16x16x32_bf16 v[240:243], a[176:179], v[176:179], v[240:243]
  ds_read_b64_tr_b16 a[140:141], v61 offset:4096
  v_cvt_pk_bf16_f32 v46, v220, v221
  v_mfma_f32_16x16x32_bf16 v[240:243], a[180:183], v[184:187], v[240:243]
  ds_read_b64_tr_b16 a[142:143], v61 offset:6144
  v_mul_f32 v222, v222, v73
  v_mfma_f32_16x16x32_bf16 v[248:251], a[176:179], v[180:183], v[248:251]
  ds_read_b64_tr_b16 a[144:145], v62 offset:0
  v_mul_f32 v223, v223, v73
  v_mfma_f32_16x16x32_bf16 v[248:251], a[180:183], v[188:191], v[248:251]
  ds_read_b64_tr_b16 a[146:147], v62 offset:2048
  v_cvt_pk_bf16_f32 v47, v222, v223
  v_mfma_f32_16x16x32_bf16 v[244:247], a[184:187], v[176:179], v[244:247]
  ds_read_b64_tr_b16 a[148:149], v62 offset:4096
  ds_read_b64_tr_b16 a[150:151], v62 offset:6144
  v_mfma_f32_16x16x32_bf16 v[244:247], a[188:191], v[184:187], v[244:247]
  buffer_store_dwordx4 v[44:47], v9, s[16:19], s41 offen offset:3072 sc1
  v_mfma_f32_16x16x32_bf16 v[252:255], a[184:187], v[180:183], v[252:255]
  s_add_u32 s41, s41, 0x1000
  ds_read_b64_tr_b16 a[152:153], v63 offset:0
  v_mfma_f32_16x16x32_bf16 v[252:255], a[188:191], v[188:191], v[252:255]
  ds_read_b64_tr_b16 a[154:155], v63 offset:2048
  buffer_load_dwordx4 v[76:79], v9, s[92:95], 0 offen offset:3072 sc1
  s_waitcnt lgkmcnt(6)
  v_mfma_f32_16x16x32_bf16 v[192:195], a[128:131], v[128:131], 0
  s_add_u32 s4, s52, 0x6700000
  ds_read_b64_tr_b16 a[156:157], v63 offset:4096
  v_mfma_f32_16x16x32_bf16 v[192:195], a[132:135], v[136:139], v[192:195]
  s_addc_u32 s5, s53, 0
  ds_read_b64_tr_b16 a[158:159], v63 offset:6144
  v_mfma_f32_16x16x32_bf16 v[200:203], a[128:131], v[132:135], 0
  s_and_b32 s5, s5, 0xffff
  ds_read_b64_tr_b16 a[160:161], v60 offset:8192
  v_mfma_f32_16x16x32_bf16 v[200:203], a[132:135], v[140:143], v[200:203]
  s_mov_b32 s6, 0x1c2000
  ds_read_b64_tr_b16 a[162:163], v60 offset:10240
  v_mul_f32 v224, v224, v72
  v_mfma_f32_16x16x32_bf16 v[196:199], a[136:139], v[128:131], 0
  s_mov_b32 s7, 0x20000
  ds_read_b64_tr_b16 a[164:165], v60 offset:12288
  v_mul_f32 v225, v225, v72
  v_mfma_f32_16x16x32_bf16 v[196:199], a[140:143], v[136:139], v[196:199]
  s_sub_u32 s38, s35, s40
  ds_read_b64_tr_b16 a[166:167], v60 offset:14336
  v_cvt_pk_bf16_f32 v32, v224, v225
  v_mfma_f32_16x16x32_bf16 v[204:207], a[136:139], v[132:135], 0
  s_lshr_b32 s25, s55, 2
  ds_read_b64_tr_b16 a[168:169], v61 offset:8192
  v_mul_f32 v226, v226, v72
  v_mfma_f32_16x16x32_bf16 v[204:207], a[140:143], v[140:143], v[204:207]
  s_waitcnt lgkmcnt(5)
  ds_read_b64_tr_b16 a[170:171], v61 offset:10240
  v_mul_f32 v227, v227, v72
  v_mfma_f32_16x16x32_bf16 v[208:211], a[144:147], v[128:131], 0
  s_lshl_b32 s25, s25, 3
  ds_read_b64_tr_b16 a[172:173], v61 offset:12288
  v_cvt_pk_bf16_f32 v33, v226, v227
  v_mfma_f32_16x16x32_bf16 v[208:211], a[148:151], v[136:139], v[208:211]
  s_and_b32 s26, s2, 7
  ds_read_b64_tr_b16 a[174:175], v61 offset:14336
  v_mul_f32 v228, v228, v72
  v_mfma_f32_16x16x32_bf16 v[216:219], a[144:147], v[132:135], 0
  s_add_u32 s25, s25, s26
  ds_read_b64_tr_b16 a[176:177], v62 offset:8192
  v_mul_f32 v229, v229, v72
  v_mfma_f32_16x16x32_bf16 v[216:219], a[148:151], v[140:143], v[216:219]
  s_mul_i32 s28, s25, 28800
  ds_read_b64_tr_b16 a[178:179], v62 offset:10240
  v_cvt_pk_bf16_f32 v34, v228, v229
  v_mfma_f32_16x16x32_bf16 v[212:215], a[152:155], v[128:131], 0
  s_lshl_b32 s26, s24, 13
  ds_read_b64_tr_b16 a[180:181], v62 offset:12288
  v_mul_f32 v230, v230, v72
  v_mfma_f32_16x16x32_bf16 v[212:215], a[156:159], v[136:139], v[212:215]
  s_add_u32 s28, s28, s26
  ds_read_b64_tr_b16 a[182:183], v62 offset:14336
  v_mul_f32 v231, v231, v72
  v_mfma_f32_16x16x32_bf16 v[220:223], a[152:155], v[132:135], 0
  s_add_u32 m0, s26, s38
  ds_read_b64_tr_b16 a[184:185], v63 offset:8192
  v_cvt_pk_bf16_f32 v35, v230, v231
  v_mfma_f32_16x16x32_bf16 v[220:223], a[156:159], v[140:143], v[220:223]
  s_waitcnt lgkmcnt(5)
  ds_read_b64_tr_b16 a[186:187], v63 offset:10240
  v_mfma_f32_16x16x32_bf16 v[192:195], a[160:163], v[144:147], v[192:195]
  s_add_u32 s27, s28, 4096
  ds_read_b64_tr_b16 a[188:189], v63 offset:12288
  ds_read_b64_tr_b16 a[190:191], v63 offset:14336
  v_mfma_f32_16x16x32_bf16 v[192:195], a[164:167], v[152:155], v[192:195]
  buffer_store_dwordx4 v[32:35], v9, s[16:19], s41 offen offset:0 sc1
  v_mfma_f32_16x16x32_bf16 v[200:203], a[160:163], v[148:151], v[200:203]
  ds_read_b64_tr_b16 a[128:129], v60 offset:16384
  v_mul_f32 v232, v232, v73
  v_mfma_f32_16x16x32_bf16 v[200:203], a[164:167], v[156:159], v[200:203]
  ds_read_b64_tr_b16 a[130:131], v60 offset:18432
  v_mul_f32 v233, v233, v73
  v_mfma_f32_16x16x32_bf16 v[196:199], a[168:171], v[144:147], v[196:199]
  ds_read_b64_tr_b16 a[132:133], v60 offset:20480
  v_cvt_pk_bf16_f32 v36, v232, v233
  v_mfma_f32_16x16x32_bf16 v[196:199], a[172:175], v[152:155], v[196:199]
  ds_read_b64_tr_b16 a[134:135], v60 offset:22528
  v_mul_f32 v234, v234, v73
  v_mfma_f32_16x16x32_bf16 v[204:207], a[168:171], v[148:151], v[204:207]
  ds_read_b64_tr_b16 a[136:137], v61 offset:16384
  v_mul_f32 v235, v235, v73
  v_mfma_f32_16x16x32_bf16 v[204:207], a[172:175], v[156:159], v[204:207]
  s_waitcnt lgkmcnt(5)
  ds_read_b64_tr_b16 a[138:139], v61 offset:18432
  v_cvt_pk_bf16_f32 v37, v234, v235
  v_mfma_f32_16x16x32_bf16 v[208:211], a[176:179], v[144:147], v[208:211]
  ds_read_b64_tr_b16 a[140:141], v61 offset:20480
  v_mul_f32 v236, v236, v73
  v_mfma_f32_16x16x32_bf16 v[208:211], a[180:183], v[152:155], v[208:211]
  ds_read_b64_tr_b16 a[142:143], v61 offset:22528
  v_mul_f32 v237, v237, v73
  v_mfma_f32_16x16x32_bf16 v[216:219], a[176:179], v[148:151], v[216:219]
  ds_read_b64_tr_b16 a[144:145], v62 offset:16384
  v_cvt_pk_bf16_f32 v38, v236, v237
  v_mfma_f32_16x16x32_bf16 v[216:219], a[180:183], v[156:159], v[216:219]
  ds_read_b64_tr_b16 a[146:147], v62 offset:18432
  v_mul_f32 v238, v238, v73
  v_mfma_f32_16x16x32_bf16 v[212:215], a[184:187], v[144:147], v[212:215]
  ds_read_b64_tr_b16 a[148:149], v62 offset:20480
  v_mul_f32 v239, v239, v73
  v_mfma_f32_16x16x32_bf16 v[212:215], a[188:191], v[152:155], v[212:215]
  ds_read_b64_tr_b16 a[150:151], v62 offset:22528
  v_cvt_pk_bf16_f32 v39, v238, v239
  v_mfma_f32_16x16x32_bf16 v[220:223], a[184:187], v[148:151], v[220:223]
  ds_read_b64_tr_b16 a[152:153], v63 offset:16384
  ds_read_b64_tr_b16 a[154:155], v63 offset:18432
  v_mfma_f32_16x16x32_bf16 v[220:223], a[188:191], v[156:159], v[220:223]
  s_waitcnt lgkmcnt(6)
  buffer_store_dwordx4 v[36:39], v9, s[16:19], s41 offen offset:1024 sc1
  v_mfma_f32_16x16x32_bf16 v[192:195], a[128:131], v[160:163], v[192:195]
  ds_read_b64_tr_b16 a[156:157], v63 offset:20480
  v_mul_f32 v240, v240, v72
  v_mfma_f32_16x16x32_bf16 v[192:195], a[132:135], v[168:171], v[192:195]
  ds_read_b64_tr_b16 a[158:159], v63 offset:22528
  v_mul_f32 v241, v241, v72
  v_mfma_f32_16x16x32_bf16 v[200:203], a[128:131], v[164:167], v[200:203]
  ds_read_b64_tr_b16 a[160:161], v60 offset:24576
  v_cvt_pk_bf16_f32 v40, v240, v241
  v_mfma_f32_16x16x32_bf16 v[200:203], a[132:135], v[172:175], v[200:203]
  ds_read_b64_tr_b16 a[162:163], v60 offset:26624
  v_mul_f32 v242, v242, v72
  v_mfma_f32_16x16x32_bf16 v[196:199], a[136:139], v[160:163], v[196:199]
  ds_read_b64_tr_b16 a[164:165], v60 offset:28672
  v_mul_f32 v243, v243, v72
  v_mfma_f32_16x16x32_bf16 v[196:199], a[140:143], v[168:171], v[196:199]
  ds_read_b64_tr_b16 a[166:167], v60 offset:30720
  v_cvt_pk_bf16_f32 v41, v242, v243
  v_mfma_f32_16x16x32_bf16 v[204:207], a[136:139], v[164:167], v[204:207]
  ds_read_b64_tr_b16 a[168:169], v61 offset:24576
  v_mul_f32 v244, v244, v72
  v_mfma_f32_16x16x32_bf16 v[204:207], a[140:143], v[172:175], v[204:207]
  s_waitcnt lgkmcnt(5)
  ds_read_b64_tr_b16 a[170:171], v61 offset:26624
  v_mul_f32 v245, v245, v72
  v_mfma_f32_16x16x32_bf16 v[208:211], a[144:147], v[160:163], v[208:211]
  ds_read_b64_tr_b16 a[172:173], v61 offset:28672
  v_cvt_pk_bf16_f32 v42, v244, v245
  v_mfma_f32_16x16x32_bf16 v[208:211], a[148:151], v[168:171], v[208:211]
  ds_read_b64_tr_b16 a[174:175], v61 offset:30720
  v_mul_f32 v246, v246, v72
  v_mfma_f32_16x16x32_bf16 v[216:219], a[144:147], v[164:167], v[216:219]
  ds_read_b64_tr_b16 a[176:177], v62 offset:24576
  v_mul_f32 v247, v247, v72
  v_mfma_f32_16x16x32_bf16 v[216:219], a[148:151], v[172:175], v[216:219]
  ds_read_b64_tr_b16 a[178:179], v62 offset:26624
  v_cvt_pk_bf16_f32 v43, v246, v247
  v_mfma_f32_16x16x32_bf16 v[212:215], a[152:155], v[160:163], v[212:215]
  s_add_u32 s36, s36, 0x8000
  ds_read_b64_tr_b16 a[180:181], v62 offset:28672
  ds_read_b64_tr_b16 a[182:183], v62 offset:30720
  v_mfma_f32_16x16x32_bf16 v[212:215], a[156:159], v[168:171], v[212:215]
  s_cmp_eq_u32 s36, 0x28000
  buffer_store_dwordx4 v[40:43], v9, s[16:19], s41 offen offset:2048 sc1
  v_mfma_f32_16x16x32_bf16 v[220:223], a[152:155], v[164:167], v[220:223]
  s_cselect_b32 s36, 0, s36
  ds_read_b64_tr_b16 a[184:185], v63 offset:24576
  v_mul_f32 v248, v248, v73
  v_mul_f32 v249, v249, v73
  v_mfma_f32_16x16x32_bf16 v[220:223], a[156:159], v[172:175], v[220:223]
  s_waitcnt lgkmcnt(5)
  ds_read_b64_tr_b16 a[186:187], v63 offset:26624
  v_cvt_pk_bf16_f32 v44, v248, v249
  v_mfma_f32_16x16x32_bf16 v[192:195], a[160:163], v[176:179], v[192:195]
  ds_read_b64_tr_b16 a[188:189], v63 offset:28672
  v_mul_f32 v250, v250, v73
  v_mfma_f32_16x16x32_bf16 v[192:195], a[164:167], v[184:187], v[192:195]
  s_waitcnt vmcnt(19)
  s_barrier
  ds_read_b64_tr_b16 a[190:191], v63 offset:30720
  v_add_u32 v60, s36, v56
  v_add_u32 v61, s36, v57
  v_add_u32 v62, s36, v58
  v_add_u32 v63, s36, v59
  v_mfma_f32_16x16x32_bf16 v[200:203], a[160:163], v[180:183], v[200:203]
  ds_read_b64_tr_b16 a[128:129], v60 offset:0
  v_mul_f32 v251, v251, v73
  v_mfma_f32_16x16x32_bf16 v[200:203], a[164:167], v[188:191], v[200:203]
  ds_read_b64_tr_b16 a[130:131], v60 offset:2048
  v_cvt_pk_bf16_f32 v45, v250, v251
  v_mfma_f32_16x16x32_bf16 v[196:199], a[168:171], v[176:179], v[196:199]
  ds_read_b64_tr_b16 a[132:133], v60 offset:4096
  v_mul_f32 v252, v252, v73
  v_mfma_f32_16x16x32_bf16 v[196:199], a[172:175], v[184:187], v[196:199]
  ds_read_b64_tr_b16 a[134:135], v60 offset:6144
  v_mul_f32 v253, v253, v73
  v_mfma_f32_16x16x32_bf16 v[204:207], a[168:171], v[180:183], v[204:207]
  ds_read_b64_tr_b16 a[136:137], v61 offset:0
  v_cvt_pk_bf16_f32 v46, v252, v253
  v_mfma_f32_16x16x32_bf16 v[204:207], a[172:175], v[188:191], v[204:207]
  s_waitcnt lgkmcnt(5)
  ds_read_b64_tr_b16 a[138:139], v61 offset:2048
  v_mul_f32 v254, v254, v73
  v_mfma_f32_16x16x32_bf16 v[208:211], a[176:179], v[176:179], v[208:211]
  ds_read_b64_tr_b16 a[140:141], v61 offset:4096
  v_mul_f32 v255, v255, v73
  v_mfma_f32_16x16x32_bf16 v[208:211], a[180:183], v[184:187], v[208:211]
  ds_read_b64_tr_b16 a[142:143], v61 offset:6144
  v_cvt_pk_bf16_f32 v47, v254, v255
  v_mfma_f32_16x16x32_bf16 v[216:219], a[176:179], v[180:183], v[216:219]
  ds_read_b64_tr_b16 a[144:145], v62 offset:0
  ds_read_b64_tr_b16 a[146:147], v62 offset:2048
  v_mfma_f32_16x16x32_bf16 v[216:219], a[180:183], v[188:191], v[216:219]
  buffer_store_dwordx4 v[44:47], v9, s[16:19], s41 offen offset:3072 sc1
  v_mfma_f32_16x16x32_bf16 v[212:215], a[184:187], v[176:179], v[212:215]
  ds_read_b64_tr_b16 a[148:149], v62 offset:4096
  v_lshrrev_b32 v21, 4, v9
  v_mfma_f32_16x16x32_bf16 v[212:215], a[188:191], v[184:187], v[212:215]
  ds_read_b64_tr_b16 a[150:151], v62 offset:6144
  v_and_b32 v21, 32, v21
  v_mfma_f32_16x16x32_bf16 v[220:223], a[184:187], v[180:183], v[220:223]
  s_add_u32 s41, s41, 0x1000
  ds_read_b64_tr_b16 a[152:153], v63 offset:0
  v_mfma_f32_16x16x32_bf16 v[220:223], a[188:191], v[188:191], v[220:223]
  ds_read_b64_tr_b16 a[154:155], v63 offset:2048
  v_xor_b32 v21, v21, v9
  s_waitcnt vmcnt(4)
  v_and_b32 v2, v76, v77
  v_and_b32 v3, v78, v79
  v_and_b32 v2, v2, v3
  v_cmp_ne_u32 vcc, 1, v2
  s_nop 4
  s_cbranch_vccnz K2_a2_wait
K2_a2_ok:
  buffer_load_dwordx4 v21, s[4:7], s28 offen offset:0 sc1 lds
  buffer_load_dwordx4 v21, s[4:7], s28 offen offset:1024 sc1 lds
  buffer_load_dwordx4 v21, s[4:7], s28 offen offset:2048 sc1 lds
  buffer_load_dwordx4 v21, s[4:7], s28 offen offset:3072 sc1 lds
  s_add_u32 m0, m0, 4096
  s_nop 0
  buffer_load_dwordx4 v21, s[4:7], s27 offen offset:0 sc1 lds
  buffer_load_dwordx4 v21, s[4:7], s27 offen offset:1024 sc1 lds
  buffer_load_dwordx4 v21, s[4:7], s27 offen offset:2048 sc1 lds
  buffer_load_dwordx4 v21, s[4:7], s27 offen offset:3072 sc1 lds
  s_waitcnt lgkmcnt(6)
  v_mfma_f32_16x16x32_bf16 v[224:227], a[128:131], v[128:131], 0
  ds_read_b64_tr_b16 a[156:157], v63 offset:4096
  v_mfma_f32_16x16x32_bf16 v[224:227], a[132:135], v[136:139], v[224:227]
  ds_read_b64_tr_b16 a[158:159], v63 offset:6144
  v_mfma_f32_16x16x32_bf16 v[232:235], a[128:131], v[132:135], 0
  ds_read_b64_tr_b16 a[160:161], v60 offset:8192
  v_mfma_f32_16x16x32_bf16 v[232:235], a[132:135], v[140:143], v[232:235]
  ds_read_b64_tr_b16 a[162:163], v60 offset:10240
  v_mul_f32 v192, v192, v72
  v_mfma_f32_16x16x32_bf16 v[228:231], a[136:139], v[128:131], 0
  ds_read_b64_tr_b16 a[164:165], v60 offset:12288
  v_mul_f32 v193, v193, v72
  v_mfma_f32_16x16x32_bf16 v[228:231], a[140:143], v[136:139], v[228:231]
  ds_read_b64_tr_b16 a[166:167], v60 offset:14336
  v_cvt_pk_bf16_f32 v32, v192, v193
  v_mfma_f32_16x16x32_bf16 v[236:239], a[136:139], v[132:135], 0
  ds_read_b64_tr_b16 a[168:169], v61 offset:8192
  v_mul_f32 v194, v194, v72
  v_mfma_f32_16x16x32_bf16 v[236:239], a[140:143], v[140:143], v[236:239]
  s_waitcnt lgkmcnt(5)
  ds_read_b64_tr_b16 a[170:171], v61 offset:10240
  v_mul_f32 v195, v195, v72
  v_mfma_f32_16x16x32_bf16 v[240:243], a[144:147], v[128:131], 0
  ds_read_b64_tr_b16 a[172:173], v61 offset:12288
  v_cvt_pk_bf16_f32 v33, v194, v195
  v_mfma_f32_16x16x32_bf16 v[240:243], a[148:151], v[136:139], v[240:243]
  ds_read_b64_tr_b16 a[174:175], v61 offset:14336
  v_mul_f32 v196, v196, v72
  v_mfma_f32_16x16x32_bf16 v[248:251], a[144:147], v[132:135], 0
  ds_read_b64_tr_b16 a[176:177], v62 offset:8192
  v_mul_f32 v197, v197, v72
  v_mfma_f32_16x16x32_bf16 v[248:251], a[148:151], v[140:143], v[248:251]
  ds_read_b64_tr_b16 a[178:179], v62 offset:10240
  v_cvt_pk_bf16_f32 v34, v196, v197
  v_mfma_f32_16x16x32_bf16 v[244:247], a[152:155], v[128:131], 0
  ds_read_b64_tr_b16 a[180:181], v62 offset:12288
  v_mul_f32 v198, v198, v72
  v_mfma_f32_16x16x32_bf16 v[244:247], a[156:159], v[136:139], v[244:247]
  ds_read_b64_tr_b16 a[182:183], v62 offset:14336
  v_mul_f32 v199, v199, v72
  v_mfma_f32_16x16x32_bf16 v[252:255], a[152:155], v[132:135], 0
  ds_read_b64_tr_b16 a[184:185], v63 offset:8192
  v_cvt_pk_bf16_f32 v35, v198, v199
  v_mfma_f32_16x16x32_bf16 v[252:255], a[156:159], v[140:143], v[252:255]
  s_waitcnt lgkmcnt(5)
  ds_read_b64_tr_b16 a[186:187], v63 offset:10240
  v_mfma_f32_16x16x32_bf16 v[224:227], a[160:163], v[144:147], v[224:227]
  ds_read_b64_tr_b16 a[188:189], v63 offset:12288
  ds_read_b64_tr_b16 a[190:191], v63 offset:14336
  v_mfma_f32_16x16x32_bf16 v[224:227], a[164:167], v[152:155], v[224:227]
  buffer_store_dwordx4 v[32:35], v9, s[16:19], s41 offen offset:0 sc1
  v_mfma_f32_16x16x32_bf16 v[232:235], a[160:163], v[148:151], v[232:235]
  ds_read_b64_tr_b16 a[128:129], v60 offset:16384
  v_mul_f32 v200, v200, v73
  v_mfma_f32_16x16x32_bf16 v[232:235], a[164:167], v[156:159], v[232:235]
  ds_read_b64_tr_b16 a[130:131], v60 offset:18432
  v_mul_f32 v201, v201, v73
  v_mfma_f32_16x16x32_bf16 v[228:231], a[168:171], v[144:147], v[228:231]
  ds_read_b64_tr_b16 a[132:133], v60 offset:20480
  v_cvt_pk_bf16_f32 v36, v200, v201
  v_mfma_f32_16x16x32_bf16 v[228:231], a[172:175], v[152:155], v[228:231]
  ds_read_b64_tr_b16 a[134:135], v60 offset:22528
  v_mul_f32 v202, v202, v73
  v_mfma_f32_16x16x32_bf16 v[236:239], a[168:171], v[148:151], v[236:239]
  ds_read_b64_tr_b16 a[136:137], v61 offset:16384
  v_mul_f32 v203, v203, v73
  v_mfma_f32_16x16x32_bf16 v[236:239], a[172:175], v[156:159], v[236:239]
  s_waitcnt lgkmcnt(5)
  ds_read_b64_tr_b16 a[138:139], v61 offset:18432
  v_cvt_pk_bf16_f32 v37, v202, v203
  v_mfma_f32_16x16x32_bf16 v[240:243], a[176:179], v[144:147], v[240:243]
  ds_read_b64_tr_b16 a[140:141], v61 offset:20480
  v_mul_f32 v204, v204, v73
  v_mfma_f32_16x16x32_bf16 v[240:243], a[180:183], v[152:155], v[240:243]
  ds_read_b64_tr_b16 a[142:143], v61 offset:22528
  v_mul_f32 v205, v205, v73
  v_mfma_f32_16x16x32_bf16 v[248:251], a[176:179], v[148:151], v[248:251]
  ds_read_b64_tr_b16 a[144:145], v62 offset:16384
  v_cvt_pk_bf16_f32 v38, v204, v205
  v_mfma_f32_16x16x32_bf16 v[248:251], a[180:183], v[156:159], v[248:251]
  ds_read_b64_tr_b16 a[146:147], v62 offset:18432
  v_mul_f32 v206, v206, v73
  v_mfma_f32_16x16x32_bf16 v[244:247], a[184:187], v[144:147], v[244:247]
  ds_read_b64_tr_b16 a[148:149], v62 offset:20480
  v_mul_f32 v207, v207, v73
  v_mfma_f32_16x16x32_bf16 v[244:247], a[188:191], v[152:155], v[244:247]
  ds_read_b64_tr_b16 a[150:151], v62 offset:22528
  v_cvt_pk_bf16_f32 v39, v206, v207
  v_mfma_f32_16x16x32_bf16 v[252:255], a[184:187], v[148:151], v[252:255]
  ds_read_b64_tr_b16 a[152:153], v63 offset:16384
  ds_read_b64_tr_b16 a[154:155], v63 offset:18432
  v_mfma_f32_16x16x32_bf16 v[252:255], a[188:191], v[156:159], v[252:255]
  s_waitcnt lgkmcnt(6)
  buffer_store_dwordx4 v[36:39], v9, s[16:19], s41 offen offset:1024 sc1
  v_mfma_f32_16x16x32_bf16 v[224:227], a[128:131], v[160:163], v[224:227]
  ds_read_b64_tr_b16 a[156:157], v63 offset:20480
  v_mul_f32 v208, v208, v72
  v_mfma_f32_16x16x32_bf16 v[224:227], a[132:135], v[168:171], v[224:227]
  ds_read_b64_tr_b16 a[158:159], v63 offset:22528
  v_mul_f32 v209, v209, v72
  v_mfma_f32_16x16x32_bf16 v[232:235], a[128:131], v[164:167], v[232:235]
  ds_read_b64_tr_b16 a[160:161], v60 offset:24576
  v_cvt_pk_bf16_f32 v40, v208, v209
  v_mfma_f32_16x16x32_bf16 v[232:235], a[132:135], v[172:175], v[232:235]
  ds_read_b64_tr_b16 a[162:163], v60 offset:26624
  v_mul_f32 v210, v210, v72
  v_mfma_f32_16x16x32_bf16 v[228:231], a[136:139], v[160:163], v[228:231]
  ds_read_b64_tr_b16 a[164:165], v60 offset:28672
  v_mul_f32 v211, v211, v72
  v_mfma_f32_16x16x32_bf16 v[228:231], a[140:143], v[168:171], v[228:231]
  ds_read_b64_tr_b16 a[166:167], v60 offset:30720
  v_cvt_pk_bf16_f32 v41, v210, v211
  v_mfma_f32_16x16x32_bf16 v[236:239], a[136:139], v[164:167], v[236:239]
  ds_read_b64_tr_b16 a[168:169], v61 offset:24576
  v_mul_f32 v212, v212, v72
  v_mfma_f32_16x16x32_bf16 v[236:239], a[140:143], v[172:175], v[236:239]
  s_waitcnt lgkmcnt(5)
  ds_read_b64_tr_b16 a[170:171], v61 offset:26624
  v_mul_f32 v213, v213, v72
  v_mfma_f32_16x16x32_bf16 v[240:243], a[144:147], v[160:163], v[240:243]
  ds_read_b64_tr_b16 a[172:173], v61 offset:28672
  v_cvt_pk_bf16_f32 v42, v212, v213
  v_mfma_f32_16x16x32_bf16 v[240:243], a[148:151], v[168:171], v[240:243]
  ds_read_b64_tr_b16 a[174:175], v61 offset:30720
  v_mul_f32 v214, v214, v72
  v_mfma_f32_16x16x32_bf16 v[248:251], a[144:147], v[164:167], v[248:251]
  ds_read_b64_tr_b16 a[176:177], v62 offset:24576
  v_mul_f32 v215, v215, v72
  v_mfma_f32_16x16x32_bf16 v[248:251], a[148:151], v[172:175], v[248:251]
  ds_read_b64_tr_b16 a[178:179], v62 offset:26624
  v_cvt_pk_bf16_f32 v43, v214, v215
  v_mfma_f32_16x16x32_bf16 v[244:247], a[152:155], v[160:163], v[244:247]
  s_add_u32 s36, s36, 0x8000
  ds_read_b64_tr_b16 a[180:181], v62 offset:28672
  ds_read_b64_tr_b16 a[182:183], v62 offset:30720
  v_mfma_f32_16x16x32_bf16 v[244:247], a[156:159], v[168:171], v[244:247]
  s_cmp_eq_u32 s36, 0x28000
  buffer_store_dwordx4 v[40:43], v9, s[16:19], s41 offen offset:2048 sc1
  v_mfma_f32_16x16x32_bf16 v[252:255], a[152:155], v[164:167], v[252:255]
  s_cselect_b32 s36, 0, s36
  ds_read_b64_tr_b16 a[184:185], v63 offset:24576
  v_mul_f32 v216, v216, v73
  v_mul_f32 v217, v217, v73
  v_mfma_f32_16x16x32_bf16 v[252:255], a[156:159], v[172:175], v[252:255]
  s_waitcnt lgkmcnt(5)
  ds_read_b64_tr_b16 a[186:187], v63 offset:26624
  v_cvt_pk_bf16_f32 v44, v216, v217
  v_mfma_f32_16x16x32_bf16 v[224:227], a[160:163], v[176:179], v[224:227]
  ds_read_b64_tr_b16 a[188:189], v63 offset:28672
  v_mul_f32 v218, v218, v73
  v_mfma_f32_16x16x32_bf16 v[224:227], a[164:167], v[184:187], v[224:227]
  s_waitcnt vmcnt(19)
  s_barrier
  ds_read_b64_tr_b16 a[190:191], v63 offset:30720
  v_add_u32 v60, s36, v56
  v_add_u32 v61, s36, v57
  v_add_u32 v62, s36, v58
  v_add_u32 v63, s36, v59
  v_mfma_f32_16x16x32_bf16 v[232:235], a[160:163], v[180:183], v[232:235]
  ds_read_b64_tr_b16 a[128:129], v60 offset:0
  v_mul_f32 v219, v219, v73
  v_mfma_f32_16x16x32_bf16 v[232:235], a[164:167], v[188:191], v[232:235]
  ds_read_b64_tr_b16 a[130:131], v60 offset:2048
  v_cvt_pk_bf16_f32 v45, v218, v219
  v_mfma_f32_16x16x32_bf16 v[228:231], a[168:171], v[176:179], v[228:231]
  ds_read_b64_tr_b16 a[132:133], v60 offset:4096
  v_mul_f32 v220, v220, v73
  v_mfma_f32_16x16x32_bf16 v[228:231], a[172:175], v[184:187], v[228:231]
  ds_read_b64_tr_b16 a[134:135], v60 offset:6144
  v_mul_f32 v221, v221, v73
  v_mfma_f32_16x16x32_bf16 v[236:239], a[168:171], v[180:183], v[236:239]
  ds_read_b64_tr_b16 a[136:137], v61 offset:0
  v_cvt_pk_bf16_f32 v46, v220, v221
  v_mfma_f32_16x16x32_bf16 v[236:239], a[172:175], v[188:191], v[236:239]
  s_waitcnt lgkmcnt(5)
  ds_read_b64_tr_b16 a[138:139], v61 offset:2048
  v_mul_f32 v222, v222, v73
  v_mfma_f32_16x16x32_bf16 v[240:243], a[176:179], v[176:179], v[240:243]
  ds_read_b64_tr_b16 a[140:141], v61 offset:4096
  v_mul_f32 v223, v223, v73
  v_mfma_f32_16x16x32_bf16 v[240:243], a[180:183], v[184:187], v[240:243]
  ds_read_b64_tr_b16 a[142:143], v61 offset:6144
  v_cvt_pk_bf16_f32 v47, v222, v223
  v_mfma_f32_16x16x32_bf16 v[248:251], a[176:179], v[180:183], v[248:251]
  ds_read_b64_tr_b16 a[144:145], v62 offset:0
  ds_read_b64_tr_b16 a[146:147], v62 offset:2048
  v_mfma_f32_16x16x32_bf16 v[248:251], a[180:183], v[188:191], v[248:251]
  buffer_store_dwordx4 v[44:47], v9, s[16:19], s41 offen offset:3072 sc1
  v_mfma_f32_16x16x32_bf16 v[244:247], a[184:187], v[176:179], v[244:247]
  ds_read_b64_tr_b16 a[148:149], v62 offset:4096
  v_mfma_f32_16x16x32_bf16 v[244:247], a[188:191], v[184:187], v[244:247]
  ds_read_b64_tr_b16 a[150:151], v62 offset:6144
  v_mfma_f32_16x16x32_bf16 v[252:255], a[184:187], v[180:183], v[252:255]
  s_add_u32 s41, s41, 0x1000
  ds_read_b64_tr_b16 a[152:153], v63 offset:0
  v_mfma_f32_16x16x32_bf16 v[252:255], a[188:191], v[188:191], v[252:255]
  ds_read_b64_tr_b16 a[154:155], v63 offset:2048
  s_waitcnt lgkmcnt(6)
  v_mfma_f32_16x16x32_bf16 v[192:195], a[128:131], v[128:131], 0
  ds_read_b64_tr_b16 a[156:157], v63 offset:4096
  v_mfma_f32_16x16x32_bf16 v[192:195], a[132:135], v[136:139], v[192:195]
  ds_read_b64_tr_b16 a[158:159], v63 offset:6144
  v_mfma_f32_16x16x32_bf16 v[200:203], a[128:131], v[132:135], 0
  ds_read_b64_tr_b16 a[160:161], v60 offset:8192
  v_mfma_f32_16x16x32_bf16 v[200:203], a[132:135], v[140:143], v[200:203]
  ds_read_b64_tr_b16 a[162:163], v60 offset:10240
  v_mul_f32 v224, v224, v72
  v_mul_f32 v225, v225, v72
  v_mfma_f32_16x16x32_bf16 v[196:199], a[136:139], v[128:131], 0
  ds_read_b64_tr_b16 a[164:165], v60 offset:12288
  v_cvt_pk_bf16_f32 v32, v224, v225
  v_mfma_f32_16x16x32_bf16 v[196:199], a[140:143], v[136:139], v[196:199]
  ds_read_b64_tr_b16 a[166:167], v60 offset:14336
  v_mul_f32 v226, v226, v72
  v_mfma_f32_16x16x32_bf16 v[204:207], a[136:139], v[132:135], 0
  ds_read_b64_tr_b16 a[168:169], v61 offset:8192
  v_mul_f32 v227, v227, v72
  v_mfma_f32_16x16x32_bf16 v[204:207], a[140:143], v[140:143], v[204:207]
  s_waitcnt lgkmcnt(5)
  ds_read_b64_tr_b16 a[170:171], v61 offset:10240
  v_cvt_pk_bf16_f32 v33, v226, v227
  v_mfma_f32_16x16x32_bf16 v[208:211], a[144:147], v[128:131], 0
  ds_read_b64_tr_b16 a[172:173], v61 offset:12288
  v_mul_f32 v228, v228, v72
  v_mfma_f32_16x16x32_bf16 v[208:211], a[148:151], v[136:139], v[208:211]
  s_waitcnt vmcnt(12)
  s_barrier
  ds_read_b64_tr_b16 a[174:175], v61 offset:14336
  v_mfma_f32_16x16x32_bf16 v[216:219], a[144:147], v[132:135], 0
  ds_read_b64_tr_b16 a[176:177], v62 offset:8192
  v_mul_f32 v229, v229, v72
  v_mfma_f32_16x16x32_bf16 v[216:219], a[148:151], v[140:143], v[216:219]
  ds_read_b64_tr_b16 a[178:179], v62 offset:10240
  buffer_store_dword v22, v23, s[92:95], s82 offen sc1
  v_mfma_f32_16x16x32_bf16 v[212:215], a[152:155], v[128:131], 0
  ds_read_b64_tr_b16 a[180:181], v62 offset:12288
  v_cvt_pk_bf16_f32 v34, v228, v229
  v_mfma_f32_16x16x32_bf16 v[212:215], a[156:159], v[136:139], v[212:215]
  ds_read_b64_tr_b16 a[182:183], v62 offset:14336
  v_mul_f32 v230, v230, v72
  v_mfma_f32_16x16x32_bf16 v[220:223], a[152:155], v[132:135], 0
  ds_read_b64_tr_b16 a[184:185], v63 offset:8192
  v_mul_f32 v231, v231, v72
  v_mfma_f32_16x16x32_bf16 v[220:223], a[156:159], v[140:143], v[220:223]
  s_waitcnt lgkmcnt(5)
  ds_read_b64_tr_b16 a[186:187], v63 offset:10240
  v_cvt_pk_bf16_f32 v35, v230, v231
  v_mfma_f32_16x16x32_bf16 v[192:195], a[160:163], v[144:147], v[192:195]
  ds_read_b64_tr_b16 a[188:189], v63 offset:12288
  ds_read_b64_tr_b16 a[190:191], v63 offset:14336
  v_mfma_f32_16x16x32_bf16 v[192:195], a[164:167], v[152:155], v[192:195]
  buffer_store_dwordx4 v[32:35], v9, s[16:19], s41 offen offset:0 sc1
  v_mfma_f32_16x16x32_bf16 v[200:203], a[160:163], v[148:151], v[200:203]
  ds_read_b64_tr_b16 a[128:129], v60 offset:16384
  v_mul_f32 v232, v232, v73
  v_mfma_f32_16x16x32_bf16 v[200:203], a[164:167], v[156:159], v[200:203]
  ds_read_b64_tr_b16 a[130:131], v60 offset:18432
  v_mul_f32 v233, v233, v73
  v_mfma_f32_16x16x32_bf16 v[196:199], a[168:171], v[144:147], v[196:199]
  ds_read_b64_tr_b16 a[132:133], v60 offset:20480
  v_cvt_pk_bf16_f32 v36, v232, v233
  v_mfma_f32_16x16x32_bf16 v[196:199], a[172:175], v[152:155], v[196:199]
  ds_read_b64_tr_b16 a[134:135], v60 offset:22528
  v_mul_f32 v234, v234, v73
  v_mfma_f32_16x16x32_bf16 v[204:207], a[168:171], v[148:151], v[204:207]
  ds_read_b64_tr_b16 a[136:137], v61 offset:16384
  v_mul_f32 v235, v235, v73
  v_mfma_f32_16x16x32_bf16 v[204:207], a[172:175], v[156:159], v[204:207]
  s_waitcnt lgkmcnt(5)
  ds_read_b64_tr_b16 a[138:139], v61 offset:18432
  v_cvt_pk_bf16_f32 v37, v234, v235
  v_mfma_f32_16x16x32_bf16 v[208:211], a[176:179], v[144:147], v[208:211]
  ds_read_b64_tr_b16 a[140:141], v61 offset:20480
  v_mul_f32 v236, v236, v73
  v_mfma_f32_16x16x32_bf16 v[208:211], a[180:183], v[152:155], v[208:211]
  ds_read_b64_tr_b16 a[142:143], v61 offset:22528
  v_mul_f32 v237, v237, v73
  v_mfma_f32_16x16x32_bf16 v[216:219], a[176:179], v[148:151], v[216:219]
  ds_read_b64_tr_b16 a[144:145], v62 offset:16384
  v_cvt_pk_bf16_f32 v38, v236, v237
  v_mfma_f32_16x16x32_bf16 v[216:219], a[180:183], v[156:159], v[216:219]
  ds_read_b64_tr_b16 a[146:147], v62 offset:18432
  v_mul_f32 v238, v238, v73
  v_mfma_f32_16x16x32_bf16 v[212:215], a[184:187], v[144:147], v[212:215]
  ds_read_b64_tr_b16 a[148:149], v62 offset:20480
  v_mul_f32 v239, v239, v73
  v_mfma_f32_16x16x32_bf16 v[212:215], a[188:191], v[152:155], v[212:215]
  ds_read_b64_tr_b16 a[150:151], v62 offset:22528
  v_cvt_pk_bf16_f32 v39, v238, v239
  v_mfma_f32_16x16x32_bf16 v[220:223], a[184:187], v[148:151], v[220:223]
  ds_read_b64_tr_b16 a[152:153], v63 offset:16384
  ds_read_b64_tr_b16 a[154:155], v63 offset:18432
  v_mfma_f32_16x16x32_bf16 v[220:223], a[188:191], v[156:159], v[220:223]
  s_waitcnt lgkmcnt(6)
  buffer_store_dwordx4 v[36:39], v9, s[16:19], s41 offen offset:1024 sc1
  v_mfma_f32_16x16x32_bf16 v[192:195], a[128:131], v[160:163], v[192:195]
  ds_read_b64_tr_b16 a[156:157], v63 offset:20480
  v_mul_f32 v240, v240, v72
  v_mfma_f32_16x16x32_bf16 v[192:195], a[132:135], v[168:171], v[192:195]
  ds_read_b64_tr_b16 a[158:159], v63 offset:22528
  v_mul_f32 v241, v241, v72
  v_mfma_f32_16x16x32_bf16 v[200:203], a[128:131], v[164:167], v[200:203]
  ds_read_b64_tr_b16 a[160:161], v60 offset:24576
  v_cvt_pk_bf16_f32 v40, v240, v241
  v_mfma_f32_16x16x32_bf16 v[200:203], a[132:135], v[172:175], v[200:203]
  ds_read_b64_tr_b16 a[162:163], v60 offset:26624
  v_mul_f32 v242, v242, v72
  v_mfma_f32_16x16x32_bf16 v[196:199], a[136:139], v[160:163], v[196:199]
  ds_read_b64_tr_b16 a[164:165], v60 offset:28672
  v_mul_f32 v243, v243, v72
  v_mfma_f32_16x16x32_bf16 v[196:199], a[140:143], v[168:171], v[196:199]
  ds_read_b64_tr_b16 a[166:167], v60 offset:30720
  v_cvt_pk_bf16_f32 v41, v242, v243
  v_mfma_f32_16x16x32_bf16 v[204:207], a[136:139], v[164:167], v[204:207]
  ds_read_b64_tr_b16 a[168:169], v61 offset:24576
  v_mul_f32 v244, v244, v72
  v_mfma_f32_16x16x32_bf16 v[204:207], a[140:143], v[172:175], v[204:207]
  s_waitcnt lgkmcnt(5)
  ds_read_b64_tr_b16 a[170:171], v61 offset:26624
  v_mul_f32 v245, v245, v72
  v_mfma_f32_16x16x32_bf16 v[208:211], a[144:147], v[160:163], v[208:211]
  ds_read_b64_tr_b16 a[172:173], v61 offset:28672
  v_cvt_pk_bf16_f32 v42, v244, v245
  v_mfma_f32_16x16x32_bf16 v[208:211], a[148:151], v[168:171], v[208:211]
  ds_read_b64_tr_b16 a[174:175], v61 offset:30720
  v_mul_f32 v246, v246, v72
  v_mfma_f32_16x16x32_bf16 v[216:219], a[144:147], v[164:167], v[216:219]
  ds_read_b64_tr_b16 a[176:177], v62 offset:24576
  v_mul_f32 v247, v247, v72
  v_mfma_f32_16x16x32_bf16 v[216:219], a[148:151], v[172:175], v[216:219]
  ds_read_b64_tr_b16 a[178:179], v62 offset:26624
  v_cvt_pk_bf16_f32 v43, v246, v247
  v_mfma_f32_16x16x32_bf16 v[212:215], a[152:155], v[160:163], v[212:215]
  ds_read_b64_tr_b16 a[180:181], v62 offset:28672
  ds_read_b64_tr_b16 a[182:183], v62 offset:30720
  v_mfma_f32_16x16x32_bf16 v[212:215], a[156:159], v[168:171], v[212:215]
  buffer_store_dwordx4 v[40:43], v9, s[16:19], s41 offen offset:2048 sc1
  v_mfma_f32_16x16x32_bf16 v[220:223], a[152:155], v[164:167], v[220:223]
  ds_read_b64_tr_b16 a[184:185], v63 offset:24576
  v_mul_f32 v248, v248, v73
  v_mfma_f32_16x16x32_bf16 v[220:223], a[156:159], v[172:175], v[220:223]
  s_waitcnt lgkmcnt(5)
  ds_read_b64_tr_b16 a[186:187], v63 offset:26624
  v_mul_f32 v249, v249, v73
  v_mfma_f32_16x16x32_bf16 v[192:195], a[160:163], v[176:179], v[192:195]
  ds_read_b64_tr_b16 a[188:189], v63 offset:28672
  v_cvt_pk_bf16_f32 v44, v248, v249
  v_mfma_f32_16x16x32_bf16 v[192:195], a[164:167], v[184:187], v[192:195]
  ds_read_b64_tr_b16 a[190:191], v63 offset:30720
  v_mul_f32 v250, v250, v73
  v_mfma_f32_16x16x32_bf16 v[200:203], a[160:163], v[180:183], v[200:203]
  v_mul_f32 v251, v251, v73
  v_mfma_f32_16x16x32_bf16 v[200:203], a[164:167], v[188:191], v[200:203]
  v_cvt_pk_bf16_f32 v45, v250, v251
  v_mfma_f32_16x16x32_bf16 v[196:199], a[168:171], v[176:179], v[196:199]
  v_mul_f32 v252, v252, v73
  v_mfma_f32_16x16x32_bf16 v[196:199], a[172:175], v[184:187], v[196:199]
  v_mul_f32 v253, v253, v73
  v_mfma_f32_16x16x32_bf16 v[204:207], a[168:171], v[180:183], v[204:207]
  v_cvt_pk_bf16_f32 v46, v252, v253
  v_mfma_f32_16x16x32_bf16 v[204:207], a[172:175], v[188:191], v[204:207]
  s_waitcnt lgkmcnt(0)
  v_mul_f32 v254, v254, v73
  v_mfma_f32_16x16x32_bf16 v[208:211], a[176:179], v[176:179], v[208:211]
  v_mul_f32 v255, v255, v73
  v_mfma_f32_16x16x32_bf16 v[208:211], a[180:183], v[184:187], v[208:211]
  v_cvt_pk_bf16_f32 v47, v254, v255
  v_mfma_f32_16x16x32_bf16 v[216:219], a[176:179], v[180:183], v[216:219]
  v_mfma_f32_16x16x32_bf16 v[216:219], a[180:183], v[188:191], v[216:219]
  buffer_store_dwordx4 v[44:47], v9, s[16:19], s41 offen offset:3072 sc1
  v_mfma_f32_16x16x32_bf16 v[212:215], a[184:187], v[176:179], v[212:215]
  v_mfma_f32_16x16x32_bf16 v[212:215], a[188:191], v[184:187], v[212:215]
  buffer_load_dword v25, v24, s[92:95], 0 offen sc0 sc1
  v_mfma_f32_16x16x32_bf16 v[220:223], a[184:187], v[180:183], v[220:223]
  s_add_u32 s41, s41, 0x1000
  v_mfma_f32_16x16x32_bf16 v[220:223], a[188:191], v[188:191], v[220:223]
  s_nop 7
  v_mul_f32 v192, v192, v72
  v_mul_f32 v193, v193, v72
  v_cvt_pk_bf16_f32 v32, v192, v193
  v_mul_f32 v194, v194, v72
  v_mul_f32 v195, v195, v72
  v_cvt_pk_bf16_f32 v33, v194, v195
  v_mul_f32 v196, v196, v72
  v_mul_f32 v197, v197, v72
  v_cvt_pk_bf16_f32 v34, v196, v197
  v_mul_f32 v198, v198, v72
  v_mul_f32 v199, v199, v72
  v_cvt_pk_bf16_f32 v35, v198, v199
  buffer_store_dwordx4 v[32:35], v9, s[16:19], s41 offen offset:0 sc1
  v_mul_f32 v200, v200, v73
  v_mul_f32 v201, v201, v73
  v_cvt_pk_bf16_f32 v36, v200, v201
  v_mul_f32 v202, v202, v73
  v_mul_f32 v203, v203, v73
  v_cvt_pk_bf16_f32 v37, v202, v203
  v_mul_f32 v204, v204, v73
  v_mul_f32 v205, v205, v73
  v_cvt_pk_bf16_f32 v38, v204, v205
  v_mul_f32 v206, v206, v73
  v_mul_f32 v207, v207, v73
  v_cvt_pk_bf16_f32 v39, v206, v207
  buffer_store_dwordx4 v[36:39], v9, s[16:19], s41 offen offset:1024 sc1
  v_mul_f32 v208, v208, v72
  v_mul_f32 v209, v209, v72
  v_cvt_pk_bf16_f32 v40, v208, v209
  v_mul_f32 v210, v210, v72
  v_mul_f32 v211, v211, v72
  v_cvt_pk_bf16_f32 v41, v210, v211
  v_mul_f32 v212, v212, v72
  v_mul_f32 v213, v213, v72
  v_cvt_pk_bf16_f32 v42, v212, v213
  v_mul_f32 v214, v214, v72
  v_mul_f32 v215, v215, v72
  v_cvt_pk_bf16_f32 v43, v214, v215
  buffer_store_dwordx4 v[40:43], v9, s[16:19], s41 offen offset:2048 sc1
  v_mul_f32 v216, v216, v73
  v_mul_f32 v217, v217, v73
  v_cvt_pk_bf16_f32 v44, v216, v217
  v_mul_f32 v218, v218, v73
  v_mul_f32 v219, v219, v73
  v_cvt_pk_bf16_f32 v45, v218, v219
  v_mul_f32 v220, v220, v73
  v_mul_f32 v221, v221, v73
  v_cvt_pk_bf16_f32 v46, v220, v221
  v_mul_f32 v222, v222, v73
  v_mul_f32 v223, v223, v73
  v_cvt_pk_bf16_f32 v47, v222, v223
  buffer_store_dwordx4 v[44:47], v9, s[16:19], s41 offen offset:3072 sc1
  s_mov_b32 s12, s90
  s_and_b32 s13, s91, 0xffff
  s_mov_b32 s14, 0x380000
  s_mov_b32 s15, 0x20000
  s_lshr_b32 s26, s82, 7
  s_sub_u32 s26, s26, 32
  s_lshl_b32 s26, s26, 2
  s_lshr_b32 s3, s47, 2
  s_add_u32 s26, s26, s3
  s_and_b32 s3, s47, 3
  s_lshl_b32 s27, s3, 2
  s_add_u32 s27, s27, s24
  s_mul_i32 s28, s3, 3
  s_add_u32 s28, s28, s24
  s_add_u32 s28, s28, 16
  s_mul_i32 s29, s26, 0x7000
  s_lshl_b32 s3, s27, 10
  s_add_u32 s29, s29, s3
  s_lshl_b32 s30, s26, 1
  s_and_b32 s3, s27, 1
  s_add_u32 s30, s30, s3
  s_mul_i32 s30, s30, 28672
  s_lshr_b32 s3, s27, 1
  s_lshl_b32 s3, s3, 6
  s_add_u32 s30, s30, s3
  s_add_u32 s30, s30, 896
  s_mul_i32 s31, s26, 0x7000
  s_lshl_b32 s3, s28, 10
  s_add_u32 s31, s31, s3
  s_lshl_b32 s32, s26, 1
  s_and_b32 s3, s28, 1
  s_add_u32 s32, s32, s3
  s_mul_i32 s32, s32, 28672
  s_lshr_b32 s3, s28, 1
  s_lshl_b32 s3, s3, 6
  s_add_u32 s32, s32, s3
  s_add_u32 s32, s32, 896
  s_cmp_eq_u32 s24, 3
  s_cselect_b32 s31, 0x70000000, s31
  s_cselect_b32 s32, 0x70000000, s32
  s_waitcnt vmcnt(4)
  v_cmp_ne_u32 vcc, 1, v25
  s_nop 4
  s_cbranch_vccnz K2_p1_wait
K2_p1_ok:
  buffer_load_dwordx4 v[128:131], v9, s[16:19], s29 offen sc1
  s_add_u32 s29, s29, 0x1c0000
  buffer_load_dwordx4 v[132:135], v9, s[16:19], s29 offen sc1
  s_add_u32 s29, s29, 0x1c0000
  buffer_load_dwordx4 v[136:139], v9, s[16:19], s29 offen sc1
  s_add_u32 s29, s29, 0x1c0000
  buffer_load_dwordx4 v[140:143], v9, s[16:19], s29 offen sc1
  s_add_u32 s29, s29, 0x1c0000
  buffer_load_dwordx4 v[144:147], v9, s[16:19], s29 offen sc1
  s_add_u32 s29, s29, 0x1c0000
  buffer_load_dwordx4 v[148:151], v9, s[16:19], s29 offen sc1
  s_add_u32 s29, s29, 0x1c0000
  buffer_load_dwordx4 v[152:155], v9, s[16:19], s29 offen sc1
  s_add_u32 s29, s29, 0x1c0000
  buffer_load_dwordx4 v[156:159], v9, s[16:19], s29 offen sc1
  s_add_u32 s29, s29, 0x1c0000
  buffer_load_dwordx4 v[160:163], v9, s[16:19], s29 offen sc1
  s_add_u32 s29, s29, 0x1c0000
  buffer_load_dwordx4 v[164:167], v9, s[16:19], s29 offen sc1
  s_add_u32 s29, s29, 0x1c0000
  buffer_load_dwordx4 v[168:171], v9, s[16:19], s29 offen sc1
  s_add_u32 s29, s29, 0x1c0000
  buffer_load_dwordx4 v[172:175], v9, s[16:19], s29 offen sc1
  s_add_u32 s29, s29, 0x1c0000
  buffer_load_dwordx4 v[176:179], v9, s[16:19], s29 offen sc1
  s_add_u32 s29, s29, 0x1c0000
  buffer_load_dwordx4 v[180:183], v9, s[16:19], s29 offen sc1
  s_add_u32 s29, s29, 0x1c0000
  buffer_load_dwordx4 v[184:187], v9, s[16:19], s29 offen sc1
  s_add_u32 s29, s29, 0x1c0000
  buffer_load_dwordx4 v[188:191], v9, s[16:19], s29 offen sc1
  v_and_b32 v1, 63, v0
  v_and_b32 v4, 15, v1
  v_lshrrev_b32 v5, 4, v1
  v_mul_u32_u24 v21, 1792, v4
  v_lshl_add_u32 v21, v5, 4, v21
  s_and_b32 s3, s55, 3
  s_mul_i32 s3, s3, 7
  s_lshl_b32 s33, s24, 1
  s_add_u32 s33, s33, s3
  s_lshl_b32 s3, s33, 4
  v_add_u32 v6, s3, v4
  v_cvt_f32_u32 v6, v6
  v_mul_f32 v10, 0x3b124925, v6
  v_add_f32 v6, 0x41800000, v6
  v_mul_f32 v12, 0x3b124925, v6
  v_cvt_f32_u32 v6, v5
  v_mul_f32 v6, 4.0, v6
  v_mul_f32 v11, v6, v10
  v_mul_f32 v13, v6, v12
  v_bfe_u32 v6, v1, 2, 2
  v_lshl_add_u32 v6, v5, 3, v6
  v_lshlrev_b32 v6, 6, v6
  v_and_b32 v7, 3, v1
  v_lshl_add_u32 v6, v7, 3, v6
  v_add_u32 v6, s38, v6
  v_and_b32 v7, 1, v5
  v_lshl_add_u32 v14, v7, 5, v6
  v_xor_b32 v15, 32, v14
  v_bfe_u32 v6, v4, 1, 2
  v_lshlrev_b32 v6, 3, v6
  v_lshrrev_b32 v7, 3, v4
  v_lshl_add_u32 v6, v7, 1, v6
  v_and_b32 v7, 1, v4
  v_add_u32 v6, v6, v7
  v_mul_u32_u24 v6, 1792, v6
  v_lshl_add_u32 v8, v5, 4, v6
  s_cmp_eq_u32 s24, 3
  s_cselect_b32 s3, 1, 3
  v_mov_b32 v6, 0x70000000
  v_cmp_lt_u32 vcc, s3, v5
  s_nop 1
  v_cndmask_b32 v8, v8, v6, vcc
  s_mul_i32 s34, s25, 57344
  s_lshl_b32 s3, s33, 5
  s_add_u32 s34, s34, s3
  s_add_u32 s35, s34, 32
  s_cmp_eq_u32 s24, 3
  s_cselect_b32 s35, 0x70000000, s35
  v_mul_f32 v48, 0x41800000, v10
  v_cos_f32 v48, v48
  v_fmamk_f32 v16, v10, 0x0, v11
  v_fmamk_f32 v17, v10, 0x3f800000, v11
  v_fmamk_f32 v18, v10, 0x40000000, v11
  v_fmamk_f32 v19, v10, 0x40400000, v11
  v_cos_f32 v32, v16
  v_sin_f32 v33, v16
  v_cos_f32 v34, v17
  v_sin_f32 v35, v17
  v_cos_f32 v36, v18
  v_sin_f32 v37, v18
  v_cos_f32 v38, v19
  v_sin_f32 v39, v19
  v_fmamk_f32 v16, v10, 0x41800000, v11
  v_fmamk_f32 v17, v10, 0x41880000, v11
  v_fmamk_f32 v18, v10, 0x41900000, v11
  v_fmamk_f32 v19, v10, 0x41980000, v11
  v_cos_f32 v40, v16
  v_sin_f32 v41, v16
  v_cos_f32 v42, v17
  v_sin_f32 v43, v17
  v_cos_f32 v44, v18
  v_sin_f32 v45, v18
  v_cos_f32 v46, v19
  v_sin_f32 v47, v19
  v_add_f32 v48, v48, v48
  v_cvt_pk_bf16_f32 v64, v32, -v33
  v_cvt_pk_bf16_f32 v65, v34, -v35
  v_cvt_pk_bf16_f32 v66, v36, -v37
  v_cvt_pk_bf16_f32 v67, v38, -v39
  v_pk_fma_f32 v[32:33], v[40:41], v[48:49], v[32:33] op_sel_hi:[1,0,1] neg_lo:[0,0,1] neg_hi:[0,0,1]
  v_pk_fma_f32 v[34:35], v[42:43], v[48:49], v[34:35] op_sel_hi:[1,0,1] neg_lo:[0,0,1] neg_hi:[0,0,1]
  v_pk_fma_f32 v[36:37], v[44:45], v[48:49], v[36:37] op_sel_hi:[1,0,1] neg_lo:[0,0,1] neg_hi:[0,0,1]
  v_pk_fma_f32 v[38:39], v[46:47], v[48:49], v[38:39] op_sel_hi:[1,0,1] neg_lo:[0,0,1] neg_hi:[0,0,1]
  v_cvt_pk_bf16_f32 v68, v40, -v41
  v_cvt_pk_bf16_f32 v69, v42, -v43
  v_cvt_pk_bf16_f32 v70, v44, -v45
  v_cvt_pk_bf16_f32 v71, v46, -v47
  v_pk_fma_f32 v[40:41], v[32:33], v[48:49], v[40:41] op_sel_hi:[1,0,1] neg_lo:[0,0,1] neg_hi:[0,0,1]
  v_pk_fma_f32 v[42:43], v[34:35], v[48:49], v[42:43] op_sel_hi:[1,0,1] neg_lo:[0,0,1] neg_hi:[0,0,1]
  v_pk_fma_f32 v[44:45], v[36:37], v[48:49], v[44:45] op_sel_hi:[1,0,1] neg_lo:[0,0,1] neg_hi:[0,0,1]
  v_pk_fma_f32 v[46:47], v[38:39], v[48:49], v[46:47] op_sel_hi:[1,0,1] neg_lo:[0,0,1] neg_hi:[0,0,1]
  v_cvt_pk_bf16_f32 v72, v32, -v33
  v_cvt_pk_bf16_f32 v73, v34, -v35
  v_cvt_pk_bf16_f32 v74, v36, -v37
  v_cvt_pk_bf16_f32 v75, v38, -v39
  v_pk_fma_f32 v[32:33], v[40:41], v[48:49], v[32:33] op_sel_hi:[1,0,1] neg_lo:[0,0,1] neg_hi:[0,0,1]
  v_pk_fma_f32 v[34:35], v[42:43], v[48:49], v[34:35] op_sel_hi:[1,0,1] neg_lo:[0,0,1] neg_hi:[0,0,1]
  v_pk_fma_f32 v[36:37], v[44:45], v[48:49], v[36:37] op_sel_hi:[1,0,1] neg_lo:[0,0,1] neg_hi:[0,0,1]
  v_pk_fma_f32 v[38:39], v[46:47], v[48:49], v[38:39] op_sel_hi:[1,0,1] neg_lo:[0,0,1] neg_hi:[0,0,1]
  v_cvt_pk_bf16_f32 v76, v40, -v41
  v_cvt_pk_bf16_f32 v77, v42, -v43
  v_cvt_pk_bf16_f32 v78, v44, -v45
  v_cvt_pk_bf16_f32 v79, v46, -v47
  v_pk_fma_f32 v[40:41], v[32:33], v[48:49], v[40:41] op_sel_hi:[1,0,1] neg_lo:[0,0,1] neg_hi:[0,0,1]
  v_pk_fma_f32 v[42:43], v[34:35], v[48:49], v[42:43] op_sel_hi:[1,0,1] neg_lo:[0,0,1] neg_hi:[0,0,1]
  v_pk_fma_f32 v[44:45], v[36:37], v[48:49], v[44:45] op_sel_hi:[1,0,1] neg_lo:[0,0,1] neg_hi:[0,0,1]
  v_pk_fma_f32 v[46:47], v[38:39], v[48:49], v[46:47] op_sel_hi:[1,0,1] neg_lo:[0,0,1] neg_hi:[0,0,1]
  v_cvt_pk_bf16_f32 v80, v32, -v33
  v_cvt_pk_bf16_f32 v81, v34, -v35
  v_cvt_pk_bf16_f32 v82, v36, -v37
  v_cvt_pk_bf16_f32 v83, v38, -v39
  v_pk_fma_f32 v[32:33], v[40:41], v[48:49], v[32:33] op_sel_hi:[1,0,1] neg_lo:[0,0,1] neg_hi:[0,0,1]
  v_pk_fma_f32 v[34:35], v[42:43], v[48:49], v[34:35] op_sel_hi:[1,0,1] neg_lo:[0,0,1] neg_hi:[0,0,1]
  v_pk_fma_f32 v[36:37], v[44:45], v[48:49], v[36:37] op_sel_hi:[1,0,1] neg_lo:[0,0,1] neg_hi:[0,0,1]
  v_pk_fma_f32 v[38:39], v[46:47], v[48:49], v[38:39] op_sel_hi:[1,0,1] neg_lo:[0,0,1] neg_hi:[0,0,1]
  v_cvt_pk_bf16_f32 v84, v40, -v41
  v_cvt_pk_bf16_f32 v85, v42, -v43
  v_cvt_pk_bf16_f32 v86, v44, -v45
  v_cvt_pk_bf16_f32 v87, v46, -v47
  v_pk_fma_f32 v[40:41], v[32:33], v[48:49], v[40:41] op_sel_hi:[1,0,1] neg_lo:[0,0,1] neg_hi:[0,0,1]
  v_pk_fma_f32 v[42:43], v[34:35], v[48:49], v[42:43] op_sel_hi:[1,0,1] neg_lo:[0,0,1] neg_hi:[0,0,1]
  v_pk_fma_f32 v[44:45], v[36:37], v[48:49], v[44:45] op_sel_hi:[1,0,1] neg_lo:[0,0,1] neg_hi:[0,0,1]
  v_pk_fma_f32 v[46:47], v[38:39], v[48:49], v[46:47] op_sel_hi:[1,0,1] neg_lo:[0,0,1] neg_hi:[0,0,1]
  v_cvt_pk_bf16_f32 v88, v32, -v33
  v_cvt_pk_bf16_f32 v89, v34, -v35
  v_cvt_pk_bf16_f32 v90, v36, -v37
  v_cvt_pk_bf16_f32 v91, v38, -v39
  v_pk_fma_f32 v[32:33], v[40:41], v[48:49], v[32:33] op_sel_hi:[1,0,1] neg_lo:[0,0,1] neg_hi:[0,0,1]
  v_pk_fma_f32 v[34:35], v[42:43], v[48:49], v[34:35] op_sel_hi:[1,0,1] neg_lo:[0,0,1] neg_hi:[0,0,1]
  v_pk_fma_f32 v[36:37], v[44:45], v[48:49], v[36:37] op_sel_hi:[1,0,1] neg_lo:[0,0,1] neg_hi:[0,0,1]
  v_pk_fma_f32 v[38:39], v[46:47], v[48:49], v[38:39] op_sel_hi:[1,0,1] neg_lo:[0,0,1] neg_hi:[0,0,1]
  v_cvt_pk_bf16_f32 v92, v40, -v41
  v_cvt_pk_bf16_f32 v93, v42, -v43
  v_cvt_pk_bf16_f32 v94, v44, -v45
  v_cvt_pk_bf16_f32 v95, v46, -v47
  v_pk_fma_f32 v[40:41], v[32:33], v[48:49], v[40:41] op_sel_hi:[1,0,1] neg_lo:[0,0,1] neg_hi:[0,0,1]
  v_pk_fma_f32 v[42:43], v[34:35], v[48:49], v[42:43] op_sel_hi:[1,0,1] neg_lo:[0,0,1] neg_hi:[0,0,1]
  v_pk_fma_f32 v[44:45], v[36:37], v[48:49], v[44:45] op_sel_hi:[1,0,1] neg_lo:[0,0,1] neg_hi:[0,0,1]
  v_pk_fma_f32 v[46:47], v[38:39], v[48:49], v[46:47] op_sel_hi:[1,0,1] neg_lo:[0,0,1] neg_hi:[0,0,1]
  v_cvt_pk_bf16_f32 v96, v32, -v33
  v_cvt_pk_bf16_f32 v97, v34, -v35
  v_cvt_pk_bf16_f32 v98, v36, -v37
  v_cvt_pk_bf16_f32 v99, v38, -v39
  v_pk_fma_f32 v[32:33], v[40:41], v[48:49], v[32:33] op_sel_hi:[1,0,1] neg_lo:[0,0,1] neg_hi:[0,0,1]
  v_pk_fma_f32 v[34:35], v[42:43], v[48:49], v[34:35] op_sel_hi:[1,0,1] neg_lo:[0,0,1] neg_hi:[0,0,1]
  v_pk_fma_f32 v[36:37], v[44:45], v[48:49], v[36:37] op_sel_hi:[1,0,1] neg_lo:[0,0,1] neg_hi:[0,0,1]
  v_pk_fma_f32 v[38:39], v[46:47], v[48:49], v[38:39] op_sel_hi:[1,0,1] neg_lo:[0,0,1] neg_hi:[0,0,1]
  v_cvt_pk_bf16_f32 v100, v40, -v41
  v_cvt_pk_bf16_f32 v101, v42, -v43
  v_cvt_pk_bf16_f32 v102, v44, -v45
  v_cvt_pk_bf16_f32 v103, v46, -v47
  v_pk_fma_f32 v[40:41], v[32:33], v[48:49], v[40:41] op_sel_hi:[1,0,1] neg_lo:[0,0,1] neg_hi:[0,0,1]
  v_pk_fma_f32 v[42:43], v[34:35], v[48:49], v[42:43] op_sel_hi:[1,0,1] neg_lo:[0,0,1] neg_hi:[0,0,1]
  v_pk_fma_f32 v[44:45], v[36:37], v[48:49], v[44:45] op_sel_hi:[1,0,1] neg_lo:[0,0,1] neg_hi:[0,0,1]
  v_pk_fma_f32 v[46:47], v[38:39], v[48:49], v[46:47] op_sel_hi:[1,0,1] neg_lo:[0,0,1] neg_hi:[0,0,1]
  v_cvt_pk_bf16_f32 v104, v32, -v33
  v_cvt_pk_bf16_f32 v105, v34, -v35
  v_cvt_pk_bf16_f32 v106, v36, -v37
  v_cvt_pk_bf16_f32 v107, v38, -v39
  v_pk_fma_f32 v[32:33], v[40:41], v[48:49], v[32:33] op_sel_hi:[1,0,1] neg_lo:[0,0,1] neg_hi:[0,0,1]
  v_pk_fma_f32 v[34:35], v[42:43], v[48:49], v[34:35] op_sel_hi:[1,0,1] neg_lo:[0,0,1] neg_hi:[0,0,1]
  v_pk_fma_f32 v[36:37], v[44:45], v[48:49], v[36:37] op_sel_hi:[1,0,1] neg_lo:[0,0,1] neg_hi:[0,0,1]
  v_pk_fma_f32 v[38:39], v[46:47], v[48:49], v[38:39] op_sel_hi:[1,0,1] neg_lo:[0,0,1] neg_hi:[0,0,1]
  v_cvt_pk_bf16_f32 v108, v40, -v41
  v_cvt_pk_bf16_f32 v109, v42, -v43
  v_cvt_pk_bf16_f32 v110, v44, -v45
  v_cvt_pk_bf16_f32 v111, v46, -v47
  v_pk_fma_f32 v[40:41], v[32:33], v[48:49], v[40:41] op_sel_hi:[1,0,1] neg_lo:[0,0,1] neg_hi:[0,0,1]
  v_pk_fma_f32 v[42:43], v[34:35], v[48:49], v[42:43] op_sel_hi:[1,0,1] neg_lo:[0,0,1] neg_hi:[0,0,1]
  v_pk_fma_f32 v[44:45], v[36:37], v[48:49], v[44:45] op_sel_hi:[1,0,1] neg_lo:[0,0,1] neg_hi:[0,0,1]
  v_pk_fma_f32 v[46:47], v[38:39], v[48:49], v[46:47] op_sel_hi:[1,0,1] neg_lo:[0,0,1] neg_hi:[0,0,1]
  v_cvt_pk_bf16_f32 v112, v32, -v33
  v_cvt_pk_bf16_f32 v113, v34, -v35
  v_cvt_pk_bf16_f32 v114, v36, -v37
  v_cvt_pk_bf16_f32 v115, v38, -v39
  v_pk_fma_f32 v[32:33], v[40:41], v[48:49], v[32:33] op_sel_hi:[1,0,1] neg_lo:[0,0,1] neg_hi:[0,0,1]
  v_pk_fma_f32 v[34:35], v[42:43], v[48:49], v[34:35] op_sel_hi:[1,0,1] neg_lo:[0,0,1] neg_hi:[0,0,1]
  v_pk_fma_f32 v[36:37], v[44:45], v[48:49], v[36:37] op_sel_hi:[1,0,1] neg_lo:[0,0,1] neg_hi:[0,0,1]
  v_pk_fma_f32 v[38:39], v[46:47], v[48:49], v[38:39] op_sel_hi:[1,0,1] neg_lo:[0,0,1] neg_hi:[0,0,1]
  v_cvt_pk_bf16_f32 v116, v40, -v41
  v_cvt_pk_bf16_f32 v117, v42, -v43
  v_cvt_pk_bf16_f32 v118, v44, -v45
  v_cvt_pk_bf16_f32 v119, v46, -v47
  v_cvt_pk_bf16_f32 v120, v32, -v33
  v_cvt_pk_bf16_f32 v121, v34, -v35
  v_cvt_pk_bf16_f32 v122, v36, -v37
  v_cvt_pk_bf16_f32 v123, v38, -v39
  v_mul_f32 v48, 0x41800000, v12
  v_cos_f32 v48, v48
  v_fmamk_f32 v16, v12, 0x0, v13
  v_fmamk_f32 v17, v12, 0x3f800000, v13
  v_fmamk_f32 v18, v12, 0x40000000, v13
  v_fmamk_f32 v19, v12, 0x40400000, v13
  v_cos_f32 v32, v16
  v_sin_f32 v33, v16
  v_cos_f32 v34, v17
  v_sin_f32 v35, v17
  v_cos_f32 v36, v18
  v_sin_f32 v37, v18
  v_cos_f32 v38, v19
  v_sin_f32 v39, v19
  v_fmamk_f32 v16, v12, 0x41800000, v13
  v_fmamk_f32 v17, v12, 0x41880000, v13
  v_fmamk_f32 v18, v12, 0x41900000, v13
  v_fmamk_f32 v19, v12, 0x41980000, v13
  v_cos_f32 v40, v16
  v_sin_f32 v41, v16
  v_cos_f32 v42, v17
  v_sin_f32 v43, v17
  v_cos_f32 v44, v18
  v_sin_f32 v45, v18
  v_cos_f32 v46, v19
  v_sin_f32 v47, v19
  v_add_f32 v48, v48, v48
  v_cvt_pk_bf16_f32 v192, v32, -v33
  v_cvt_pk_bf16_f32 v193, v34, -v35
  v_cvt_pk_bf16_f32 v194, v36, -v37
  v_cvt_pk_bf16_f32 v195, v38, -v39
  v_pk_fma_f32 v[32:33], v[40:41], v[48:49], v[32:33] op_sel_hi:[1,0,1] neg_lo:[0,0,1] neg_hi:[0,0,1]
  v_pk_fma_f32 v[34:35], v[42:43], v[48:49], v[34:35] op_sel_hi:[1,0,1] neg_lo:[0,0,1] neg_hi:[0,0,1]
  v_pk_fma_f32 v[36:37], v[44:45], v[48:49], v[36:37] op_sel_hi:[1,0,1] neg_lo:[0,0,1] neg_hi:[0,0,1]
  v_pk_fma_f32 v[38:39], v[46:47], v[48:49], v[38:39] op_sel_hi:[1,0,1] neg_lo:[0,0,1] neg_hi:[0,0,1]
  v_cvt_pk_bf16_f32 v196, v40, -v41
  v_cvt_pk_bf16_f32 v197, v42, -v43
  v_cvt_pk_bf16_f32 v198, v44, -v45
  v_cvt_pk_bf16_f32 v199, v46, -v47
  v_pk_fma_f32 v[40:41], v[32:33], v[48:49], v[40:41] op_sel_hi:[1,0,1] neg_lo:[0,0,1] neg_hi:[0,0,1]
  v_pk_fma_f32 v[42:43], v[34:35], v[48:49], v[42:43] op_sel_hi:[1,0,1] neg_lo:[0,0,1] neg_hi:[0,0,1]
  v_pk_fma_f32 v[44:45], v[36:37], v[48:49], v[44:45] op_sel_hi:[1,0,1] neg_lo:[0,0,1] neg_hi:[0,0,1]
  v_pk_fma_f32 v[46:47], v[38:39], v[48:49], v[46:47] op_sel_hi:[1,0,1] neg_lo:[0,0,1] neg_hi:[0,0,1]
  v_cvt_pk_bf16_f32 v200, v32, -v33
  v_cvt_pk_bf16_f32 v201, v34, -v35
  v_cvt_pk_bf16_f32 v202, v36, -v37
  v_cvt_pk_bf16_f32 v203, v38, -v39
  v_pk_fma_f32 v[32:33], v[40:41], v[48:49], v[32:33] op_sel_hi:[1,0,1] neg_lo:[0,0,1] neg_hi:[0,0,1]
  v_pk_fma_f32 v[34:35], v[42:43], v[48:49], v[34:35] op_sel_hi:[1,0,1] neg_lo:[0,0,1] neg_hi:[0,0,1]
  v_pk_fma_f32 v[36:37], v[44:45], v[48:49], v[36:37] op_sel_hi:[1,0,1] neg_lo:[0,0,1] neg_hi:[0,0,1]
  v_pk_fma_f32 v[38:39], v[46:47], v[48:49], v[38:39] op_sel_hi:[1,0,1] neg_lo:[0,0,1] neg_hi:[0,0,1]
  v_cvt_pk_bf16_f32 v204, v40, -v41
  v_cvt_pk_bf16_f32 v205, v42, -v43
  v_cvt_pk_bf16_f32 v206, v44, -v45
  v_cvt_pk_bf16_f32 v207, v46, -v47
  v_pk_fma_f32 v[40:41], v[32:33], v[48:49], v[40:41] op_sel_hi:[1,0,1] neg_lo:[0,0,1] neg_hi:[0,0,1]
  v_pk_fma_f32 v[42:43], v[34:35], v[48:49], v[42:43] op_sel_hi:[1,0,1] neg_lo:[0,0,1] neg_hi:[0,0,1]
  v_pk_fma_f32 v[44:45], v[36:37], v[48:49], v[44:45] op_sel_hi:[1,0,1] neg_lo:[0,0,1] neg_hi:[0,0,1]
  v_pk_fma_f32 v[46:47], v[38:39], v[48:49], v[46:47] op_sel_hi:[1,0,1] neg_lo:[0,0,1] neg_hi:[0,0,1]
  v_cvt_pk_bf16_f32 v208, v32, -v33
  v_cvt_pk_bf16_f32 v209, v34, -v35
  v_cvt_pk_bf16_f32 v210, v36, -v37
  v_cvt_pk_bf16_f32 v211, v38, -v39
  v_pk_fma_f32 v[32:33], v[40:41], v[48:49], v[32:33] op_sel_hi:[1,0,1] neg_lo:[0,0,1] neg_hi:[0,0,1]
  v_pk_fma_f32 v[34:35], v[42:43], v[48:49], v[34:35] op_sel_hi:[1,0,1] neg_lo:[0,0,1] neg_hi:[0,0,1]
  v_pk_fma_f32 v[36:37], v[44:45], v[48:49], v[36:37] op_sel_hi:[1,0,1] neg_lo:[0,0,1] neg_hi:[0,0,1]
  v_pk_fma_f32 v[38:39], v[46:47], v[48:49], v[38:39] op_sel_hi:[1,0,1] neg_lo:[0,0,1] neg_hi:[0,0,1]
  v_cvt_pk_bf16_f32 v212, v40, -v41
  v_cvt_pk_bf16_f32 v213, v42, -v43
  v_cvt_pk_bf16_f32 v214, v44, -v45
  v_cvt_pk_bf16_f32 v215, v46, -v47
  v_pk_fma_f32 v[40:41], v[32:33], v[48:49], v[40:41] op_sel_hi:[1,0,1] neg_lo:[0,0,1] neg_hi:[0,0,1]
  v_pk_fma_f32 v[42:43], v[34:35], v[48:49], v[42:43] op_sel_hi:[1,0,1] neg_lo:[0,0,1] neg_hi:[0,0,1]
  v_pk_fma_f32 v[44:45], v[36:37], v[48:49], v[44:45] op_sel_hi:[1,0,1] neg_lo:[0,0,1] neg_hi:[0,0,1]
  v_pk_fma_f32 v[46:47], v[38:39], v[48:49], v[46:47] op_sel_hi:[1,0,1] neg_lo:[0,0,1] neg_hi:[0,0,1]
  v_cvt_pk_bf16_f32 v216, v32, -v33
  v_cvt_pk_bf16_f32 v217, v34, -v35
  v_cvt_pk_bf16_f32 v218, v36, -v37
  v_cvt_pk_bf16_f32 v219, v38, -v39
  v_pk_fma_f32 v[32:33], v[40:41], v[48:49], v[32:33] op_sel_hi:[1,0,1] neg_lo:[0,0,1] neg_hi:[0,0,1]
  v_pk_fma_f32 v[34:35], v[42:43], v[48:49], v[34:35] op_sel_hi:[1,0,1] neg_lo:[0,0,1] neg_hi:[0,0,1]
  v_pk_fma_f32 v[36:37], v[44:45], v[48:49], v[36:37] op_sel_hi:[1,0,1] neg_lo:[0,0,1] neg_hi:[0,0,1]
  v_pk_fma_f32 v[38:39], v[46:47], v[48:49], v[38:39] op_sel_hi:[1,0,1] neg_lo:[0,0,1] neg_hi:[0,0,1]
  v_cvt_pk_bf16_f32 v220, v40, -v41
  v_cvt_pk_bf16_f32 v221, v42, -v43
  v_cvt_pk_bf16_f32 v222, v44, -v45
  v_cvt_pk_bf16_f32 v223, v46, -v47
  v_pk_fma_f32 v[40:41], v[32:33], v[48:49], v[40:41] op_sel_hi:[1,0,1] neg_lo:[0,0,1] neg_hi:[0,0,1]
  v_pk_fma_f32 v[42:43], v[34:35], v[48:49], v[42:43] op_sel_hi:[1,0,1] neg_lo:[0,0,1] neg_hi:[0,0,1]
  v_pk_fma_f32 v[44:45], v[36:37], v[48:49], v[44:45] op_sel_hi:[1,0,1] neg_lo:[0,0,1] neg_hi:[0,0,1]
  v_pk_fma_f32 v[46:47], v[38:39], v[48:49], v[46:47] op_sel_hi:[1,0,1] neg_lo:[0,0,1] neg_hi:[0,0,1]
  v_cvt_pk_bf16_f32 v224, v32, -v33
  v_cvt_pk_bf16_f32 v225, v34, -v35
  v_cvt_pk_bf16_f32 v226, v36, -v37
  v_cvt_pk_bf16_f32 v227, v38, -v39
  v_pk_fma_f32 v[32:33], v[40:41], v[48:49], v[32:33] op_sel_hi:[1,0,1] neg_lo:[0,0,1] neg_hi:[0,0,1]
  v_pk_fma_f32 v[34:35], v[42:43], v[48:49], v[34:35] op_sel_hi:[1,0,1] neg_lo:[0,0,1] neg_hi:[0,0,1]
  v_pk_fma_f32 v[36:37], v[44:45], v[48:49], v[36:37] op_sel_hi:[1,0,1] neg_lo:[0,0,1] neg_hi:[0,0,1]
  v_pk_fma_f32 v[38:39], v[46:47], v[48:49], v[38:39] op_sel_hi:[1,0,1] neg_lo:[0,0,1] neg_hi:[0,0,1]
  v_cvt_pk_bf16_f32 v228, v40, -v41
  v_cvt_pk_bf16_f32 v229, v42, -v43
  v_cvt_pk_bf16_f32 v230, v44, -v45
  v_cvt_pk_bf16_f32 v231, v46, -v47
  v_pk_fma_f32 v[40:41], v[32:33], v[48:49], v[40:41] op_sel_hi:[1,0,1] neg_lo:[0,0,1] neg_hi:[0,0,1]
  v_pk_fma_f32 v[42:43], v[34:35], v[48:49], v[42:43] op_sel_hi:[1,0,1] neg_lo:[0,0,1] neg_hi:[0,0,1]
  v_pk_fma_f32 v[44:45], v[36:37], v[48:49], v[44:45] op_sel_hi:[1,0,1] neg_lo:[0,0,1] neg_hi:[0,0,1]
  v_pk_fma_f32 v[46:47], v[38:39], v[48:49], v[46:47] op_sel_hi:[1,0,1] neg_lo:[0,0,1] neg_hi:[0,0,1]
  v_cvt_pk_bf16_f32 v232, v32, -v33
  v_cvt_pk_bf16_f32 v233, v34, -v35
  v_cvt_pk_bf16_f32 v234, v36, -v37
  v_cvt_pk_bf16_f32 v235, v38, -v39
  v_pk_fma_f32 v[32:33], v[40:41], v[48:49], v[32:33] op_sel_hi:[1,0,1] neg_lo:[0,0,1] neg_hi:[0,0,1]
  v_pk_fma_f32 v[34:35], v[42:43], v[48:49], v[34:35] op_sel_hi:[1,0,1] neg_lo:[0,0,1] neg_hi:[0,0,1]
  v_pk_fma_f32 v[36:37], v[44:45], v[48:49], v[36:37] op_sel_hi:[1,0,1] neg_lo:[0,0,1] neg_hi:[0,0,1]
  v_pk_fma_f32 v[38:39], v[46:47], v[48:49], v[38:39] op_sel_hi:[1,0,1] neg_lo:[0,0,1] neg_hi:[0,0,1]
  v_cvt_pk_bf16_f32 v236, v40, -v41
  v_cvt_pk_bf16_f32 v237, v42, -v43
  v_cvt_pk_bf16_f32 v238, v44, -v45
  v_cvt_pk_bf16_f32 v239, v46, -v47
  v_pk_fma_f32 v[40:41], v[32:33], v[48:49], v[40:41] op_sel_hi:[1,0,1] neg_lo:[0,0,1] neg_hi:[0,0,1]
  v_pk_fma_f32 v[42:43], v[34:35], v[48:49], v[42:43] op_sel_hi:[1,0,1] neg_lo:[0,0,1] neg_hi:[0,0,1]
  v_pk_fma_f32 v[44:45], v[36:37], v[48:49], v[44:45] op_sel_hi:[1,0,1] neg_lo:[0,0,1] neg_hi:[0,0,1]
  v_pk_fma_f32 v[46:47], v[38:39], v[48:49], v[46:47] op_sel_hi:[1,0,1] neg_lo:[0,0,1] neg_hi:[0,0,1]
  v_cvt_pk_bf16_f32 v240, v32, -v33
  v_cvt_pk_bf16_f32 v241, v34, -v35
  v_cvt_pk_bf16_f32 v242, v36, -v37
  v_cvt_pk_bf16_f32 v243, v38, -v39
  v_pk_fma_f32 v[32:33], v[40:41], v[48:49], v[32:33] op_sel_hi:[1,0,1] neg_lo:[0,0,1] neg_hi:[0,0,1]
  v_pk_fma_f32 v[34:35], v[42:43], v[48:49], v[34:35] op_sel_hi:[1,0,1] neg_lo:[0,0,1] neg_hi:[0,0,1]
  v_pk_fma_f32 v[36:37], v[44:45], v[48:49], v[36:37] op_sel_hi:[1,0,1] neg_lo:[0,0,1] neg_hi:[0,0,1]
  v_pk_fma_f32 v[38:39], v[46:47], v[48:49], v[38:39] op_sel_hi:[1,0,1] neg_lo:[0,0,1] neg_hi:[0,0,1]
  v_cvt_pk_bf16_f32 v244, v40, -v41
  v_cvt_pk_bf16_f32 v245, v42, -v43
  v_cvt_pk_bf16_f32 v246, v44, -v45
  v_cvt_pk_bf16_f32 v247, v46, -v47
  v_cvt_pk_bf16_f32 v248, v32, -v33
  v_cvt_pk_bf16_f32 v249, v34, -v35
  v_cvt_pk_bf16_f32 v250, v36, -v37
  v_cvt_pk_bf16_f32 v251, v38, -v39
  s_waitcnt vmcnt(16)
  s_barrier
  s_add_u32 s3, s82, 2048
  buffer_store_dword v22, v23, s[92:95], s3 offen sc1
  v_cmp_eq_u32 vcc, 0, v5
  v_mov_b32 v121, 0
  v_mov_b32 v122, 0
  v_mov_b32 v123, 0
  v_cndmask_b32 v120, 0, v120, vcc
  v_mov_b32 v249, 0
  v_mov_b32 v250, 0
  v_mov_b32 v251, 0
  v_cndmask_b32 v248, 0, v248, vcc
  s_waitcnt vmcnt(16)
  v_lshlrev_b32 v32, 16, v128
  v_and_b32 v33, 0xffff0000, v128
  v_lshlrev_b32 v34, 16, v129
  v_and_b32 v35, 0xffff0000, v129
  v_lshlrev_b32 v36, 16, v130
  v_and_b32 v37, 0xffff0000, v130
  v_lshlrev_b32 v38, 16, v131
  v_and_b32 v39, 0xffff0000, v131
  s_waitcnt vmcnt(15)
  v_lshlrev_b32 v40, 16, v132
  v_and_b32 v41, 0xffff0000, v132
  v_pk_add_f32 v[32:33], v[32:33], v[40:41]
  v_lshlrev_b32 v40, 16, v133
  v_and_b32 v41, 0xffff0000, v133
  v_pk_add_f32 v[34:35], v[34:35], v[40:41]
  v_lshlrev_b32 v40, 16, v134
  v_and_b32 v41, 0xffff0000, v134
  v_pk_add_f32 v[36:37], v[36:37], v[40:41]
  v_lshlrev_b32 v40, 16, v135
  v_and_b32 v41, 0xffff0000, v135
  v_pk_add_f32 v[38:39], v[38:39], v[40:41]
  s_waitcnt vmcnt(14)
  v_lshlrev_b32 v40, 16, v136
  v_and_b32 v41, 0xffff0000, v136
  v_pk_add_f32 v[32:33], v[32:33], v[40:41]
  v_lshlrev_b32 v40, 16, v137
  v_and_b32 v41, 0xffff0000, v137
  v_pk_add_f32 v[34:35], v[34:35], v[40:41]
  v_lshlrev_b32 v40, 16, v138
  v_and_b32 v41, 0xffff0000, v138
  v_pk_add_f32 v[36:37], v[36:37], v[40:41]
  v_lshlrev_b32 v40, 16, v139
  v_and_b32 v41, 0xffff0000, v139
  v_pk_add_f32 v[38:39], v[38:39], v[40:41]
  s_waitcnt vmcnt(13)
  v_lshlrev_b32 v40, 16, v140
  v_and_b32 v41, 0xffff0000, v140
  v_pk_add_f32 v[32:33], v[32:33], v[40:41]
  v_lshlrev_b32 v40, 16, v141
  v_and_b32 v41, 0xffff0000, v141
  v_pk_add_f32 v[34:35], v[34:35], v[40:41]
  v_lshlrev_b32 v40, 16, v142
  v_and_b32 v41, 0xffff0000, v142
  v_pk_add_f32 v[36:37], v[36:37], v[40:41]
  v_lshlrev_b32 v40, 16, v143
  v_and_b32 v41, 0xffff0000, v143
  v_pk_add_f32 v[38:39], v[38:39], v[40:41]
  s_waitcnt vmcnt(12)
  v_lshlrev_b32 v40, 16, v144
  v_and_b32 v41, 0xffff0000, v144
  v_pk_add_f32 v[32:33], v[32:33], v[40:41]
  v_lshlrev_b32 v40, 16, v145
  v_and_b32 v41, 0xffff0000, v145
  v_pk_add_f32 v[34:35], v[34:35], v[40:41]
  v_lshlrev_b32 v40, 16, v146
  v_and_b32 v41, 0xffff0000, v146
  v_pk_add_f32 v[36:37], v[36:37], v[40:41]
  v_lshlrev_b32 v40, 16, v147
  v_and_b32 v41, 0xffff0000, v147
  v_pk_add_f32 v[38:39], v[38:39], v[40:41]
  s_waitcnt vmcnt(11)
  v_lshlrev_b32 v40, 16, v148
  v_and_b32 v41, 0xffff0000, v148
  v_pk_add_f32 v[32:33], v[32:33], v[40:41]
  v_lshlrev_b32 v40, 16, v149
  v_and_b32 v41, 0xffff0000, v149
  v_pk_add_f32 v[34:35], v[34:35], v[40:41]
  v_lshlrev_b32 v40, 16, v150
  v_and_b32 v41, 0xffff0000, v150
  v_pk_add_f32 v[36:37], v[36:37], v[40:41]
  v_lshlrev_b32 v40, 16, v151
  v_and_b32 v41, 0xffff0000, v151
  v_pk_add_f32 v[38:39], v[38:39], v[40:41]
  s_waitcnt vmcnt(10)
  v_lshlrev_b32 v40, 16, v152
  v_and_b32 v41, 0xffff0000, v152
  v_pk_add_f32 v[32:33], v[32:33], v[40:41]
  v_lshlrev_b32 v40, 16, v153
  v_and_b32 v41, 0xffff0000, v153
  v_pk_add_f32 v[34:35], v[34:35], v[40:41]
  v_lshlrev_b32 v40, 16, v154
  v_and_b32 v41, 0xffff0000, v154
  v_pk_add_f32 v[36:37], v[36:37], v[40:41]
  v_lshlrev_b32 v40, 16, v155
  v_and_b32 v41, 0xffff0000, v155
  v_pk_add_f32 v[38:39], v[38:39], v[40:41]
  s_waitcnt vmcnt(9)
  v_lshlrev_b32 v40, 16, v156
  v_and_b32 v41, 0xffff0000, v156
  v_pk_add_f32 v[32:33], v[32:33], v[40:41]
  v_lshlrev_b32 v40, 16, v157
  v_and_b32 v41, 0xffff0000, v157
  v_pk_add_f32 v[34:35], v[34:35], v[40:41]
  v_lshlrev_b32 v40, 16, v158
  v_and_b32 v41, 0xffff0000, v158
  v_pk_add_f32 v[36:37], v[36:37], v[40:41]
  v_lshlrev_b32 v40, 16, v159
  v_and_b32 v41, 0xffff0000, v159
  v_pk_add_f32 v[38:39], v[38:39], v[40:41]
  s_waitcnt vmcnt(8)
  v_lshlrev_b32 v40, 16, v160
  v_and_b32 v41, 0xffff0000, v160
  v_pk_add_f32 v[32:33], v[32:33], v[40:41]
  v_lshlrev_b32 v40, 16, v161
  v_and_b32 v41, 0xffff0000, v161
  v_pk_add_f32 v[34:35], v[34:35], v[40:41]
  v_lshlrev_b32 v40, 16, v162
  v_and_b32 v41, 0xffff0000, v162
  v_pk_add_f32 v[36:37], v[36:37], v[40:41]
  v_lshlrev_b32 v40, 16, v163
  v_and_b32 v41, 0xffff0000, v163
  v_pk_add_f32 v[38:39], v[38:39], v[40:41]
  s_waitcnt vmcnt(7)
  v_lshlrev_b32 v40, 16, v164
  v_and_b32 v41, 0xffff0000, v164
  v_pk_add_f32 v[32:33], v[32:33], v[40:41]
  v_lshlrev_b32 v40, 16, v165
  v_and_b32 v41, 0xffff0000, v165
  v_pk_add_f32 v[34:35], v[34:35], v[40:41]
  v_lshlrev_b32 v40, 16, v166
  v_and_b32 v41, 0xffff0000, v166
  v_pk_add_f32 v[36:37], v[36:37], v[40:41]
  v_lshlrev_b32 v40, 16, v167
  v_and_b32 v41, 0xffff0000, v167
  v_pk_add_f32 v[38:39], v[38:39], v[40:41]
  s_waitcnt vmcnt(6)
  v_lshlrev_b32 v40, 16, v168
  v_and_b32 v41, 0xffff0000, v168
  v_pk_add_f32 v[32:33], v[32:33], v[40:41]
  v_lshlrev_b32 v40, 16, v169
  v_and_b32 v41, 0xffff0000, v169
  v_pk_add_f32 v[34:35], v[34:35], v[40:41]
  v_lshlrev_b32 v40, 16, v170
  v_and_b32 v41, 0xffff0000, v170
  v_pk_add_f32 v[36:37], v[36:37], v[40:41]
  v_lshlrev_b32 v40, 16, v171
  v_and_b32 v41, 0xffff0000, v171
  v_pk_add_f32 v[38:39], v[38:39], v[40:41]
  s_waitcnt vmcnt(5)
  v_lshlrev_b32 v40, 16, v172
  v_and_b32 v41, 0xffff0000, v172
  v_pk_add_f32 v[32:33], v[32:33], v[40:41]
  v_lshlrev_b32 v40, 16, v173
  v_and_b32 v41, 0xffff0000, v173
  v_pk_add_f32 v[34:35], v[34:35], v[40:41]
  v_lshlrev_b32 v40, 16, v174
  v_and_b32 v41, 0xffff0000, v174
  v_pk_add_f32 v[36:37], v[36:37], v[40:41]
  v_lshlrev_b32 v40, 16, v175
  v_and_b32 v41, 0xffff0000, v175
  v_pk_add_f32 v[38:39], v[38:39], v[40:41]
  s_waitcnt vmcnt(4)
  v_lshlrev_b32 v40, 16, v176
  v_and_b32 v41, 0xffff0000, v176
  v_pk_add_f32 v[32:33], v[32:33], v[40:41]
  v_lshlrev_b32 v40, 16, v177
  v_and_b32 v41, 0xffff0000, v177
  v_pk_add_f32 v[34:35], v[34:35], v[40:41]
  v_lshlrev_b32 v40, 16, v178
  v_and_b32 v41, 0xffff0000, v178
  v_pk_add_f32 v[36:37], v[36:37], v[40:41]
  v_lshlrev_b32 v40, 16, v179
  v_and_b32 v41, 0xffff0000, v179
  v_pk_add_f32 v[38:39], v[38:39], v[40:41]
  s_waitcnt vmcnt(3)
  v_lshlrev_b32 v40, 16, v180
  v_and_b32 v41, 0xffff0000, v180
  v_pk_add_f32 v[32:33], v[32:33], v[40:41]
  v_lshlrev_b32 v40, 16, v181
  v_and_b32 v41, 0xffff0000, v181
  v_pk_add_f32 v[34:35], v[34:35], v[40:41]
  v_lshlrev_b32 v40, 16, v182
  v_and_b32 v41, 0xffff0000, v182
  v_pk_add_f32 v[36:37], v[36:37], v[40:41]
  v_lshlrev_b32 v40, 16, v183
  v_and_b32 v41, 0xffff0000, v183
  v_pk_add_f32 v[38:39], v[38:39], v[40:41]
  s_waitcnt vmcnt(2)
  v_lshlrev_b32 v40, 16, v184
  v_and_b32 v41, 0xffff0000, v184
  v_pk_add_f32 v[32:33], v[32:33], v[40:41]
  v_lshlrev_b32 v40, 16, v185
  v_and_b32 v41, 0xffff0000, v185
  v_pk_add_f32 v[34:35], v[34:35], v[40:41]
  v_lshlrev_b32 v40, 16, v186
  v_and_b32 v41, 0xffff0000, v186
  v_pk_add_f32 v[36:37], v[36:37], v[40:41]
  v_lshlrev_b32 v40, 16, v187
  v_and_b32 v41, 0xffff0000, v187
  v_pk_add_f32 v[38:39], v[38:39], v[40:41]
  s_waitcnt vmcnt(1)
  v_lshlrev_b32 v40, 16, v188
  v_and_b32 v41, 0xffff0000, v188
  v_pk_add_f32 v[32:33], v[32:33], v[40:41]
  v_lshlrev_b32 v40, 16, v189
  v_and_b32 v41, 0xffff0000, v189
  v_pk_add_f32 v[34:35], v[34:35], v[40:41]
  v_lshlrev_b32 v40, 16, v190
  v_and_b32 v41, 0xffff0000, v190
  v_pk_add_f32 v[36:37], v[36:37], v[40:41]
  v_lshlrev_b32 v40, 16, v191
  v_and_b32 v41, 0xffff0000, v191
  v_pk_add_f32 v[38:39], v[38:39], v[40:41]
  v_cvt_pk_bf16_f32 v44, v32, v33
  v_cvt_pk_bf16_f32 v45, v34, v35
  v_cvt_pk_bf16_f32 v46, v36, v37
  v_cvt_pk_bf16_f32 v47, v38, v39
  s_nop 1
  v_permlane32_swap_b32 v44, v46
  v_permlane32_swap_b32 v45, v47
  s_nop 1
  v_permlane16_swap_b32 v44, v46
  v_permlane16_swap_b32 v45, v47
  buffer_store_dwordx4 v[44:47], v21, s[12:15], s30 offen
  buffer_load_dword v25, v24, s[92:95], 0 offen offset:2048 sc1
  s_waitcnt vmcnt(0)
  v_cmp_ne_u32 vcc, 1, v25
  s_nop 4
  s_cbranch_vccnz K2_p2_wait
K2_p2_ok:
  buffer_load_dwordx4 v[128:131], v9, s[16:19], s31 offen sc1
  s_add_u32 s31, s31, 0x1c0000
  buffer_load_dwordx4 v[132:135], v9, s[16:19], s31 offen sc1
  s_add_u32 s31, s31, 0x1c0000
  buffer_load_dwordx4 v[136:139], v9, s[16:19], s31 offen sc1
  s_add_u32 s31, s31, 0x1c0000
  buffer_load_dwordx4 v[140:143], v9, s[16:19], s31 offen sc1
  s_add_u32 s31, s31, 0x1c0000
  buffer_load_dwordx4 v[144:147], v9, s[16:19], s31 offen sc1
  s_add_u32 s31, s31, 0x1c0000
  buffer_load_dwordx4 v[148:151], v9, s[16:19], s31 offen sc1
  s_add_u32 s31, s31, 0x1c0000
  buffer_load_dwordx4 v[152:155], v9, s[16:19], s31 offen sc1
  s_add_u32 s31, s31, 0x1c0000
  buffer_load_dwordx4 v[156:159], v9, s[16:19], s31 offen sc1
  s_add_u32 s31, s31, 0x1c0000
  buffer_load_dwordx4 v[160:163], v9, s[16:19], s31 offen sc1
  s_add_u32 s31, s31, 0x1c0000
  buffer_load_dwordx4 v[164:167], v9, s[16:19], s31 offen sc1
  s_add_u32 s31, s31, 0x1c0000
  buffer_load_dwordx4 v[168:171], v9, s[16:19], s31 offen sc1
  s_add_u32 s31, s31, 0x1c0000
  buffer_load_dwordx4 v[172:175], v9, s[16:19], s31 offen sc1
  s_add_u32 s31, s31, 0x1c0000
  buffer_load_dwordx4 v[176:179], v9, s[16:19], s31 offen sc1
  s_add_u32 s31, s31, 0x1c0000
  buffer_load_dwordx4 v[180:183], v9, s[16:19], s31 offen sc1
  s_add_u32 s31, s31, 0x1c0000
  buffer_load_dwordx4 v[184:187], v9, s[16:19], s31 offen sc1
  s_add_u32 s31, s31, 0x1c0000
  buffer_load_dwordx4 v[188:191], v9, s[16:19], s31 offen sc1
  ds_read_b64_tr_b16 v[32:33], v14 offset:0
  ds_read_b64_tr_b16 v[34:35], v14 offset:256
  ds_read_b64_tr_b16 v[36:37], v15 offset:0
  ds_read_b64_tr_b16 v[38:39], v15 offset:256
  ds_read_b64_tr_b16 v[40:41], v14 offset:2048
  ds_read_b64_tr_b16 v[42:43], v14 offset:2304
  ds_read_b64_tr_b16 v[44:45], v15 offset:2048
  ds_read_b64_tr_b16 v[46:47], v15 offset:2304
  ds_read_b64_tr_b16 v[48:49], v14 offset:4096
  ds_read_b64_tr_b16 v[50:51], v14 offset:4352
  ds_read_b64_tr_b16 v[52:53], v15 offset:4096
  ds_read_b64_tr_b16 v[54:55], v15 offset:4352
  s_waitcnt lgkmcnt(8)
  v_mfma_f32_16x16x32_bf16 v[56:59], v[64:67], v[32:35], 0
  v_mfma_f32_16x16x32_bf16 v[60:63], v[64:67], v[36:39], 0
  v_mfma_f32_16x16x32_bf16 v[124:127], v[192:195], v[32:35], 0
  v_mfma_f32_16x16x32_bf16 v[252:255], v[192:195], v[36:39], 0
  ds_read_b64_tr_b16 v[32:33], v14 offset:6144
  ds_read_b64_tr_b16 v[34:35], v14 offset:6400
  ds_read_b64_tr_b16 v[36:37], v15 offset:6144
  ds_read_b64_tr_b16 v[38:39], v15 offset:6400
  s_waitcnt lgkmcnt(8)
  v_mfma_f32_16x16x32_bf16 v[56:59], v[68:71], v[40:43], v[56:59]
  v_mfma_f32_16x16x32_bf16 v[60:63], v[68:71], v[44:47], v[60:63]
  v_mfma_f32_16x16x32_bf16 v[124:127], v[196:199], v[40:43], v[124:127]
  v_mfma_f32_16x16x32_bf16 v[252:255], v[196:199], v[44:47], v[252:255]
  ds_read_b64_tr_b16 v[40:41], v14 offset:8192
  ds_read_b64_tr_b16 v[42:43], v14 offset:8448
  ds_read_b64_tr_b16 v[44:45], v15 offset:8192
  ds_read_b64_tr_b16 v[46:47], v15 offset:8448
  s_waitcnt lgkmcnt(8)
  v_mfma_f32_16x16x32_bf16 v[56:59], v[72:75], v[48:51], v[56:59]
  v_mfma_f32_16x16x32_bf16 v[60:63], v[72:75], v[52:55], v[60:63]
  v_mfma_f32_16x16x32_bf16 v[124:127], v[200:203], v[48:51], v[124:127]
  v_mfma_f32_16x16x32_bf16 v[252:255], v[200:203], v[52:55], v[252:255]
  ds_read_b64_tr_b16 v[48:49], v14 offset:10240
  ds_read_b64_tr_b16 v[50:51], v14 offset:10496
  ds_read_b64_tr_b16 v[52:53], v15 offset:10240
  ds_read_b64_tr_b16 v[54:55], v15 offset:10496
  s_waitcnt lgkmcnt(8)
  v_mfma_f32_16x16x32_bf16 v[56:59], v[76:79], v[32:35], v[56:59]
  v_mfma_f32_16x16x32_bf16 v[60:63], v[76:79], v[36:39], v[60:63]
  v_mfma_f32_16x16x32_bf16 v[124:127], v[204:207], v[32:35], v[124:127]
  v_mfma_f32_16x16x32_bf16 v[252:255], v[204:207], v[36:39], v[252:255]
  ds_read_b64_tr_b16 v[32:33], v14 offset:12288
  ds_read_b64_tr_b16 v[34:35], v14 offset:12544
  ds_read_b64_tr_b16 v[36:37], v15 offset:12288
  ds_read_b64_tr_b16 v[38:39], v15 offset:12544
  s_waitcnt lgkmcnt(8)
  v_mfma_f32_16x16x32_bf16 v[56:59], v[80:83], v[40:43], v[56:59]
  v_mfma_f32_16x16x32_bf16 v[60:63], v[80:83], v[44:47], v[60:63]
  v_mfma_f32_16x16x32_bf16 v[124:127], v[208:211], v[40:43], v[124:127]
  v_mfma_f32_16x16x32_bf16 v[252:255], v[208:211], v[44:47], v[252:255]
  ds_read_b64_tr_b16 v[40:41], v14 offset:14336
  ds_read_b64_tr_b16 v[42:43], v14 offset:14592
  ds_read_b64_tr_b16 v[44:45], v15 offset:14336
  ds_read_b64_tr_b16 v[46:47], v15 offset:14592
  s_waitcnt lgkmcnt(8)
  v_mfma_f32_16x16x32_bf16 v[56:59], v[84:87], v[48:51], v[56:59]
  v_mfma_f32_16x16x32_bf16 v[60:63], v[84:87], v[52:55], v[60:63]
  v_mfma_f32_16x16x32_bf16 v[124:127], v[212:215], v[48:51], v[124:127]
  v_mfma_f32_16x16x32_bf16 v[252:255], v[212:215], v[52:55], v[252:255]
  ds_read_b64_tr_b16 v[48:49], v14 offset:16384
  ds_read_b64_tr_b16 v[50:51], v14 offset:16640
  ds_read_b64_tr_b16 v[52:53], v15 offset:16384
  ds_read_b64_tr_b16 v[54:55], v15 offset:16640
  s_waitcnt lgkmcnt(8)
  v_mfma_f32_16x16x32_bf16 v[56:59], v[88:91], v[32:35], v[56:59]
  v_mfma_f32_16x16x32_bf16 v[60:63], v[88:91], v[36:39], v[60:63]
  v_mfma_f32_16x16x32_bf16 v[124:127], v[216:219], v[32:35], v[124:127]
  v_mfma_f32_16x16x32_bf16 v[252:255], v[216:219], v[36:39], v[252:255]
  ds_read_b64_tr_b16 v[32:33], v14 offset:18432
  ds_read_b64_tr_b16 v[34:35], v14 offset:18688
  ds_read_b64_tr_b16 v[36:37], v15 offset:18432
  ds_read_b64_tr_b16 v[38:39], v15 offset:18688
  s_waitcnt lgkmcnt(8)
  v_mfma_f32_16x16x32_bf16 v[56:59], v[92:95], v[40:43], v[56:59]
  v_mfma_f32_16x16x32_bf16 v[60:63], v[92:95], v[44:47], v[60:63]
  v_mfma_f32_16x16x32_bf16 v[124:127], v[220:223], v[40:43], v[124:127]
  v_mfma_f32_16x16x32_bf16 v[252:255], v[220:223], v[44:47], v[252:255]
  ds_read_b64_tr_b16 v[40:41], v14 offset:20480
  ds_read_b64_tr_b16 v[42:43], v14 offset:20736
  ds_read_b64_tr_b16 v[44:45], v15 offset:20480
  ds_read_b64_tr_b16 v[46:47], v15 offset:20736
  s_waitcnt lgkmcnt(8)
  v_mfma_f32_16x16x32_bf16 v[56:59], v[96:99], v[48:51], v[56:59]
  v_mfma_f32_16x16x32_bf16 v[60:63], v[96:99], v[52:55], v[60:63]
  v_mfma_f32_16x16x32_bf16 v[124:127], v[224:227], v[48:51], v[124:127]
  v_mfma_f32_16x16x32_bf16 v[252:255], v[224:227], v[52:55], v[252:255]
  ds_read_b64_tr_b16 v[48:49], v14 offset:22528
  ds_read_b64_tr_b16 v[50:51], v14 offset:22784
  ds_read_b64_tr_b16 v[52:53], v15 offset:22528
  ds_read_b64_tr_b16 v[54:55], v15 offset:22784
  s_waitcnt lgkmcnt(8)
  v_mfma_f32_16x16x32_bf16 v[56:59], v[100:103], v[32:35], v[56:59]
  v_mfma_f32_16x16x32_bf16 v[60:63], v[100:103], v[36:39], v[60:63]
  v_mfma_f32_16x16x32_bf16 v[124:127], v[228:231], v[32:35], v[124:127]
  v_mfma_f32_16x16x32_bf16 v[252:255], v[228:231], v[36:39], v[252:255]
  ds_read_b64_tr_b16 v[32:33], v14 offset:24576
  ds_read_b64_tr_b16 v[34:35], v14 offset:24832
  ds_read_b64_tr_b16 v[36:37], v15 offset:24576
  ds_read_b64_tr_b16 v[38:39], v15 offset:24832
  s_waitcnt lgkmcnt(8)
  v_mfma_f32_16x16x32_bf16 v[56:59], v[104:107], v[40:43], v[56:59]
  v_mfma_f32_16x16x32_bf16 v[60:63], v[104:107], v[44:47], v[60:63]
  v_mfma_f32_16x16x32_bf16 v[124:127], v[232:235], v[40:43], v[124:127]
  v_mfma_f32_16x16x32_bf16 v[252:255], v[232:235], v[44:47], v[252:255]
  ds_read_b64_tr_b16 v[40:41], v14 offset:26624
  ds_read_b64_tr_b16 v[42:43], v14 offset:26880
  ds_read_b64_tr_b16 v[44:45], v15 offset:26624
  ds_read_b64_tr_b16 v[46:47], v15 offset:26880
  s_waitcnt lgkmcnt(8)
  v_mfma_f32_16x16x32_bf16 v[56:59], v[108:111], v[48:51], v[56:59]
  v_mfma_f32_16x16x32_bf16 v[60:63], v[108:111], v[52:55], v[60:63]
  v_mfma_f32_16x16x32_bf16 v[124:127], v[236:239], v[48:51], v[124:127]
  v_mfma_f32_16x16x32_bf16 v[252:255], v[236:239], v[52:55], v[252:255]
  ds_read_b64_tr_b16 v[48:49], v14 offset:28672
  ds_read_b64_tr_b16 v[50:51], v14 offset:28928
  ds_read_b64_tr_b16 v[52:53], v15 offset:28672
  ds_read_b64_tr_b16 v[54:55], v15 offset:28928
  s_waitcnt lgkmcnt(8)
  v_mfma_f32_16x16x32_bf16 v[56:59], v[112:115], v[32:35], v[56:59]
  v_mfma_f32_16x16x32_bf16 v[60:63], v[112:115], v[36:39], v[60:63]
  v_mfma_f32_16x16x32_bf16 v[124:127], v[240:243], v[32:35], v[124:127]
  v_mfma_f32_16x16x32_bf16 v[252:255], v[240:243], v[36:39], v[252:255]
  s_waitcnt lgkmcnt(4)
  v_mfma_f32_16x16x32_bf16 v[56:59], v[116:119], v[40:43], v[56:59]
  v_mfma_f32_16x16x32_bf16 v[60:63], v[116:119], v[44:47], v[60:63]
  v_mfma_f32_16x16x32_bf16 v[124:127], v[244:247], v[40:43], v[124:127]
  v_mfma_f32_16x16x32_bf16 v[252:255], v[244:247], v[44:47], v[252:255]
  s_waitcnt lgkmcnt(0)
  v_mfma_f32_16x16x32_bf16 v[56:59], v[120:123], v[48:51], v[56:59]
  v_mfma_f32_16x16x32_bf16 v[60:63], v[120:123], v[52:55], v[60:63]
  v_mfma_f32_16x16x32_bf16 v[124:127], v[248:251], v[48:51], v[124:127]
  v_mfma_f32_16x16x32_bf16 v[252:255], v[248:251], v[52:55], v[252:255]
  s_nop 7
  v_cvt_pk_bf16_f32 v48, v56, v57
  v_cvt_pk_bf16_f32 v49, v58, v59
  v_cvt_pk_bf16_f32 v52, v60, v61
  v_cvt_pk_bf16_f32 v53, v62, v63
  v_cvt_pk_bf16_f32 v50, v124, v125
  v_cvt_pk_bf16_f32 v51, v126, v127
  v_cvt_pk_bf16_f32 v54, v252, v253
  v_cvt_pk_bf16_f32 v55, v254, v255
  s_nop 1
  v_permlane32_swap_b32 v48, v50
  v_permlane32_swap_b32 v49, v51
  s_nop 1
  v_permlane16_swap_b32 v48, v50
  v_permlane16_swap_b32 v49, v51
  s_nop 1
  v_permlane32_swap_b32 v52, v54
  v_permlane32_swap_b32 v53, v55
  s_nop 1
  v_permlane16_swap_b32 v52, v54
  v_permlane16_swap_b32 v53, v55
  s_add_u32 s3, s34, 7168
  buffer_store_dwordx4 v[48:51], v8, s[12:15], s34 offen
  buffer_store_dwordx4 v[52:55], v8, s[12:15], s3 offen
  s_waitcnt vmcnt(17)
  v_lshlrev_b32 v32, 16, v128
  v_and_b32 v33, 0xffff0000, v128
  v_lshlrev_b32 v34, 16, v129
  v_and_b32 v35, 0xffff0000, v129
  v_lshlrev_b32 v36, 16, v130
  v_and_b32 v37, 0xffff0000, v130
  v_lshlrev_b32 v38, 16, v131
  v_and_b32 v39, 0xffff0000, v131
  s_waitcnt vmcnt(16)
  v_lshlrev_b32 v40, 16, v132
  v_and_b32 v41, 0xffff0000, v132
  v_pk_add_f32 v[32:33], v[32:33], v[40:41]
  v_lshlrev_b32 v40, 16, v133
  v_and_b32 v41, 0xffff0000, v133
  v_pk_add_f32 v[34:35], v[34:35], v[40:41]
  v_lshlrev_b32 v40, 16, v134
  v_and_b32 v41, 0xffff0000, v134
  v_pk_add_f32 v[36:37], v[36:37], v[40:41]
  v_lshlrev_b32 v40, 16, v135
  v_and_b32 v41, 0xffff0000, v135
  v_pk_add_f32 v[38:39], v[38:39], v[40:41]
  s_waitcnt vmcnt(15)
  v_lshlrev_b32 v40, 16, v136
  v_and_b32 v41, 0xffff0000, v136
  v_pk_add_f32 v[32:33], v[32:33], v[40:41]
  v_lshlrev_b32 v40, 16, v137
  v_and_b32 v41, 0xffff0000, v137
  v_pk_add_f32 v[34:35], v[34:35], v[40:41]
  v_lshlrev_b32 v40, 16, v138
  v_and_b32 v41, 0xffff0000, v138
  v_pk_add_f32 v[36:37], v[36:37], v[40:41]
  v_lshlrev_b32 v40, 16, v139
  v_and_b32 v41, 0xffff0000, v139
  v_pk_add_f32 v[38:39], v[38:39], v[40:41]
  s_waitcnt vmcnt(14)
  v_lshlrev_b32 v40, 16, v140
  v_and_b32 v41, 0xffff0000, v140
  v_pk_add_f32 v[32:33], v[32:33], v[40:41]
  v_lshlrev_b32 v40, 16, v141
  v_and_b32 v41, 0xffff0000, v141
  v_pk_add_f32 v[34:35], v[34:35], v[40:41]
  v_lshlrev_b32 v40, 16, v142
  v_and_b32 v41, 0xffff0000, v142
  v_pk_add_f32 v[36:37], v[36:37], v[40:41]
  v_lshlrev_b32 v40, 16, v143
  v_and_b32 v41, 0xffff0000, v143
  v_pk_add_f32 v[38:39], v[38:39], v[40:41]
  s_waitcnt vmcnt(13)
  v_lshlrev_b32 v40, 16, v144
  v_and_b32 v41, 0xffff0000, v144
  v_pk_add_f32 v[32:33], v[32:33], v[40:41]
  v_lshlrev_b32 v40, 16, v145
  v_and_b32 v41, 0xffff0000, v145
  v_pk_add_f32 v[34:35], v[34:35], v[40:41]
  v_lshlrev_b32 v40, 16, v146
  v_and_b32 v41, 0xffff0000, v146
  v_pk_add_f32 v[36:37], v[36:37], v[40:41]
  v_lshlrev_b32 v40, 16, v147
  v_and_b32 v41, 0xffff0000, v147
  v_pk_add_f32 v[38:39], v[38:39], v[40:41]
  s_waitcnt vmcnt(12)
  v_lshlrev_b32 v40, 16, v148
  v_and_b32 v41, 0xffff0000, v148
  v_pk_add_f32 v[32:33], v[32:33], v[40:41]
  v_lshlrev_b32 v40, 16, v149
  v_and_b32 v41, 0xffff0000, v149
  v_pk_add_f32 v[34:35], v[34:35], v[40:41]
  v_lshlrev_b32 v40, 16, v150
  v_and_b32 v41, 0xffff0000, v150
  v_pk_add_f32 v[36:37], v[36:37], v[40:41]
  v_lshlrev_b32 v40, 16, v151
  v_and_b32 v41, 0xffff0000, v151
  v_pk_add_f32 v[38:39], v[38:39], v[40:41]
  s_waitcnt vmcnt(11)
  v_lshlrev_b32 v40, 16, v152
  v_and_b32 v41, 0xffff0000, v152
  v_pk_add_f32 v[32:33], v[32:33], v[40:41]
  v_lshlrev_b32 v40, 16, v153
  v_and_b32 v41, 0xffff0000, v153
  v_pk_add_f32 v[34:35], v[34:35], v[40:41]
  v_lshlrev_b32 v40, 16, v154
  v_and_b32 v41, 0xffff0000, v154
  v_pk_add_f32 v[36:37], v[36:37], v[40:41]
  v_lshlrev_b32 v40, 16, v155
  v_and_b32 v41, 0xffff0000, v155
  v_pk_add_f32 v[38:39], v[38:39], v[40:41]
  s_waitcnt vmcnt(10)
  v_lshlrev_b32 v40, 16, v156
  v_and_b32 v41, 0xffff0000, v156
  v_pk_add_f32 v[32:33], v[32:33], v[40:41]
  v_lshlrev_b32 v40, 16, v157
  v_and_b32 v41, 0xffff0000, v157
  v_pk_add_f32 v[34:35], v[34:35], v[40:41]
  v_lshlrev_b32 v40, 16, v158
  v_and_b32 v41, 0xffff0000, v158
  v_pk_add_f32 v[36:37], v[36:37], v[40:41]
  v_lshlrev_b32 v40, 16, v159
  v_and_b32 v41, 0xffff0000, v159
  v_pk_add_f32 v[38:39], v[38:39], v[40:41]
  s_waitcnt vmcnt(9)
  v_lshlrev_b32 v40, 16, v160
  v_and_b32 v41, 0xffff0000, v160
  v_pk_add_f32 v[32:33], v[32:33], v[40:41]
  v_lshlrev_b32 v40, 16, v161
  v_and_b32 v41, 0xffff0000, v161
  v_pk_add_f32 v[34:35], v[34:35], v[40:41]
  v_lshlrev_b32 v40, 16, v162
  v_and_b32 v41, 0xffff0000, v162
  v_pk_add_f32 v[36:37], v[36:37], v[40:41]
  v_lshlrev_b32 v40, 16, v163
  v_and_b32 v41, 0xffff0000, v163
  v_pk_add_f32 v[38:39], v[38:39], v[40:41]
  s_waitcnt vmcnt(8)
  v_lshlrev_b32 v40, 16, v164
  v_and_b32 v41, 0xffff0000, v164
  v_pk_add_f32 v[32:33], v[32:33], v[40:41]
  v_lshlrev_b32 v40, 16, v165
  v_and_b32 v41, 0xffff0000, v165
  v_pk_add_f32 v[34:35], v[34:35], v[40:41]
  v_lshlrev_b32 v40, 16, v166
  v_and_b32 v41, 0xffff0000, v166
  v_pk_add_f32 v[36:37], v[36:37], v[40:41]
  v_lshlrev_b32 v40, 16, v167
  v_and_b32 v41, 0xffff0000, v167
  v_pk_add_f32 v[38:39], v[38:39], v[40:41]
  s_waitcnt vmcnt(7)
  v_lshlrev_b32 v40, 16, v168
  v_and_b32 v41, 0xffff0000, v168
  v_pk_add_f32 v[32:33], v[32:33], v[40:41]
  v_lshlrev_b32 v40, 16, v169
  v_and_b32 v41, 0xffff0000, v169
  v_pk_add_f32 v[34:35], v[34:35], v[40:41]
  v_lshlrev_b32 v40, 16, v170
  v_and_b32 v41, 0xffff0000, v170
  v_pk_add_f32 v[36:37], v[36:37], v[40:41]
  v_lshlrev_b32 v40, 16, v171
  v_and_b32 v41, 0xffff0000, v171
  v_pk_add_f32 v[38:39], v[38:39], v[40:41]
  s_waitcnt vmcnt(6)
  v_lshlrev_b32 v40, 16, v172
  v_and_b32 v41, 0xffff0000, v172
  v_pk_add_f32 v[32:33], v[32:33], v[40:41]
  v_lshlrev_b32 v40, 16, v173
  v_and_b32 v41, 0xffff0000, v173
  v_pk_add_f32 v[34:35], v[34:35], v[40:41]
  v_lshlrev_b32 v40, 16, v174
  v_and_b32 v41, 0xffff0000, v174
  v_pk_add_f32 v[36:37], v[36:37], v[40:41]
  v_lshlrev_b32 v40, 16, v175
  v_and_b32 v41, 0xffff0000, v175
  v_pk_add_f32 v[38:39], v[38:39], v[40:41]
  s_waitcnt vmcnt(5)
  v_lshlrev_b32 v40, 16, v176
  v_and_b32 v41, 0xffff0000, v176
  v_pk_add_f32 v[32:33], v[32:33], v[40:41]
  v_lshlrev_b32 v40, 16, v177
  v_and_b32 v41, 0xffff0000, v177
  v_pk_add_f32 v[34:35], v[34:35], v[40:41]
  v_lshlrev_b32 v40, 16, v178
  v_and_b32 v41, 0xffff0000, v178
  v_pk_add_f32 v[36:37], v[36:37], v[40:41]
  v_lshlrev_b32 v40, 16, v179
  v_and_b32 v41, 0xffff0000, v179
  v_pk_add_f32 v[38:39], v[38:39], v[40:41]
  s_waitcnt vmcnt(4)
  v_lshlrev_b32 v40, 16, v180
  v_and_b32 v41, 0xffff0000, v180
  v_pk_add_f32 v[32:33], v[32:33], v[40:41]
  v_lshlrev_b32 v40, 16, v181
  v_and_b32 v41, 0xffff0000, v181
  v_pk_add_f32 v[34:35], v[34:35], v[40:41]
  v_lshlrev_b32 v40, 16, v182
  v_and_b32 v41, 0xffff0000, v182
  v_pk_add_f32 v[36:37], v[36:37], v[40:41]
  v_lshlrev_b32 v40, 16, v183
  v_and_b32 v41, 0xffff0000, v183
  v_pk_add_f32 v[38:39], v[38:39], v[40:41]
  s_waitcnt vmcnt(3)
  v_lshlrev_b32 v40, 16, v184
  v_and_b32 v41, 0xffff0000, v184
  v_pk_add_f32 v[32:33], v[32:33], v[40:41]
  v_lshlrev_b32 v40, 16, v185
  v_and_b32 v41, 0xffff0000, v185
  v_pk_add_f32 v[34:35], v[34:35], v[40:41]
  v_lshlrev_b32 v40, 16, v186
  v_and_b32 v41, 0xffff0000, v186
  v_pk_add_f32 v[36:37], v[36:37], v[40:41]
  v_lshlrev_b32 v40, 16, v187
  v_and_b32 v41, 0xffff0000, v187
  v_pk_add_f32 v[38:39], v[38:39], v[40:41]
  s_waitcnt vmcnt(2)
  v_lshlrev_b32 v40, 16, v188
  v_and_b32 v41, 0xffff0000, v188
  v_pk_add_f32 v[32:33], v[32:33], v[40:41]
  v_lshlrev_b32 v40, 16, v189
  v_and_b32 v41, 0xffff0000, v189
  v_pk_add_f32 v[34:35], v[34:35], v[40:41]
  v_lshlrev_b32 v40, 16, v190
  v_and_b32 v41, 0xffff0000, v190
  v_pk_add_f32 v[36:37], v[36:37], v[40:41]
  v_lshlrev_b32 v40, 16, v191
  v_and_b32 v41, 0xffff0000, v191
  v_pk_add_f32 v[38:39], v[38:39], v[40:41]
  v_cvt_pk_bf16_f32 v44, v32, v33
  v_cvt_pk_bf16_f32 v45, v34, v35
  v_cvt_pk_bf16_f32 v46, v36, v37
  v_cvt_pk_bf16_f32 v47, v38, v39
  s_nop 1
  v_permlane32_swap_b32 v44, v46
  v_permlane32_swap_b32 v45, v47
  s_nop 1
  v_permlane16_swap_b32 v44, v46
  v_permlane16_swap_b32 v45, v47
  buffer_store_dwordx4 v[44:47], v21, s[12:15], s32 offen
K2_END:
  s_endpgm
K2_merge:
K2_merge2:
  s_cmp_eq_u32 s97, 1
  s_cbranch_scc1 K2_have
  s_add_u32 s4, s52, 0x6000000
  s_addc_u32 s5, s53, 0
  s_and_b32 s5, s5, 0xffff
  s_mov_b32 s6, 0x8000
  s_mov_b32 s7, 0x20000
  v_mov_b32 v3, s43
K2_poll:
  buffer_load_dword v2, v3, s[4:7], 0 offen sc1
  s_waitcnt vmcnt(0)
  v_readfirstlane_b32 s3, v2
  s_nop 3
  s_cmp_eq_u32 s3, 1
  s_cbranch_scc1 K2_got
  s_sleep 2
  s_branch K2_poll
K2_got:
  s_mov_b32 s98, s42
  buffer_load_dwordx4 a[64:67], v9, s[12:15], s98 offen offset:0 sc1
  buffer_load_dwordx4 a[68:71], v9, s[12:15], s98 offen offset:1024 sc1
  buffer_load_dwordx4 a[72:75], v9, s[12:15], s98 offen offset:2048 sc1
  buffer_load_dwordx4 a[76:79], v9, s[12:15], s98 offen offset:3072 sc1
  s_add_u32 s98, s98, 0x1000
  buffer_load_dwordx4 a[80:83], v9, s[12:15], s98 offen offset:0 sc1
  buffer_load_dwordx4 a[84:87], v9, s[12:15], s98 offen offset:1024 sc1
  buffer_load_dwordx4 a[88:91], v9, s[12:15], s98 offen offset:2048 sc1
  buffer_load_dwordx4 a[92:95], v9, s[12:15], s98 offen offset:3072 sc1
  s_add_u32 s98, s98, 0x1000
  buffer_load_dwordx4 a[96:99], v9, s[12:15], s98 offen offset:0 sc1
  buffer_load_dwordx4 a[100:103], v9, s[12:15], s98 offen offset:1024 sc1
  buffer_load_dwordx4 a[104:107], v9, s[12:15], s98 offen offset:2048 sc1
  buffer_load_dwordx4 a[108:111], v9, s[12:15], s98 offen offset:3072 sc1
  s_add_u32 s98, s98, 0x1000
  buffer_load_dwordx4 a[112:115], v9, s[12:15], s98 offen offset:0 sc1
  buffer_load_dwordx4 a[116:119], v9, s[12:15], s98 offen offset:1024 sc1
  buffer_load_dwordx4 a[120:123], v9, s[12:15], s98 offen offset:2048 sc1
  buffer_load_dwordx4 a[124:127], v9, s[12:15], s98 offen offset:3072 sc1
  s_add_u32 s98, s98, 0x1000
  buffer_load_dwordx4 v[28:31], v9, s[12:15], s98 offen offset:0 sc1
  s_waitcnt vmcnt(0)
K2_have:
  s_waitcnt vmcnt(8)
  v_sub_f32 v74, v28, v12
  v_min_f32 v74, 0x42200000, v74
  v_exp_f32 v74, v74
  s_nop 0
  v_fma_f32 v18, v74, v29, v10
  v_rcp_f32 v72, v18
  v_sub_f32 v75, v30, v13
  v_min_f32 v75, 0x42200000, v75
  v_exp_f32 v75, v75
  s_nop 0
  v_fma_f32 v18, v75, v31, v11
  v_rcp_f32 v73, v18
  v_accvgpr_read_b32 v32, a64
  v_accvgpr_read_b32 v33, a65
  v_accvgpr_read_b32 v34, a66
  v_accvgpr_read_b32 v35, a67
  v_lshlrev_b32 v36, 16, v32
  v_and_b32 v37, 0xffff0000, v32
  v_lshlrev_b32 v38, 16, v33
  v_and_b32 v39, 0xffff0000, v33
  v_lshlrev_b32 v40, 16, v34
  v_and_b32 v41, 0xffff0000, v34
  v_lshlrev_b32 v42, 16, v35
  v_and_b32 v43, 0xffff0000, v35
  v_fmac_f32 v128, v36, v74
  v_fmac_f32 v129, v37, v74
  v_fmac_f32 v130, v38, v74
  v_fmac_f32 v131, v39, v74
  v_fmac_f32 v132, v40, v74
  v_fmac_f32 v133, v41, v74
  v_fmac_f32 v134, v42, v74
  v_fmac_f32 v135, v43, v74
  v_cvt_pk_bf16_f32 v128, v128, v129
  v_cvt_pk_bf16_f32 v129, v130, v131
  v_cvt_pk_bf16_f32 v130, v132, v133
  v_cvt_pk_bf16_f32 v131, v134, v135
  v_accvgpr_read_b32 v32, a68
  v_accvgpr_read_b32 v33, a69
  v_accvgpr_read_b32 v34, a70
  v_accvgpr_read_b32 v35, a71
  v_lshlrev_b32 v36, 16, v32
  v_and_b32 v37, 0xffff0000, v32
  v_lshlrev_b32 v38, 16, v33
  v_and_b32 v39, 0xffff0000, v33
  v_lshlrev_b32 v40, 16, v34
  v_and_b32 v41, 0xffff0000, v34
  v_lshlrev_b32 v42, 16, v35
  v_and_b32 v43, 0xffff0000, v35
  v_fmac_f32 v136, v36, v75
  v_fmac_f32 v137, v37, v75
  v_fmac_f32 v138, v38, v75
  v_fmac_f32 v139, v39, v75
  v_fmac_f32 v140, v40, v75
  v_fmac_f32 v141, v41, v75
  v_fmac_f32 v142, v42, v75
  v_fmac_f32 v143, v43, v75
  v_cvt_pk_bf16_f32 v132, v136, v137
  v_cvt_pk_bf16_f32 v133, v138, v139
  v_cvt_pk_bf16_f32 v134, v140, v141
  v_cvt_pk_bf16_f32 v135, v142, v143
  v_accvgpr_read_b32 v32, a72
  v_accvgpr_read_b32 v33, a73
  v_accvgpr_read_b32 v34, a74
  v_accvgpr_read_b32 v35, a75
  v_lshlrev_b32 v36, 16, v32
  v_and_b32 v37, 0xffff0000, v32
  v_lshlrev_b32 v38, 16, v33
  v_and_b32 v39, 0xffff0000, v33
  v_lshlrev_b32 v40, 16, v34
  v_and_b32 v41, 0xffff0000, v34
  v_lshlrev_b32 v42, 16, v35
  v_and_b32 v43, 0xffff0000, v35
  v_fmac_f32 v144, v36, v74
  v_fmac_f32 v145, v37, v74
  v_fmac_f32 v146, v38, v74
  v_fmac_f32 v147, v39, v74
  v_fmac_f32 v148, v40, v74
  v_fmac_f32 v149, v41, v74
  v_fmac_f32 v150, v42, v74
  v_fmac_f32 v151, v43, v74
  v_cvt_pk_bf16_f32 v136, v144, v145
  v_cvt_pk_bf16_f32 v137, v146, v147
  v_cvt_pk_bf16_f32 v138, v148, v149
  v_cvt_pk_bf16_f32 v139, v150, v151
  v_accvgpr_read_b32 v32, a76
  v_accvgpr_read_b32 v33, a77
  v_accvgpr_read_b32 v34, a78
  v_accvgpr_read_b32 v35, a79
  v_lshlrev_b32 v36, 16, v32
  v_and_b32 v37, 0xffff0000, v32
  v_lshlrev_b32 v38, 16, v33
  v_and_b32 v39, 0xffff0000, v33
  v_lshlrev_b32 v40, 16, v34
  v_and_b32 v41, 0xffff0000, v34
  v_lshlrev_b32 v42, 16, v35
  v_and_b32 v43, 0xffff0000, v35
  v_fmac_f32 v152, v36, v75
  v_fmac_f32 v153, v37, v75
  v_fmac_f32 v154, v38, v75
  v_fmac_f32 v155, v39, v75
  v_fmac_f32 v156, v40, v75
  v_fmac_f32 v157, v41, v75
  v_fmac_f32 v158, v42, v75
  v_fmac_f32 v159, v43, v75
  v_cvt_pk_bf16_f32 v140, v152, v153
  v_cvt_pk_bf16_f32 v141, v154, v155
  v_cvt_pk_bf16_f32 v142, v156, v157
  v_cvt_pk_bf16_f32 v143, v158, v159
  s_waitcnt lgkmcnt(6)
  v_mfma_f32_16x16x32_bf16 v[96:99], a[128:131], v[128:131], 0
  s_mov_b32 m0, s35
  ds_read_b64_tr_b16 a[156:157], v63 offset:4096
  ds_read_b64_tr_b16 a[158:159], v63 offset:6144
  v_accvgpr_read_b32 v32, a80
  v_accvgpr_read_b32 v33, a81
  v_accvgpr_read_b32 v34, a82
  v_accvgpr_read_b32 v35, a83
  v_lshlrev_b32 v36, 16, v32
  v_and_b32 v37, 0xffff0000, v32
  v_lshlrev_b32 v38, 16, v33
  v_mfma_f32_16x16x32_bf16 v[96:99], a[132:135], v[136:139], v[96:99]
  buffer_load_dwordx4 v4, s[8:11], s31 offen offset:0 sc1 lds
  v_and_b32 v39, 0xffff0000, v33
  v_lshlrev_b32 v40, 16, v34
  v_and_b32 v41, 0xffff0000, v34
  v_lshlrev_b32 v42, 16, v35
  v_and_b32 v43, 0xffff0000, v35
  v_fmac_f32 v160, v36, v74
  v_fmac_f32 v161, v37, v74
  v_mfma_f32_16x16x32_bf16 v[104:107], a[128:131], v[132:135], 0
  ds_read_b64_tr_b16 a[160:161], v60 offset:8192
  v_fmac_f32 v162, v38, v74
  v_fmac_f32 v163, v39, v74
  v_fmac_f32 v164, v40, v74
  v_fmac_f32 v165, v41, v74
  v_fmac_f32 v166, v42, v74
  v_fmac_f32 v167, v43, v74
  v_cvt_pk_bf16_f32 v144, v160, v161
  v_mfma_f32_16x16x32_bf16 v[104:107], a[132:135], v[140:143], v[104:107]
  ds_read_b64_tr_b16 a[162:163], v60 offset:10240
  v_cvt_pk_bf16_f32 v145, v162, v163
  v_cvt_pk_bf16_f32 v146, v164, v165
  v_cvt_pk_bf16_f32 v147, v166, v167
  v_accvgpr_read_b32 v32, a84
  v_accvgpr_read_b32 v33, a85
  v_accvgpr_read_b32 v34, a86
  v_accvgpr_read_b32 v35, a87
  v_mfma_f32_16x16x32_bf16 v[100:103], a[136:139], v[128:131], 0
  ds_read_b64_tr_b16 a[164:165], v60 offset:12288
  ds_read_b64_tr_b16 a[166:167], v60 offset:14336
  v_lshlrev_b32 v36, 16, v32
  v_and_b32 v37, 0xffff0000, v32
  v_lshlrev_b32 v38, 16, v33
  v_and_b32 v39, 0xffff0000, v33
  v_lshlrev_b32 v40, 16, v34
  v_and_b32 v41, 0xffff0000, v34
  v_lshlrev_b32 v42, 16, v35
  v_mfma_f32_16x16x32_bf16 v[100:103], a[140:143], v[136:139], v[100:103]
  buffer_load_dwordx4 v5, s[8:11], s31 offen offset:1024 sc1 lds
  v_and_b32 v43, 0xffff0000, v35
  v_fmac_f32 v168, v36, v75
  v_fmac_f32 v169, v37, v75
  v_fmac_f32 v170, v38, v75
  v_fmac_f32 v171, v39, v75
  v_fmac_f32 v172, v40, v75
  v_fmac_f32 v173, v41, v75
  v_mfma_f32_16x16x32_bf16 v[108:111], a[136:139], v[132:135], 0
  ds_read_b64_tr_b16 a[168:169], v61 offset:8192
  v_fmac_f32 v174, v42, v75
  v_fmac_f32 v175, v43, v75
  v_cvt_pk_bf16_f32 v148, v168, v169
  v_cvt_pk_bf16_f32 v149, v170, v171
  v_cvt_pk_bf16_f32 v150, v172, v173
  v_cvt_pk_bf16_f32 v151, v174, v175
  v_mfma_f32_16x16x32_bf16 v[108:111], a[140:143], v[140:143], v[108:111]
  s_waitcnt lgkmcnt(5)
  ds_read_b64_tr_b16 a[170:171], v61 offset:10240
  v_accvgpr_read_b32 v32, a88
  v_accvgpr_read_b32 v33, a89
  v_accvgpr_read_b32 v34, a90
  v_accvgpr_read_b32 v35, a91
  v_lshlrev_b32 v36, 16, v32
  v_and_b32 v37, 0xffff0000, v32
  v_lshlrev_b32 v38, 16, v33
  v_mfma_f32_16x16x32_bf16 v[112:115], a[144:147], v[128:131], 0
  ds_read_b64_tr_b16 a[172:173], v61 offset:12288
  ds_read_b64_tr_b16 a[174:175], v61 offset:14336
  v_and_b32 v39, 0xffff0000, v33
  v_lshlrev_b32 v40, 16, v34
  v_and_b32 v41, 0xffff0000, v34
  v_lshlrev_b32 v42, 16, v35
  v_and_b32 v43, 0xffff0000, v35
  v_fmac_f32 v176, v36, v74
  v_fmac_f32 v177, v37, v74
  v_mfma_f32_16x16x32_bf16 v[112:115], a[148:151], v[136:139], v[112:115]
  buffer_load_dwordx4 v6, s[8:11], s31 offen offset:2048 sc1 lds
  v_fmac_f32 v178, v38, v74
  v_fmac_f32 v179, v39, v74
  v_fmac_f32 v180, v40, v74
  v_fmac_f32 v181, v41, v74
  v_fmac_f32 v182, v42, v74
  v_fmac_f32 v183, v43, v74
  v_cvt_pk_bf16_f32 v152, v176, v177
  v_mfma_f32_16x16x32_bf16 v[120:123], a[144:147], v[132:135], 0
  ds_read_b64_tr_b16 a[176:177], v62 offset:8192
  v_cvt_pk_bf16_f32 v153, v178, v179
  v_cvt_pk_bf16_f32 v154, v180, v181
  v_cvt_pk_bf16_f32 v155, v182, v183
  v_accvgpr_read_b32 v32, a92
  v_accvgpr_read_b32 v33, a93
  v_accvgpr_read_b32 v34, a94
  v_accvgpr_read_b32 v35, a95
  v_mfma_f32_16x16x32_bf16 v[120:123], a[148:151], v[140:143], v[120:123]
  ds_read_b64_tr_b16 a[178:179], v62 offset:10240
  v_lshlrev_b32 v36, 16, v32
  v_and_b32 v37, 0xffff0000, v32
  v_lshlrev_b32 v38, 16, v33
  v_and_b32 v39, 0xffff0000, v33
  v_lshlrev_b32 v40, 16, v34
  v_and_b32 v41, 0xffff0000, v34
  v_lshlrev_b32 v42, 16, v35
  v_mfma_f32_16x16x32_bf16 v[116:119], a[152:155], v[128:131], 0
  ds_read_b64_tr_b16 a[180:181], v62 offset:12288
  ds_read_b64_tr_b16 a[182:183], v62 offset:14336
  v_and_b32 v43, 0xffff0000, v35
  v_fmac_f32 v184, v36, v75
  v_fmac_f32 v185, v37, v75
  v_fmac_f32 v186, v38, v75
  v_fmac_f32 v187, v39, v75
  v_fmac_f32 v188, v40, v75
  v_fmac_f32 v189, v41, v75
  v_mfma_f32_16x16x32_bf16 v[116:119], a[156:159], v[136:139], v[116:119]
  buffer_load_dwordx4 v7, s[8:11], s31 offen offset:3072 sc1 lds
  v_fmac_f32 v190, v42, v75
  v_fmac_f32 v191, v43, v75
  v_cvt_pk_bf16_f32 v156, v184, v185
  v_cvt_pk_bf16_f32 v157, v186, v187
  v_cvt_pk_bf16_f32 v158, v188, v189
  v_cvt_pk_bf16_f32 v159, v190, v191
  v_mfma_f32_16x16x32_bf16 v[124:127], a[152:155], v[132:135], 0
  s_add_u32 m0, s35, 0x4000
  ds_read_b64_tr_b16 a[184:185], v63 offset:8192
  v_mfma_f32_16x16x32_bf16 v[124:127], a[156:159], v[140:143], v[124:127]
  s_waitcnt lgkmcnt(5)
  ds_read_b64_tr_b16 a[186:187], v63 offset:10240
  v_mfma_f32_16x16x32_bf16 v[96:99], a[160:163], v[144:147], v[96:99]
  ds_read_b64_tr_b16 a[188:189], v63 offset:12288
  ds_read_b64_tr_b16 a[190:191], v63 offset:14336
  v_accvgpr_read_b32 v32, a96
  v_accvgpr_read_b32 v33, a97
  v_accvgpr_read_b32 v34, a98
  v_accvgpr_read_b32 v35, a99
  v_lshlrev_b32 v36, 16, v32
  v_and_b32 v37, 0xffff0000, v32
  v_lshlrev_b32 v38, 16, v33
  v_mfma_f32_16x16x32_bf16 v[96:99], a[164:167], v[152:155], v[96:99]
  buffer_load_dwordx4 v4, s[8:11], s32 offen offset:0 sc1 lds
  v_and_b32 v39, 0xffff0000, v33
  v_lshlrev_b32 v40, 16, v34
  v_and_b32 v41, 0xffff0000, v34
  v_lshlrev_b32 v42, 16, v35
  v_and_b32 v43, 0xffff0000, v35
  v_fmac_f32 v192, v36, v74
  v_fmac_f32 v193, v37, v74
  v_mfma_f32_16x16x32_bf16 v[104:107], a[160:163], v[148:151], v[104:107]
  ds_read_b64_tr_b16 a[128:129], v60 offset:16384
  v_fmac_f32 v194, v38, v74
  v_fmac_f32 v195, v39, v74
  v_fmac_f32 v196, v40, v74
  v_fmac_f32 v197, v41, v74
  v_fmac_f32 v198, v42, v74
  v_fmac_f32 v199, v43, v74
  v_cvt_pk_bf16_f32 v160, v192, v193
  v_mfma_f32_16x16x32_bf16 v[104:107], a[164:167], v[156:159], v[104:107]
  ds_read_b64_tr_b16 a[130:131], v60 offset:18432
  v_cvt_pk_bf16_f32 v161, v194, v195
  v_cvt_pk_bf16_f32 v162, v196, v197
  v_cvt_pk_bf16_f32 v163, v198, v199
  v_accvgpr_read_b32 v32, a100
  v_accvgpr_read_b32 v33, a101
  v_accvgpr_read_b32 v34, a102
  v_accvgpr_read_b32 v35, a103
  v_mfma_f32_16x16x32_bf16 v[100:103], a[168:171], v[144:147], v[100:103]
  ds_read_b64_tr_b16 a[132:133], v60 offset:20480
  ds_read_b64_tr_b16 a[134:135], v60 offset:22528
  v_lshlrev_b32 v36, 16, v32
  v_and_b32 v37, 0xffff0000, v32
  v_lshlrev_b32 v38, 16, v33
  v_and_b32 v39, 0xffff0000, v33
  v_lshlrev_b32 v40, 16, v34
  v_and_b32 v41, 0xffff0000, v34
  v_lshlrev_b32 v42, 16, v35
  v_mfma_f32_16x16x32_bf16 v[100:103], a[172:175], v[152:155], v[100:103]
  buffer_load_dwordx4 v5, s[8:11], s32 offen offset:1024 sc1 lds
  v_and_b32 v43, 0xffff0000, v35
  v_fmac_f32 v200, v36, v75
  v_fmac_f32 v201, v37, v75
  v_fmac_f32 v202, v38, v75
  v_fmac_f32 v203, v39, v75
  v_fmac_f32 v204, v40, v75
  v_fmac_f32 v205, v41, v75
  v_mfma_f32_16x16x32_bf16 v[108:111], a[168:171], v[148:151], v[108:111]
  ds_read_b64_tr_b16 a[136:137], v61 offset:16384
  v_fmac_f32 v206, v42, v75
  v_fmac_f32 v207, v43, v75
  v_cvt_pk_bf16_f32 v164, v200, v201
  v_cvt_pk_bf16_f32 v165, v202, v203
  v_cvt_pk_bf16_f32 v166, v204, v205
  v_cvt_pk_bf16_f32 v167, v206, v207
  v_mfma_f32_16x16x32_bf16 v[108:111], a[172:175], v[156:159], v[108:111]
  s_waitcnt lgkmcnt(5)
  ds_read_b64_tr_b16 a[138:139], v61 offset:18432
  v_accvgpr_read_b32 v32, a104
  v_accvgpr_read_b32 v33, a105
  v_accvgpr_read_b32 v34, a106
  v_accvgpr_read_b32 v35, a107
  v_lshlrev_b32 v36, 16, v32
  v_and_b32 v37, 0xffff0000, v32
  v_lshlrev_b32 v38, 16, v33
  v_mfma_f32_16x16x32_bf16 v[112:115], a[176:179], v[144:147], v[112:115]
  ds_read_b64_tr_b16 a[140:141], v61 offset:20480
  ds_read_b64_tr_b16 a[142:143], v61 offset:22528
  v_and_b32 v39, 0xffff0000, v33
  v_lshlrev_b32 v40, 16, v34
  v_and_b32 v41, 0xffff0000, v34
  v_lshlrev_b32 v42, 16, v35
  v_and_b32 v43, 0xffff0000, v35
  v_fmac_f32 v208, v36, v74
  v_fmac_f32 v209, v37, v74
  v_mfma_f32_16x16x32_bf16 v[112:115], a[180:183], v[152:155], v[112:115]
  buffer_load_dwordx4 v6, s[8:11], s32 offen offset:2048 sc1 lds
  v_fmac_f32 v210, v38, v74
  v_fmac_f32 v211, v39, v74
  v_fmac_f32 v212, v40, v74
  v_fmac_f32 v213, v41, v74
  v_fmac_f32 v214, v42, v74
  v_fmac_f32 v215, v43, v74
  v_cvt_pk_bf16_f32 v168, v208, v209
  v_mfma_f32_16x16x32_bf16 v[120:123], a[176:179], v[148:151], v[120:123]
  ds_read_b64_tr_b16 a[144:145], v62 offset:16384
  v_cvt_pk_bf16_f32 v169, v210, v211
  v_cvt_pk_bf16_f32 v170, v212, v213
  v_cvt_pk_bf16_f32 v171, v214, v215
  v_accvgpr_read_b32 v32, a108
  v_accvgpr_read_b32 v33, a109
  v_accvgpr_read_b32 v34, a110
  v_accvgpr_read_b32 v35, a111
  v_mfma_f32_16x16x32_bf16 v[120:123], a[180:183], v[156:159], v[120:123]
  ds_read_b64_tr_b16 a[146:147], v62 offset:18432
  v_lshlrev_b32 v36, 16, v32
  v_and_b32 v37, 0xffff0000, v32
  v_lshlrev_b32 v38, 16, v33
  v_and_b32 v39, 0xffff0000, v33
  v_lshlrev_b32 v40, 16, v34
  v_and_b32 v41, 0xffff0000, v34
  v_lshlrev_b32 v42, 16, v35
  v_mfma_f32_16x16x32_bf16 v[116:119], a[184:187], v[144:147], v[116:119]
  ds_read_b64_tr_b16 a[148:149], v62 offset:20480
  ds_read_b64_tr_b16 a[150:151], v62 offset:22528
  v_and_b32 v43, 0xffff0000, v35
  v_fmac_f32 v216, v36, v75
  v_fmac_f32 v217, v37, v75
  v_fmac_f32 v218, v38, v75
  v_fmac_f32 v219, v39, v75
  v_fmac_f32 v220, v40, v75
  v_fmac_f32 v221, v41, v75
  v_mfma_f32_16x16x32_bf16 v[116:119], a[188:191], v[152:155], v[116:119]
  buffer_load_dwordx4 v7, s[8:11], s32 offen offset:3072 sc1 lds
  v_fmac_f32 v222, v42, v75
  v_fmac_f32 v223, v43, v75
  v_cvt_pk_bf16_f32 v172, v216, v217
  v_cvt_pk_bf16_f32 v173, v218, v219
  v_cvt_pk_bf16_f32 v174, v220, v221
  v_cvt_pk_bf16_f32 v175, v222, v223
  v_mfma_f32_16x16x32_bf16 v[124:127], a[184:187], v[148:151], v[124:127]
  s_add_u32 s35, s35, 0x8000
  ds_read_b64_tr_b16 a[152:153], v63 offset:16384
  v_mfma_f32_16x16x32_bf16 v[124:127], a[188:191], v[156:159], v[124:127]
  s_waitcnt lgkmcnt(5)
  ds_read_b64_tr_b16 a[154:155], v63 offset:18432
  v_mfma_f32_16x16x32_bf16 v[96:99], a[128:131], v[160:163], v[96:99]
  s_cmp_eq_u32 s35, s56
  ds_read_b64_tr_b16 a[156:157], v63 offset:20480
  v_accvgpr_read_b32 v32, a112
  v_accvgpr_read_b32 v33, a113
  v_accvgpr_read_b32 v34, a114
  v_accvgpr_read_b32 v35, a115
  v_lshlrev_b32 v36, 16, v32
  v_and_b32 v37, 0xffff0000, v32
  v_lshlrev_b32 v38, 16, v33
  v_mfma_f32_16x16x32_bf16 v[96:99], a[132:135], v[168:171], v[96:99]
  s_cselect_b32 s35, s40, s35
  ds_read_b64_tr_b16 a[158:159], v63 offset:22528
  v_and_b32 v39, 0xffff0000, v33
  v_lshlrev_b32 v40, 16, v34
  v_and_b32 v41, 0xffff0000, v34
  v_lshlrev_b32 v42, 16, v35
  v_and_b32 v43, 0xffff0000, v35
  v_fmac_f32 v224, v36, v74
  v_fmac_f32 v225, v37, v74
  v_mfma_f32_16x16x32_bf16 v[104:107], a[128:131], v[164:167], v[104:107]
  s_add_u32 s32, s31, s34
  ds_read_b64_tr_b16 a[160:161], v60 offset:24576
  v_fmac_f32 v226, v38, v74
  v_fmac_f32 v227, v39, v74
  v_fmac_f32 v228, v40, v74
  v_fmac_f32 v229, v41, v74
  v_fmac_f32 v230, v42, v74
  v_fmac_f32 v231, v43, v74
  v_cvt_pk_bf16_f32 v176, v224, v225
  v_mfma_f32_16x16x32_bf16 v[104:107], a[132:135], v[172:175], v[104:107]
  s_add_u32 s31, s31, s33
  ds_read_b64_tr_b16 a[162:163], v60 offset:26624
  v_cvt_pk_bf16_f32 v177, v226, v227
  v_cvt_pk_bf16_f32 v178, v228, v229
  v_cvt_pk_bf16_f32 v179, v230, v231
  v_accvgpr_read_b32 v32, a116
  v_accvgpr_read_b32 v33, a117
  v_accvgpr_read_b32 v34, a118
  v_accvgpr_read_b32 v35, a119
  v_mfma_f32_16x16x32_bf16 v[100:103], a[136:139], v[160:163], v[100:103]
  ds_read_b64_tr_b16 a[164:165], v60 offset:28672
  v_lshlrev_b32 v36, 16, v32
  v_and_b32 v37, 0xffff0000, v32
  v_lshlrev_b32 v38, 16, v33
  v_and_b32 v39, 0xffff0000, v33
  v_lshlrev_b32 v40, 16, v34
  v_and_b32 v41, 0xffff0000, v34
  v_lshlrev_b32 v42, 16, v35
  v_mfma_f32_16x16x32_bf16 v[100:103], a[140:143], v[168:171], v[100:103]
  ds_read_b64_tr_b16 a[166:167], v60 offset:30720
  v_and_b32 v43, 0xffff0000, v35
  v_fmac_f32 v232, v36, v75
  v_fmac_f32 v233, v37, v75
  v_fmac_f32 v234, v38, v75
  v_fmac_f32 v235, v39, v75
  v_fmac_f32 v236, v40, v75
  v_fmac_f32 v237, v41, v75
  v_mfma_f32_16x16x32_bf16 v[108:111], a[136:139], v[164:167], v[108:111]
  ds_read_b64_tr_b16 a[168:169], v61 offset:24576
  v_fmac_f32 v238, v42, v75
  v_fmac_f32 v239, v43, v75
  v_cvt_pk_bf16_f32 v180, v232, v233
  v_cvt_pk_bf16_f32 v181, v234, v235
  v_cvt_pk_bf16_f32 v182, v236, v237
  v_cvt_pk_bf16_f32 v183, v238, v239
  v_mfma_f32_16x16x32_bf16 v[108:111], a[140:143], v[172:175], v[108:111]
  s_waitcnt lgkmcnt(5)
  ds_read_b64_tr_b16 a[170:171], v61 offset:26624
  v_accvgpr_read_b32 v32, a120
  v_accvgpr_read_b32 v33, a121
  v_accvgpr_read_b32 v34, a122
  v_accvgpr_read_b32 v35, a123
  v_lshlrev_b32 v36, 16, v32
  v_and_b32 v37, 0xffff0000, v32
  v_lshlrev_b32 v38, 16, v33
  v_mfma_f32_16x16x32_bf16 v[112:115], a[144:147], v[160:163], v[112:115]
  ds_read_b64_tr_b16 a[172:173], v61 offset:28672
  v_and_b32 v39, 0xffff0000, v33
  v_lshlrev_b32 v40, 16, v34
  v_and_b32 v41, 0xffff0000, v34
  v_lshlrev_b32 v42, 16, v35
  v_and_b32 v43, 0xffff0000, v35
  v_fmac_f32 v240, v36, v74
  v_fmac_f32 v241, v37, v74
  v_mfma_f32_16x16x32_bf16 v[112:115], a[148:151], v[168:171], v[112:115]
  ds_read_b64_tr_b16 a[174:175], v61 offset:30720
  v_fmac_f32 v242, v38, v74
  v_fmac_f32 v243, v39, v74
  v_fmac_f32 v244, v40, v74
  v_fmac_f32 v245, v41, v74
  v_fmac_f32 v246, v42, v74
  v_fmac_f32 v247, v43, v74
  v_cvt_pk_bf16_f32 v184, v240, v241
  v_mfma_f32_16x16x32_bf16 v[120:123], a[144:147], v[164:167], v[120:123]
  ds_read_b64_tr_b16 a[176:177], v62 offset:24576
  v_cvt_pk_bf16_f32 v185, v242, v243
  v_cvt_pk_bf16_f32 v186, v244, v245
  v_cvt_pk_bf16_f32 v187, v246, v247
  v_accvgpr_read_b32 v32, a124
  v_accvgpr_read_b32 v33, a125
  v_accvgpr_read_b32 v34, a126
  v_accvgpr_read_b32 v35, a127
  v_mfma_f32_16x16x32_bf16 v[120:123], a[148:151], v[172:175], v[120:123]
  ds_read_b64_tr_b16 a[178:179], v62 offset:26624
  v_lshlrev_b32 v36, 16, v32
  v_and_b32 v37, 0xffff0000, v32
  v_lshlrev_b32 v38, 16, v33
  v_and_b32 v39, 0xffff0000, v33
  v_lshlrev_b32 v40, 16, v34
  v_and_b32 v41, 0xffff0000, v34
  v_lshlrev_b32 v42, 16, v35
  v_mfma_f32_16x16x32_bf16 v[116:119], a[152:155], v[160:163], v[116:119]
  s_add_u32 s36, s36, 0x8000
  ds_read_b64_tr_b16 a[180:181], v62 offset:28672
  v_and_b32 v43, 0xffff0000, v35
  v_fmac_f32 v248, v36, v75
  v_fmac_f32 v249, v37, v75
  v_fmac_f32 v250, v38, v75
  v_fmac_f32 v251, v39, v75
  v_fmac_f32 v252, v40, v75
  v_fmac_f32 v253, v41, v75
  v_mfma_f32_16x16x32_bf16 v[116:119], a[156:159], v[168:171], v[116:119]
  s_cmp_eq_u32 s36, 0x28000
  ds_read_b64_tr_b16 a[182:183], v62 offset:30720
  v_fmac_f32 v254, v42, v75
  v_fmac_f32 v255, v43, v75
  v_cvt_pk_bf16_f32 v188, v248, v249
  v_cvt_pk_bf16_f32 v189, v250, v251
  v_cvt_pk_bf16_f32 v190, v252, v253
  v_cvt_pk_bf16_f32 v191, v254, v255
  v_mfma_f32_16x16x32_bf16 v[124:127], a[152:155], v[164:167], v[124:127]
  s_cselect_b32 s36, 0, s36
  ds_read_b64_tr_b16 a[184:185], v63 offset:24576
  v_mfma_f32_16x16x32_bf16 v[124:127], a[156:159], v[172:175], v[124:127]
  s_waitcnt lgkmcnt(5)
  ds_read_b64_tr_b16 a[186:187], v63 offset:26624
  v_mfma_f32_16x16x32_bf16 v[96:99], a[160:163], v[176:179], v[96:99]
  ds_read_b64_tr_b16 a[188:189], v63 offset:28672
  v_mfma_f32_16x16x32_bf16 v[96:99], a[164:167], v[184:187], v[96:99]
  s_waitcnt vmcnt(16)
  s_barrier
  ds_read_b64_tr_b16 a[190:191], v63 offset:30720
  v_add_u32 v60, s36, v56
  v_add_u32 v61, s36, v57
  v_add_u32 v62, s36, v58
  v_add_u32 v63, s36, v59
  v_mfma_f32_16x16x32_bf16 v[104:107], a[160:163], v[180:183], v[104:107]
  ds_read_b64_tr_b16 a[128:129], v60 offset:0
  v_mfma_f32_16x16x32_bf16 v[104:107], a[164:167], v[188:191], v[104:107]
  ds_read_b64_tr_b16 a[130:131], v60 offset:2048
  v_mfma_f32_16x16x32_bf16 v[100:103], a[168:171], v[176:179], v[100:103]
  ds_read_b64_tr_b16 a[132:133], v60 offset:4096
  v_mfma_f32_16x16x32_bf16 v[100:103], a[172:175], v[184:187], v[100:103]
  ds_read_b64_tr_b16 a[134:135], v60 offset:6144
  v_mfma_f32_16x16x32_bf16 v[108:111], a[168:171], v[180:183], v[108:111]
  ds_read_b64_tr_b16 a[136:137], v61 offset:0
  v_mfma_f32_16x16x32_bf16 v[108:111], a[172:175], v[188:191], v[108:111]
  s_waitcnt lgkmcnt(5)
  ds_read_b64_tr_b16 a[138:139], v61 offset:2048
  v_mfma_f32_16x16x32_bf16 v[112:115], a[176:179], v[176:179], v[112:115]
  ds_read_b64_tr_b16 a[140:141], v61 offset:4096
  v_mfma_f32_16x16x32_bf16 v[112:115], a[180:183], v[184:187], v[112:115]
  ds_read_b64_tr_b16 a[142:143], v61 offset:6144
  v_mfma_f32_16x16x32_bf16 v[120:123], a[176:179], v[180:183], v[120:123]
  ds_read_b64_tr_b16 a[144:145], v62 offset:0
  v_mfma_f32_16x16x32_bf16 v[120:123], a[180:183], v[188:191], v[120:123]
  ds_read_b64_tr_b16 a[146:147], v62 offset:2048
  v_mfma_f32_16x16x32_bf16 v[116:119], a[184:187], v[176:179], v[116:119]
  ds_read_b64_tr_b16 a[148:149], v62 offset:4096
  v_mfma_f32_16x16x32_bf16 v[116:119], a[188:191], v[184:187], v[116:119]
  ds_read_b64_tr_b16 a[150:151], v62 offset:6144
  v_mfma_f32_16x16x32_bf16 v[124:127], a[184:187], v[180:183], v[124:127]
  ds_read_b64_tr_b16 a[152:153], v63 offset:0
  v_mfma_f32_16x16x32_bf16 v[124:127], a[188:191], v[188:191], v[124:127]
  ds_read_b64_tr_b16 a[154:155], v63 offset:2048
  s_branch K2_proj1
K2_a2_wait:
  buffer_load_dwordx4 v[76:79], v9, s[92:95], 0 offen offset:3072 sc1
  s_waitcnt vmcnt(0)
  v_and_b32 v2, v76, v77
  v_and_b32 v3, v78, v79
  v_and_b32 v2, v2, v3
  v_cmp_ne_u32 vcc, 1, v2
  s_nop 4
  s_cbranch_vccz K2_a2_ok
  s_sleep 16
  s_branch K2_a2_wait
K2_p1_wait:
  s_sleep 2
  buffer_load_dword v25, v24, s[92:95], 0 offen offset:0 sc1
  s_waitcnt vmcnt(0)
  v_cmp_ne_u32 vcc, 1, v25
  s_nop 4
  s_cbranch_vccz K2_p1_ok
  s_branch K2_p1_wait
K2_p2_wait:
  s_sleep 2
  buffer_load_dword v25, v24, s[92:95], 0 offen offset:2048 sc1
  s_waitcnt vmcnt(0)
  v_cmp_ne_u32 vcc, 1, v25
  s_nop 4
  s_cbranch_vccz K2_p2_ok
  s_branch K2_p2_wait
K2_next:
  s_mov_b32 s50, s54
  s_cmp_gt_u32 s30, s28
  s_cselect_b32 s3, s30, -1
  s_min_u32 s50, s50, s3
  s_cmp_gt_u32 s99, s28
  s_cselect_b32 s3, s99, -1
  s_min_u32 s50, s50, s3
  s_cmp_gt_u32 s85, s28
  s_cselect_b32 s3, s85, -1
  s_min_u32 s50, s50, s3
  s_branch K2_top
K2_act_sw:
  s_mov_b32 s8, s48
  s_and_b32 s9, s49, 0xffff
  s_mov_b32 s10, 0x380000
  s_mov_b32 s11, 0x20000
  v_add_u32 v4, 0, v16
  v_add_u32 v5, 6144, v16
  v_add_u32 v6, 12288, v16
  v_add_u32 v7, 18432, v16
  s_mul_i32 s31, s47, 229376
  s_add_u32 s32, s31, 114688
  s_mov_b32 s33, 128
  s_mov_b32 s34, 114816
  s_getpc_b64 s[4:5]
L_pc_4:
  s_add_u32 s4, s4, K2_segend-L_pc_4
  s_addc_u32 s5, s5, (K2_segend-L_pc_4)>>32
  s_and_b32 s5, s5, 0xffff
  s_mov_b32 s6, K2_CODE_END-K2_segend
  s_mov_b32 s7, 0x20000
  v_and_b32 v3, 15, v0
  v_lshlrev_b32 v3, 5, v3
  v_add_u32 v3, s55, v3
  v_lshlrev_b32 v3, 7, v3
  buffer_load_dword v26, v3, s[4:7], 0 offen
  s_add_u32 s92, s52, 0x6008000
  s_addc_u32 s93, s53, 0
  s_and_b32 s93, s93, 0xffff
  s_mov_b32 s94, 0x2000
  s_mov_b32 s95, 0x20000
  v_mov_b32 v22, 1
  v_lshlrev_b32 v23, 13, v0
  s_and_b32 s3, s82, -128
  v_lshrrev_b32 v24, 2, v9
  v_and_b32 v24, 60, v24
  v_add_u32 v24, s3, v24
  s_branch K2_ev1
K2_act_pub:
  s_add_u32 s4, s52, 0x6008000
  s_addc_u32 s5, s53, 0
  s_and_b32 s5, s5, 0xffff
  s_mov_b32 s6, 0x2000
  s_mov_b32 s7, 0x20000
  s_and_b32 s3, s83, 0xffff
  s_lshr_b32 s83, s83, 16
  v_mov_b32 v2, 1
  v_lshlrev_b32 v3, 13, v0
  buffer_store_dword v2, v3, s[4:7], s3 offen sc1
  buffer_store_dword v2, v3, s[4:7], s83 offen sc1
  s_mov_b32 s85, -1
  s_branch K2_ev1b
K2_act_ff:
  s_waitcnt vmcnt(8)
  s_add_u32 s4, s52, 0x6000000
  s_addc_u32 s5, s53, 0
  s_and_b32 s5, s5, 0xffff
  s_mov_b32 s6, 0x8000
  s_mov_b32 s7, 0x20000
  v_mov_b32 v2, 1
  v_mov_b32 v3, s43
  s_mov_b64 exec, 1
  buffer_store_dword v2, v3, s[4:7], 0 offen sc1
  s_mov_b64 exec, -1
  s_mov_b32 s99, -1
  s_branch K2_ev2
K2_aux:
  s_cmp_eq_u32 s39, 0
  s_cbranch_scc1 K2_aux_q
  s_cmp_eq_u32 s96, 1
  s_cbranch_scc0 K2_tailsel
  s_mov_b32 s98, s42
  s_mov_b32 s97, 1
  buffer_load_dwordx4 a[64:67], v9, s[12:15], s98 offen offset:0 sc1
  buffer_load_dwordx4 a[68:71], v9, s[12:15], s98 offen offset:1024 sc1
  buffer_load_dwordx4 a[72:75], v9, s[12:15], s98 offen offset:2048 sc1
  buffer_load_dwordx4 a[76:79], v9, s[12:15], s98 offen offset:3072 sc1
  s_add_u32 s98, s98, 0x1000
  buffer_load_dwordx4 a[80:83], v9, s[12:15], s98 offen offset:0 sc1
  buffer_load_dwordx4 a[84:87], v9, s[12:15], s98 offen offset:1024 sc1
  buffer_load_dwordx4 a[88:91], v9, s[12:15], s98 offen offset:2048 sc1
  buffer_load_dwordx4 a[92:95], v9, s[12:15], s98 offen offset:3072 sc1
  s_add_u32 s98, s98, 0x1000
  buffer_load_dwordx4 a[96:99], v9, s[12:15], s98 offen offset:0 sc1
  buffer_load_dwordx4 a[100:103], v9, s[12:15], s98 offen offset:1024 sc1
  buffer_load_dwordx4 a[104:107], v9, s[12:15], s98 offen offset:2048 sc1
  buffer_load_dwordx4 a[108:111], v9, s[12:15], s98 offen offset:3072 sc1
  s_add_u32 s98, s98, 0x1000
  buffer_load_dwordx4 a[112:115], v9, s[12:15], s98 offen offset:0 sc1
  buffer_load_dwordx4 a[116:119], v9, s[12:15], s98 offen offset:1024 sc1
  buffer_load_dwordx4 a[120:123], v9, s[12:15], s98 offen offset:2048 sc1
  buffer_load_dwordx4 a[124:127], v9, s[12:15], s98 offen offset:3072 sc1
  s_add_u32 s98, s98, 0x1000
  buffer_load_dwordx4 v[28:31], v9, s[12:15], s98 offen offset:0 sc1
  s_branch K2_tailsel
K2_tail1:
  s_waitcnt lgkmcnt(0)
  ds_read_b128 a[128:131], v8 offset:16384
  ds_read_b128 a[132:135], v8 offset:17408
  ds_read_b128 a[136:139], v8 offset:18432
  ds_read_b128 a[140:143], v8 offset:19456
  ds_read_b128 a[144:147], v8 offset:20480
  ds_read_b128 a[148:151], v8 offset:21504
  ds_read_b128 a[152:155], v8 offset:22528
  ds_read_b128 a[156:159], v8 offset:23552
  s_cmp_eq_u32 s39, 0
  s_cbranch_scc0 K2_tail
K2_aux_q:
  v_accvgpr_mov_b32 a0, a64
  v_accvgpr_mov_b32 a1, a65
  v_accvgpr_mov_b32 a2, a66
  v_accvgpr_mov_b32 a3, a67
  v_accvgpr_mov_b32 a4, a68
  v_accvgpr_mov_b32 a5, a69
  v_accvgpr_mov_b32 a6, a70
  v_accvgpr_mov_b32 a7, a71
  v_accvgpr_mov_b32 a8, a72
  v_accvgpr_mov_b32 a9, a73
  v_accvgpr_mov_b32 a10, a74
  v_accvgpr_mov_b32 a11, a75
  v_accvgpr_mov_b32 a12, a76
  v_accvgpr_mov_b32 a13, a77
  v_accvgpr_mov_b32 a14, a78
  v_accvgpr_mov_b32 a15, a79
  v_accvgpr_mov_b32 a16, a80
  v_accvgpr_mov_b32 a17, a81
  v_accvgpr_mov_b32 a18, a82
  v_accvgpr_mov_b32 a19, a83
  v_accvgpr_mov_b32 a20, a84
  v_accvgpr_mov_b32 a21, a85
  v_accvgpr_mov_b32 a22, a86
  v_accvgpr_mov_b32 a23, a87
  v_accvgpr_mov_b32 a24, a88
  v_accvgpr_mov_b32 a25, a89
  v_accvgpr_mov_b32 a26, a90
  v_accvgpr_mov_b32 a27, a91
  v_accvgpr_mov_b32 a28, a92
  v_accvgpr_mov_b32 a29, a93
  v_accvgpr_mov_b32 a30, a94
  v_accvgpr_mov_b32 a31, a95
  v_accvgpr_mov_b32 a32, a96
  v_accvgpr_mov_b32 a33, a97
  v_accvgpr_mov_b32 a34, a98
  v_accvgpr_mov_b32 a35, a99
  v_accvgpr_mov_b32 a36, a100
  v_accvgpr_mov_b32 a37, a101
  v_accvgpr_mov_b32 a38, a102
  v_accvgpr_mov_b32 a39, a103
  v_accvgpr_mov_b32 a40, a104
  v_accvgpr_mov_b32 a41, a105
  v_accvgpr_mov_b32 a42, a106
  v_accvgpr_mov_b32 a43, a107
  v_accvgpr_mov_b32 a44, a108
  v_accvgpr_mov_b32 a45, a109
  v_accvgpr_mov_b32 a46, a110
  v_accvgpr_mov_b32 a47, a111
  v_accvgpr_mov_b32 a48, a112
  v_accvgpr_mov_b32 a49, a113
  v_accvgpr_mov_b32 a50, a114
  v_accvgpr_mov_b32 a51, a115
  v_accvgpr_mov_b32 a52, a116
  v_accvgpr_mov_b32 a53, a117
  v_accvgpr_mov_b32 a54, a118
  v_accvgpr_mov_b32 a55, a119
  v_accvgpr_mov_b32 a56, a120
  v_accvgpr_mov_b32 a57, a121
  v_accvgpr_mov_b32 a58, a122
  v_accvgpr_mov_b32 a59, a123
  v_accvgpr_mov_b32 a60, a124
  v_accvgpr_mov_b32 a61, a125
  v_accvgpr_mov_b32 a62, a126
  v_accvgpr_mov_b32 a63, a127
  s_branch K2_tail
K2_empty:
  v_accvgpr_mov_b32 a0, a64
  v_accvgpr_mov_b32 a1, a65
  v_accvgpr_mov_b32 a2, a66
  v_accvgpr_mov_b32 a3, a67
  v_accvgpr_mov_b32 a4, a68
  v_accvgpr_mov_b32 a5, a69
  v_accvgpr_mov_b32 a6, a70
  v_accvgpr_mov_b32 a7, a71
  v_accvgpr_mov_b32 a8, a72
  v_accvgpr_mov_b32 a9, a73
  v_accvgpr_mov_b32 a10, a74
  v_accvgpr_mov_b32 a11, a75
  v_accvgpr_mov_b32 a12, a76
  v_accvgpr_mov_b32 a13, a77
  v_accvgpr_mov_b32 a14, a78
  v_accvgpr_mov_b32 a15, a79
  v_accvgpr_mov_b32 a16, a80
  v_accvgpr_mov_b32 a17, a81
  v_accvgpr_mov_b32 a18, a82
  v_accvgpr_mov_b32 a19, a83
  v_accvgpr_mov_b32 a20, a84
  v_accvgpr_mov_b32 a21, a85
  v_accvgpr_mov_b32 a22, a86
  v_accvgpr_mov_b32 a23, a87
  v_accvgpr_mov_b32 a24, a88
  v_accvgpr_mov_b32 a25, a89
  v_accvgpr_mov_b32 a26, a90
  v_accvgpr_mov_b32 a27, a91
  v_accvgpr_mov_b32 a28, a92
  v_accvgpr_mov_b32 a29, a93
  v_accvgpr_mov_b32 a30, a94
  v_accvgpr_mov_b32 a31, a95
  v_accvgpr_mov_b32 a32, a96
  v_accvgpr_mov_b32 a33, a97
  v_accvgpr_mov_b32 a34, a98
  v_accvgpr_mov_b32 a35, a99
  v_accvgpr_mov_b32 a36, a100
  v_accvgpr_mov_b32 a37, a101
  v_accvgpr_mov_b32 a38, a102
  v_accvgpr_mov_b32 a39, a103
  v_accvgpr_mov_b32 a40, a104
  v_accvgpr_mov_b32 a41, a105
  v_accvgpr_mov_b32 a42, a106
  v_accvgpr_mov_b32 a43, a107
  v_accvgpr_mov_b32 a44, a108
  v_accvgpr_mov_b32 a45, a109
  v_accvgpr_mov_b32 a46, a110
  v_accvgpr_mov_b32 a47, a111
  v_accvgpr_mov_b32 a48, a112
  v_accvgpr_mov_b32 a49, a113
  v_accvgpr_mov_b32 a50, a114
  v_accvgpr_mov_b32 a51, a115
  v_accvgpr_mov_b32 a52, a116
  v_accvgpr_mov_b32 a53, a117
  v_accvgpr_mov_b32 a54, a118
  v_accvgpr_mov_b32 a55, a119
  v_accvgpr_mov_b32 a56, a120
  v_accvgpr_mov_b32 a57, a121
  v_accvgpr_mov_b32 a58, a122
  v_accvgpr_mov_b32 a59, a123
  v_accvgpr_mov_b32 a60, a124
  v_accvgpr_mov_b32 a61, a125
  v_accvgpr_mov_b32 a62, a126
  v_accvgpr_mov_b32 a63, a127
  s_mov_b32 s38, s25
K2_idle:
  s_cmp_eq_u32 s28, s29
  s_cselect_b32 s31, s37, s31
  s_cmp_eq_u32 s28, s30
  s_cbranch_scc0 K2_swb_5
  s_getpc_b64 s[58:59]
  s_add_u32 s58, s58, 12
  s_addc_u32 s59, s59, 0
  s_branch K2_switch
K2_swb_5:
  s_mov_b32 m0, s35
  s_add_u32 s28, s28, 1
  buffer_load_dwordx4 v4, s[8:11], s31 offen offset:0 sc1 lds
  buffer_load_dwordx4 v5, s[8:11], s31 offen offset:1024 sc1 lds
  buffer_load_dwordx4 v6, s[8:11], s31 offen offset:2048 sc1 lds
  buffer_load_dwordx4 v7, s[8:11], s31 offen offset:3072 sc1 lds
  s_add_u32 m0, s35, 0x4000
  s_add_u32 s35, s35, 0x8000
  buffer_load_dwordx4 v4, s[8:11], s32 offen offset:0 sc1 lds
  buffer_load_dwordx4 v5, s[8:11], s32 offen offset:1024 sc1 lds
  buffer_load_dwordx4 v6, s[8:11], s32 offen offset:2048 sc1 lds
  buffer_load_dwordx4 v7, s[8:11], s32 offen offset:3072 sc1 lds
  s_cmp_eq_u32 s35, s56
  s_cselect_b32 s35, s40, s35
  s_add_u32 s32, s31, s34
  s_add_u32 s31, s31, s33
  s_cmp_eq_u32 s28, s29
  s_cselect_b32 s31, s37, s31
  s_waitcnt vmcnt(16)
  s_barrier
  s_cmp_ge_u32 s28, s99
  s_cbranch_scc0 K2_idle_nf
  s_add_u32 s4, s52, 0x6000000
  s_addc_u32 s5, s53, 0
  s_and_b32 s5, s5, 0xffff
  s_mov_b32 s6, 0x8000
  s_mov_b32 s7, 0x20000
  v_mov_b32 v2, 1
  v_mov_b32 v3, s43
  s_mov_b64 exec, 1
  buffer_store_dword v2, v3, s[4:7], 0 offen sc1
  s_mov_b64 exec, -1
  s_mov_b32 s99, -1
K2_idle_nf:
  s_cmp_ge_u32 s28, s85
  s_cbranch_scc0 K2_idle_np
  s_add_u32 s4, s52, 0x6008000
  s_addc_u32 s5, s53, 0
  s_and_b32 s5, s5, 0xffff
  s_mov_b32 s6, 0x2000
  s_mov_b32 s7, 0x20000
  s_and_b32 s3, s83, 0xffff
  s_lshr_b32 s83, s83, 16
  v_mov_b32 v2, 1
  v_lshlrev_b32 v3, 13, v0
  buffer_store_dword v2, v3, s[4:7], s3 offen sc1
  buffer_store_dword v2, v3, s[4:7], s83 offen sc1
  s_mov_b32 s85, -1
K2_idle_np:
  s_add_u32 s36, s36, 0x8000
  s_cmp_eq_u32 s36, 0x28000
  s_cselect_b32 s36, 0, s36
  v_add_u32 v8, s36, v9
  s_sub_u32 s38, s38, 1
  s_cmp_eq_u32 s38, 0
  s_cbranch_scc0 K2_idle
  s_branch K2_segend
K2_rare_0:
  s_mov_b32 s44, s28
  s_mov_b32 s57, s50
  s_getpc_b64 s[80:81]
K2_pc_6:
  s_add_u32 s80, s80, K2_rb_0-K2_pc_6
  s_addc_u32 s81, s81, -1
  s_branch K2_rare
K2_rare_1:
  s_mov_b32 s44, s39
  s_mov_b32 s57, 2
  s_getpc_b64 s[80:81]
K2_pc_7:
  s_add_u32 s80, s80, K2_rb_1-K2_pc_7
  s_addc_u32 s81, s81, -1
  s_branch K2_rare
K2_rare:
  v_max3_f32 v14, v80, v81, v82
  v_max3_f32 v14, v14, v83, v84
  v_max3_f32 v14, v14, v85, v86
  v_max_f32 v14, v14, v87
  v_max3_f32 v15, v88, v89, v90
  v_max3_f32 v15, v15, v91, v92
  v_max3_f32 v15, v15, v93, v94
  v_max_f32 v15, v15, v95
  v_mov_b32 v18, v14
  v_mov_b32 v19, v15
  s_nop 0
  v_permlane16_swap_b32 v14, v18
  v_permlane16_swap_b32 v15, v19
  s_nop 0
  v_max_f32 v14, v14, v18
  v_max_f32 v15, v15, v19
  v_mov_b32 v18, v14
  v_mov_b32 v19, v15
  s_nop 0
  v_permlane32_swap_b32 v14, v18
  v_permlane32_swap_b32 v15, v19
  s_nop 0
  v_max_f32 v14, v14, v18
  v_max_f32 v15, v15, v19
  v_max_f32 v14, 0, v14
  v_sub_f32 v20, 0, v14
  v_exp_f32 v20, v20
  v_add_f32 v12, v12, v14
  v_max_f32 v15, 0, v15
  v_sub_f32 v21, 0, v15
  v_exp_f32 v21, v21
  v_add_f32 v13, v13, v15
  v_sub_f32 v32, v80, v14
  v_sub_f32 v33, v81, v14
  v_sub_f32 v34, v82, v14
  v_sub_f32 v35, v83, v14
  v_sub_f32 v36, v84, v14
  v_sub_f32 v37, v85, v14
  v_sub_f32 v38, v86, v14
  v_sub_f32 v39, v87, v14
  v_sub_f32 v40, v88, v15
  v_sub_f32 v41, v89, v15
  v_sub_f32 v42, v90, v15
  v_sub_f32 v43, v91, v15
  v_sub_f32 v44, v92, v15
  v_sub_f32 v45, v93, v15
  v_sub_f32 v46, v94, v15
  v_sub_f32 v47, v95, v15
  v_exp_f32 v32, v32
  v_exp_f32 v33, v33
  v_exp_f32 v34, v34
  v_exp_f32 v35, v35
  v_exp_f32 v36, v36
  v_exp_f32 v37, v37
  v_exp_f32 v38, v38
  v_exp_f32 v39, v39
  v_exp_f32 v40, v40
  v_exp_f32 v41, v41
  v_exp_f32 v42, v42
  v_exp_f32 v43, v43
  v_exp_f32 v44, v44
  v_exp_f32 v45, v45
  v_exp_f32 v46, v46
  v_exp_f32 v47, v47
  v_sub_f32 v64, v64, v14
  v_sub_f32 v65, v65, v14
  v_sub_f32 v66, v66, v14
  v_sub_f32 v67, v67, v14
  v_sub_f32 v68, v68, v15
  v_sub_f32 v69, v69, v15
  v_sub_f32 v70, v70, v15
  v_sub_f32 v71, v71, v15
  v_add_f32 v112, v64, v96
  v_add_f32 v113, v64, v97
  v_add_f32 v114, v64, v98
  v_add_f32 v115, v64, v99
  v_add_f32 v116, v64, v100
  v_add_f32 v117, v64, v101
  v_add_f32 v118, v64, v102
  v_add_f32 v119, v64, v103
  v_add_f32 v120, v68, v104
  v_add_f32 v121, v68, v105
  v_add_f32 v122, v68, v106
  v_add_f32 v123, v68, v107
  v_add_f32 v124, v68, v108
  v_add_f32 v125, v68, v109
  v_add_f32 v126, v68, v110
  v_add_f32 v127, v68, v111
  v_mul_f32 v10, v10, v20
  v_mul_f32 v11, v11, v21
  v_mul_f32 v128, v128, v20
  v_mul_f32 v129, v129, v20
  v_mul_f32 v130, v130, v20
  v_mul_f32 v131, v131, v20
  v_mul_f32 v132, v132, v20
  v_mul_f32 v133, v133, v20
  v_mul_f32 v134, v134, v20
  v_mul_f32 v135, v135, v20
  v_mul_f32 v136, v136, v21
  v_mul_f32 v137, v137, v21
  v_mul_f32 v138, v138, v21
  v_mul_f32 v139, v139, v21
  v_mul_f32 v140, v140, v21
  v_mul_f32 v141, v141, v21
  v_mul_f32 v142, v142, v21
  v_mul_f32 v143, v143, v21
  v_mul_f32 v144, v144, v20
  v_mul_f32 v145, v145, v20
  v_mul_f32 v146, v146, v20
  v_mul_f32 v147, v147, v20
  v_mul_f32 v148, v148, v20
  v_mul_f32 v149, v149, v20
  v_mul_f32 v150, v150, v20
  v_mul_f32 v151, v151, v20
  v_mul_f32 v152, v152, v21
  v_mul_f32 v153, v153, v21
  v_mul_f32 v154, v154, v21
  v_mul_f32 v155, v155, v21
  v_mul_f32 v156, v156, v21
  v_mul_f32 v157, v157, v21
  v_mul_f32 v158, v158, v21
  v_mul_f32 v159, v159, v21
  v_mul_f32 v160, v160, v20
  v_mul_f32 v161, v161, v20
  v_mul_f32 v162, v162, v20
  v_mul_f32 v163, v163, v20
  v_mul_f32 v164, v164, v20
  v_mul_f32 v165, v165, v20
  v_mul_f32 v166, v166, v20
  v_mul_f32 v167, v167, v20
  v_mul_f32 v168, v168, v21
  v_mul_f32 v169, v169, v21
  v_mul_f32 v170, v170, v21
  v_mul_f32 v171, v171, v21
  v_mul_f32 v172, v172, v21
  v_mul_f32 v173, v173, v21
  v_mul_f32 v174, v174, v21
  v_mul_f32 v175, v175, v21
  v_mul_f32 v176, v176, v20
  v_mul_f32 v177, v177, v20
  v_mul_f32 v178, v178, v20
  v_mul_f32 v179, v179, v20
  v_mul_f32 v180, v180, v20
  v_mul_f32 v181, v181, v20
  v_mul_f32 v182, v182, v20
  v_mul_f32 v183, v183, v20
  v_mul_f32 v184, v184, v21
  v_mul_f32 v185, v185, v21
  v_mul_f32 v186, v186, v21
  v_mul_f32 v187, v187, v21
  v_mul_f32 v188, v188, v21
  v_mul_f32 v189, v189, v21
  v_mul_f32 v190, v190, v21
  v_mul_f32 v191, v191, v21
  v_mul_f32 v192, v192, v20
  v_mul_f32 v193, v193, v20
  v_mul_f32 v194, v194, v20
  v_mul_f32 v195, v195, v20
  v_mul_f32 v196, v196, v20
  v_mul_f32 v197, v197, v20
  v_mul_f32 v198, v198, v20
  v_mul_f32 v199, v199, v20
  v_mul_f32 v200, v200, v21
  v_mul_f32 v201, v201, v21
  v_mul_f32 v202, v202, v21
  v_mul_f32 v203, v203, v21
  v_mul_f32 v204, v204, v21
  v_mul_f32 v205, v205, v21
  v_mul_f32 v206, v206, v21
  v_mul_f32 v207, v207, v21
  v_mul_f32 v208, v208, v20
  v_mul_f32 v209, v209, v20
  v_mul_f32 v210, v210, v20
  v_mul_f32 v211, v211, v20
  v_mul_f32 v212, v212, v20
  v_mul_f32 v213, v213, v20
  v_mul_f32 v214, v214, v20
  v_mul_f32 v215, v215, v20
  v_mul_f32 v216, v216, v21
  v_mul_f32 v217, v217, v21
  v_mul_f32 v218, v218, v21
  v_mul_f32 v219, v219, v21
  v_mul_f32 v220, v220, v21
  v_mul_f32 v221, v221, v21
  v_mul_f32 v222, v222, v21
  v_mul_f32 v223, v223, v21
  v_mul_f32 v224, v224, v20
  v_mul_f32 v225, v225, v20
  v_mul_f32 v226, v226, v20
  v_mul_f32 v227, v227, v20
  v_mul_f32 v228, v228, v20
  v_mul_f32 v229, v229, v20
  v_mul_f32 v230, v230, v20
  v_mul_f32 v231, v231, v20
  v_mul_f32 v232, v232, v21
  v_mul_f32 v233, v233, v21
  v_mul_f32 v234, v234, v21
  v_mul_f32 v235, v235, v21
  v_mul_f32 v236, v236, v21
  v_mul_f32 v237, v237, v21
  v_mul_f32 v238, v238, v21
  v_mul_f32 v239, v239, v21
  v_mul_f32 v240, v240, v20
  v_mul_f32 v241, v241, v20
  v_mul_f32 v242, v242, v20
  v_mul_f32 v243, v243, v20
  v_mul_f32 v244, v244, v20
  v_mul_f32 v245, v245, v20
  v_mul_f32 v246, v246, v20
  v_mul_f32 v247, v247, v20
  v_mul_f32 v248, v248, v21
  v_mul_f32 v249, v249, v21
  v_mul_f32 v250, v250, v21
  v_mul_f32 v251, v251, v21
  v_mul_f32 v252, v252, v21
  v_mul_f32 v253, v253, v21
  v_mul_f32 v254, v254, v21
  v_mul_f32 v255, v255, v21
  s_cmp_eq_u32 s44, s57
  s_setpc_b64 s[80:81]
K2_switch:
  s_mov_b32 s8, s48
  s_and_b32 s9, s49, 0xffff
  s_mov_b32 s10, 0x380000
  s_mov_b32 s11, 0x20000
  v_add_u32 v4, 0, v16
  v_add_u32 v5, 6144, v16
  v_add_u32 v6, 12288, v16
  v_add_u32 v7, 18432, v16
  s_mul_i32 s31, s47, 229376
  s_add_u32 s32, s31, 114688
  s_mov_b32 s33, 128
  s_mov_b32 s34, 114816
  s_getpc_b64 s[4:5]
L_pc_8:
  s_add_u32 s4, s4, K2_segend-L_pc_8
  s_addc_u32 s5, s5, (K2_segend-L_pc_8)>>32
  s_and_b32 s5, s5, 0xffff
  s_mov_b32 s6, K2_CODE_END-K2_segend
  s_mov_b32 s7, 0x20000
  v_and_b32 v3, 15, v0
  v_lshlrev_b32 v3, 5, v3
  v_add_u32 v3, s55, v3
  v_lshlrev_b32 v3, 7, v3
  buffer_load_dword v26, v3, s[4:7], 0 offen
  s_add_u32 s92, s52, 0x6008000
  s_addc_u32 s93, s53, 0
  s_and_b32 s93, s93, 0xffff
  s_mov_b32 s94, 0x2000
  s_mov_b32 s95, 0x20000
  v_mov_b32 v22, 1
  v_lshlrev_b32 v23, 13, v0
  s_and_b32 s3, s82, -128
  v_lshrrev_b32 v24, 2, v9
  v_and_b32 v24, 60, v24
  v_add_u32 v24, s3, v24
  s_setpc_b64 s[58:59]
K2_partial:
  s_mul_i32 s3, s47, 7
  s_add_u32 s3, s3, s46
  s_add_u32 s54, s3, 112
  s_add_u32 s25, s47, 224
  s_add_u32 s57, s47, 240
  s_cmp_eq_u32 s47, 0
  s_cselect_b32 s26, 1, 0
  s_cmp_eq_u32 s46, 7
  s_cselect_b32 s3, s25, s3
  s_cselect_b32 s54, s57, s54
  s_cselect_b32 s26, s26, 2
  s_lshl_b32 s25, s54, 16
  s_or_b32 s25, s25, s3
  s_lshl_b32 s57, s25, 2
  s_add_u32 s100, s57, 0x0c000c00
  s_add_u32 s4, s52, 0x6008000
  s_addc_u32 s5, s53, 0
  s_and_b32 s5, s5, 0xffff
  s_mov_b32 s6, 0x2000
  s_mov_b32 s7, 0x20000
  s_lshr_b32 s3, s3, 5
  s_lshr_b32 s54, s54, 5
  s_sub_u32 s54, s54, s3
  s_lshl_b32 s54, s54, 2
  s_sub_u32 s54, s54, 4
  s_add_u32 s3, s3, 16
  s_lshl_b32 s3, s3, 7
  v_lshrrev_b32 v2, 2, v9
  v_and_b32 v3, 32, v0
  v_mul_lo_u32 v3, s54, v3
  v_add3_u32 v26, v2, v3, s3
  buffer_load_dword v25, v26, s[4:7], 0 offen sc1
  v_cvt_pk_bf16_f32 v32, v128, v129
  v_cvt_pk_bf16_f32 v33, v130, v131
  v_cvt_pk_bf16_f32 v34, v132, v133
  v_cvt_pk_bf16_f32 v35, v134, v135
  buffer_store_dwordx4 v[32:35], v9, s[12:15], s42 offen offset:0 sc1
  v_cvt_pk_bf16_f32 v36, v136, v137
  v_cvt_pk_bf16_f32 v37, v138, v139
  v_cvt_pk_bf16_f32 v38, v140, v141
  v_cvt_pk_bf16_f32 v39, v142, v143
  buffer_store_dwordx4 v[36:39], v9, s[12:15], s42 offen offset:1024 sc1
  v_cvt_pk_bf16_f32 v40, v144, v145
  v_cvt_pk_bf16_f32 v41, v146, v147
  v_cvt_pk_bf16_f32 v42, v148, v149
  v_cvt_pk_bf16_f32 v43, v150, v151
  buffer_store_dwordx4 v[40:43], v9, s[12:15], s42 offen offset:2048 sc1
  v_cvt_pk_bf16_f32 v44, v152, v153
  v_cvt_pk_bf16_f32 v45, v154, v155
  v_cvt_pk_bf16_f32 v46, v156, v157
  v_cvt_pk_bf16_f32 v47, v158, v159
  buffer_store_dwordx4 v[44:47], v9, s[12:15], s42 offen offset:3072 sc1
  v_cvt_pk_bf16_f32 v32, v160, v161
  v_cvt_pk_bf16_f32 v33, v162, v163
  v_cvt_pk_bf16_f32 v34, v164, v165
  v_cvt_pk_bf16_f32 v35, v166, v167
  s_add_u32 s42, s42, 0x1000
  buffer_store_dwordx4 v[32:35], v9, s[12:15], s42 offen offset:0 sc1
  v_cvt_pk_bf16_f32 v36, v168, v169
  v_cvt_pk_bf16_f32 v37, v170, v171
  v_cvt_pk_bf16_f32 v38, v172, v173
  v_cvt_pk_bf16_f32 v39, v174, v175
  buffer_store_dwordx4 v[36:39], v9, s[12:15], s42 offen offset:1024 sc1
  v_cvt_pk_bf16_f32 v40, v176, v177
  v_cvt_pk_bf16_f32 v41, v178, v179
  v_cvt_pk_bf16_f32 v42, v180, v181
  v_cvt_pk_bf16_f32 v43, v182, v183
  buffer_store_dwordx4 v[40:43], v9, s[12:15], s42 offen offset:2048 sc1
  v_cvt_pk_bf16_f32 v44, v184, v185
  v_cvt_pk_bf16_f32 v45, v186, v187
  v_cvt_pk_bf16_f32 v46, v188, v189
  v_cvt_pk_bf16_f32 v47, v190, v191
  buffer_store_dwordx4 v[44:47], v9, s[12:15], s42 offen offset:3072 sc1
  v_cvt_pk_bf16_f32 v32, v192, v193
  v_cvt_pk_bf16_f32 v33, v194, v195
  v_cvt_pk_bf16_f32 v34, v196, v197
  v_cvt_pk_bf16_f32 v35, v198, v199
  s_add_u32 s42, s42, 0x1000
  buffer_store_dwordx4 v[32:35], v9, s[12:15], s42 offen offset:0 sc1
  v_cvt_pk_bf16_f32 v36, v200, v201
  v_cvt_pk_bf16_f32 v37, v202, v203
  v_cvt_pk_bf16_f32 v38, v204, v205
  v_cvt_pk_bf16_f32 v39, v206, v207
  buffer_store_dwordx4 v[36:39], v9, s[12:15], s42 offen offset:1024 sc1
  v_cvt_pk_bf16_f32 v40, v208, v209
  v_cvt_pk_bf16_f32 v41, v210, v211
  v_cvt_pk_bf16_f32 v42, v212, v213
  v_cvt_pk_bf16_f32 v43, v214, v215
  buffer_store_dwordx4 v[40:43], v9, s[12:15], s42 offen offset:2048 sc1
  v_cvt_pk_bf16_f32 v44, v216, v217
  v_cvt_pk_bf16_f32 v45, v218, v219
  v_cvt_pk_bf16_f32 v46, v220, v221
  v_cvt_pk_bf16_f32 v47, v222, v223
  buffer_store_dwordx4 v[44:47], v9, s[12:15], s42 offen offset:3072 sc1
  v_cvt_pk_bf16_f32 v32, v224, v225
  v_cvt_pk_bf16_f32 v33, v226, v227
  v_cvt_pk_bf16_f32 v34, v228, v229
  v_cvt_pk_bf16_f32 v35, v230, v231
  s_add_u32 s42, s42, 0x1000
  buffer_store_dwordx4 v[32:35], v9, s[12:15], s42 offen offset:0 sc1
  v_cvt_pk_bf16_f32 v36, v232, v233
  v_cvt_pk_bf16_f32 v37, v234, v235
  v_cvt_pk_bf16_f32 v38, v236, v237
  v_cvt_pk_bf16_f32 v39, v238, v239
  buffer_store_dwordx4 v[36:39], v9, s[12:15], s42 offen offset:1024 sc1
  v_cvt_pk_bf16_f32 v40, v240, v241
  v_cvt_pk_bf16_f32 v41, v242, v243
  v_cvt_pk_bf16_f32 v42, v244, v245
  v_cvt_pk_bf16_f32 v43, v246, v247
  buffer_store_dwordx4 v[40:43], v9, s[12:15], s42 offen offset:2048 sc1
  v_cvt_pk_bf16_f32 v44, v248, v249
  v_cvt_pk_bf16_f32 v45, v250, v251
  v_cvt_pk_bf16_f32 v46, v252, v253
  v_cvt_pk_bf16_f32 v47, v254, v255
  buffer_store_dwordx4 v[44:47], v9, s[12:15], s42 offen offset:3072 sc1
  v_mov_b32 v20, v12
  v_mov_b32 v21, v10
  v_mov_b32 v22, v13
  v_mov_b32 v23, v11
  s_add_u32 s42, s42, 0x1000
  buffer_store_dwordx4 v[20:23], v9, s[12:15], s42 offen sc1
  s_mov_b32 s39, 2
  s_mov_b32 s27, 1
  s_sub_u32 s38, s35, s40
  s_cmp_eq_u32 s26, 0
  s_cbranch_scc1 K2_nocol
  s_waitcnt vmcnt(17)
  v_cmp_ne_u32 vcc, 1, v25
  s_nop 4
  s_cbranch_vccnz K2_a1_wait
K2_a1_ok:
  v_lshrrev_b32 v2, 3, v9
  v_and_b32 v2, 32, v2
  v_xor_b32 v2, v2, v9
  v_xor_b32 v3, 64, v2
  v_bfe_u32 v18, v0, 0, 4
  v_bfe_u32 v19, v0, 4, 2
  v_lshlrev_b32 v19, 5, v19
  v_lshl_add_u32 v18, v18, 7, v19
  s_add_u32 s4, s52, 0x6100000
  s_addc_u32 s5, s53, 0
  s_and_b32 s5, s5, 0xffff
  s_mov_b32 s6, 0x1c2000
  s_mov_b32 s7, 0x20000
  s_add_u32 s20, s52, 0x6400000
  s_addc_u32 s21, s53, 0
  s_and_b32 s21, s21, 0xffff
  s_mov_b32 s22, 0x1c2000
  s_mov_b32 s23, 0x20000
  s_bfe_u32 s54, s25, 0x100000
  s_lshl_b32 s54, s54, 13
  s_lshl_b32 s3, s24, 11
  s_add_u32 s54, s54, s3
  s_add_u32 s3, s3, s38
  s_add_u32 m0, s3, 0
  s_nop 0
  buffer_load_dwordx4 v2, s[4:7], s54 offen sc1 lds
  buffer_load_dwordx4 v3, s[4:7], s54 offen offset:1024 sc1 lds
  buffer_load_dwordx4 v[240:243], v18, s[20:23], s54 offen sc1
  buffer_load_dwordx4 v[244:247], v18, s[20:23], s54 offen offset:16 sc1
  s_bfe_u32 s54, s25, 0x100010
  s_lshl_b32 s54, s54, 13
  s_lshl_b32 s3, s24, 11
  s_add_u32 s54, s54, s3
  s_add_u32 s3, s3, s38
  s_add_u32 m0, s3, 16384
  s_nop 0
  buffer_load_dwordx4 v2, s[4:7], s54 offen sc1 lds
  buffer_load_dwordx4 v3, s[4:7], s54 offen offset:1024 sc1 lds
  buffer_load_dwordx4 v[248:251], v18, s[20:23], s54 offen sc1
  buffer_load_dwordx4 v[252:255], v18, s[20:23], s54 offen offset:16 sc1
  v_and_b32 v1, 63, v0
  v_and_b32 v2, 15, v1
  v_lshrrev_b32 v3, 4, v1
  s_lshl_b32 s3, s24, 4
  v_add_u32 v24, s3, v2
  v_accvgpr_read_b32 v80, a232
  v_accvgpr_read_b32 v81, a233
  v_accvgpr_read_b32 v82, a234
  v_accvgpr_read_b32 v83, a235
  v_accvgpr_read_b32 v84, a236
  v_accvgpr_read_b32 v85, a237
  v_accvgpr_read_b32 v86, a238
  v_accvgpr_read_b32 v87, a239
  v_accvgpr_read_b32 v88, a240
  v_accvgpr_read_b32 v89, a241
  v_accvgpr_read_b32 v90, a242
  v_accvgpr_read_b32 v91, a243
  v_accvgpr_read_b32 v92, a244
  v_accvgpr_read_b32 v93, a245
  v_accvgpr_read_b32 v94, a246
  v_accvgpr_read_b32 v95, a247
  v_bfe_u32 v18, v1, 2, 2
  v_lshl_add_u32 v19, v3, 3, v18
  v_lshlrev_b32 v19, 7, v19
  v_and_b32 v20, 3, v1
  v_lshl_add_u32 v19, v20, 3, v19
  v_add_u32 v19, s38, v19
  v_lshrrev_b32 v18, 1, v18
  v_and_b32 v20, 1, v3
  v_lshl_add_u32 v18, v20, 1, v18
  v_xor_b32 v20, 0, v18
  v_lshl_add_u32 v216, v20, 5, v19
  v_xor_b32 v20, 1, v18
  v_lshl_add_u32 v217, v20, 5, v19
  v_xor_b32 v20, 2, v18
  v_lshl_add_u32 v218, v20, 5, v19
  v_xor_b32 v20, 3, v18
  v_lshl_add_u32 v219, v20, 5, v19
  v_lshlrev_b32 v19, 7, v24
  v_lshl_add_u32 v19, v3, 3, v19
  s_add_u32 s3, s38, 0x2000
  v_add_u32 v19, s3, v19
  v_bfe_u32 v18, v2, 1, 1
  v_bfe_u32 v20, v2, 3, 1
  v_lshl_add_u32 v18, v20, 1, v18
  v_xor_b32 v20, 0, v18
  v_lshl_add_u32 v220, v20, 5, v19
  v_xor_b32 v20, 1, v18
  v_lshl_add_u32 v221, v20, 5, v19
  v_xor_b32 v20, 2, v18
  v_lshl_add_u32 v222, v20, 5, v19
  v_xor_b32 v20, 3, v18
  v_lshl_add_u32 v223, v20, 5, v19
  v_mul_u32_u24 v25, 28800, v24
  v_lshl_add_u32 v25, v3, 4, v25
  s_waitcnt vmcnt(8)
  s_add_u32 s4, s52, 0x6000000
  s_addc_u32 s5, s53, 0
  s_and_b32 s5, s5, 0xffff
  s_mov_b32 s6, 0x8000
  s_mov_b32 s7, 0x20000
  v_mov_b32 v2, 1
  v_mov_b32 v3, s43
  s_mov_b64 exec, 1
  buffer_store_dword v2, v3, s[4:7], 0 offen sc1
  s_mov_b64 exec, -1
  s_mov_b32 s99, -1
  s_waitcnt vmcnt(1)
K2_col:
  s_and_b32 s54, s25, 0xffff
  s_mov_b32 s57, 0x36124925
  s_cmp_eq_u32 s54, 0
  s_cselect_b32 s57, 0x35924925, s57
  s_cmp_eq_u32 s54, 224
  s_cselect_b32 s57, 0x35924925, s57
  v_mul_f32 v224, s57, v80
  v_mul_f32 v232, s57, v88
  v_mul_f32 v225, s57, v81
  v_mul_f32 v233, s57, v89
  v_mul_f32 v226, s57, v82
  v_mul_f32 v234, s57, v90
  v_mul_f32 v227, s57, v83
  v_mul_f32 v235, s57, v91
  v_mul_f32 v228, s57, v84
  v_mul_f32 v236, s57, v92
  v_mul_f32 v229, s57, v85
  v_mul_f32 v237, s57, v93
  v_mul_f32 v230, s57, v86
  v_mul_f32 v238, s57, v94
  v_mul_f32 v231, s57, v87
  v_mul_f32 v239, s57, v95
  s_barrier
  ds_read_b64_tr_b16 v[96:97], v216 offset:0
  ds_read_b64_tr_b16 v[98:99], v216 offset:512
  ds_read_b64_tr_b16 v[100:101], v216 offset:4096
  ds_read_b64_tr_b16 v[102:103], v216 offset:4608
  ds_read_b64_tr_b16 v[104:105], v217 offset:0
  ds_read_b64_tr_b16 v[106:107], v217 offset:512
  ds_read_b64_tr_b16 v[108:109], v217 offset:4096
  ds_read_b64_tr_b16 v[110:111], v217 offset:4608
  ds_read_b64_tr_b16 v[112:113], v218 offset:0
  ds_read_b64_tr_b16 v[114:115], v218 offset:512
  ds_read_b64_tr_b16 v[116:117], v218 offset:4096
  ds_read_b64_tr_b16 v[118:119], v218 offset:4608
  ds_read_b64_tr_b16 v[120:121], v219 offset:0
  ds_read_b64_tr_b16 v[122:123], v219 offset:512
  ds_read_b64_tr_b16 v[124:125], v219 offset:4096
  ds_read_b64_tr_b16 v[126:127], v219 offset:4608
  s_waitcnt lgkmcnt(12)
  v_mfma_f32_16x16x32_bf16 v[128:131], v[96:99], a[192:195], 0
  v_mfma_f32_16x16x32_bf16 v[144:147], v[96:99], a[200:203], 0
  v_mfma_f32_16x16x32_bf16 v[128:131], v[100:103], a[196:199], v[128:131]
  v_mfma_f32_16x16x32_bf16 v[144:147], v[100:103], a[204:207], v[144:147]
  s_waitcnt lgkmcnt(8)
  v_mfma_f32_16x16x32_bf16 v[132:135], v[104:107], a[192:195], 0
  v_mfma_f32_16x16x32_bf16 v[148:151], v[104:107], a[200:203], 0
  v_mfma_f32_16x16x32_bf16 v[132:135], v[108:111], a[196:199], v[132:135]
  v_mfma_f32_16x16x32_bf16 v[148:151], v[108:111], a[204:207], v[148:151]
  s_waitcnt lgkmcnt(4)
  v_mfma_f32_16x16x32_bf16 v[136:139], v[112:115], a[192:195], 0
  v_mfma_f32_16x16x32_bf16 v[152:155], v[112:115], a[200:203], 0
  v_mfma_f32_16x16x32_bf16 v[136:139], v[116:119], a[196:199], v[136:139]
  v_mfma_f32_16x16x32_bf16 v[152:155], v[116:119], a[204:207], v[152:155]
  s_waitcnt lgkmcnt(0)
  v_mfma_f32_16x16x32_bf16 v[140:143], v[120:123], a[192:195], 0
  v_mfma_f32_16x16x32_bf16 v[156:159], v[120:123], a[200:203], 0
  v_mfma_f32_16x16x32_bf16 v[140:143], v[124:127], a[196:199], v[140:143]
  v_mfma_f32_16x16x32_bf16 v[156:159], v[124:127], a[204:207], v[156:159]
  s_nop 7
  v_add_f32 v184, v128, v145
  v_sub_f32 v192, v129, v144
  v_add_f32 v185, v130, v147
  v_sub_f32 v193, v131, v146
  v_add_f32 v186, v132, v149
  v_sub_f32 v194, v133, v148
  v_add_f32 v187, v134, v151
  v_sub_f32 v195, v135, v150
  v_add_f32 v188, v136, v153
  v_sub_f32 v196, v137, v152
  v_add_f32 v189, v138, v155
  v_sub_f32 v197, v139, v154
  v_add_f32 v190, v140, v157
  v_sub_f32 v198, v141, v156
  v_add_f32 v191, v142, v159
  v_sub_f32 v199, v143, v158
  v_pk_mul_f32 v[160:161], v[184:185], v[80:81]
  v_pk_mul_f32 v[168:169], v[192:193], v[80:81]
  v_pk_fma_f32 v[160:161], v[192:193], v[88:89], v[160:161]
  v_pk_fma_f32 v[168:169], v[184:185], v[88:89], v[168:169] neg_lo:[1,0,0] neg_hi:[1,0,0]
  v_pk_mul_f32 v[162:163], v[186:187], v[82:83]
  v_pk_mul_f32 v[170:171], v[194:195], v[82:83]
  v_pk_fma_f32 v[162:163], v[194:195], v[90:91], v[162:163]
  v_pk_fma_f32 v[170:171], v[186:187], v[90:91], v[170:171] neg_lo:[1,0,0] neg_hi:[1,0,0]
  v_pk_mul_f32 v[164:165], v[188:189], v[84:85]
  v_pk_mul_f32 v[172:173], v[196:197], v[84:85]
  v_pk_fma_f32 v[164:165], v[196:197], v[92:93], v[164:165]
  v_pk_fma_f32 v[172:173], v[188:189], v[92:93], v[172:173] neg_lo:[1,0,0] neg_hi:[1,0,0]
  v_pk_mul_f32 v[166:167], v[190:191], v[86:87]
  v_pk_mul_f32 v[174:175], v[198:199], v[86:87]
  v_pk_fma_f32 v[166:167], v[198:199], v[94:95], v[166:167]
  v_pk_fma_f32 v[174:175], v[190:191], v[94:95], v[174:175] neg_lo:[1,0,0] neg_hi:[1,0,0]
  v_cvt_pk_bf16_f32 v176, v160, v161
  v_cvt_pk_bf16_f32 v180, v168, v169
  v_cvt_pk_bf16_f32 v177, v162, v163
  v_cvt_pk_bf16_f32 v181, v170, v171
  v_cvt_pk_bf16_f32 v178, v164, v165
  v_cvt_pk_bf16_f32 v182, v172, v173
  v_cvt_pk_bf16_f32 v179, v166, v167
  v_cvt_pk_bf16_f32 v183, v174, v175
  s_nop 1
  v_mfma_f32_16x16x32_bf16 v[184:187], a[208:211], v[176:179], 0
  v_mfma_f32_16x16x32_bf16 v[192:195], a[208:211], v[180:183], 0
  v_mfma_f32_16x16x32_bf16 v[188:191], a[212:215], v[176:179], 0
  v_mfma_f32_16x16x32_bf16 v[196:199], a[212:215], v[180:183], 0
  v_mfma_f32_16x16x32_bf16 v[184:187], a[216:219], v[180:183], v[184:187]
  v_mfma_f32_16x16x32_bf16 v[192:195], a[224:227], v[176:179], v[192:195]
  v_mfma_f32_16x16x32_bf16 v[188:191], a[220:223], v[180:183], v[188:191]
  v_mfma_f32_16x16x32_bf16 v[196:199], a[228:231], v[176:179], v[196:199]
  v_lshlrev_b32 v128, 16, v240
  v_lshlrev_b32 v129, 16, v241
  v_lshlrev_b32 v130, 16, v242
  v_lshlrev_b32 v131, 16, v243
  v_lshlrev_b32 v132, 16, v244
  v_lshlrev_b32 v133, 16, v245
  v_lshlrev_b32 v134, 16, v246
  v_lshlrev_b32 v135, 16, v247
  v_and_b32 v144, 0xffff0000, v240
  v_and_b32 v145, 0xffff0000, v241
  v_and_b32 v146, 0xffff0000, v242
  v_and_b32 v147, 0xffff0000, v243
  v_and_b32 v148, 0xffff0000, v244
  v_and_b32 v149, 0xffff0000, v245
  v_and_b32 v150, 0xffff0000, v246
  v_and_b32 v151, 0xffff0000, v247
  v_pk_mul_f32 v[160:161], v[184:185], v[128:129]
  v_pk_mul_f32 v[168:169], v[192:193], v[128:129]
  v_pk_fma_f32 v[160:161], v[192:193], v[144:145], v[160:161] neg_lo:[1,0,0] neg_hi:[1,0,0]
  v_pk_fma_f32 v[168:169], v[184:185], v[144:145], v[168:169]
  v_pk_mul_f32 v[162:163], v[186:187], v[130:131]
  v_pk_mul_f32 v[170:171], v[194:195], v[130:131]
  v_pk_fma_f32 v[162:163], v[194:195], v[146:147], v[162:163] neg_lo:[1,0,0] neg_hi:[1,0,0]
  v_pk_fma_f32 v[170:171], v[186:187], v[146:147], v[170:171]
  v_pk_mul_f32 v[164:165], v[188:189], v[132:133]
  v_pk_mul_f32 v[172:173], v[196:197], v[132:133]
  v_pk_fma_f32 v[164:165], v[196:197], v[148:149], v[164:165] neg_lo:[1,0,0] neg_hi:[1,0,0]
  v_pk_fma_f32 v[172:173], v[188:189], v[148:149], v[172:173]
  v_pk_mul_f32 v[166:167], v[190:191], v[134:135]
  v_pk_mul_f32 v[174:175], v[198:199], v[134:135]
  v_pk_fma_f32 v[166:167], v[198:199], v[150:151], v[166:167] neg_lo:[1,0,0] neg_hi:[1,0,0]
  v_pk_fma_f32 v[174:175], v[190:191], v[150:151], v[174:175]
  v_cvt_pk_bf16_f32 v176, v160, v161
  v_cvt_pk_bf16_f32 v180, v168, v169
  v_cvt_pk_bf16_f32 v177, v162, v163
  v_cvt_pk_bf16_f32 v181, v170, v171
  v_cvt_pk_bf16_f32 v178, v164, v165
  v_cvt_pk_bf16_f32 v182, v172, v173
  v_cvt_pk_bf16_f32 v179, v166, v167
  v_cvt_pk_bf16_f32 v183, v174, v175
  s_nop 1
  v_mfma_f32_16x16x32_bf16 v[184:187], a[208:211], v[176:179], 0
  v_mfma_f32_16x16x32_bf16 v[192:195], a[208:211], v[180:183], 0
  v_mfma_f32_16x16x32_bf16 v[188:191], a[212:215], v[176:179], 0
  v_mfma_f32_16x16x32_bf16 v[196:199], a[212:215], v[180:183], 0
  v_mfma_f32_16x16x32_bf16 v[184:187], a[224:227], v[180:183], v[184:187]
  v_mfma_f32_16x16x32_bf16 v[192:195], a[216:219], v[176:179], v[192:195]
  v_mfma_f32_16x16x32_bf16 v[188:191], a[228:231], v[180:183], v[188:191]
  v_mfma_f32_16x16x32_bf16 v[196:199], a[220:223], v[176:179], v[196:199]
  s_nop 7
  v_pk_mul_f32 v[160:161], v[184:185], v[224:225]
  v_pk_mul_f32 v[168:169], v[192:193], v[224:225]
  v_pk_fma_f32 v[160:161], v[192:193], v[232:233], v[160:161] neg_lo:[1,0,0] neg_hi:[1,0,0]
  v_pk_fma_f32 v[168:169], v[184:185], v[232:233], v[168:169]
  v_pk_mul_f32 v[162:163], v[186:187], v[226:227]
  v_pk_mul_f32 v[170:171], v[194:195], v[226:227]
  v_pk_fma_f32 v[162:163], v[194:195], v[234:235], v[162:163] neg_lo:[1,0,0] neg_hi:[1,0,0]
  v_pk_fma_f32 v[170:171], v[186:187], v[234:235], v[170:171]
  v_pk_mul_f32 v[164:165], v[188:189], v[228:229]
  v_pk_mul_f32 v[172:173], v[196:197], v[228:229]
  v_pk_fma_f32 v[164:165], v[196:197], v[236:237], v[164:165] neg_lo:[1,0,0] neg_hi:[1,0,0]
  v_pk_fma_f32 v[172:173], v[188:189], v[236:237], v[172:173]
  v_pk_mul_f32 v[166:167], v[190:191], v[230:231]
  v_pk_mul_f32 v[174:175], v[198:199], v[230:231]
  v_pk_fma_f32 v[166:167], v[198:199], v[238:239], v[166:167] neg_lo:[1,0,0] neg_hi:[1,0,0]
  v_pk_fma_f32 v[174:175], v[190:191], v[238:239], v[174:175]
  v_cvt_pk_bf16_f32 v128, v160, v168
  v_cvt_pk_bf16_f32 v129, v161, v169
  ds_write_b64 v220, v[128:129]
  v_cvt_pk_bf16_f32 v130, v162, v170
  v_cvt_pk_bf16_f32 v131, v163, v171
  ds_write_b64 v221, v[130:131]
  v_cvt_pk_bf16_f32 v132, v164, v172
  v_cvt_pk_bf16_f32 v133, v165, v173
  ds_write_b64 v222, v[132:133]
  v_cvt_pk_bf16_f32 v134, v166, v174
  v_cvt_pk_bf16_f32 v135, v167, v175
  ds_write_b64 v223, v[134:135]
  s_waitcnt lgkmcnt(0)
  s_barrier
  ds_read_b64_tr_b16 v[96:97], v216 offset:8192
  ds_read_b64_tr_b16 v[98:99], v216 offset:8704
  ds_read_b64_tr_b16 v[100:101], v216 offset:12288
  ds_read_b64_tr_b16 v[102:103], v216 offset:12800
  ds_read_b64_tr_b16 v[104:105], v217 offset:8192
  ds_read_b64_tr_b16 v[106:107], v217 offset:8704
  ds_read_b64_tr_b16 v[108:109], v217 offset:12288
  ds_read_b64_tr_b16 v[110:111], v217 offset:12800
  ds_read_b64_tr_b16 v[112:113], v218 offset:8192
  ds_read_b64_tr_b16 v[114:115], v218 offset:8704
  ds_read_b64_tr_b16 v[116:117], v218 offset:12288
  ds_read_b64_tr_b16 v[118:119], v218 offset:12800
  ds_read_b64_tr_b16 v[120:121], v219 offset:8192
  ds_read_b64_tr_b16 v[122:123], v219 offset:8704
  ds_read_b64_tr_b16 v[124:125], v219 offset:12288
  ds_read_b64_tr_b16 v[126:127], v219 offset:12800
  s_waitcnt lgkmcnt(12)
  v_mfma_f32_16x16x32_bf16 v[128:131], v[96:99], a[192:195], 0
  v_mfma_f32_16x16x32_bf16 v[144:147], v[96:99], a[200:203], 0
  v_mfma_f32_16x16x32_bf16 v[128:131], v[100:103], a[196:199], v[128:131]
  v_mfma_f32_16x16x32_bf16 v[144:147], v[100:103], a[204:207], v[144:147]
  s_waitcnt lgkmcnt(8)
  v_mfma_f32_16x16x32_bf16 v[132:135], v[104:107], a[192:195], 0
  v_mfma_f32_16x16x32_bf16 v[148:151], v[104:107], a[200:203], 0
  v_mfma_f32_16x16x32_bf16 v[132:135], v[108:111], a[196:199], v[132:135]
  v_mfma_f32_16x16x32_bf16 v[148:151], v[108:111], a[204:207], v[148:151]
  s_waitcnt lgkmcnt(4)
  v_mfma_f32_16x16x32_bf16 v[136:139], v[112:115], a[192:195], 0
  v_mfma_f32_16x16x32_bf16 v[152:155], v[112:115], a[200:203], 0
  v_mfma_f32_16x16x32_bf16 v[136:139], v[116:119], a[196:199], v[136:139]
  v_mfma_f32_16x16x32_bf16 v[152:155], v[116:119], a[204:207], v[152:155]
  s_waitcnt lgkmcnt(0)
  v_mfma_f32_16x16x32_bf16 v[140:143], v[120:123], a[192:195], 0
  v_mfma_f32_16x16x32_bf16 v[156:159], v[120:123], a[200:203], 0
  v_mfma_f32_16x16x32_bf16 v[140:143], v[124:127], a[196:199], v[140:143]
  v_mfma_f32_16x16x32_bf16 v[156:159], v[124:127], a[204:207], v[156:159]
  s_nop 7
  v_sub_f32 v160, v128, v145
  v_add_f32 v168, v129, v144
  v_sub_f32 v161, v130, v147
  v_add_f32 v169, v131, v146
  v_sub_f32 v162, v132, v149
  v_add_f32 v170, v133, v148
  v_sub_f32 v163, v134, v151
  v_add_f32 v171, v135, v150
  v_sub_f32 v164, v136, v153
  v_add_f32 v172, v137, v152
  v_sub_f32 v165, v138, v155
  v_add_f32 v173, v139, v154
  v_sub_f32 v166, v140, v157
  v_add_f32 v174, v141, v156
  v_sub_f32 v167, v142, v159
  v_add_f32 v175, v143, v158
  v_cvt_pk_bf16_f32 v176, v160, v161
  v_cvt_pk_bf16_f32 v180, v168, v169
  v_cvt_pk_bf16_f32 v177, v162, v163
  v_cvt_pk_bf16_f32 v181, v170, v171
  v_cvt_pk_bf16_f32 v178, v164, v165
  v_cvt_pk_bf16_f32 v182, v172, v173
  v_cvt_pk_bf16_f32 v179, v166, v167
  v_cvt_pk_bf16_f32 v183, v174, v175
  s_add_u32 s4, s52, 0x6700000
  s_addc_u32 s5, s53, 0
  s_and_b32 s5, s5, 0xffff
  s_mov_b32 s6, 0x1c2000
  s_mov_b32 s7, 0x20000
  s_lshl_b32 s3, s54, 7
  buffer_store_dwordx4 v[176:179], v25, s[4:7], s3 offen sc1
  buffer_store_dwordx4 v[180:183], v25, s[4:7], s3 offen offset:64 sc1
  v_add_u32 v216, 0x4000, v216
  v_add_u32 v217, 0x4000, v217
  v_add_u32 v218, 0x4000, v218
  v_add_u32 v219, 0x4000, v219
  v_add_u32 v220, 0x4000, v220
  v_add_u32 v221, 0x4000, v221
  v_add_u32 v222, 0x4000, v222
  v_add_u32 v223, 0x4000, v223
  v_mov_b64 v[240:241], v[248:249]
  v_mov_b64 v[242:243], v[250:251]
  v_mov_b64 v[244:245], v[252:253]
  v_mov_b64 v[246:247], v[254:255]
  s_lshr_b32 s25, s25, 16
  s_sub_u32 s26, s26, 1
  s_cmp_eq_u32 s26, 0
  s_cbranch_scc0 K2_col
  v_and_b32 v1, 63, v0
  v_and_b32 v2, 15, v1
  v_lshrrev_b32 v3, 4, v1
  v_lshlrev_b32 v3, 2, v3
  v_sub_u32 v17, v2, v3
  v_lshrrev_b32 v2, 3, v1
  s_lshl_b32 s3, s24, 5
  v_add_u32 v2, s3, v2
  v_mul_u32_u24 v2, 896, v2
  v_lshrrev_b32 v3, 4, v1
  v_lshlrev_b32 v3, 1, v3
  v_and_b32 v16, 7, v1
  v_xor_b32 v3, v16, v3
  v_lshl_add_u32 v16, v3, 4, v2
  v_mov_b32 v76, 0
  s_cmp_eq_u32 s39, 0
  s_cselect_b32 s3, 1, s27
  s_cmp_eq_u32 s3, 0
  s_cselect_b32 s3, 0, 0xff800000
  v_mov_b32 v2, s3
  v_mov_b32 v29, 0
  v_cmp_gt_i32 s[4:5], 0, v17
  v_cmp_gt_i32 s[6:7], 1, v17
  v_cmp_gt_i32 s[20:21], 2, v17
  v_cmp_gt_i32 s[22:23], 3, v17
  v_mov_b32 v100, v2
  v_mov_b32 v104, 0
  v_cndmask_b32 v96, 0, v2, s[4:5]
  v_cndmask_b32 v108, 0, v2, s[4:5]
  v_mov_b32 v101, v2
  v_mov_b32 v105, 0
  v_cndmask_b32 v97, 0, v2, s[6:7]
  v_cndmask_b32 v109, 0, v2, s[6:7]
  v_mov_b32 v102, v2
  v_mov_b32 v106, 0
  v_cndmask_b32 v98, 0, v2, s[20:21]
  v_cndmask_b32 v110, 0, v2, s[20:21]
  v_mov_b32 v103, v2
  v_mov_b32 v107, 0
  v_cndmask_b32 v99, 0, v2, s[22:23]
  v_cndmask_b32 v111, 0, v2, s[22:23]
  v_lshrrev_b32 v2, 2, v1
  v_lshlrev_b32 v3, 7, v2
  v_and_b32 v18, 3, v1
  v_lshl_add_u32 v3, v18, 3, v3
  v_bfe_u32 v2, v2, 1, 2
  v_xor_b32 v18, 0, v2
  v_lshl_add_u32 v56, v18, 5, v3
  v_xor_b32 v18, 1, v2
  v_lshl_add_u32 v57, v18, 5, v3
  v_xor_b32 v18, 2, v2
  v_lshl_add_u32 v58, v18, 5, v3
  v_xor_b32 v18, 3, v2
  v_lshl_add_u32 v59, v18, 5, v3
  s_add_u32 s20, s52, 0x6000000
  s_addc_u32 s21, s53, 0
  s_and_b32 s21, s21, 0xffff
  s_mov_b32 s22, 0x8000
  s_mov_b32 s23, 0x20000
  v_mov_b32 v27, s43
  v_mov_b64 v[128:129], 0
  v_mov_b64 v[130:131], 0
  v_mov_b64 v[132:133], 0
  v_mov_b64 v[134:135], 0
  v_mov_b64 v[136:137], 0
  v_mov_b64 v[138:139], 0
  v_mov_b64 v[140:141], 0
  v_mov_b64 v[142:143], 0
  v_mov_b64 v[144:145], 0
  v_mov_b64 v[146:147], 0
  v_mov_b64 v[148:149], 0
  v_mov_b64 v[150:151], 0
  v_mov_b64 v[152:153], 0
  v_mov_b64 v[154:155], 0
  v_mov_b64 v[156:157], 0
  v_mov_b64 v[158:159], 0
  v_mov_b64 v[160:161], 0
  v_mov_b64 v[162:163], 0
  v_mov_b64 v[164:165], 0
  v_mov_b64 v[166:167], 0
  v_mov_b64 v[168:169], 0
  v_mov_b64 v[170:171], 0
  v_mov_b64 v[172:173], 0
  v_mov_b64 v[174:175], 0
  v_mov_b64 v[176:177], 0
  v_mov_b64 v[178:179], 0
  v_mov_b64 v[180:181], 0
  v_mov_b64 v[182:183], 0
  v_mov_b64 v[184:185], 0
  v_mov_b64 v[186:187], 0
  v_mov_b64 v[188:189], 0
  v_mov_b64 v[190:191], 0
  v_mov_b64 v[192:193], 0
  v_mov_b64 v[194:195], 0
  v_mov_b64 v[196:197], 0
  v_mov_b64 v[198:199], 0
  v_mov_b64 v[200:201], 0
  v_mov_b64 v[202:203], 0
  v_mov_b64 v[204:205], 0
  v_mov_b64 v[206:207], 0
  v_mov_b64 v[208:209], 0
  v_mov_b64 v[210:211], 0
  v_mov_b64 v[212:213], 0
  v_mov_b64 v[214:215], 0
  v_mov_b64 v[216:217], 0
  v_mov_b64 v[218:219], 0
  v_mov_b64 v[220:221], 0
  v_mov_b64 v[222:223], 0
  v_mov_b64 v[224:225], 0
  v_mov_b64 v[226:227], 0
  v_mov_b64 v[228:229], 0
  v_mov_b64 v[230:231], 0
  v_mov_b64 v[232:233], 0
  v_mov_b64 v[234:235], 0
  v_mov_b64 v[236:237], 0
  v_mov_b64 v[238:239], 0
  v_mov_b64 v[240:241], 0
  v_mov_b64 v[242:243], 0
  v_mov_b64 v[244:245], 0
  v_mov_b64 v[246:247], 0
  v_mov_b64 v[248:249], 0
  v_mov_b64 v[250:251], 0
  v_mov_b64 v[252:253], 0
  v_mov_b64 v[254:255], 0
  s_barrier
  s_mov_b32 s101, -1
  s_branch K2_pt_end
K2_nocol:
  v_mov_b64 v[128:129], 0
  v_mov_b64 v[130:131], 0
  v_mov_b64 v[132:133], 0
  v_mov_b64 v[134:135], 0
  v_mov_b64 v[136:137], 0
  v_mov_b64 v[138:139], 0
  v_mov_b64 v[140:141], 0
  v_mov_b64 v[142:143], 0
  v_mov_b64 v[144:145], 0
  v_mov_b64 v[146:147], 0
  v_mov_b64 v[148:149], 0
  v_mov_b64 v[150:151], 0
  v_mov_b64 v[152:153], 0
  v_mov_b64 v[154:155], 0
  v_mov_b64 v[156:157], 0
  v_mov_b64 v[158:159], 0
  v_mov_b64 v[160:161], 0
  v_mov_b64 v[162:163], 0
  v_mov_b64 v[164:165], 0
  v_mov_b64 v[166:167], 0
  v_mov_b64 v[168:169], 0
  v_mov_b64 v[170:171], 0
  v_mov_b64 v[172:173], 0
  v_mov_b64 v[174:175], 0
  v_mov_b64 v[176:177], 0
  v_mov_b64 v[178:179], 0
  v_mov_b64 v[180:181], 0
  v_mov_b64 v[182:183], 0
  v_mov_b64 v[184:185], 0
  v_mov_b64 v[186:187], 0
  v_mov_b64 v[188:189], 0
  v_mov_b64 v[190:191], 0
  v_mov_b64 v[192:193], 0
  v_mov_b64 v[194:195], 0
  v_mov_b64 v[196:197], 0
  v_mov_b64 v[198:199], 0
  v_mov_b64 v[200:201], 0
  v_mov_b64 v[202:203], 0
  v_mov_b64 v[204:205], 0
  v_mov_b64 v[206:207], 0
  v_mov_b64 v[208:209], 0
  v_mov_b64 v[210:211], 0
  v_mov_b64 v[212:213], 0
  v_mov_b64 v[214:215], 0
  v_mov_b64 v[216:217], 0
  v_mov_b64 v[218:219], 0
  v_mov_b64 v[220:221], 0
  v_mov_b64 v[222:223], 0
  v_mov_b64 v[224:225], 0
  v_mov_b64 v[226:227], 0
  v_mov_b64 v[228:229], 0
  v_mov_b64 v[230:231], 0
  v_mov_b64 v[232:233], 0
  v_mov_b64 v[234:235], 0
  v_mov_b64 v[236:237], 0
  v_mov_b64 v[238:239], 0
  v_mov_b64 v[240:241], 0
  v_mov_b64 v[242:243], 0
  v_mov_b64 v[244:245], 0
  v_mov_b64 v[246:247], 0
  v_mov_b64 v[248:249], 0
  v_mov_b64 v[250:251], 0
  v_mov_b64 v[252:253], 0
  v_mov_b64 v[254:255], 0
  s_mov_b32 s101, 0
K2_pt_end:
  s_mov_b32 s25, s45
  s_lshl_b32 s3, s46, 2
  s_add_u32 s3, s3, s24
  s_add_u32 s26, s3, 1
  s_branch K2_seg
K2_a1_wait:
  s_sleep 4
  buffer_load_dword v25, v26, s[4:7], 0 offen sc1
  s_waitcnt vmcnt(0)
  v_cmp_ne_u32 vcc, 1, v25
  s_nop 4
  s_cbranch_vccz K2_a1_ok
  s_branch K2_a1_wait
K1_zwait:
  v_lshrrev_b32 v1, 2, v9
  s_sleep 4
  buffer_load_dword v127, v1, s[92:95], 0 offen sc1
  s_waitcnt vmcnt(0)
  s_branch K1_zp
K1_K_swx:
  s_cmp_eq_u32 s31, 7
  s_cbranch_scc1 K1_K_last
  s_cmp_eq_u32 s31, 6
  s_cbranch_scc1 K1_K_swx6
  global_load_dword v23, v[160:161], off offset:384
  v_and_b32 v1, 15, v0
  s_lshl_b32 s3, s24, 4
  v_add_u32 v1, s3, v1
  v_min_u32 v1, 58, v1
  v_mov_b32 v163, 0
  s_mul_i32 s3, s55, 57344
  s_add_u32 s4, s36, s3
  s_addc_u32 s5, s37, 0
  v_subrev_u32 v2, 0, v1
  v_mul_u32_u24 v2, 12, v2
  v_min_u32 v2, 436, v2
  v_mul_u32_u24 v2, 128, v2
  v_mov_b32 v25, s5
  v_add_co_u32 v24, vcc, s4, v2
  v_mov_b32 v26, 512
  s_nop 0
  v_addc_co_u32 v25, vcc, 0, v25, vcc
  v_cmp_le_u32 vcc, 0, v1
  s_nop 1
  v_cndmask_b32 v160, v160, v24, vcc
  v_cndmask_b32 v161, v161, v25, vcc
  v_cndmask_b32 v162, v162, v26, vcc
  s_and_b32 s3, s55, 15
  s_mul_i32 s3, s3, 229376
  s_add_u32 s3, s3, s51
  s_add_u32 s4, s40, s3
  s_addc_u32 s5, s41, 0
  v_subrev_u32 v2, 38, v1
  v_mul_u32_u24 v2, 3, v2
  v_min_u32 v2, 25, v2
  v_mul_u32_u24 v2, 8192, v2
  v_mov_b32 v25, s5
  v_add_co_u32 v24, vcc, s4, v2
  v_mov_b32 v26, 8192
  s_nop 0
  v_addc_co_u32 v25, vcc, 0, v25, vcc
  v_cmp_le_u32 vcc, 38, v1
  s_nop 1
  v_cndmask_b32 v160, v160, v24, vcc
  v_cndmask_b32 v161, v161, v25, vcc
  v_cndmask_b32 v162, v162, v26, vcc
  s_and_b32 s3, s2, 7
  s_lshl_b32 s3, s3, 5
  s_add_u32 s3, s3, s55
  s_mul_i32 s3, s3, 7168
  s_add_u32 s4, s96, s3
  s_addc_u32 s5, s97, 0
  v_subrev_u32 v2, 48, v1
  v_mul_u32_u24 v2, 12, v2
  v_min_u32 v2, 44, v2
  v_mul_u32_u24 v2, 128, v2
  v_mov_b32 v25, s5
  v_add_co_u32 v24, vcc, s4, v2
  v_mov_b32 v26, 512
  s_nop 0
  v_addc_co_u32 v25, vcc, 0, v25, vcc
  v_cmp_le_u32 vcc, 48, v1
  s_nop 1
  v_cndmask_b32 v160, v160, v24, vcc
  v_cndmask_b32 v161, v161, v25, vcc
  v_cndmask_b32 v162, v162, v26, vcc
  s_and_b32 s3, s2, 7
  s_lshl_b32 s4, s55, 3
  s_add_u32 s3, s3, s4
  s_mul_i32 s3, s3, 3600
  s_add_u32 s4, s98, s3
  s_addc_u32 s5, s99, 0
  v_subrev_u32 v2, 53, v1
  v_mul_u32_u24 v2, 9, v2
  v_min_u32 v2, 17, v2
  v_mul_u32_u24 v2, 128, v2
  v_mov_b32 v25, s5
  v_add_co_u32 v24, vcc, s4, v2
  v_mov_b32 v26, 512
  s_nop 0
  v_addc_co_u32 v25, vcc, 0, v25, vcc
  v_cmp_le_u32 vcc, 53, v1
  s_nop 1
  v_cndmask_b32 v160, v160, v24, vcc
  v_cndmask_b32 v161, v161, v25, vcc
  v_cndmask_b32 v162, v162, v26, vcc
  s_and_b32 s3, s2, 7
  s_lshl_b32 s4, s55, 3
  s_add_u32 s3, s3, s4
  s_mul_i32 s3, s3, 3600
  s_add_u32 s4, s100, s3
  s_addc_u32 s5, s101, 0
  v_subrev_u32 v2, 56, v1
  v_mul_u32_u24 v2, 9, v2
  v_min_u32 v2, 17, v2
  v_mul_u32_u24 v2, 128, v2
  v_mov_b32 v25, s5
  v_add_co_u32 v24, vcc, s4, v2
  v_mov_b32 v26, 512
  s_nop 0
  v_addc_co_u32 v25, vcc, 0, v25, vcc
  v_cmp_le_u32 vcc, 56, v1
  s_nop 1
  v_cndmask_b32 v160, v160, v24, vcc
  v_cndmask_b32 v161, v161, v25, vcc
  v_cndmask_b32 v162, v162, v26, vcc
  s_mov_b32 s50, 6
  v_mov_b32 v164, v162
  v_mov_b32 v162, 0
  s_branch K1_K_swx_back
K1_K_swx6:
  v_mov_b32 v164, 0
  v_mov_b32 v162, 0
  s_mov_b32 s8, s36
  s_and_b32 s9, s37, 0xffff
  s_mov_b32 s10, 0x1c0000
  s_mov_b32 s11, 0x20000
  v_and_b32 v1, 63, v0
  v_lshrrev_b32 v2, 3, v1
  s_lshl_b32 s3, s24, 5
  v_add_u32 v2, s3, v2
  v_mul_u32_u24 v2, 896, v2
  v_lshrrev_b32 v3, 4, v1
  v_and_b32 v1, 7, v1
  v_xor_b32 v1, v1, v3
  v_lshlrev_b32 v1, 4, v1
  v_add_u32 v4, v2, v1
  v_xor_b32 v3, 64, v1
  v_add_u32 v5, v2, v3
  v_add_u32 v5, 6144, v5
  v_add_u32 v6, v2, v1
  v_add_u32 v6, 12288, v6
  v_xor_b32 v3, 64, v1
  v_add_u32 v7, v2, v3
  v_add_u32 v7, 18432, v7
  s_bfe_u32 s3, s55, 0x30001
  s_sub_u32 s4, 15, s3
  s_bitcmp1_b32 s55, 0
  s_cselect_b32 s3, s4, s3
  s_mul_i32 s28, s3, 114688
  s_mov_b32 s6, s28
  s_mov_b32 s26, 0
  s_lshl_b32 s33, s24, 12
  s_add_u32 s34, s33, 16384
  s_mov_b32 s32, 0x40000000
  s_mov_b32 s38, 1024
  s_mov_b32 s39, 8192
  s_mov_b32 s44, 8192
  s_lshr_b32 s37, s59, 1
  s_mul_i32 s3, s54, 1048576
  s_add_u32 s37, s37, s3
  s_mul_i32 s3, s57, 131072
  s_add_u32 s37, s37, s3
  s_lshr_b32 s3, s24, 1
  s_mul_i32 s3, s3, 65536
  s_add_u32 s37, s37, s3
  s_mov_b32 s36, s37
  s_sub_u32 s45, s33, s59
  s_mov_b32 s50, 7
  s_getpc_b64 s[20:21]
L_pc_9:
  s_add_u32 s20, s20, K1_Q-L_pc_9
  s_addc_u32 s21, s21, (K1_Q-L_pc_9)>>32
  s_and_b32 s21, s21, 0xffff
  s_mov_b32 s22, K2_segend-K1_Q
  s_mov_b32 s23, 0x20000
  v_and_b32 v1, 15, v0
  v_lshlrev_b32 v1, 5, v1
  v_add_u32 v1, s55, v1
  v_lshlrev_b32 v1, 7, v1
  buffer_load_dword v23, v1, s[20:23], 0 offen
  s_branch K1_K_swx_back
K1_V_swx:
  s_cmp_eq_u32 s31, 7
  s_cbranch_scc1 K1_V_last
  s_cmp_eq_u32 s31, 6
  s_cbranch_scc1 K1_V_swx6
  global_load_dword v23, v[160:161], off offset:384
  v_and_b32 v1, 15, v0
  s_lshl_b32 s3, s24, 4
  v_add_u32 v1, s3, v1
  v_min_u32 v1, 58, v1
  v_mov_b32 v163, 0
  s_mul_i32 s3, s55, 57344
  s_add_u32 s4, s36, s3
  s_addc_u32 s5, s37, 0
  v_subrev_u32 v2, 0, v1
  v_mul_u32_u24 v2, 12, v2
  v_min_u32 v2, 436, v2
  v_mul_u32_u24 v2, 128, v2
  v_mov_b32 v25, s5
  v_add_co_u32 v24, vcc, s4, v2
  v_mov_b32 v26, 512
  s_nop 0
  v_addc_co_u32 v25, vcc, 0, v25, vcc
  v_cmp_le_u32 vcc, 0, v1
  s_nop 1
  v_cndmask_b32 v160, v160, v24, vcc
  v_cndmask_b32 v161, v161, v25, vcc
  v_cndmask_b32 v162, v162, v26, vcc
  s_and_b32 s3, s55, 15
  s_mul_i32 s3, s3, 229376
  s_add_u32 s3, s3, s51
  s_add_u32 s4, s40, s3
  s_addc_u32 s5, s41, 0
  v_subrev_u32 v2, 38, v1
  v_mul_u32_u24 v2, 3, v2
  v_min_u32 v2, 25, v2
  v_mul_u32_u24 v2, 8192, v2
  v_mov_b32 v25, s5
  v_add_co_u32 v24, vcc, s4, v2
  v_mov_b32 v26, 8192
  s_nop 0
  v_addc_co_u32 v25, vcc, 0, v25, vcc
  v_cmp_le_u32 vcc, 38, v1
  s_nop 1
  v_cndmask_b32 v160, v160, v24, vcc
  v_cndmask_b32 v161, v161, v25, vcc
  v_cndmask_b32 v162, v162, v26, vcc
  s_and_b32 s3, s2, 7
  s_lshl_b32 s3, s3, 5
  s_add_u32 s3, s3, s55
  s_mul_i32 s3, s3, 7168
  s_add_u32 s4, s96, s3
  s_addc_u32 s5, s97, 0
  v_subrev_u32 v2, 48, v1
  v_mul_u32_u24 v2, 12, v2
  v_min_u32 v2, 44, v2
  v_mul_u32_u24 v2, 128, v2
  v_mov_b32 v25, s5
  v_add_co_u32 v24, vcc, s4, v2
  v_mov_b32 v26, 512
  s_nop 0
  v_addc_co_u32 v25, vcc, 0, v25, vcc
  v_cmp_le_u32 vcc, 48, v1
  s_nop 1
  v_cndmask_b32 v160, v160, v24, vcc
  v_cndmask_b32 v161, v161, v25, vcc
  v_cndmask_b32 v162, v162, v26, vcc
  s_and_b32 s3, s2, 7
  s_lshl_b32 s4, s55, 3
  s_add_u32 s3, s3, s4
  s_mul_i32 s3, s3, 3600
  s_add_u32 s4, s98, s3
  s_addc_u32 s5, s99, 0
  v_subrev_u32 v2, 53, v1
  v_mul_u32_u24 v2, 9, v2
  v_min_u32 v2, 17, v2
  v_mul_u32_u24 v2, 128, v2
  v_mov_b32 v25, s5
  v_add_co_u32 v24, vcc, s4, v2
  v_mov_b32 v26, 512
  s_nop 0
  v_addc_co_u32 v25, vcc, 0, v25, vcc
  v_cmp_le_u32 vcc, 53, v1
  s_nop 1
  v_cndmask_b32 v160, v160, v24, vcc
  v_cndmask_b32 v161, v161, v25, vcc
  v_cndmask_b32 v162, v162, v26, vcc
  s_and_b32 s3, s2, 7
  s_lshl_b32 s4, s55, 3
  s_add_u32 s3, s3, s4
  s_mul_i32 s3, s3, 3600
  s_add_u32 s4, s100, s3
  s_addc_u32 s5, s101, 0
  v_subrev_u32 v2, 56, v1
  v_mul_u32_u24 v2, 9, v2
  v_min_u32 v2, 17, v2
  v_mul_u32_u24 v2, 128, v2
  v_mov_b32 v25, s5
  v_add_co_u32 v24, vcc, s4, v2
  v_mov_b32 v26, 512
  s_nop 0
  v_addc_co_u32 v25, vcc, 0, v25, vcc
  v_cmp_le_u32 vcc, 56, v1
  s_nop 1
  v_cndmask_b32 v160, v160, v24, vcc
  v_cndmask_b32 v161, v161, v25, vcc
  v_cndmask_b32 v162, v162, v26, vcc
  s_mov_b32 s50, 6
  v_mov_b32 v164, v162
  v_mov_b32 v162, 0
  s_branch K1_V_swx_back
K1_V_swx6:
  v_mov_b32 v164, 0
  v_mov_b32 v162, 0
  s_mov_b32 s8, s36
  s_and_b32 s9, s37, 0xffff
  s_mov_b32 s10, 0x1c0000
  s_mov_b32 s11, 0x20000
  v_and_b32 v1, 63, v0
  v_lshrrev_b32 v2, 3, v1
  s_lshl_b32 s3, s24, 5
  v_add_u32 v2, s3, v2
  v_mul_u32_u24 v2, 896, v2
  v_lshrrev_b32 v3, 4, v1
  v_and_b32 v1, 7, v1
  v_xor_b32 v1, v1, v3
  v_lshlrev_b32 v1, 4, v1
  v_add_u32 v4, v2, v1
  v_xor_b32 v3, 64, v1
  v_add_u32 v5, v2, v3
  v_add_u32 v5, 6144, v5
  v_add_u32 v6, v2, v1
  v_add_u32 v6, 12288, v6
  v_xor_b32 v3, 64, v1
  v_add_u32 v7, v2, v3
  v_add_u32 v7, 18432, v7
  s_bfe_u32 s3, s55, 0x30001
  s_sub_u32 s4, 15, s3
  s_bitcmp1_b32 s55, 0
  s_cselect_b32 s3, s4, s3
  s_mul_i32 s28, s3, 114688
  s_mov_b32 s6, s28
  s_mov_b32 s26, 0
  s_lshl_b32 s33, s24, 12
  s_add_u32 s34, s33, 16384
  s_mov_b32 s32, 0x40000000
  s_mov_b32 s38, 16384
  s_mov_b32 s39, 1024
  s_mov_b32 s44, 1024
  s_add_u32 s37, s59, 0x1000000
  s_mul_i32 s3, s54, 1048576
  s_add_u32 s37, s37, s3
  s_mul_i32 s3, s57, 131072
  s_add_u32 s37, s37, s3
  s_lshr_b32 s3, s24, 1
  s_mul_i32 s3, s3, 65536
  s_add_u32 s37, s37, s3
  s_mov_b32 s36, s37
  s_sub_u32 s45, s33, s59
  s_mov_b32 s50, 7
  s_getpc_b64 s[20:21]
L_pc_10:
  s_add_u32 s20, s20, K1_Q-L_pc_10
  s_addc_u32 s21, s21, (K1_Q-L_pc_10)>>32
  s_and_b32 s21, s21, 0xffff
  s_mov_b32 s22, K2_segend-K1_Q
  s_mov_b32 s23, 0x20000
  v_and_b32 v1, 15, v0
  v_lshlrev_b32 v1, 5, v1
  v_add_u32 v1, s55, v1
  v_lshlrev_b32 v1, 7, v1
  buffer_load_dword v23, v1, s[20:23], 0 offen
  s_branch K1_V_swx_back
K2_CODE_END:
.section .rodata,"a"
.p2align 6
.amdhsa_kernel concat_heads__spectral_gfnet__compressed_kv_cla__prompt_kernel
  .amdhsa_next_free_vgpr 512
  .amdhsa_next_free_sgpr 102
  .amdhsa_accum_offset 256
  .amdhsa_group_segment_fixed_size 0
  .amdhsa_kernarg_size 96
  .amdhsa_user_sgpr_count 2
  .amdhsa_user_sgpr_kernarg_segment_ptr 1
  .amdhsa_system_sgpr_workgroup_id_x 1
  .amdhsa_float_denorm_mode_32 3
.end_amdhsa_kernel
```
